```python
import torch

def _softmax(x, axis=-1):
    return torch.softmax(x, dim=axis)
def _gelu(x):
    return torch.nn.functional.gelu(x, approximate="tanh")
def _silu(x):
    return torch.nn.functional.silu(x)
def _sigmoid(x):
    return torch.sigmoid(x)
def _layernorm(x, axis=-1, eps=1e-5):
    m = x.mean(dim=axis, keepdim=True)
    v = x.var(dim=axis, keepdim=True, unbiased=False)
    return (x - m) / torch.sqrt(v + eps)
def _scatter_add(tgt, idx, src, axis=0):
    return tgt.clone().index_add_(axis, idx, src)
def _segment_sum(src, seg, n):
    out = torch.zeros((n,) + src.shape[1:], dtype=src.dtype)
    return out.index_add_(0, seg, src)
def _pad(x, pw):
    flat = tuple(v for pair in reversed(pw) for v in pair)
    return torch.nn.functional.pad(x, flat)

kernel_name = 'sequential_preLN__compressed_kv_cla__dense_activation_gelu__prompt'

def setup_inputs():

    _w = (lambda a: (lambda t: t.to(torch.bfloat16) if t.is_floating_point() else t)(torch.as_tensor(a)))
    def _A_setup():
        B, H, Sq, Sk, D, M = 1, 32, 2048, 2048, 128, 640
        Dc = 4 * D
        return {
            "x": _w((lambda *s: torch.randn(*s, dtype=torch.bfloat16) * 0.05)(B, Sq, M)),
            "c_kv": _w((lambda *s: torch.randn(*s, dtype=torch.bfloat16) * 0.4)(B, Sk, Dc)),
            "w_q": _w((lambda *s: torch.randn(*s, dtype=torch.bfloat16) * 1.6)(M, H, D) * (M ** -0.5)),
            "w_uk": _w((lambda *s: torch.randn(*s, dtype=torch.bfloat16) * 1.6)(Dc, H, D) * (Dc ** -0.5)),
            "w_uv": _w((lambda *s: torch.randn(*s, dtype=torch.bfloat16) * 0.4)(Dc, H, D) * (Dc ** -0.5)),
            "w_o": _w((lambda *s: torch.randn(*s, dtype=torch.bfloat16) * 0.4)(H, D, M) * ((H * D) ** -0.5)),
        }
    _A_in = _A_setup()

    def _B_setup():
        B, S, D, F = 1, 2048, 640, 1728
        return {
            "x": _w((lambda *s: torch.randn(*s, dtype=torch.bfloat16) * 0.05)(B, S, D)),
            "w1": _w((lambda *s: torch.randn(*s, dtype=torch.bfloat16) * 0.8)(D, F) * (D ** -0.5)),
            "b1": _w((lambda *s: torch.randn(*s, dtype=torch.bfloat16) * 12.8)(F) * 0.01),
            "w2": _w((lambda *s: torch.randn(*s, dtype=torch.bfloat16) * 0.2)(F, D) * (F ** -0.5)),
            "b2": _w((lambda *s: torch.randn(*s, dtype=torch.bfloat16) * 3.2)(D) * 0.01),
        }
    _B_in = _B_setup()

    return {
        "A_x": _A_in["x"],
        "A_c_kv": _A_in["c_kv"],
        "A_w_q": _A_in["w_q"],
        "A_w_uk": _A_in["w_uk"],
        "A_w_uv": _A_in["w_uv"],
        "A_w_o": _A_in["w_o"],
        "B_x": _B_in["x"],
        "B_w1": _B_in["w1"],
        "B_b1": _B_in["b1"],
        "B_w2": _B_in["w2"],
        "B_b2": _B_in["b2"],
    }

def reference(A_x, A_c_kv, A_w_q, A_w_uk, A_w_uv, A_w_o, B_x, B_w1, B_b1, B_w2, B_b2):
    def _A_ref(x, c_kv, w_q, w_uk, w_uv, w_o):
        B, Sq, M = x.shape[0], x.shape[1], x.shape[2]
        Sk = c_kv.shape[1]
        H, D = w_q.shape[1], w_q.shape[2]
        q = torch.einsum("bqm,mhd->bhqd", x, w_q)
        k = torch.einsum("bkc,chd->bhkd", c_kv, w_uk)
        v = torch.einsum("bkc,chd->bhkd", c_kv, w_uv)
        scores = torch.einsum("bhqd,bhkd->bhqk", q, k) * (D ** -0.5)
        off = Sk - Sq
        qi = torch.arange(Sq)[:, None]
        kj = torch.arange(Sk)[None, :]
        cmask = kj <= (qi + off)
        scores = torch.where(cmask[None, None], scores, -1e9)
        p = _softmax(scores, axis=-1)
        ctx = torch.einsum("bhqk,bhkd->bhqd", p, v)
        return torch.einsum("bhqd,hdm->bqm", ctx, w_o)

    def _B_ref(x, w1, b1, w2, b2):
        h = torch.einsum("bsd,df->bsf", x, w1) + b1
        h = _gelu(h)
        return torch.einsum("bsf,fd->bsd", h, w2) + b2

    x = A_x
    h = x + _A_ref(_layernorm(x, axis=-1), A_c_kv, A_w_q, A_w_uk, A_w_uv, A_w_o)
    h2 = h + _B_ref(_layernorm(h, axis=-1), B_w1, B_b1, B_w2, B_b2)
    return h2
```

```asm
; @launch kernel=k1_kernel grid=(256,1,1) block=(512,1,1) lds=163840
; @launch kernel=k2_kernel grid=(256,1,1) block=(512,1,1) lds=163840
; @launch kernel=k3_kernel grid=(256,1,1) block=(256,1,1) lds=90112
; @launch kernel=k5_kernel grid=(224,1,1) block=(256,1,1) lds=81920
; @launch kernel=k6_kernel grid=(256,1,1) block=(256,1,1) lds=90112
.amdgcn_target "amdgcn-amd-amdhsa--gfx950"
.text
.globl k1_kernel
.p2align 8
.type k1_kernel,@function
k1_kernel:
    s_cmp_ge_u32 s2, 256
    s_cbranch_scc1 K1_END
    s_load_dwordx2 s[4:5], s[0:1], 8
    s_load_dwordx4 s[8:11], s[0:1], 24
    s_load_dwordx2 s[6:7], s[0:1], 0
    s_load_dwordx2 s[12:13], s[0:1], 104
    v_lshrrev_b32 v1, 6, v0
    v_and_b32 v0, 63, v0
    v_readfirstlane_b32 s3, v1
    s_and_b32 s36, s2, 7
    s_lshr_b32 s37, s2, 3
    s_and_b32 s37, s37, 3
    s_lshl_b32 s37, s37, 3
    s_add_u32 s36, s36, s37
    s_lshr_b32 s37, s2, 5
    s_lshr_b32 s38, s36, 4
    s_and_b32 s43, s36, 15
    s_lshr_b32 s39, s3, 2
    s_and_b32 s40, s3, 3
    s_waitcnt lgkmcnt(0)
    s_mov_b32 s16, s4
    s_mov_b32 s17, s5
    s_mov_b32 s18, 2097152
    s_mov_b32 s19, 0x00020000
    s_cmp_eq_u32 s38, 0
    s_cselect_b32 s20, s8, s10
    s_cselect_b32 s21, s9, s11
    s_mov_b32 s22, 4194304
    s_mov_b32 s23, 0x00020000
    s_mov_b32 s44, 4194304
    s_mov_b32 s45, 20971520
    s_cselect_b32 s44, s44, s45
    s_add_u32 s24, s12, s44
    s_addc_u32 s25, s13, 0
    s_mov_b32 s26, 0x1000000
    s_mov_b32 s27, 0x00020000
    s_mov_b32 s28, s6
    s_mov_b32 s29, s7
    s_mov_b32 s30, 2621440
    s_mov_b32 s31, 0x00020000
    s_mov_b32 s32, s12
    s_mov_b32 s33, s13
    s_mov_b32 s34, 2621440
    s_mov_b32 s35, 0x00020000
    v_lshrrev_b32 v2, 3, v0
    s_lshl_b32 s45, s37, 8
    s_lshl_b32 s46, s3, 5
    s_add_u32 s45, s45, s46
    v_add_u32 v2, s45, v2
    v_lshlrev_b32 v2, 10, v2
    v_lshrrev_b32 v4, 4, v0
    v_and_b32 v3, 7, v0
    v_xor_b32 v12, v3, v4
    v_lshl_add_u32 v5, v12, 4, v2
    v_xor_b32 v12, 4, v12
    v_lshl_add_u32 v8, v12, 4, v2
    v_lshrrev_b32 v2, 5, v0
    s_lshr_b32 s45, s3, 1
    s_and_b32 s45, s45, 1
    s_lshl_b32 s45, s45, 2
    s_lshl_b32 s46, s43, 9
    s_lshl_b32 s47, s3, 2
    v_add_u32 v3, 0, v2
    v_or_b32 v4, s45, v3
    v_lshlrev_b32 v4, 1, v4
    v_and_b32 v12, 31, v0
    v_xor_b32 v4, v4, v12
    v_add_u32 v3, s47, v3
    v_lshlrev_b32 v3, 13, v3
    v_lshl_add_u32 v3, v4, 4, v3
    v_add_u32 v6, s46, v3
    v_add_u32 v3, 2, v2
    v_or_b32 v4, s45, v3
    v_lshlrev_b32 v4, 1, v4
    v_and_b32 v12, 31, v0
    v_xor_b32 v4, v4, v12
    v_add_u32 v3, s47, v3
    v_lshlrev_b32 v3, 13, v3
    v_lshl_add_u32 v3, v4, 4, v3
    v_add_u32 v7, s46, v3
    s_lshl_b32 s41, s3, 12
    s_lshl_b32 s42, s3, 11
    v_lshrrev_b32 v2, 4, v0
    v_and_b32 v3, 15, v0
    s_lshl_b32 s45, s2, 3
    s_lshl_b32 s46, s3, 2
    s_add_u32 s45, s45, s46
    v_add_u32 v37, s45, v2
    s_movk_i32 s46, 1280
    v_mul_lo_u32 v38, v37, s46
    v_lshlrev_b32 v4, 4, v3
    v_add_u32 v38, v38, v4
    v_and_b32 v12, 15, v0
    v_lshrrev_b32 v13, 4, v0
    v_lshrrev_b32 v14, 2, v12
    v_and_b32 v15, 3, v12
    v_and_b32 v16, 1, v14
    v_lshlrev_b32 v16, 1, v16
    v_lshrrev_b32 v17, 1, v14
    v_or_b32 v16, v16, v17
    v_lshl_add_u32 v17, v16, 2, v15
    v_lshl_add_u32 v18, v14, 3, v15
    s_lshl_b32 s45, s39, 14
    s_lshl_b32 s46, s40, 7
    s_cmp_eq_u32 s38, 0
    s_cbranch_scc0 K1_ADDRV
    v_add_u32 v19, 0, v17
    v_lshrrev_b32 v20, 1, v19
    v_and_b32 v20, 7, v20
    v_xor_b32 v20, v20, v13
    v_lshlrev_b32 v19, 7, v19
    v_lshl_add_u32 v19, v20, 4, v19
    v_add_u32 v9, s45, v19
    v_mov_b32 v10, v9
    v_lshlrev_b32 v21, 4, v15
    v_add_u32 v21, 0, v21
    v_add_u32 v21, s46, v21
    v_and_b32 v19, 1, v13
    v_lshl_add_u32 v19, v19, 2, v14
    v_lshlrev_b32 v19, 5, v19
    v_xor_b32 v19, v19, v21
    v_lshl_add_u32 v20, v13, 3, v14
    v_lshl_add_u32 v19, v20, 9, v19
    v_add_u32 v25, 98304, v19
    v_lshlrev_b32 v21, 4, v15
    v_add_u32 v21, 8, v21
    v_add_u32 v21, s46, v21
    v_and_b32 v19, 1, v13
    v_lshl_add_u32 v19, v19, 2, v14
    v_lshlrev_b32 v19, 5, v19
    v_xor_b32 v19, v19, v21
    v_lshl_add_u32 v20, v13, 3, v14
    v_lshl_add_u32 v19, v20, 9, v19
    v_add_u32 v26, 98304, v19
    s_branch K1_ADDRD
K1_ADDRV:
    v_add_u32 v19, 0, v18
    v_lshrrev_b32 v20, 1, v19
    v_and_b32 v20, 7, v20
    v_xor_b32 v20, v20, v13
    v_lshlrev_b32 v19, 7, v19
    v_lshl_add_u32 v19, v20, 4, v19
    v_add_u32 v9, s45, v19
    v_add_u32 v19, 4, v18
    v_lshrrev_b32 v20, 1, v19
    v_and_b32 v20, 7, v20
    v_xor_b32 v20, v20, v13
    v_lshlrev_b32 v19, 7, v19
    v_lshl_add_u32 v19, v20, 4, v19
    v_add_u32 v10, s45, v19
    v_and_b32 v21, 1, v15
    v_lshlrev_b32 v21, 1, v21
    v_lshrrev_b32 v22, 1, v15
    v_or_b32 v21, v21, v22
    v_lshlrev_b32 v21, 3, v21
    v_add_u32 v21, s46, v21
    v_and_b32 v19, 1, v13
    v_lshl_add_u32 v19, v19, 2, v14
    v_lshlrev_b32 v19, 5, v19
    v_xor_b32 v19, v19, v21
    v_lshl_add_u32 v20, v13, 3, v14
    v_lshl_add_u32 v19, v20, 9, v19
    v_add_u32 v25, 98304, v19
    v_add_u32 v21, 32, v21
    v_and_b32 v19, 1, v13
    v_lshl_add_u32 v19, v19, 2, v14
    v_lshlrev_b32 v19, 5, v19
    v_xor_b32 v19, v19, v21
    v_lshl_add_u32 v20, v13, 3, v14
    v_lshl_add_u32 v19, v20, 9, v19
    v_add_u32 v26, 98304, v19
K1_ADDRD:
    v_xor_b32 v27, 64, v25
    v_xor_b32 v28, 64, v26
    v_xor_b32 v23, 64, v9
    v_xor_b32 v24, 64, v10
    v_add_u32 v29, 65536, v9
    v_add_u32 v30, 65536, v10
    v_add_u32 v31, 65536, v23
    v_add_u32 v32, 65536, v24
    v_lshrrev_b32 v19, 1, v13
    v_lshlrev_b32 v19, 10, v19
    v_and_b32 v20, 1, v13
    v_lshl_add_u32 v19, v20, 9, v19
    v_lshl_add_u32 v11, v12, 4, v19
    s_add_u32 m0, s41, 0
    s_mov_b32 s47, 0
    buffer_load_dwordx4 v5, s[16:19], s47 offen lds
    s_add_u32 m0, s41, 1024
    s_mov_b32 s47, 8192
    buffer_load_dwordx4 v8, s[16:19], s47 offen lds
    s_add_u32 m0, s41, 2048
    s_mov_b32 s47, 16384
    buffer_load_dwordx4 v5, s[16:19], s47 offen lds
    s_add_u32 m0, s41, 3072
    s_mov_b32 s47, 24576
    buffer_load_dwordx4 v8, s[16:19], s47 offen lds
    s_add_u32 m0, s42, 98304
    s_mov_b32 s47, 0
    buffer_load_dwordx4 v6, s[20:23], s47 offen lds
    s_add_u32 m0, s42, 99328
    s_mov_b32 s47, 0
    buffer_load_dwordx4 v7, s[20:23], s47 offen lds
    s_add_u32 m0, s42, 114688
    s_mov_b32 s47, 262144
    buffer_load_dwordx4 v6, s[20:23], s47 offen lds
    s_add_u32 m0, s42, 115712
    s_mov_b32 s47, 262144
    buffer_load_dwordx4 v7, s[20:23], s47 offen lds
    s_add_u32 m0, s41, 32768
    s_mov_b32 s47, 128
    buffer_load_dwordx4 v5, s[16:19], s47 offen lds
    s_add_u32 m0, s41, 33792
    s_mov_b32 s47, 8320
    buffer_load_dwordx4 v8, s[16:19], s47 offen lds
    s_add_u32 m0, s41, 34816
    s_mov_b32 s47, 16512
    buffer_load_dwordx4 v5, s[16:19], s47 offen lds
    s_add_u32 m0, s41, 35840
    s_mov_b32 s47, 24704
    buffer_load_dwordx4 v8, s[16:19], s47 offen lds
    s_add_u32 m0, s42, 131072
    s_mov_b32 s47, 524288
    buffer_load_dwordx4 v6, s[20:23], s47 offen lds
    s_add_u32 m0, s42, 132096
    s_mov_b32 s47, 524288
    buffer_load_dwordx4 v7, s[20:23], s47 offen lds
    s_cmp_ge_u32 s3, 2
    s_cbranch_scc1 K1_NOLN
    buffer_load_dwordx4 v[40:43], v38, s[28:31], 0 offen offset:0
    buffer_load_dwordx4 v[44:47], v38, s[28:31], 0 offen offset:256
    buffer_load_dwordx4 v[48:51], v38, s[28:31], 0 offen offset:512
    buffer_load_dwordx4 v[52:55], v38, s[28:31], 0 offen offset:768
    buffer_load_dwordx4 v[56:59], v38, s[28:31], 0 offen offset:1024
K1_NOLN:
    v_mov_b32 v128, 0
    v_mov_b32 v129, 0
    v_mov_b32 v130, 0
    v_mov_b32 v131, 0
    v_mov_b32 v132, 0
    v_mov_b32 v133, 0
    v_mov_b32 v134, 0
    v_mov_b32 v135, 0
    v_mov_b32 v136, 0
    v_mov_b32 v137, 0
    v_mov_b32 v138, 0
    v_mov_b32 v139, 0
    v_mov_b32 v140, 0
    v_mov_b32 v141, 0
    v_mov_b32 v142, 0
    v_mov_b32 v143, 0
    v_mov_b32 v144, 0
    v_mov_b32 v145, 0
    v_mov_b32 v146, 0
    v_mov_b32 v147, 0
    v_mov_b32 v148, 0
    v_mov_b32 v149, 0
    v_mov_b32 v150, 0
    v_mov_b32 v151, 0
    v_mov_b32 v152, 0
    v_mov_b32 v153, 0
    v_mov_b32 v154, 0
    v_mov_b32 v155, 0
    v_mov_b32 v156, 0
    v_mov_b32 v157, 0
    v_mov_b32 v158, 0
    v_mov_b32 v159, 0
    v_mov_b32 v160, 0
    v_mov_b32 v161, 0
    v_mov_b32 v162, 0
    v_mov_b32 v163, 0
    v_mov_b32 v164, 0
    v_mov_b32 v165, 0
    v_mov_b32 v166, 0
    v_mov_b32 v167, 0
    v_mov_b32 v168, 0
    v_mov_b32 v169, 0
    v_mov_b32 v170, 0
    v_mov_b32 v171, 0
    v_mov_b32 v172, 0
    v_mov_b32 v173, 0
    v_mov_b32 v174, 0
    v_mov_b32 v175, 0
    v_mov_b32 v176, 0
    v_mov_b32 v177, 0
    v_mov_b32 v178, 0
    v_mov_b32 v179, 0
    v_mov_b32 v180, 0
    v_mov_b32 v181, 0
    v_mov_b32 v182, 0
    v_mov_b32 v183, 0
    v_mov_b32 v184, 0
    v_mov_b32 v185, 0
    v_mov_b32 v186, 0
    v_mov_b32 v187, 0
    v_mov_b32 v188, 0
    v_mov_b32 v189, 0
    v_mov_b32 v190, 0
    v_mov_b32 v191, 0
    v_mov_b32 v192, 0
    v_mov_b32 v193, 0
    v_mov_b32 v194, 0
    v_mov_b32 v195, 0
    v_mov_b32 v196, 0
    v_mov_b32 v197, 0
    v_mov_b32 v198, 0
    v_mov_b32 v199, 0
    v_mov_b32 v200, 0
    v_mov_b32 v201, 0
    v_mov_b32 v202, 0
    v_mov_b32 v203, 0
    v_mov_b32 v204, 0
    v_mov_b32 v205, 0
    v_mov_b32 v206, 0
    v_mov_b32 v207, 0
    v_mov_b32 v208, 0
    v_mov_b32 v209, 0
    v_mov_b32 v210, 0
    v_mov_b32 v211, 0
    v_mov_b32 v212, 0
    v_mov_b32 v213, 0
    v_mov_b32 v214, 0
    v_mov_b32 v215, 0
    v_mov_b32 v216, 0
    v_mov_b32 v217, 0
    v_mov_b32 v218, 0
    v_mov_b32 v219, 0
    v_mov_b32 v220, 0
    v_mov_b32 v221, 0
    v_mov_b32 v222, 0
    v_mov_b32 v223, 0
    v_mov_b32 v224, 0
    v_mov_b32 v225, 0
    v_mov_b32 v226, 0
    v_mov_b32 v227, 0
    v_mov_b32 v228, 0
    v_mov_b32 v229, 0
    v_mov_b32 v230, 0
    v_mov_b32 v231, 0
    v_mov_b32 v232, 0
    v_mov_b32 v233, 0
    v_mov_b32 v234, 0
    v_mov_b32 v235, 0
    v_mov_b32 v236, 0
    v_mov_b32 v237, 0
    v_mov_b32 v238, 0
    v_mov_b32 v239, 0
    v_mov_b32 v240, 0
    v_mov_b32 v241, 0
    v_mov_b32 v242, 0
    v_mov_b32 v243, 0
    v_mov_b32 v244, 0
    v_mov_b32 v245, 0
    v_mov_b32 v246, 0
    v_mov_b32 v247, 0
    v_mov_b32 v248, 0
    v_mov_b32 v249, 0
    v_mov_b32 v250, 0
    v_mov_b32 v251, 0
    v_mov_b32 v252, 0
    v_mov_b32 v253, 0
    v_mov_b32 v254, 0
    v_mov_b32 v255, 0
    s_waitcnt vmcnt(8)
    s_barrier
    s_cmp_eq_u32 s38, 0
    s_cbranch_scc0 K1_VTYPE
    ds_read_b64_tr_b16 v[96:97], v25 offset:0
    ds_read_b64_tr_b16 v[98:99], v25 offset:2048
    ds_read_b64_tr_b16 v[100:101], v26 offset:0
    ds_read_b64_tr_b16 v[102:103], v26 offset:2048
    ds_read_b64_tr_b16 v[104:105], v27 offset:0
    ds_read_b64_tr_b16 v[106:107], v27 offset:2048
    ds_read_b64_tr_b16 v[108:109], v28 offset:0
    ds_read_b64_tr_b16 v[110:111], v28 offset:2048
    ds_read_b128 v[64:67], v9 offset:0
    ds_read_b128 v[68:71], v9 offset:2048
    ds_read_b128 v[72:75], v9 offset:4096
    ds_read_b128 v[76:79], v9 offset:6144
    ds_read_b128 v[80:83], v9 offset:8192
    ds_read_b128 v[84:87], v9 offset:10240
    ds_read_b128 v[88:91], v9 offset:12288
    ds_read_b128 v[92:95], v9 offset:14336
    s_waitcnt vmcnt(6)
    s_barrier
    s_waitcnt lgkmcnt(7)
    v_mfma_f32_16x16x32_bf16 v[128:131], v[96:99], v[64:67], v[128:131]
    v_mfma_f32_16x16x32_bf16 v[132:135], v[100:103], v[64:67], v[132:135]
    v_mfma_f32_16x16x32_bf16 v[136:139], v[104:107], v[64:67], v[136:139]
    v_mfma_f32_16x16x32_bf16 v[140:143], v[108:111], v[64:67], v[140:143]
    ds_read_b128 v[64:67], v23 offset:0
    ds_read_b64_tr_b16 v[112:113], v25 offset:16384
    ds_read_b64_tr_b16 v[114:115], v25 offset:18432
    ds_read_b64_tr_b16 v[116:117], v26 offset:16384
    ds_read_b64_tr_b16 v[118:119], v26 offset:18432
    s_waitcnt lgkmcnt(11)
    v_mfma_f32_16x16x32_bf16 v[144:147], v[96:99], v[68:71], v[144:147]
    v_mfma_f32_16x16x32_bf16 v[148:151], v[100:103], v[68:71], v[148:151]
    v_mfma_f32_16x16x32_bf16 v[152:155], v[104:107], v[68:71], v[152:155]
    v_mfma_f32_16x16x32_bf16 v[156:159], v[108:111], v[68:71], v[156:159]
    ds_read_b128 v[68:71], v23 offset:2048
    ds_read_b64_tr_b16 v[120:121], v27 offset:16384
    ds_read_b64_tr_b16 v[122:123], v27 offset:18432
    ds_read_b64_tr_b16 v[124:125], v28 offset:16384
    ds_read_b64_tr_b16 v[126:127], v28 offset:18432
    s_waitcnt lgkmcnt(15)
    v_mfma_f32_16x16x32_bf16 v[160:163], v[96:99], v[72:75], v[160:163]
    v_mfma_f32_16x16x32_bf16 v[164:167], v[100:103], v[72:75], v[164:167]
    v_mfma_f32_16x16x32_bf16 v[168:171], v[104:107], v[72:75], v[168:171]
    v_mfma_f32_16x16x32_bf16 v[172:175], v[108:111], v[72:75], v[172:175]
    ds_read_b128 v[72:75], v23 offset:4096
    s_add_u32 m0, s42, 147456
    s_mov_b32 s47, 786432
    buffer_load_dwordx4 v6, s[20:23], s47 offen lds
    s_add_u32 m0, s42, 148480
    s_waitcnt lgkmcnt(15)
    v_mfma_f32_16x16x32_bf16 v[176:179], v[96:99], v[76:79], v[176:179]
    v_mfma_f32_16x16x32_bf16 v[180:183], v[100:103], v[76:79], v[180:183]
    v_mfma_f32_16x16x32_bf16 v[184:187], v[104:107], v[76:79], v[184:187]
    v_mfma_f32_16x16x32_bf16 v[188:191], v[108:111], v[76:79], v[188:191]
    ds_read_b128 v[76:79], v23 offset:6144
    s_mov_b32 s47, 786432
    buffer_load_dwordx4 v7, s[20:23], s47 offen lds
    s_add_u32 m0, s41, 65536
    s_mov_b32 s47, 256
    s_waitcnt lgkmcnt(15)
    v_mfma_f32_16x16x32_bf16 v[192:195], v[96:99], v[80:83], v[192:195]
    v_mfma_f32_16x16x32_bf16 v[196:199], v[100:103], v[80:83], v[196:199]
    v_mfma_f32_16x16x32_bf16 v[200:203], v[104:107], v[80:83], v[200:203]
    v_mfma_f32_16x16x32_bf16 v[204:207], v[108:111], v[80:83], v[204:207]
    ds_read_b128 v[80:83], v23 offset:8192
    buffer_load_dwordx4 v5, s[16:19], s47 offen lds
    s_add_u32 m0, s41, 66560
    s_mov_b32 s47, 8448
    buffer_load_dwordx4 v8, s[16:19], s47 offen lds
    s_waitcnt lgkmcnt(15)
    v_mfma_f32_16x16x32_bf16 v[208:211], v[96:99], v[84:87], v[208:211]
    v_mfma_f32_16x16x32_bf16 v[212:215], v[100:103], v[84:87], v[212:215]
    v_mfma_f32_16x16x32_bf16 v[216:219], v[104:107], v[84:87], v[216:219]
    v_mfma_f32_16x16x32_bf16 v[220:223], v[108:111], v[84:87], v[220:223]
    ds_read_b128 v[84:87], v23 offset:10240
    s_add_u32 m0, s41, 67584
    s_mov_b32 s47, 16640
    buffer_load_dwordx4 v5, s[16:19], s47 offen lds
    s_add_u32 m0, s41, 68608
    s_waitcnt lgkmcnt(15)
    v_mfma_f32_16x16x32_bf16 v[224:227], v[96:99], v[88:91], v[224:227]
    v_mfma_f32_16x16x32_bf16 v[228:231], v[100:103], v[88:91], v[228:231]
    v_mfma_f32_16x16x32_bf16 v[232:235], v[104:107], v[88:91], v[232:235]
    v_mfma_f32_16x16x32_bf16 v[236:239], v[108:111], v[88:91], v[236:239]
    ds_read_b128 v[88:91], v23 offset:12288
    s_mov_b32 s47, 24832
    buffer_load_dwordx4 v8, s[16:19], s47 offen lds
    s_waitcnt lgkmcnt(15)
    v_mfma_f32_16x16x32_bf16 v[240:243], v[96:99], v[92:95], v[240:243]
    v_mfma_f32_16x16x32_bf16 v[244:247], v[100:103], v[92:95], v[244:247]
    v_mfma_f32_16x16x32_bf16 v[248:251], v[104:107], v[92:95], v[248:251]
    v_mfma_f32_16x16x32_bf16 v[252:255], v[108:111], v[92:95], v[252:255]
    ds_read_b128 v[92:95], v23 offset:14336
    s_waitcnt vmcnt(6)
    s_barrier
    s_waitcnt lgkmcnt(13)
    v_mfma_f32_16x16x32_bf16 v[128:131], v[112:115], v[64:67], v[128:131]
    s_waitcnt lgkmcnt(11)
    v_mfma_f32_16x16x32_bf16 v[132:135], v[116:119], v[64:67], v[132:135]
    s_waitcnt lgkmcnt(8)
    v_mfma_f32_16x16x32_bf16 v[136:139], v[120:123], v[64:67], v[136:139]
    s_waitcnt lgkmcnt(6)
    v_mfma_f32_16x16x32_bf16 v[140:143], v[124:127], v[64:67], v[140:143]
    ds_read_b128 v[64:67], v9 offset:32768
    ds_read_b64_tr_b16 v[96:97], v25 offset:32768
    ds_read_b64_tr_b16 v[98:99], v25 offset:34816
    v_mfma_f32_16x16x32_bf16 v[144:147], v[112:115], v[68:71], v[144:147]
    v_mfma_f32_16x16x32_bf16 v[148:151], v[116:119], v[68:71], v[148:151]
    v_mfma_f32_16x16x32_bf16 v[152:155], v[120:123], v[68:71], v[152:155]
    v_mfma_f32_16x16x32_bf16 v[156:159], v[124:127], v[68:71], v[156:159]
    ds_read_b128 v[68:71], v9 offset:34816
    ds_read_b64_tr_b16 v[100:101], v26 offset:32768
    ds_read_b64_tr_b16 v[102:103], v26 offset:34816
    s_waitcnt lgkmcnt(11)
    v_mfma_f32_16x16x32_bf16 v[160:163], v[112:115], v[72:75], v[160:163]
    v_mfma_f32_16x16x32_bf16 v[164:167], v[116:119], v[72:75], v[164:167]
    v_mfma_f32_16x16x32_bf16 v[168:171], v[120:123], v[72:75], v[168:171]
    v_mfma_f32_16x16x32_bf16 v[172:175], v[124:127], v[72:75], v[172:175]
    ds_read_b128 v[72:75], v9 offset:36864
    ds_read_b64_tr_b16 v[104:105], v27 offset:32768
    ds_read_b64_tr_b16 v[106:107], v27 offset:34816
    s_waitcnt lgkmcnt(13)
    v_mfma_f32_16x16x32_bf16 v[176:179], v[112:115], v[76:79], v[176:179]
    v_mfma_f32_16x16x32_bf16 v[180:183], v[116:119], v[76:79], v[180:183]
    v_mfma_f32_16x16x32_bf16 v[184:187], v[120:123], v[76:79], v[184:187]
    v_mfma_f32_16x16x32_bf16 v[188:191], v[124:127], v[76:79], v[188:191]
    ds_read_b128 v[76:79], v9 offset:38912
    ds_read_b64_tr_b16 v[108:109], v28 offset:32768
    ds_read_b64_tr_b16 v[110:111], v28 offset:34816
    s_waitcnt lgkmcnt(15)
    v_mfma_f32_16x16x32_bf16 v[192:195], v[112:115], v[80:83], v[192:195]
    v_mfma_f32_16x16x32_bf16 v[196:199], v[116:119], v[80:83], v[196:199]
    v_mfma_f32_16x16x32_bf16 v[200:203], v[120:123], v[80:83], v[200:203]
    v_mfma_f32_16x16x32_bf16 v[204:207], v[124:127], v[80:83], v[204:207]
    ds_read_b128 v[80:83], v9 offset:40960
    s_add_u32 m0, s42, 98304
    s_mov_b32 s47, 1048576
    s_waitcnt lgkmcnt(15)
    v_mfma_f32_16x16x32_bf16 v[208:211], v[112:115], v[84:87], v[208:211]
    v_mfma_f32_16x16x32_bf16 v[212:215], v[116:119], v[84:87], v[212:215]
    v_mfma_f32_16x16x32_bf16 v[216:219], v[120:123], v[84:87], v[216:219]
    v_mfma_f32_16x16x32_bf16 v[220:223], v[124:127], v[84:87], v[220:223]
    ds_read_b128 v[84:87], v9 offset:43008
    buffer_load_dwordx4 v6, s[20:23], s47 offen lds
    s_add_u32 m0, s42, 99328
    s_waitcnt lgkmcnt(15)
    v_mfma_f32_16x16x32_bf16 v[224:227], v[112:115], v[88:91], v[224:227]
    v_mfma_f32_16x16x32_bf16 v[228:231], v[116:119], v[88:91], v[228:231]
    v_mfma_f32_16x16x32_bf16 v[232:235], v[120:123], v[88:91], v[232:235]
    v_mfma_f32_16x16x32_bf16 v[236:239], v[124:127], v[88:91], v[236:239]
    ds_read_b128 v[88:91], v9 offset:45056
    s_mov_b32 s47, 1048576
    buffer_load_dwordx4 v7, s[20:23], s47 offen lds
    s_waitcnt lgkmcnt(15)
    v_mfma_f32_16x16x32_bf16 v[240:243], v[112:115], v[92:95], v[240:243]
    v_mfma_f32_16x16x32_bf16 v[244:247], v[116:119], v[92:95], v[244:247]
    v_mfma_f32_16x16x32_bf16 v[248:251], v[120:123], v[92:95], v[248:251]
    v_mfma_f32_16x16x32_bf16 v[252:255], v[124:127], v[92:95], v[252:255]
    ds_read_b128 v[92:95], v9 offset:47104
    s_waitcnt vmcnt(6)
    s_barrier
    s_waitcnt lgkmcnt(13)
    v_mfma_f32_16x16x32_bf16 v[128:131], v[96:99], v[64:67], v[128:131]
    s_waitcnt lgkmcnt(10)
    v_mfma_f32_16x16x32_bf16 v[132:135], v[100:103], v[64:67], v[132:135]
    s_waitcnt lgkmcnt(7)
    v_mfma_f32_16x16x32_bf16 v[136:139], v[104:107], v[64:67], v[136:139]
    s_waitcnt lgkmcnt(4)
    v_mfma_f32_16x16x32_bf16 v[140:143], v[108:111], v[64:67], v[140:143]
    ds_read_b128 v[64:67], v23 offset:32768
    ds_read_b64_tr_b16 v[112:113], v25 offset:49152
    ds_read_b64_tr_b16 v[114:115], v25 offset:51200
    ds_read_b64_tr_b16 v[116:117], v26 offset:49152
    ds_read_b64_tr_b16 v[118:119], v26 offset:51200
    v_mfma_f32_16x16x32_bf16 v[144:147], v[96:99], v[68:71], v[144:147]
    v_mfma_f32_16x16x32_bf16 v[148:151], v[100:103], v[68:71], v[148:151]
    v_mfma_f32_16x16x32_bf16 v[152:155], v[104:107], v[68:71], v[152:155]
    v_mfma_f32_16x16x32_bf16 v[156:159], v[108:111], v[68:71], v[156:159]
    ds_read_b128 v[68:71], v23 offset:34816
    ds_read_b64_tr_b16 v[120:121], v27 offset:49152
    ds_read_b64_tr_b16 v[122:123], v27 offset:51200
    ds_read_b64_tr_b16 v[124:125], v28 offset:49152
    ds_read_b64_tr_b16 v[126:127], v28 offset:51200
    v_mfma_f32_16x16x32_bf16 v[160:163], v[96:99], v[72:75], v[160:163]
    v_mfma_f32_16x16x32_bf16 v[164:167], v[100:103], v[72:75], v[164:167]
    v_mfma_f32_16x16x32_bf16 v[168:171], v[104:107], v[72:75], v[168:171]
    v_mfma_f32_16x16x32_bf16 v[172:175], v[108:111], v[72:75], v[172:175]
    ds_read_b128 v[72:75], v23 offset:36864
    s_add_u32 m0, s42, 114688
    s_mov_b32 s47, 1310720
    buffer_load_dwordx4 v6, s[20:23], s47 offen lds
    s_add_u32 m0, s42, 115712
    v_mfma_f32_16x16x32_bf16 v[176:179], v[96:99], v[76:79], v[176:179]
    v_mfma_f32_16x16x32_bf16 v[180:183], v[100:103], v[76:79], v[180:183]
    v_mfma_f32_16x16x32_bf16 v[184:187], v[104:107], v[76:79], v[184:187]
    v_mfma_f32_16x16x32_bf16 v[188:191], v[108:111], v[76:79], v[188:191]
    ds_read_b128 v[76:79], v23 offset:38912
    s_mov_b32 s47, 1310720
    buffer_load_dwordx4 v7, s[20:23], s47 offen lds
    s_add_u32 m0, s41, 0
    s_mov_b32 s47, 384
    s_waitcnt lgkmcnt(15)
    v_mfma_f32_16x16x32_bf16 v[192:195], v[96:99], v[80:83], v[192:195]
    v_mfma_f32_16x16x32_bf16 v[196:199], v[100:103], v[80:83], v[196:199]
    v_mfma_f32_16x16x32_bf16 v[200:203], v[104:107], v[80:83], v[200:203]
    v_mfma_f32_16x16x32_bf16 v[204:207], v[108:111], v[80:83], v[204:207]
    ds_read_b128 v[80:83], v23 offset:40960
    buffer_load_dwordx4 v5, s[16:19], s47 offen lds
    s_add_u32 m0, s41, 1024
    s_mov_b32 s47, 8576
    buffer_load_dwordx4 v8, s[16:19], s47 offen lds
    s_waitcnt lgkmcnt(15)
    v_mfma_f32_16x16x32_bf16 v[208:211], v[96:99], v[84:87], v[208:211]
    v_mfma_f32_16x16x32_bf16 v[212:215], v[100:103], v[84:87], v[212:215]
    v_mfma_f32_16x16x32_bf16 v[216:219], v[104:107], v[84:87], v[216:219]
    v_mfma_f32_16x16x32_bf16 v[220:223], v[108:111], v[84:87], v[220:223]
    ds_read_b128 v[84:87], v23 offset:43008
    s_add_u32 m0, s41, 2048
    s_mov_b32 s47, 16768
    buffer_load_dwordx4 v5, s[16:19], s47 offen lds
    s_add_u32 m0, s41, 3072
    s_waitcnt lgkmcnt(15)
    v_mfma_f32_16x16x32_bf16 v[224:227], v[96:99], v[88:91], v[224:227]
    v_mfma_f32_16x16x32_bf16 v[228:231], v[100:103], v[88:91], v[228:231]
    v_mfma_f32_16x16x32_bf16 v[232:235], v[104:107], v[88:91], v[232:235]
    v_mfma_f32_16x16x32_bf16 v[236:239], v[108:111], v[88:91], v[236:239]
    ds_read_b128 v[88:91], v23 offset:45056
    s_mov_b32 s47, 24960
    buffer_load_dwordx4 v8, s[16:19], s47 offen lds
    s_waitcnt lgkmcnt(15)
    v_mfma_f32_16x16x32_bf16 v[240:243], v[96:99], v[92:95], v[240:243]
    v_mfma_f32_16x16x32_bf16 v[244:247], v[100:103], v[92:95], v[244:247]
    v_mfma_f32_16x16x32_bf16 v[248:251], v[104:107], v[92:95], v[248:251]
    v_mfma_f32_16x16x32_bf16 v[252:255], v[108:111], v[92:95], v[252:255]
    ds_read_b128 v[92:95], v23 offset:47104
    s_waitcnt vmcnt(6)
    s_barrier
    s_waitcnt lgkmcnt(13)
    v_mfma_f32_16x16x32_bf16 v[128:131], v[112:115], v[64:67], v[128:131]
    s_waitcnt lgkmcnt(11)
    v_mfma_f32_16x16x32_bf16 v[132:135], v[116:119], v[64:67], v[132:135]
    s_waitcnt lgkmcnt(8)
    v_mfma_f32_16x16x32_bf16 v[136:139], v[120:123], v[64:67], v[136:139]
    s_waitcnt lgkmcnt(6)
    v_mfma_f32_16x16x32_bf16 v[140:143], v[124:127], v[64:67], v[140:143]
    ds_read_b128 v[64:67], v29 offset:0
    ds_read_b64_tr_b16 v[96:97], v25 offset:0
    ds_read_b64_tr_b16 v[98:99], v25 offset:2048
    v_mfma_f32_16x16x32_bf16 v[144:147], v[112:115], v[68:71], v[144:147]
    v_mfma_f32_16x16x32_bf16 v[148:151], v[116:119], v[68:71], v[148:151]
    v_mfma_f32_16x16x32_bf16 v[152:155], v[120:123], v[68:71], v[152:155]
    v_mfma_f32_16x16x32_bf16 v[156:159], v[124:127], v[68:71], v[156:159]
    ds_read_b128 v[68:71], v29 offset:2048
    ds_read_b64_tr_b16 v[100:101], v26 offset:0
    ds_read_b64_tr_b16 v[102:103], v26 offset:2048
    s_waitcnt lgkmcnt(11)
    v_mfma_f32_16x16x32_bf16 v[160:163], v[112:115], v[72:75], v[160:163]
    v_mfma_f32_16x16x32_bf16 v[164:167], v[116:119], v[72:75], v[164:167]
    v_mfma_f32_16x16x32_bf16 v[168:171], v[120:123], v[72:75], v[168:171]
    v_mfma_f32_16x16x32_bf16 v[172:175], v[124:127], v[72:75], v[172:175]
    ds_read_b128 v[72:75], v29 offset:4096
    ds_read_b64_tr_b16 v[104:105], v27 offset:0
    ds_read_b64_tr_b16 v[106:107], v27 offset:2048
    s_waitcnt lgkmcnt(13)
    v_mfma_f32_16x16x32_bf16 v[176:179], v[112:115], v[76:79], v[176:179]
    v_mfma_f32_16x16x32_bf16 v[180:183], v[116:119], v[76:79], v[180:183]
    v_mfma_f32_16x16x32_bf16 v[184:187], v[120:123], v[76:79], v[184:187]
    v_mfma_f32_16x16x32_bf16 v[188:191], v[124:127], v[76:79], v[188:191]
    ds_read_b128 v[76:79], v29 offset:6144
    ds_read_b64_tr_b16 v[108:109], v28 offset:0
    ds_read_b64_tr_b16 v[110:111], v28 offset:2048
    s_waitcnt lgkmcnt(15)
    v_mfma_f32_16x16x32_bf16 v[192:195], v[112:115], v[80:83], v[192:195]
    v_mfma_f32_16x16x32_bf16 v[196:199], v[116:119], v[80:83], v[196:199]
    v_mfma_f32_16x16x32_bf16 v[200:203], v[120:123], v[80:83], v[200:203]
    v_mfma_f32_16x16x32_bf16 v[204:207], v[124:127], v[80:83], v[204:207]
    ds_read_b128 v[80:83], v29 offset:8192
    s_add_u32 m0, s42, 131072
    s_mov_b32 s47, 1572864
    s_waitcnt lgkmcnt(15)
    v_mfma_f32_16x16x32_bf16 v[208:211], v[112:115], v[84:87], v[208:211]
    v_mfma_f32_16x16x32_bf16 v[212:215], v[116:119], v[84:87], v[212:215]
    v_mfma_f32_16x16x32_bf16 v[216:219], v[120:123], v[84:87], v[216:219]
    v_mfma_f32_16x16x32_bf16 v[220:223], v[124:127], v[84:87], v[220:223]
    ds_read_b128 v[84:87], v29 offset:10240
    buffer_load_dwordx4 v6, s[20:23], s47 offen lds
    s_add_u32 m0, s42, 132096
    s_waitcnt lgkmcnt(15)
    v_mfma_f32_16x16x32_bf16 v[224:227], v[112:115], v[88:91], v[224:227]
    v_mfma_f32_16x16x32_bf16 v[228:231], v[116:119], v[88:91], v[228:231]
    v_mfma_f32_16x16x32_bf16 v[232:235], v[120:123], v[88:91], v[232:235]
    v_mfma_f32_16x16x32_bf16 v[236:239], v[124:127], v[88:91], v[236:239]
    ds_read_b128 v[88:91], v29 offset:12288
    s_mov_b32 s47, 1572864
    buffer_load_dwordx4 v7, s[20:23], s47 offen lds
    s_waitcnt lgkmcnt(15)
    v_mfma_f32_16x16x32_bf16 v[240:243], v[112:115], v[92:95], v[240:243]
    v_mfma_f32_16x16x32_bf16 v[244:247], v[116:119], v[92:95], v[244:247]
    v_mfma_f32_16x16x32_bf16 v[248:251], v[120:123], v[92:95], v[248:251]
    v_mfma_f32_16x16x32_bf16 v[252:255], v[124:127], v[92:95], v[252:255]
    ds_read_b128 v[92:95], v29 offset:14336
    s_waitcnt vmcnt(6)
    s_barrier
    s_waitcnt lgkmcnt(13)
    v_mfma_f32_16x16x32_bf16 v[128:131], v[96:99], v[64:67], v[128:131]
    s_waitcnt lgkmcnt(10)
    v_mfma_f32_16x16x32_bf16 v[132:135], v[100:103], v[64:67], v[132:135]
    s_waitcnt lgkmcnt(7)
    v_mfma_f32_16x16x32_bf16 v[136:139], v[104:107], v[64:67], v[136:139]
    s_waitcnt lgkmcnt(4)
    v_mfma_f32_16x16x32_bf16 v[140:143], v[108:111], v[64:67], v[140:143]
    ds_read_b128 v[64:67], v31 offset:0
    ds_read_b64_tr_b16 v[112:113], v25 offset:16384
    ds_read_b64_tr_b16 v[114:115], v25 offset:18432
    ds_read_b64_tr_b16 v[116:117], v26 offset:16384
    ds_read_b64_tr_b16 v[118:119], v26 offset:18432
    v_mfma_f32_16x16x32_bf16 v[144:147], v[96:99], v[68:71], v[144:147]
    v_mfma_f32_16x16x32_bf16 v[148:151], v[100:103], v[68:71], v[148:151]
    v_mfma_f32_16x16x32_bf16 v[152:155], v[104:107], v[68:71], v[152:155]
    v_mfma_f32_16x16x32_bf16 v[156:159], v[108:111], v[68:71], v[156:159]
    ds_read_b128 v[68:71], v31 offset:2048
    ds_read_b64_tr_b16 v[120:121], v27 offset:16384
    ds_read_b64_tr_b16 v[122:123], v27 offset:18432
    ds_read_b64_tr_b16 v[124:125], v28 offset:16384
    ds_read_b64_tr_b16 v[126:127], v28 offset:18432
    v_mfma_f32_16x16x32_bf16 v[160:163], v[96:99], v[72:75], v[160:163]
    v_mfma_f32_16x16x32_bf16 v[164:167], v[100:103], v[72:75], v[164:167]
    v_mfma_f32_16x16x32_bf16 v[168:171], v[104:107], v[72:75], v[168:171]
    v_mfma_f32_16x16x32_bf16 v[172:175], v[108:111], v[72:75], v[172:175]
    ds_read_b128 v[72:75], v31 offset:4096
    s_add_u32 m0, s42, 147456
    s_mov_b32 s47, 1835008
    buffer_load_dwordx4 v6, s[20:23], s47 offen lds
    s_add_u32 m0, s42, 148480
    v_mfma_f32_16x16x32_bf16 v[176:179], v[96:99], v[76:79], v[176:179]
    v_mfma_f32_16x16x32_bf16 v[180:183], v[100:103], v[76:79], v[180:183]
    v_mfma_f32_16x16x32_bf16 v[184:187], v[104:107], v[76:79], v[184:187]
    v_mfma_f32_16x16x32_bf16 v[188:191], v[108:111], v[76:79], v[188:191]
    ds_read_b128 v[76:79], v31 offset:6144
    s_mov_b32 s47, 1835008
    buffer_load_dwordx4 v7, s[20:23], s47 offen lds
    s_add_u32 m0, s41, 32768
    s_mov_b32 s47, 512
    s_waitcnt lgkmcnt(15)
    v_mfma_f32_16x16x32_bf16 v[192:195], v[96:99], v[80:83], v[192:195]
    v_mfma_f32_16x16x32_bf16 v[196:199], v[100:103], v[80:83], v[196:199]
    v_mfma_f32_16x16x32_bf16 v[200:203], v[104:107], v[80:83], v[200:203]
    v_mfma_f32_16x16x32_bf16 v[204:207], v[108:111], v[80:83], v[204:207]
    ds_read_b128 v[80:83], v31 offset:8192
    buffer_load_dwordx4 v5, s[16:19], s47 offen lds
    s_add_u32 m0, s41, 33792
    s_mov_b32 s47, 8704
    buffer_load_dwordx4 v8, s[16:19], s47 offen lds
    s_waitcnt lgkmcnt(15)
    v_mfma_f32_16x16x32_bf16 v[208:211], v[96:99], v[84:87], v[208:211]
    v_mfma_f32_16x16x32_bf16 v[212:215], v[100:103], v[84:87], v[212:215]
    v_mfma_f32_16x16x32_bf16 v[216:219], v[104:107], v[84:87], v[216:219]
    v_mfma_f32_16x16x32_bf16 v[220:223], v[108:111], v[84:87], v[220:223]
    ds_read_b128 v[84:87], v31 offset:10240
    s_add_u32 m0, s41, 34816
    s_mov_b32 s47, 16896
    buffer_load_dwordx4 v5, s[16:19], s47 offen lds
    s_add_u32 m0, s41, 35840
    s_waitcnt lgkmcnt(15)
    v_mfma_f32_16x16x32_bf16 v[224:227], v[96:99], v[88:91], v[224:227]
    v_mfma_f32_16x16x32_bf16 v[228:231], v[100:103], v[88:91], v[228:231]
    v_mfma_f32_16x16x32_bf16 v[232:235], v[104:107], v[88:91], v[232:235]
    v_mfma_f32_16x16x32_bf16 v[236:239], v[108:111], v[88:91], v[236:239]
    ds_read_b128 v[88:91], v31 offset:12288
    s_mov_b32 s47, 25088
    buffer_load_dwordx4 v8, s[16:19], s47 offen lds
    s_waitcnt lgkmcnt(15)
    v_mfma_f32_16x16x32_bf16 v[240:243], v[96:99], v[92:95], v[240:243]
    v_mfma_f32_16x16x32_bf16 v[244:247], v[100:103], v[92:95], v[244:247]
    v_mfma_f32_16x16x32_bf16 v[248:251], v[104:107], v[92:95], v[248:251]
    v_mfma_f32_16x16x32_bf16 v[252:255], v[108:111], v[92:95], v[252:255]
    ds_read_b128 v[92:95], v31 offset:14336
    s_waitcnt vmcnt(6)
    s_barrier
    s_waitcnt lgkmcnt(13)
    v_mfma_f32_16x16x32_bf16 v[128:131], v[112:115], v[64:67], v[128:131]
    s_waitcnt lgkmcnt(11)
    v_mfma_f32_16x16x32_bf16 v[132:135], v[116:119], v[64:67], v[132:135]
    s_waitcnt lgkmcnt(8)
    v_mfma_f32_16x16x32_bf16 v[136:139], v[120:123], v[64:67], v[136:139]
    s_waitcnt lgkmcnt(6)
    v_mfma_f32_16x16x32_bf16 v[140:143], v[124:127], v[64:67], v[140:143]
    ds_read_b128 v[64:67], v9 offset:0
    ds_read_b64_tr_b16 v[96:97], v25 offset:32768
    ds_read_b64_tr_b16 v[98:99], v25 offset:34816
    v_mfma_f32_16x16x32_bf16 v[144:147], v[112:115], v[68:71], v[144:147]
    v_mfma_f32_16x16x32_bf16 v[148:151], v[116:119], v[68:71], v[148:151]
    v_mfma_f32_16x16x32_bf16 v[152:155], v[120:123], v[68:71], v[152:155]
    v_mfma_f32_16x16x32_bf16 v[156:159], v[124:127], v[68:71], v[156:159]
    ds_read_b128 v[68:71], v9 offset:2048
    ds_read_b64_tr_b16 v[100:101], v26 offset:32768
    ds_read_b64_tr_b16 v[102:103], v26 offset:34816
    s_waitcnt lgkmcnt(11)
    v_mfma_f32_16x16x32_bf16 v[160:163], v[112:115], v[72:75], v[160:163]
    v_mfma_f32_16x16x32_bf16 v[164:167], v[116:119], v[72:75], v[164:167]
    v_mfma_f32_16x16x32_bf16 v[168:171], v[120:123], v[72:75], v[168:171]
    v_mfma_f32_16x16x32_bf16 v[172:175], v[124:127], v[72:75], v[172:175]
    ds_read_b128 v[72:75], v9 offset:4096
    ds_read_b64_tr_b16 v[104:105], v27 offset:32768
    ds_read_b64_tr_b16 v[106:107], v27 offset:34816
    s_waitcnt lgkmcnt(13)
    v_mfma_f32_16x16x32_bf16 v[176:179], v[112:115], v[76:79], v[176:179]
    v_mfma_f32_16x16x32_bf16 v[180:183], v[116:119], v[76:79], v[180:183]
    v_mfma_f32_16x16x32_bf16 v[184:187], v[120:123], v[76:79], v[184:187]
    v_mfma_f32_16x16x32_bf16 v[188:191], v[124:127], v[76:79], v[188:191]
    ds_read_b128 v[76:79], v9 offset:6144
    ds_read_b64_tr_b16 v[108:109], v28 offset:32768
    ds_read_b64_tr_b16 v[110:111], v28 offset:34816
    s_waitcnt lgkmcnt(15)
    v_mfma_f32_16x16x32_bf16 v[192:195], v[112:115], v[80:83], v[192:195]
    v_mfma_f32_16x16x32_bf16 v[196:199], v[116:119], v[80:83], v[196:199]
    v_mfma_f32_16x16x32_bf16 v[200:203], v[120:123], v[80:83], v[200:203]
    v_mfma_f32_16x16x32_bf16 v[204:207], v[124:127], v[80:83], v[204:207]
    ds_read_b128 v[80:83], v9 offset:8192
    s_add_u32 m0, s42, 98304
    s_mov_b32 s47, 2097152
    s_waitcnt lgkmcnt(15)
    v_mfma_f32_16x16x32_bf16 v[208:211], v[112:115], v[84:87], v[208:211]
    v_mfma_f32_16x16x32_bf16 v[212:215], v[116:119], v[84:87], v[212:215]
    v_mfma_f32_16x16x32_bf16 v[216:219], v[120:123], v[84:87], v[216:219]
    v_mfma_f32_16x16x32_bf16 v[220:223], v[124:127], v[84:87], v[220:223]
    ds_read_b128 v[84:87], v9 offset:10240
    buffer_load_dwordx4 v6, s[20:23], s47 offen lds
    s_add_u32 m0, s42, 99328
    s_waitcnt lgkmcnt(15)
    v_mfma_f32_16x16x32_bf16 v[224:227], v[112:115], v[88:91], v[224:227]
    v_mfma_f32_16x16x32_bf16 v[228:231], v[116:119], v[88:91], v[228:231]
    v_mfma_f32_16x16x32_bf16 v[232:235], v[120:123], v[88:91], v[232:235]
    v_mfma_f32_16x16x32_bf16 v[236:239], v[124:127], v[88:91], v[236:239]
    ds_read_b128 v[88:91], v9 offset:12288
    s_mov_b32 s47, 2097152
    buffer_load_dwordx4 v7, s[20:23], s47 offen lds
    s_waitcnt lgkmcnt(15)
    v_mfma_f32_16x16x32_bf16 v[240:243], v[112:115], v[92:95], v[240:243]
    v_mfma_f32_16x16x32_bf16 v[244:247], v[116:119], v[92:95], v[244:247]
    v_mfma_f32_16x16x32_bf16 v[248:251], v[120:123], v[92:95], v[248:251]
    v_mfma_f32_16x16x32_bf16 v[252:255], v[124:127], v[92:95], v[252:255]
    ds_read_b128 v[92:95], v9 offset:14336
    s_waitcnt vmcnt(6)
    s_barrier
    s_waitcnt lgkmcnt(13)
    v_mfma_f32_16x16x32_bf16 v[128:131], v[96:99], v[64:67], v[128:131]
    s_waitcnt lgkmcnt(10)
    v_mfma_f32_16x16x32_bf16 v[132:135], v[100:103], v[64:67], v[132:135]
    s_waitcnt lgkmcnt(7)
    v_mfma_f32_16x16x32_bf16 v[136:139], v[104:107], v[64:67], v[136:139]
    s_waitcnt lgkmcnt(4)
    v_mfma_f32_16x16x32_bf16 v[140:143], v[108:111], v[64:67], v[140:143]
    ds_read_b128 v[64:67], v23 offset:0
    ds_read_b64_tr_b16 v[112:113], v25 offset:49152
    ds_read_b64_tr_b16 v[114:115], v25 offset:51200
    ds_read_b64_tr_b16 v[116:117], v26 offset:49152
    ds_read_b64_tr_b16 v[118:119], v26 offset:51200
    v_mfma_f32_16x16x32_bf16 v[144:147], v[96:99], v[68:71], v[144:147]
    v_mfma_f32_16x16x32_bf16 v[148:151], v[100:103], v[68:71], v[148:151]
    v_mfma_f32_16x16x32_bf16 v[152:155], v[104:107], v[68:71], v[152:155]
    v_mfma_f32_16x16x32_bf16 v[156:159], v[108:111], v[68:71], v[156:159]
    ds_read_b128 v[68:71], v23 offset:2048
    ds_read_b64_tr_b16 v[120:121], v27 offset:49152
    ds_read_b64_tr_b16 v[122:123], v27 offset:51200
    ds_read_b64_tr_b16 v[124:125], v28 offset:49152
    ds_read_b64_tr_b16 v[126:127], v28 offset:51200
    v_mfma_f32_16x16x32_bf16 v[160:163], v[96:99], v[72:75], v[160:163]
    v_mfma_f32_16x16x32_bf16 v[164:167], v[100:103], v[72:75], v[164:167]
    v_mfma_f32_16x16x32_bf16 v[168:171], v[104:107], v[72:75], v[168:171]
    v_mfma_f32_16x16x32_bf16 v[172:175], v[108:111], v[72:75], v[172:175]
    ds_read_b128 v[72:75], v23 offset:4096
    s_add_u32 m0, s42, 114688
    s_mov_b32 s47, 2359296
    buffer_load_dwordx4 v6, s[20:23], s47 offen lds
    s_add_u32 m0, s42, 115712
    v_mfma_f32_16x16x32_bf16 v[176:179], v[96:99], v[76:79], v[176:179]
    v_mfma_f32_16x16x32_bf16 v[180:183], v[100:103], v[76:79], v[180:183]
    v_mfma_f32_16x16x32_bf16 v[184:187], v[104:107], v[76:79], v[184:187]
    v_mfma_f32_16x16x32_bf16 v[188:191], v[108:111], v[76:79], v[188:191]
    ds_read_b128 v[76:79], v23 offset:6144
    s_mov_b32 s47, 2359296
    buffer_load_dwordx4 v7, s[20:23], s47 offen lds
    s_add_u32 m0, s41, 65536
    s_mov_b32 s47, 640
    s_waitcnt lgkmcnt(15)
    v_mfma_f32_16x16x32_bf16 v[192:195], v[96:99], v[80:83], v[192:195]
    v_mfma_f32_16x16x32_bf16 v[196:199], v[100:103], v[80:83], v[196:199]
    v_mfma_f32_16x16x32_bf16 v[200:203], v[104:107], v[80:83], v[200:203]
    v_mfma_f32_16x16x32_bf16 v[204:207], v[108:111], v[80:83], v[204:207]
    ds_read_b128 v[80:83], v23 offset:8192
    buffer_load_dwordx4 v5, s[16:19], s47 offen lds
    s_add_u32 m0, s41, 66560
    s_mov_b32 s47, 8832
    buffer_load_dwordx4 v8, s[16:19], s47 offen lds
    s_waitcnt lgkmcnt(15)
    v_mfma_f32_16x16x32_bf16 v[208:211], v[96:99], v[84:87], v[208:211]
    v_mfma_f32_16x16x32_bf16 v[212:215], v[100:103], v[84:87], v[212:215]
    v_mfma_f32_16x16x32_bf16 v[216:219], v[104:107], v[84:87], v[216:219]
    v_mfma_f32_16x16x32_bf16 v[220:223], v[108:111], v[84:87], v[220:223]
    ds_read_b128 v[84:87], v23 offset:10240
    s_add_u32 m0, s41, 67584
    s_mov_b32 s47, 17024
    buffer_load_dwordx4 v5, s[16:19], s47 offen lds
    s_add_u32 m0, s41, 68608
    s_waitcnt lgkmcnt(15)
    v_mfma_f32_16x16x32_bf16 v[224:227], v[96:99], v[88:91], v[224:227]
    v_mfma_f32_16x16x32_bf16 v[228:231], v[100:103], v[88:91], v[228:231]
    v_mfma_f32_16x16x32_bf16 v[232:235], v[104:107], v[88:91], v[232:235]
    v_mfma_f32_16x16x32_bf16 v[236:239], v[108:111], v[88:91], v[236:239]
    ds_read_b128 v[88:91], v23 offset:12288
    s_mov_b32 s47, 25216
    buffer_load_dwordx4 v8, s[16:19], s47 offen lds
    s_waitcnt lgkmcnt(15)
    v_mfma_f32_16x16x32_bf16 v[240:243], v[96:99], v[92:95], v[240:243]
    v_mfma_f32_16x16x32_bf16 v[244:247], v[100:103], v[92:95], v[244:247]
    v_mfma_f32_16x16x32_bf16 v[248:251], v[104:107], v[92:95], v[248:251]
    v_mfma_f32_16x16x32_bf16 v[252:255], v[108:111], v[92:95], v[252:255]
    ds_read_b128 v[92:95], v23 offset:14336
    s_waitcnt vmcnt(6)
    s_barrier
    s_waitcnt lgkmcnt(13)
    v_mfma_f32_16x16x32_bf16 v[128:131], v[112:115], v[64:67], v[128:131]
    s_waitcnt lgkmcnt(11)
    v_mfma_f32_16x16x32_bf16 v[132:135], v[116:119], v[64:67], v[132:135]
    s_waitcnt lgkmcnt(8)
    v_mfma_f32_16x16x32_bf16 v[136:139], v[120:123], v[64:67], v[136:139]
    s_waitcnt lgkmcnt(6)
    v_mfma_f32_16x16x32_bf16 v[140:143], v[124:127], v[64:67], v[140:143]
    ds_read_b128 v[64:67], v9 offset:32768
    ds_read_b64_tr_b16 v[96:97], v25 offset:0
    ds_read_b64_tr_b16 v[98:99], v25 offset:2048
    v_mfma_f32_16x16x32_bf16 v[144:147], v[112:115], v[68:71], v[144:147]
    v_mfma_f32_16x16x32_bf16 v[148:151], v[116:119], v[68:71], v[148:151]
    v_mfma_f32_16x16x32_bf16 v[152:155], v[120:123], v[68:71], v[152:155]
    v_mfma_f32_16x16x32_bf16 v[156:159], v[124:127], v[68:71], v[156:159]
    ds_read_b128 v[68:71], v9 offset:34816
    ds_read_b64_tr_b16 v[100:101], v26 offset:0
    ds_read_b64_tr_b16 v[102:103], v26 offset:2048
    s_waitcnt lgkmcnt(11)
    v_mfma_f32_16x16x32_bf16 v[160:163], v[112:115], v[72:75], v[160:163]
    v_mfma_f32_16x16x32_bf16 v[164:167], v[116:119], v[72:75], v[164:167]
    v_mfma_f32_16x16x32_bf16 v[168:171], v[120:123], v[72:75], v[168:171]
    v_mfma_f32_16x16x32_bf16 v[172:175], v[124:127], v[72:75], v[172:175]
    ds_read_b128 v[72:75], v9 offset:36864
    ds_read_b64_tr_b16 v[104:105], v27 offset:0
    ds_read_b64_tr_b16 v[106:107], v27 offset:2048
    s_waitcnt lgkmcnt(13)
    v_mfma_f32_16x16x32_bf16 v[176:179], v[112:115], v[76:79], v[176:179]
    v_mfma_f32_16x16x32_bf16 v[180:183], v[116:119], v[76:79], v[180:183]
    v_mfma_f32_16x16x32_bf16 v[184:187], v[120:123], v[76:79], v[184:187]
    v_mfma_f32_16x16x32_bf16 v[188:191], v[124:127], v[76:79], v[188:191]
    ds_read_b128 v[76:79], v9 offset:38912
    ds_read_b64_tr_b16 v[108:109], v28 offset:0
    ds_read_b64_tr_b16 v[110:111], v28 offset:2048
    s_waitcnt lgkmcnt(15)
    v_mfma_f32_16x16x32_bf16 v[192:195], v[112:115], v[80:83], v[192:195]
    v_mfma_f32_16x16x32_bf16 v[196:199], v[116:119], v[80:83], v[196:199]
    v_mfma_f32_16x16x32_bf16 v[200:203], v[120:123], v[80:83], v[200:203]
    v_mfma_f32_16x16x32_bf16 v[204:207], v[124:127], v[80:83], v[204:207]
    ds_read_b128 v[80:83], v9 offset:40960
    s_add_u32 m0, s42, 131072
    s_mov_b32 s47, 2621440
    s_waitcnt lgkmcnt(15)
    v_mfma_f32_16x16x32_bf16 v[208:211], v[112:115], v[84:87], v[208:211]
    v_mfma_f32_16x16x32_bf16 v[212:215], v[116:119], v[84:87], v[212:215]
    v_mfma_f32_16x16x32_bf16 v[216:219], v[120:123], v[84:87], v[216:219]
    v_mfma_f32_16x16x32_bf16 v[220:223], v[124:127], v[84:87], v[220:223]
    ds_read_b128 v[84:87], v9 offset:43008
    buffer_load_dwordx4 v6, s[20:23], s47 offen lds
    s_add_u32 m0, s42, 132096
    s_waitcnt lgkmcnt(15)
    v_mfma_f32_16x16x32_bf16 v[224:227], v[112:115], v[88:91], v[224:227]
    v_mfma_f32_16x16x32_bf16 v[228:231], v[116:119], v[88:91], v[228:231]
    v_mfma_f32_16x16x32_bf16 v[232:235], v[120:123], v[88:91], v[232:235]
    v_mfma_f32_16x16x32_bf16 v[236:239], v[124:127], v[88:91], v[236:239]
    ds_read_b128 v[88:91], v9 offset:45056
    s_mov_b32 s47, 2621440
    buffer_load_dwordx4 v7, s[20:23], s47 offen lds
    s_waitcnt lgkmcnt(15)
    v_mfma_f32_16x16x32_bf16 v[240:243], v[112:115], v[92:95], v[240:243]
    v_mfma_f32_16x16x32_bf16 v[244:247], v[116:119], v[92:95], v[244:247]
    v_mfma_f32_16x16x32_bf16 v[248:251], v[120:123], v[92:95], v[248:251]
    v_mfma_f32_16x16x32_bf16 v[252:255], v[124:127], v[92:95], v[252:255]
    ds_read_b128 v[92:95], v9 offset:47104
    s_waitcnt vmcnt(6)
    s_barrier
    s_waitcnt lgkmcnt(13)
    v_mfma_f32_16x16x32_bf16 v[128:131], v[96:99], v[64:67], v[128:131]
    s_waitcnt lgkmcnt(10)
    v_mfma_f32_16x16x32_bf16 v[132:135], v[100:103], v[64:67], v[132:135]
    s_waitcnt lgkmcnt(7)
    v_mfma_f32_16x16x32_bf16 v[136:139], v[104:107], v[64:67], v[136:139]
    s_waitcnt lgkmcnt(4)
    v_mfma_f32_16x16x32_bf16 v[140:143], v[108:111], v[64:67], v[140:143]
    ds_read_b128 v[64:67], v23 offset:32768
    ds_read_b64_tr_b16 v[112:113], v25 offset:16384
    ds_read_b64_tr_b16 v[114:115], v25 offset:18432
    ds_read_b64_tr_b16 v[116:117], v26 offset:16384
    ds_read_b64_tr_b16 v[118:119], v26 offset:18432
    v_mfma_f32_16x16x32_bf16 v[144:147], v[96:99], v[68:71], v[144:147]
    v_mfma_f32_16x16x32_bf16 v[148:151], v[100:103], v[68:71], v[148:151]
    v_mfma_f32_16x16x32_bf16 v[152:155], v[104:107], v[68:71], v[152:155]
    v_mfma_f32_16x16x32_bf16 v[156:159], v[108:111], v[68:71], v[156:159]
    ds_read_b128 v[68:71], v23 offset:34816
    ds_read_b64_tr_b16 v[120:121], v27 offset:16384
    ds_read_b64_tr_b16 v[122:123], v27 offset:18432
    ds_read_b64_tr_b16 v[124:125], v28 offset:16384
    ds_read_b64_tr_b16 v[126:127], v28 offset:18432
    v_mfma_f32_16x16x32_bf16 v[160:163], v[96:99], v[72:75], v[160:163]
    v_mfma_f32_16x16x32_bf16 v[164:167], v[100:103], v[72:75], v[164:167]
    v_mfma_f32_16x16x32_bf16 v[168:171], v[104:107], v[72:75], v[168:171]
    v_mfma_f32_16x16x32_bf16 v[172:175], v[108:111], v[72:75], v[172:175]
    ds_read_b128 v[72:75], v23 offset:36864
    s_add_u32 m0, s42, 147456
    s_mov_b32 s47, 2883584
    buffer_load_dwordx4 v6, s[20:23], s47 offen lds
    s_add_u32 m0, s42, 148480
    v_mfma_f32_16x16x32_bf16 v[176:179], v[96:99], v[76:79], v[176:179]
    v_mfma_f32_16x16x32_bf16 v[180:183], v[100:103], v[76:79], v[180:183]
    v_mfma_f32_16x16x32_bf16 v[184:187], v[104:107], v[76:79], v[184:187]
    v_mfma_f32_16x16x32_bf16 v[188:191], v[108:111], v[76:79], v[188:191]
    ds_read_b128 v[76:79], v23 offset:38912
    s_mov_b32 s47, 2883584
    buffer_load_dwordx4 v7, s[20:23], s47 offen lds
    s_add_u32 m0, s41, 0
    s_mov_b32 s47, 768
    s_waitcnt lgkmcnt(15)
    v_mfma_f32_16x16x32_bf16 v[192:195], v[96:99], v[80:83], v[192:195]
    v_mfma_f32_16x16x32_bf16 v[196:199], v[100:103], v[80:83], v[196:199]
    v_mfma_f32_16x16x32_bf16 v[200:203], v[104:107], v[80:83], v[200:203]
    v_mfma_f32_16x16x32_bf16 v[204:207], v[108:111], v[80:83], v[204:207]
    ds_read_b128 v[80:83], v23 offset:40960
    buffer_load_dwordx4 v5, s[16:19], s47 offen lds
    s_add_u32 m0, s41, 1024
    s_mov_b32 s47, 8960
    buffer_load_dwordx4 v8, s[16:19], s47 offen lds
    s_waitcnt lgkmcnt(15)
    v_mfma_f32_16x16x32_bf16 v[208:211], v[96:99], v[84:87], v[208:211]
    v_mfma_f32_16x16x32_bf16 v[212:215], v[100:103], v[84:87], v[212:215]
    v_mfma_f32_16x16x32_bf16 v[216:219], v[104:107], v[84:87], v[216:219]
    v_mfma_f32_16x16x32_bf16 v[220:223], v[108:111], v[84:87], v[220:223]
    ds_read_b128 v[84:87], v23 offset:43008
    s_add_u32 m0, s41, 2048
    s_mov_b32 s47, 17152
    buffer_load_dwordx4 v5, s[16:19], s47 offen lds
    s_add_u32 m0, s41, 3072
    s_waitcnt lgkmcnt(15)
    v_mfma_f32_16x16x32_bf16 v[224:227], v[96:99], v[88:91], v[224:227]
    v_mfma_f32_16x16x32_bf16 v[228:231], v[100:103], v[88:91], v[228:231]
    v_mfma_f32_16x16x32_bf16 v[232:235], v[104:107], v[88:91], v[232:235]
    v_mfma_f32_16x16x32_bf16 v[236:239], v[108:111], v[88:91], v[236:239]
    ds_read_b128 v[88:91], v23 offset:45056
    s_mov_b32 s47, 25344
    buffer_load_dwordx4 v8, s[16:19], s47 offen lds
    s_waitcnt lgkmcnt(15)
    v_mfma_f32_16x16x32_bf16 v[240:243], v[96:99], v[92:95], v[240:243]
    v_mfma_f32_16x16x32_bf16 v[244:247], v[100:103], v[92:95], v[244:247]
    v_mfma_f32_16x16x32_bf16 v[248:251], v[104:107], v[92:95], v[248:251]
    v_mfma_f32_16x16x32_bf16 v[252:255], v[108:111], v[92:95], v[252:255]
    ds_read_b128 v[92:95], v23 offset:47104
    s_waitcnt vmcnt(6)
    s_barrier
    s_waitcnt lgkmcnt(13)
    v_mfma_f32_16x16x32_bf16 v[128:131], v[112:115], v[64:67], v[128:131]
    s_waitcnt lgkmcnt(11)
    v_mfma_f32_16x16x32_bf16 v[132:135], v[116:119], v[64:67], v[132:135]
    s_waitcnt lgkmcnt(8)
    v_mfma_f32_16x16x32_bf16 v[136:139], v[120:123], v[64:67], v[136:139]
    s_waitcnt lgkmcnt(6)
    v_mfma_f32_16x16x32_bf16 v[140:143], v[124:127], v[64:67], v[140:143]
    ds_read_b128 v[64:67], v29 offset:0
    ds_read_b64_tr_b16 v[96:97], v25 offset:32768
    ds_read_b64_tr_b16 v[98:99], v25 offset:34816
    v_mfma_f32_16x16x32_bf16 v[144:147], v[112:115], v[68:71], v[144:147]
    v_mfma_f32_16x16x32_bf16 v[148:151], v[116:119], v[68:71], v[148:151]
    v_mfma_f32_16x16x32_bf16 v[152:155], v[120:123], v[68:71], v[152:155]
    v_mfma_f32_16x16x32_bf16 v[156:159], v[124:127], v[68:71], v[156:159]
    ds_read_b128 v[68:71], v29 offset:2048
    ds_read_b64_tr_b16 v[100:101], v26 offset:32768
    ds_read_b64_tr_b16 v[102:103], v26 offset:34816
    s_waitcnt lgkmcnt(11)
    v_mfma_f32_16x16x32_bf16 v[160:163], v[112:115], v[72:75], v[160:163]
    v_mfma_f32_16x16x32_bf16 v[164:167], v[116:119], v[72:75], v[164:167]
    v_mfma_f32_16x16x32_bf16 v[168:171], v[120:123], v[72:75], v[168:171]
    v_mfma_f32_16x16x32_bf16 v[172:175], v[124:127], v[72:75], v[172:175]
    ds_read_b128 v[72:75], v29 offset:4096
    ds_read_b64_tr_b16 v[104:105], v27 offset:32768
    ds_read_b64_tr_b16 v[106:107], v27 offset:34816
    s_waitcnt lgkmcnt(13)
    v_mfma_f32_16x16x32_bf16 v[176:179], v[112:115], v[76:79], v[176:179]
    v_mfma_f32_16x16x32_bf16 v[180:183], v[116:119], v[76:79], v[180:183]
    v_mfma_f32_16x16x32_bf16 v[184:187], v[120:123], v[76:79], v[184:187]
    v_mfma_f32_16x16x32_bf16 v[188:191], v[124:127], v[76:79], v[188:191]
    ds_read_b128 v[76:79], v29 offset:6144
    ds_read_b64_tr_b16 v[108:109], v28 offset:32768
    ds_read_b64_tr_b16 v[110:111], v28 offset:34816
    s_waitcnt lgkmcnt(15)
    v_mfma_f32_16x16x32_bf16 v[192:195], v[112:115], v[80:83], v[192:195]
    v_mfma_f32_16x16x32_bf16 v[196:199], v[116:119], v[80:83], v[196:199]
    v_mfma_f32_16x16x32_bf16 v[200:203], v[120:123], v[80:83], v[200:203]
    v_mfma_f32_16x16x32_bf16 v[204:207], v[124:127], v[80:83], v[204:207]
    ds_read_b128 v[80:83], v29 offset:8192
    s_add_u32 m0, s42, 98304
    s_mov_b32 s47, 3145728
    s_waitcnt lgkmcnt(15)
    v_mfma_f32_16x16x32_bf16 v[208:211], v[112:115], v[84:87], v[208:211]
    v_mfma_f32_16x16x32_bf16 v[212:215], v[116:119], v[84:87], v[212:215]
    v_mfma_f32_16x16x32_bf16 v[216:219], v[120:123], v[84:87], v[216:219]
    v_mfma_f32_16x16x32_bf16 v[220:223], v[124:127], v[84:87], v[220:223]
    ds_read_b128 v[84:87], v29 offset:10240
    buffer_load_dwordx4 v6, s[20:23], s47 offen lds
    s_add_u32 m0, s42, 99328
    s_waitcnt lgkmcnt(15)
    v_mfma_f32_16x16x32_bf16 v[224:227], v[112:115], v[88:91], v[224:227]
    v_mfma_f32_16x16x32_bf16 v[228:231], v[116:119], v[88:91], v[228:231]
    v_mfma_f32_16x16x32_bf16 v[232:235], v[120:123], v[88:91], v[232:235]
    v_mfma_f32_16x16x32_bf16 v[236:239], v[124:127], v[88:91], v[236:239]
    ds_read_b128 v[88:91], v29 offset:12288
    s_mov_b32 s47, 3145728
    buffer_load_dwordx4 v7, s[20:23], s47 offen lds
    s_waitcnt lgkmcnt(15)
    v_mfma_f32_16x16x32_bf16 v[240:243], v[112:115], v[92:95], v[240:243]
    v_mfma_f32_16x16x32_bf16 v[244:247], v[116:119], v[92:95], v[244:247]
    v_mfma_f32_16x16x32_bf16 v[248:251], v[120:123], v[92:95], v[248:251]
    v_mfma_f32_16x16x32_bf16 v[252:255], v[124:127], v[92:95], v[252:255]
    ds_read_b128 v[92:95], v29 offset:14336
    s_waitcnt vmcnt(6)
    s_barrier
    s_waitcnt lgkmcnt(13)
    v_mfma_f32_16x16x32_bf16 v[128:131], v[96:99], v[64:67], v[128:131]
    s_waitcnt lgkmcnt(10)
    v_mfma_f32_16x16x32_bf16 v[132:135], v[100:103], v[64:67], v[132:135]
    s_waitcnt lgkmcnt(7)
    v_mfma_f32_16x16x32_bf16 v[136:139], v[104:107], v[64:67], v[136:139]
    s_waitcnt lgkmcnt(4)
    v_mfma_f32_16x16x32_bf16 v[140:143], v[108:111], v[64:67], v[140:143]
    ds_read_b128 v[64:67], v31 offset:0
    ds_read_b64_tr_b16 v[112:113], v25 offset:49152
    ds_read_b64_tr_b16 v[114:115], v25 offset:51200
    ds_read_b64_tr_b16 v[116:117], v26 offset:49152
    ds_read_b64_tr_b16 v[118:119], v26 offset:51200
    v_mfma_f32_16x16x32_bf16 v[144:147], v[96:99], v[68:71], v[144:147]
    v_mfma_f32_16x16x32_bf16 v[148:151], v[100:103], v[68:71], v[148:151]
    v_mfma_f32_16x16x32_bf16 v[152:155], v[104:107], v[68:71], v[152:155]
    v_mfma_f32_16x16x32_bf16 v[156:159], v[108:111], v[68:71], v[156:159]
    ds_read_b128 v[68:71], v31 offset:2048
    ds_read_b64_tr_b16 v[120:121], v27 offset:49152
    ds_read_b64_tr_b16 v[122:123], v27 offset:51200
    ds_read_b64_tr_b16 v[124:125], v28 offset:49152
    ds_read_b64_tr_b16 v[126:127], v28 offset:51200
    v_mfma_f32_16x16x32_bf16 v[160:163], v[96:99], v[72:75], v[160:163]
    v_mfma_f32_16x16x32_bf16 v[164:167], v[100:103], v[72:75], v[164:167]
    v_mfma_f32_16x16x32_bf16 v[168:171], v[104:107], v[72:75], v[168:171]
    v_mfma_f32_16x16x32_bf16 v[172:175], v[108:111], v[72:75], v[172:175]
    ds_read_b128 v[72:75], v31 offset:4096
    s_add_u32 m0, s42, 114688
    s_mov_b32 s47, 3407872
    buffer_load_dwordx4 v6, s[20:23], s47 offen lds
    s_add_u32 m0, s42, 115712
    v_mfma_f32_16x16x32_bf16 v[176:179], v[96:99], v[76:79], v[176:179]
    v_mfma_f32_16x16x32_bf16 v[180:183], v[100:103], v[76:79], v[180:183]
    v_mfma_f32_16x16x32_bf16 v[184:187], v[104:107], v[76:79], v[184:187]
    v_mfma_f32_16x16x32_bf16 v[188:191], v[108:111], v[76:79], v[188:191]
    ds_read_b128 v[76:79], v31 offset:6144
    s_mov_b32 s47, 3407872
    buffer_load_dwordx4 v7, s[20:23], s47 offen lds
    s_add_u32 m0, s41, 32768
    s_mov_b32 s47, 896
    s_waitcnt lgkmcnt(15)
    v_mfma_f32_16x16x32_bf16 v[192:195], v[96:99], v[80:83], v[192:195]
    v_mfma_f32_16x16x32_bf16 v[196:199], v[100:103], v[80:83], v[196:199]
    v_mfma_f32_16x16x32_bf16 v[200:203], v[104:107], v[80:83], v[200:203]
    v_mfma_f32_16x16x32_bf16 v[204:207], v[108:111], v[80:83], v[204:207]
    ds_read_b128 v[80:83], v31 offset:8192
    buffer_load_dwordx4 v5, s[16:19], s47 offen lds
    s_add_u32 m0, s41, 33792
    s_mov_b32 s47, 9088
    buffer_load_dwordx4 v8, s[16:19], s47 offen lds
    s_waitcnt lgkmcnt(15)
    v_mfma_f32_16x16x32_bf16 v[208:211], v[96:99], v[84:87], v[208:211]
    v_mfma_f32_16x16x32_bf16 v[212:215], v[100:103], v[84:87], v[212:215]
    v_mfma_f32_16x16x32_bf16 v[216:219], v[104:107], v[84:87], v[216:219]
    v_mfma_f32_16x16x32_bf16 v[220:223], v[108:111], v[84:87], v[220:223]
    ds_read_b128 v[84:87], v31 offset:10240
    s_add_u32 m0, s41, 34816
    s_mov_b32 s47, 17280
    buffer_load_dwordx4 v5, s[16:19], s47 offen lds
    s_add_u32 m0, s41, 35840
    s_waitcnt lgkmcnt(15)
    v_mfma_f32_16x16x32_bf16 v[224:227], v[96:99], v[88:91], v[224:227]
    v_mfma_f32_16x16x32_bf16 v[228:231], v[100:103], v[88:91], v[228:231]
    v_mfma_f32_16x16x32_bf16 v[232:235], v[104:107], v[88:91], v[232:235]
    v_mfma_f32_16x16x32_bf16 v[236:239], v[108:111], v[88:91], v[236:239]
    ds_read_b128 v[88:91], v31 offset:12288
    s_mov_b32 s47, 25472
    buffer_load_dwordx4 v8, s[16:19], s47 offen lds
    s_waitcnt lgkmcnt(15)
    v_mfma_f32_16x16x32_bf16 v[240:243], v[96:99], v[92:95], v[240:243]
    v_mfma_f32_16x16x32_bf16 v[244:247], v[100:103], v[92:95], v[244:247]
    v_mfma_f32_16x16x32_bf16 v[248:251], v[104:107], v[92:95], v[248:251]
    v_mfma_f32_16x16x32_bf16 v[252:255], v[108:111], v[92:95], v[252:255]
    ds_read_b128 v[92:95], v31 offset:14336
    s_waitcnt vmcnt(6)
    s_barrier
    s_waitcnt lgkmcnt(13)
    v_mfma_f32_16x16x32_bf16 v[128:131], v[112:115], v[64:67], v[128:131]
    s_waitcnt lgkmcnt(11)
    v_mfma_f32_16x16x32_bf16 v[132:135], v[116:119], v[64:67], v[132:135]
    s_waitcnt lgkmcnt(8)
    v_mfma_f32_16x16x32_bf16 v[136:139], v[120:123], v[64:67], v[136:139]
    s_waitcnt lgkmcnt(6)
    v_mfma_f32_16x16x32_bf16 v[140:143], v[124:127], v[64:67], v[140:143]
    ds_read_b128 v[64:67], v9 offset:0
    ds_read_b64_tr_b16 v[96:97], v25 offset:0
    ds_read_b64_tr_b16 v[98:99], v25 offset:2048
    v_mfma_f32_16x16x32_bf16 v[144:147], v[112:115], v[68:71], v[144:147]
    v_mfma_f32_16x16x32_bf16 v[148:151], v[116:119], v[68:71], v[148:151]
    v_mfma_f32_16x16x32_bf16 v[152:155], v[120:123], v[68:71], v[152:155]
    v_mfma_f32_16x16x32_bf16 v[156:159], v[124:127], v[68:71], v[156:159]
    ds_read_b128 v[68:71], v9 offset:2048
    ds_read_b64_tr_b16 v[100:101], v26 offset:0
    ds_read_b64_tr_b16 v[102:103], v26 offset:2048
    s_waitcnt lgkmcnt(11)
    v_mfma_f32_16x16x32_bf16 v[160:163], v[112:115], v[72:75], v[160:163]
    v_mfma_f32_16x16x32_bf16 v[164:167], v[116:119], v[72:75], v[164:167]
    v_mfma_f32_16x16x32_bf16 v[168:171], v[120:123], v[72:75], v[168:171]
    v_mfma_f32_16x16x32_bf16 v[172:175], v[124:127], v[72:75], v[172:175]
    ds_read_b128 v[72:75], v9 offset:4096
    ds_read_b64_tr_b16 v[104:105], v27 offset:0
    ds_read_b64_tr_b16 v[106:107], v27 offset:2048
    s_waitcnt lgkmcnt(13)
    v_mfma_f32_16x16x32_bf16 v[176:179], v[112:115], v[76:79], v[176:179]
    v_mfma_f32_16x16x32_bf16 v[180:183], v[116:119], v[76:79], v[180:183]
    v_mfma_f32_16x16x32_bf16 v[184:187], v[120:123], v[76:79], v[184:187]
    v_mfma_f32_16x16x32_bf16 v[188:191], v[124:127], v[76:79], v[188:191]
    ds_read_b128 v[76:79], v9 offset:6144
    ds_read_b64_tr_b16 v[108:109], v28 offset:0
    ds_read_b64_tr_b16 v[110:111], v28 offset:2048
    s_waitcnt lgkmcnt(15)
    v_mfma_f32_16x16x32_bf16 v[192:195], v[112:115], v[80:83], v[192:195]
    v_mfma_f32_16x16x32_bf16 v[196:199], v[116:119], v[80:83], v[196:199]
    v_mfma_f32_16x16x32_bf16 v[200:203], v[120:123], v[80:83], v[200:203]
    v_mfma_f32_16x16x32_bf16 v[204:207], v[124:127], v[80:83], v[204:207]
    ds_read_b128 v[80:83], v9 offset:8192
    s_add_u32 m0, s42, 131072
    s_mov_b32 s47, 3670016
    s_waitcnt lgkmcnt(15)
    v_mfma_f32_16x16x32_bf16 v[208:211], v[112:115], v[84:87], v[208:211]
    v_mfma_f32_16x16x32_bf16 v[212:215], v[116:119], v[84:87], v[212:215]
    v_mfma_f32_16x16x32_bf16 v[216:219], v[120:123], v[84:87], v[216:219]
    v_mfma_f32_16x16x32_bf16 v[220:223], v[124:127], v[84:87], v[220:223]
    ds_read_b128 v[84:87], v9 offset:10240
    buffer_load_dwordx4 v6, s[20:23], s47 offen lds
    s_add_u32 m0, s42, 132096
    s_waitcnt lgkmcnt(15)
    v_mfma_f32_16x16x32_bf16 v[224:227], v[112:115], v[88:91], v[224:227]
    v_mfma_f32_16x16x32_bf16 v[228:231], v[116:119], v[88:91], v[228:231]
    v_mfma_f32_16x16x32_bf16 v[232:235], v[120:123], v[88:91], v[232:235]
    v_mfma_f32_16x16x32_bf16 v[236:239], v[124:127], v[88:91], v[236:239]
    ds_read_b128 v[88:91], v9 offset:12288
    s_mov_b32 s47, 3670016
    buffer_load_dwordx4 v7, s[20:23], s47 offen lds
    s_waitcnt lgkmcnt(15)
    v_mfma_f32_16x16x32_bf16 v[240:243], v[112:115], v[92:95], v[240:243]
    v_mfma_f32_16x16x32_bf16 v[244:247], v[116:119], v[92:95], v[244:247]
    v_mfma_f32_16x16x32_bf16 v[248:251], v[120:123], v[92:95], v[248:251]
    v_mfma_f32_16x16x32_bf16 v[252:255], v[124:127], v[92:95], v[252:255]
    ds_read_b128 v[92:95], v9 offset:14336
    s_waitcnt vmcnt(6)
    s_barrier
    s_waitcnt lgkmcnt(13)
    v_mfma_f32_16x16x32_bf16 v[128:131], v[96:99], v[64:67], v[128:131]
    s_waitcnt lgkmcnt(10)
    v_mfma_f32_16x16x32_bf16 v[132:135], v[100:103], v[64:67], v[132:135]
    s_waitcnt lgkmcnt(7)
    v_mfma_f32_16x16x32_bf16 v[136:139], v[104:107], v[64:67], v[136:139]
    s_waitcnt lgkmcnt(4)
    v_mfma_f32_16x16x32_bf16 v[140:143], v[108:111], v[64:67], v[140:143]
    ds_read_b128 v[64:67], v23 offset:0
    ds_read_b64_tr_b16 v[112:113], v25 offset:16384
    ds_read_b64_tr_b16 v[114:115], v25 offset:18432
    v_mfma_f32_16x16x32_bf16 v[144:147], v[96:99], v[68:71], v[144:147]
    v_mfma_f32_16x16x32_bf16 v[148:151], v[100:103], v[68:71], v[148:151]
    v_mfma_f32_16x16x32_bf16 v[152:155], v[104:107], v[68:71], v[152:155]
    v_mfma_f32_16x16x32_bf16 v[156:159], v[108:111], v[68:71], v[156:159]
    ds_read_b128 v[68:71], v23 offset:2048
    ds_read_b64_tr_b16 v[116:117], v26 offset:16384
    ds_read_b64_tr_b16 v[118:119], v26 offset:18432
    v_mfma_f32_16x16x32_bf16 v[160:163], v[96:99], v[72:75], v[160:163]
    v_mfma_f32_16x16x32_bf16 v[164:167], v[100:103], v[72:75], v[164:167]
    v_mfma_f32_16x16x32_bf16 v[168:171], v[104:107], v[72:75], v[168:171]
    v_mfma_f32_16x16x32_bf16 v[172:175], v[108:111], v[72:75], v[172:175]
    ds_read_b128 v[72:75], v23 offset:4096
    ds_read_b64_tr_b16 v[120:121], v27 offset:16384
    ds_read_b64_tr_b16 v[122:123], v27 offset:18432
    v_mfma_f32_16x16x32_bf16 v[176:179], v[96:99], v[76:79], v[176:179]
    v_mfma_f32_16x16x32_bf16 v[180:183], v[100:103], v[76:79], v[180:183]
    v_mfma_f32_16x16x32_bf16 v[184:187], v[104:107], v[76:79], v[184:187]
    v_mfma_f32_16x16x32_bf16 v[188:191], v[108:111], v[76:79], v[188:191]
    ds_read_b128 v[76:79], v23 offset:6144
    ds_read_b64_tr_b16 v[124:125], v28 offset:16384
    ds_read_b64_tr_b16 v[126:127], v28 offset:18432
    s_waitcnt lgkmcnt(15)
    v_mfma_f32_16x16x32_bf16 v[192:195], v[96:99], v[80:83], v[192:195]
    v_mfma_f32_16x16x32_bf16 v[196:199], v[100:103], v[80:83], v[196:199]
    v_mfma_f32_16x16x32_bf16 v[200:203], v[104:107], v[80:83], v[200:203]
    v_mfma_f32_16x16x32_bf16 v[204:207], v[108:111], v[80:83], v[204:207]
    ds_read_b128 v[80:83], v23 offset:8192
    s_add_u32 m0, s42, 147456
    s_mov_b32 s47, 3932160
    s_waitcnt lgkmcnt(15)
    v_mfma_f32_16x16x32_bf16 v[208:211], v[96:99], v[84:87], v[208:211]
    v_mfma_f32_16x16x32_bf16 v[212:215], v[100:103], v[84:87], v[212:215]
    v_mfma_f32_16x16x32_bf16 v[216:219], v[104:107], v[84:87], v[216:219]
    v_mfma_f32_16x16x32_bf16 v[220:223], v[108:111], v[84:87], v[220:223]
    ds_read_b128 v[84:87], v23 offset:10240
    buffer_load_dwordx4 v6, s[20:23], s47 offen lds
    s_add_u32 m0, s42, 148480
    s_waitcnt lgkmcnt(15)
    v_mfma_f32_16x16x32_bf16 v[224:227], v[96:99], v[88:91], v[224:227]
    v_mfma_f32_16x16x32_bf16 v[228:231], v[100:103], v[88:91], v[228:231]
    v_mfma_f32_16x16x32_bf16 v[232:235], v[104:107], v[88:91], v[232:235]
    v_mfma_f32_16x16x32_bf16 v[236:239], v[108:111], v[88:91], v[236:239]
    ds_read_b128 v[88:91], v23 offset:12288
    s_mov_b32 s47, 3932160
    buffer_load_dwordx4 v7, s[20:23], s47 offen lds
    s_waitcnt lgkmcnt(15)
    v_mfma_f32_16x16x32_bf16 v[240:243], v[96:99], v[92:95], v[240:243]
    v_mfma_f32_16x16x32_bf16 v[244:247], v[100:103], v[92:95], v[244:247]
    v_mfma_f32_16x16x32_bf16 v[248:251], v[104:107], v[92:95], v[248:251]
    v_mfma_f32_16x16x32_bf16 v[252:255], v[108:111], v[92:95], v[252:255]
    ds_read_b128 v[92:95], v23 offset:14336
    s_waitcnt vmcnt(2)
    s_barrier
    s_waitcnt lgkmcnt(13)
    v_mfma_f32_16x16x32_bf16 v[128:131], v[112:115], v[64:67], v[128:131]
    s_waitcnt lgkmcnt(10)
    v_mfma_f32_16x16x32_bf16 v[132:135], v[116:119], v[64:67], v[132:135]
    s_waitcnt lgkmcnt(7)
    v_mfma_f32_16x16x32_bf16 v[136:139], v[120:123], v[64:67], v[136:139]
    s_waitcnt lgkmcnt(4)
    v_mfma_f32_16x16x32_bf16 v[140:143], v[124:127], v[64:67], v[140:143]
    ds_read_b128 v[64:67], v9 offset:32768
    ds_read_b64_tr_b16 v[96:97], v25 offset:32768
    v_mfma_f32_16x16x32_bf16 v[144:147], v[112:115], v[68:71], v[144:147]
    v_mfma_f32_16x16x32_bf16 v[148:151], v[116:119], v[68:71], v[148:151]
    v_mfma_f32_16x16x32_bf16 v[152:155], v[120:123], v[68:71], v[152:155]
    v_mfma_f32_16x16x32_bf16 v[156:159], v[124:127], v[68:71], v[156:159]
    ds_read_b128 v[68:71], v9 offset:34816
    ds_read_b64_tr_b16 v[98:99], v25 offset:34816
    v_mfma_f32_16x16x32_bf16 v[160:163], v[112:115], v[72:75], v[160:163]
    v_mfma_f32_16x16x32_bf16 v[164:167], v[116:119], v[72:75], v[164:167]
    v_mfma_f32_16x16x32_bf16 v[168:171], v[120:123], v[72:75], v[168:171]
    v_mfma_f32_16x16x32_bf16 v[172:175], v[124:127], v[72:75], v[172:175]
    ds_read_b128 v[72:75], v9 offset:36864
    ds_read_b64_tr_b16 v[100:101], v26 offset:32768
    v_mfma_f32_16x16x32_bf16 v[176:179], v[112:115], v[76:79], v[176:179]
    v_mfma_f32_16x16x32_bf16 v[180:183], v[116:119], v[76:79], v[180:183]
    v_mfma_f32_16x16x32_bf16 v[184:187], v[120:123], v[76:79], v[184:187]
    v_mfma_f32_16x16x32_bf16 v[188:191], v[124:127], v[76:79], v[188:191]
    ds_read_b128 v[76:79], v9 offset:38912
    ds_read_b64_tr_b16 v[102:103], v26 offset:34816
    s_waitcnt lgkmcnt(11)
    v_mfma_f32_16x16x32_bf16 v[192:195], v[112:115], v[80:83], v[192:195]
    v_mfma_f32_16x16x32_bf16 v[196:199], v[116:119], v[80:83], v[196:199]
    v_mfma_f32_16x16x32_bf16 v[200:203], v[120:123], v[80:83], v[200:203]
    v_mfma_f32_16x16x32_bf16 v[204:207], v[124:127], v[80:83], v[204:207]
    ds_read_b128 v[80:83], v9 offset:40960
    ds_read_b64_tr_b16 v[104:105], v27 offset:32768
    s_waitcnt lgkmcnt(12)
    v_mfma_f32_16x16x32_bf16 v[208:211], v[112:115], v[84:87], v[208:211]
    v_mfma_f32_16x16x32_bf16 v[212:215], v[116:119], v[84:87], v[212:215]
    v_mfma_f32_16x16x32_bf16 v[216:219], v[120:123], v[84:87], v[216:219]
    v_mfma_f32_16x16x32_bf16 v[220:223], v[124:127], v[84:87], v[220:223]
    ds_read_b128 v[84:87], v9 offset:43008
    ds_read_b64_tr_b16 v[106:107], v27 offset:34816
    s_waitcnt lgkmcnt(13)
    v_mfma_f32_16x16x32_bf16 v[224:227], v[112:115], v[88:91], v[224:227]
    v_mfma_f32_16x16x32_bf16 v[228:231], v[116:119], v[88:91], v[228:231]
    v_mfma_f32_16x16x32_bf16 v[232:235], v[120:123], v[88:91], v[232:235]
    v_mfma_f32_16x16x32_bf16 v[236:239], v[124:127], v[88:91], v[236:239]
    ds_read_b128 v[88:91], v9 offset:45056
    ds_read_b64_tr_b16 v[108:109], v28 offset:32768
    s_waitcnt lgkmcnt(14)
    v_mfma_f32_16x16x32_bf16 v[240:243], v[112:115], v[92:95], v[240:243]
    v_mfma_f32_16x16x32_bf16 v[244:247], v[116:119], v[92:95], v[244:247]
    v_mfma_f32_16x16x32_bf16 v[248:251], v[120:123], v[92:95], v[248:251]
    v_mfma_f32_16x16x32_bf16 v[252:255], v[124:127], v[92:95], v[252:255]
    ds_read_b128 v[92:95], v9 offset:47104
    ds_read_b64_tr_b16 v[110:111], v28 offset:34816
    s_waitcnt vmcnt(0)
    s_barrier
    s_waitcnt lgkmcnt(12)
    v_mfma_f32_16x16x32_bf16 v[128:131], v[96:99], v[64:67], v[128:131]
    s_waitcnt lgkmcnt(8)
    v_mfma_f32_16x16x32_bf16 v[132:135], v[100:103], v[64:67], v[132:135]
    s_waitcnt lgkmcnt(4)
    v_mfma_f32_16x16x32_bf16 v[136:139], v[104:107], v[64:67], v[136:139]
    s_waitcnt lgkmcnt(0)
    v_mfma_f32_16x16x32_bf16 v[140:143], v[108:111], v[64:67], v[140:143]
    ds_read_b128 v[64:67], v23 offset:32768
    ds_read_b64_tr_b16 v[112:113], v25 offset:49152
    v_mfma_f32_16x16x32_bf16 v[144:147], v[96:99], v[68:71], v[144:147]
    v_mfma_f32_16x16x32_bf16 v[148:151], v[100:103], v[68:71], v[148:151]
    v_mfma_f32_16x16x32_bf16 v[152:155], v[104:107], v[68:71], v[152:155]
    v_mfma_f32_16x16x32_bf16 v[156:159], v[108:111], v[68:71], v[156:159]
    ds_read_b128 v[68:71], v23 offset:34816
    ds_read_b64_tr_b16 v[114:115], v25 offset:51200
    v_mfma_f32_16x16x32_bf16 v[160:163], v[96:99], v[72:75], v[160:163]
    v_mfma_f32_16x16x32_bf16 v[164:167], v[100:103], v[72:75], v[164:167]
    v_mfma_f32_16x16x32_bf16 v[168:171], v[104:107], v[72:75], v[168:171]
    v_mfma_f32_16x16x32_bf16 v[172:175], v[108:111], v[72:75], v[172:175]
    ds_read_b128 v[72:75], v23 offset:36864
    ds_read_b64_tr_b16 v[116:117], v26 offset:49152
    v_mfma_f32_16x16x32_bf16 v[176:179], v[96:99], v[76:79], v[176:179]
    v_mfma_f32_16x16x32_bf16 v[180:183], v[100:103], v[76:79], v[180:183]
    v_mfma_f32_16x16x32_bf16 v[184:187], v[104:107], v[76:79], v[184:187]
    v_mfma_f32_16x16x32_bf16 v[188:191], v[108:111], v[76:79], v[188:191]
    ds_read_b128 v[76:79], v23 offset:38912
    ds_read_b64_tr_b16 v[118:119], v26 offset:51200
    v_mfma_f32_16x16x32_bf16 v[192:195], v[96:99], v[80:83], v[192:195]
    v_mfma_f32_16x16x32_bf16 v[196:199], v[100:103], v[80:83], v[196:199]
    v_mfma_f32_16x16x32_bf16 v[200:203], v[104:107], v[80:83], v[200:203]
    v_mfma_f32_16x16x32_bf16 v[204:207], v[108:111], v[80:83], v[204:207]
    ds_read_b128 v[80:83], v23 offset:40960
    ds_read_b64_tr_b16 v[120:121], v27 offset:49152
    v_mfma_f32_16x16x32_bf16 v[208:211], v[96:99], v[84:87], v[208:211]
    v_mfma_f32_16x16x32_bf16 v[212:215], v[100:103], v[84:87], v[212:215]
    v_mfma_f32_16x16x32_bf16 v[216:219], v[104:107], v[84:87], v[216:219]
    v_mfma_f32_16x16x32_bf16 v[220:223], v[108:111], v[84:87], v[220:223]
    ds_read_b128 v[84:87], v23 offset:43008
    ds_read_b64_tr_b16 v[122:123], v27 offset:51200
    v_mfma_f32_16x16x32_bf16 v[224:227], v[96:99], v[88:91], v[224:227]
    v_mfma_f32_16x16x32_bf16 v[228:231], v[100:103], v[88:91], v[228:231]
    v_mfma_f32_16x16x32_bf16 v[232:235], v[104:107], v[88:91], v[232:235]
    v_mfma_f32_16x16x32_bf16 v[236:239], v[108:111], v[88:91], v[236:239]
    ds_read_b128 v[88:91], v23 offset:45056
    ds_read_b64_tr_b16 v[124:125], v28 offset:49152
    v_mfma_f32_16x16x32_bf16 v[240:243], v[96:99], v[92:95], v[240:243]
    v_mfma_f32_16x16x32_bf16 v[244:247], v[100:103], v[92:95], v[244:247]
    v_mfma_f32_16x16x32_bf16 v[248:251], v[104:107], v[92:95], v[248:251]
    v_mfma_f32_16x16x32_bf16 v[252:255], v[108:111], v[92:95], v[252:255]
    ds_read_b128 v[92:95], v23 offset:47104
    ds_read_b64_tr_b16 v[126:127], v28 offset:51200
    s_waitcnt lgkmcnt(12)
    v_mfma_f32_16x16x32_bf16 v[128:131], v[112:115], v[64:67], v[128:131]
    s_waitcnt lgkmcnt(8)
    v_mfma_f32_16x16x32_bf16 v[132:135], v[116:119], v[64:67], v[132:135]
    s_waitcnt lgkmcnt(4)
    v_mfma_f32_16x16x32_bf16 v[136:139], v[120:123], v[64:67], v[136:139]
    s_waitcnt lgkmcnt(0)
    v_mfma_f32_16x16x32_bf16 v[140:143], v[124:127], v[64:67], v[140:143]
    v_mfma_f32_16x16x32_bf16 v[144:147], v[112:115], v[68:71], v[144:147]
    v_mfma_f32_16x16x32_bf16 v[148:151], v[116:119], v[68:71], v[148:151]
    v_mfma_f32_16x16x32_bf16 v[152:155], v[120:123], v[68:71], v[152:155]
    v_mfma_f32_16x16x32_bf16 v[156:159], v[124:127], v[68:71], v[156:159]
    v_mfma_f32_16x16x32_bf16 v[160:163], v[112:115], v[72:75], v[160:163]
    v_mfma_f32_16x16x32_bf16 v[164:167], v[116:119], v[72:75], v[164:167]
    v_mfma_f32_16x16x32_bf16 v[168:171], v[120:123], v[72:75], v[168:171]
    v_mfma_f32_16x16x32_bf16 v[172:175], v[124:127], v[72:75], v[172:175]
    v_mfma_f32_16x16x32_bf16 v[176:179], v[112:115], v[76:79], v[176:179]
    v_mfma_f32_16x16x32_bf16 v[180:183], v[116:119], v[76:79], v[180:183]
    v_mfma_f32_16x16x32_bf16 v[184:187], v[120:123], v[76:79], v[184:187]
    v_mfma_f32_16x16x32_bf16 v[188:191], v[124:127], v[76:79], v[188:191]
    v_mfma_f32_16x16x32_bf16 v[192:195], v[112:115], v[80:83], v[192:195]
    v_mfma_f32_16x16x32_bf16 v[196:199], v[116:119], v[80:83], v[196:199]
    v_mfma_f32_16x16x32_bf16 v[200:203], v[120:123], v[80:83], v[200:203]
    v_mfma_f32_16x16x32_bf16 v[204:207], v[124:127], v[80:83], v[204:207]
    v_mfma_f32_16x16x32_bf16 v[208:211], v[112:115], v[84:87], v[208:211]
    v_mfma_f32_16x16x32_bf16 v[212:215], v[116:119], v[84:87], v[212:215]
    v_mfma_f32_16x16x32_bf16 v[216:219], v[120:123], v[84:87], v[216:219]
    v_mfma_f32_16x16x32_bf16 v[220:223], v[124:127], v[84:87], v[220:223]
    v_mfma_f32_16x16x32_bf16 v[224:227], v[112:115], v[88:91], v[224:227]
    v_mfma_f32_16x16x32_bf16 v[228:231], v[116:119], v[88:91], v[228:231]
    v_mfma_f32_16x16x32_bf16 v[232:235], v[120:123], v[88:91], v[232:235]
    v_mfma_f32_16x16x32_bf16 v[236:239], v[124:127], v[88:91], v[236:239]
    v_mfma_f32_16x16x32_bf16 v[240:243], v[112:115], v[92:95], v[240:243]
    v_mfma_f32_16x16x32_bf16 v[244:247], v[116:119], v[92:95], v[244:247]
    v_mfma_f32_16x16x32_bf16 v[248:251], v[120:123], v[92:95], v[248:251]
    v_mfma_f32_16x16x32_bf16 v[252:255], v[124:127], v[92:95], v[252:255]
    s_lshl_b32 s45, s43, 1
    s_lshr_b32 s46, s40, 1
    s_add_u32 s45, s45, s46
    s_lshl_b32 s45, s45, 19
    s_lshl_b32 s46, s37, 3
    s_lshl_b32 s48, s39, 2
    s_add_u32 s46, s46, s48
    s_lshl_b32 s46, s46, 13
    s_add_u32 s45, s45, s46
    s_and_b32 s46, s40, 1
    s_lshl_b32 s46, s46, 12
    s_add_u32 s49, s45, s46
    v_cvt_pk_bf16_f32 v64, v128, v129
    v_cvt_pk_bf16_f32 v65, v130, v131
    v_cvt_pk_bf16_f32 v66, v132, v133
    v_cvt_pk_bf16_f32 v67, v134, v135
    s_add_u32 s48, s49, 0
    buffer_store_dwordx4 v[64:67], v11, s[24:27], s48 offen offset:0
    v_cvt_pk_bf16_f32 v68, v136, v137
    v_cvt_pk_bf16_f32 v69, v138, v139
    v_cvt_pk_bf16_f32 v70, v140, v141
    v_cvt_pk_bf16_f32 v71, v142, v143
    s_add_u32 s48, s49, 2048
    buffer_store_dwordx4 v[68:71], v11, s[24:27], s48 offen offset:0
    v_cvt_pk_bf16_f32 v72, v144, v145
    v_cvt_pk_bf16_f32 v73, v146, v147
    v_cvt_pk_bf16_f32 v74, v148, v149
    v_cvt_pk_bf16_f32 v75, v150, v151
    s_add_u32 s48, s49, 0
    buffer_store_dwordx4 v[72:75], v11, s[24:27], s48 offen offset:256
    v_cvt_pk_bf16_f32 v76, v152, v153
    v_cvt_pk_bf16_f32 v77, v154, v155
    v_cvt_pk_bf16_f32 v78, v156, v157
    v_cvt_pk_bf16_f32 v79, v158, v159
    s_add_u32 s48, s49, 2048
    buffer_store_dwordx4 v[76:79], v11, s[24:27], s48 offen offset:256
    v_cvt_pk_bf16_f32 v80, v160, v161
    v_cvt_pk_bf16_f32 v81, v162, v163
    v_cvt_pk_bf16_f32 v82, v164, v165
    v_cvt_pk_bf16_f32 v83, v166, v167
    s_add_u32 s48, s49, 8192
    buffer_store_dwordx4 v[80:83], v11, s[24:27], s48 offen offset:0
    v_cvt_pk_bf16_f32 v84, v168, v169
    v_cvt_pk_bf16_f32 v85, v170, v171
    v_cvt_pk_bf16_f32 v86, v172, v173
    v_cvt_pk_bf16_f32 v87, v174, v175
    s_add_u32 s48, s49, 10240
    buffer_store_dwordx4 v[84:87], v11, s[24:27], s48 offen offset:0
    v_cvt_pk_bf16_f32 v88, v176, v177
    v_cvt_pk_bf16_f32 v89, v178, v179
    v_cvt_pk_bf16_f32 v90, v180, v181
    v_cvt_pk_bf16_f32 v91, v182, v183
    s_add_u32 s48, s49, 8192
    buffer_store_dwordx4 v[88:91], v11, s[24:27], s48 offen offset:256
    v_cvt_pk_bf16_f32 v92, v184, v185
    v_cvt_pk_bf16_f32 v93, v186, v187
    v_cvt_pk_bf16_f32 v94, v188, v189
    v_cvt_pk_bf16_f32 v95, v190, v191
    s_add_u32 s48, s49, 10240
    buffer_store_dwordx4 v[92:95], v11, s[24:27], s48 offen offset:256
    v_cvt_pk_bf16_f32 v64, v192, v193
    v_cvt_pk_bf16_f32 v65, v194, v195
    v_cvt_pk_bf16_f32 v66, v196, v197
    v_cvt_pk_bf16_f32 v67, v198, v199
    s_add_u32 s48, s49, 16384
    buffer_store_dwordx4 v[64:67], v11, s[24:27], s48 offen offset:0
    v_cvt_pk_bf16_f32 v68, v200, v201
    v_cvt_pk_bf16_f32 v69, v202, v203
    v_cvt_pk_bf16_f32 v70, v204, v205
    v_cvt_pk_bf16_f32 v71, v206, v207
    s_add_u32 s48, s49, 18432
    buffer_store_dwordx4 v[68:71], v11, s[24:27], s48 offen offset:0
    v_cvt_pk_bf16_f32 v72, v208, v209
    v_cvt_pk_bf16_f32 v73, v210, v211
    v_cvt_pk_bf16_f32 v74, v212, v213
    v_cvt_pk_bf16_f32 v75, v214, v215
    s_add_u32 s48, s49, 16384
    buffer_store_dwordx4 v[72:75], v11, s[24:27], s48 offen offset:256
    v_cvt_pk_bf16_f32 v76, v216, v217
    v_cvt_pk_bf16_f32 v77, v218, v219
    v_cvt_pk_bf16_f32 v78, v220, v221
    v_cvt_pk_bf16_f32 v79, v222, v223
    s_add_u32 s48, s49, 18432
    buffer_store_dwordx4 v[76:79], v11, s[24:27], s48 offen offset:256
    v_cvt_pk_bf16_f32 v80, v224, v225
    v_cvt_pk_bf16_f32 v81, v226, v227
    v_cvt_pk_bf16_f32 v82, v228, v229
    v_cvt_pk_bf16_f32 v83, v230, v231
    s_add_u32 s48, s49, 24576
    buffer_store_dwordx4 v[80:83], v11, s[24:27], s48 offen offset:0
    v_cvt_pk_bf16_f32 v84, v232, v233
    v_cvt_pk_bf16_f32 v85, v234, v235
    v_cvt_pk_bf16_f32 v86, v236, v237
    v_cvt_pk_bf16_f32 v87, v238, v239
    s_add_u32 s48, s49, 26624
    buffer_store_dwordx4 v[84:87], v11, s[24:27], s48 offen offset:0
    v_cvt_pk_bf16_f32 v88, v240, v241
    v_cvt_pk_bf16_f32 v89, v242, v243
    v_cvt_pk_bf16_f32 v90, v244, v245
    v_cvt_pk_bf16_f32 v91, v246, v247
    s_add_u32 s48, s49, 24576
    buffer_store_dwordx4 v[88:91], v11, s[24:27], s48 offen offset:256
    v_cvt_pk_bf16_f32 v92, v248, v249
    v_cvt_pk_bf16_f32 v93, v250, v251
    v_cvt_pk_bf16_f32 v94, v252, v253
    v_cvt_pk_bf16_f32 v95, v254, v255
    s_add_u32 s48, s49, 26624
    buffer_store_dwordx4 v[92:95], v11, s[24:27], s48 offen offset:256
    s_branch K1_LN
K1_VTYPE:
    ds_read_b64_tr_b16 v[96:97], v25 offset:0
    ds_read_b64_tr_b16 v[98:99], v25 offset:2048
    ds_read_b64_tr_b16 v[100:101], v26 offset:0
    ds_read_b64_tr_b16 v[102:103], v26 offset:2048
    ds_read_b64_tr_b16 v[104:105], v27 offset:0
    ds_read_b64_tr_b16 v[106:107], v27 offset:2048
    ds_read_b64_tr_b16 v[108:109], v28 offset:0
    ds_read_b64_tr_b16 v[110:111], v28 offset:2048
    ds_read_b128 v[64:67], v9 offset:0
    ds_read_b128 v[68:71], v10 offset:0
    ds_read_b128 v[72:75], v9 offset:4096
    ds_read_b128 v[76:79], v10 offset:4096
    ds_read_b128 v[80:83], v9 offset:8192
    ds_read_b128 v[84:87], v10 offset:8192
    ds_read_b128 v[88:91], v9 offset:12288
    ds_read_b128 v[92:95], v10 offset:12288
    s_waitcnt vmcnt(6)
    s_barrier
    s_waitcnt lgkmcnt(7)
    v_mfma_f32_16x16x32_bf16 v[128:131], v[64:67], v[96:99], v[128:131]
    v_mfma_f32_16x16x32_bf16 v[132:135], v[64:67], v[100:103], v[132:135]
    v_mfma_f32_16x16x32_bf16 v[136:139], v[64:67], v[104:107], v[136:139]
    v_mfma_f32_16x16x32_bf16 v[140:143], v[64:67], v[108:111], v[140:143]
    ds_read_b128 v[64:67], v23 offset:0
    ds_read_b64_tr_b16 v[112:113], v25 offset:16384
    ds_read_b64_tr_b16 v[114:115], v25 offset:18432
    ds_read_b64_tr_b16 v[116:117], v26 offset:16384
    ds_read_b64_tr_b16 v[118:119], v26 offset:18432
    s_waitcnt lgkmcnt(11)
    v_mfma_f32_16x16x32_bf16 v[144:147], v[68:71], v[96:99], v[144:147]
    v_mfma_f32_16x16x32_bf16 v[148:151], v[68:71], v[100:103], v[148:151]
    v_mfma_f32_16x16x32_bf16 v[152:155], v[68:71], v[104:107], v[152:155]
    v_mfma_f32_16x16x32_bf16 v[156:159], v[68:71], v[108:111], v[156:159]
    ds_read_b128 v[68:71], v24 offset:0
    ds_read_b64_tr_b16 v[120:121], v27 offset:16384
    ds_read_b64_tr_b16 v[122:123], v27 offset:18432
    ds_read_b64_tr_b16 v[124:125], v28 offset:16384
    ds_read_b64_tr_b16 v[126:127], v28 offset:18432
    s_waitcnt lgkmcnt(15)
    v_mfma_f32_16x16x32_bf16 v[160:163], v[72:75], v[96:99], v[160:163]
    v_mfma_f32_16x16x32_bf16 v[164:167], v[72:75], v[100:103], v[164:167]
    v_mfma_f32_16x16x32_bf16 v[168:171], v[72:75], v[104:107], v[168:171]
    v_mfma_f32_16x16x32_bf16 v[172:175], v[72:75], v[108:111], v[172:175]
    ds_read_b128 v[72:75], v23 offset:4096
    s_add_u32 m0, s42, 147456
    s_mov_b32 s47, 786432
    buffer_load_dwordx4 v6, s[20:23], s47 offen lds
    s_add_u32 m0, s42, 148480
    s_waitcnt lgkmcnt(15)
    v_mfma_f32_16x16x32_bf16 v[176:179], v[76:79], v[96:99], v[176:179]
    v_mfma_f32_16x16x32_bf16 v[180:183], v[76:79], v[100:103], v[180:183]
    v_mfma_f32_16x16x32_bf16 v[184:187], v[76:79], v[104:107], v[184:187]
    v_mfma_f32_16x16x32_bf16 v[188:191], v[76:79], v[108:111], v[188:191]
    ds_read_b128 v[76:79], v24 offset:4096
    s_mov_b32 s47, 786432
    buffer_load_dwordx4 v7, s[20:23], s47 offen lds
    s_add_u32 m0, s41, 65536
    s_mov_b32 s47, 256
    s_waitcnt lgkmcnt(15)
    v_mfma_f32_16x16x32_bf16 v[192:195], v[80:83], v[96:99], v[192:195]
    v_mfma_f32_16x16x32_bf16 v[196:199], v[80:83], v[100:103], v[196:199]
    v_mfma_f32_16x16x32_bf16 v[200:203], v[80:83], v[104:107], v[200:203]
    v_mfma_f32_16x16x32_bf16 v[204:207], v[80:83], v[108:111], v[204:207]
    ds_read_b128 v[80:83], v23 offset:8192
    buffer_load_dwordx4 v5, s[16:19], s47 offen lds
    s_add_u32 m0, s41, 66560
    s_mov_b32 s47, 8448
    buffer_load_dwordx4 v8, s[16:19], s47 offen lds
    s_waitcnt lgkmcnt(15)
    v_mfma_f32_16x16x32_bf16 v[208:211], v[84:87], v[96:99], v[208:211]
    v_mfma_f32_16x16x32_bf16 v[212:215], v[84:87], v[100:103], v[212:215]
    v_mfma_f32_16x16x32_bf16 v[216:219], v[84:87], v[104:107], v[216:219]
    v_mfma_f32_16x16x32_bf16 v[220:223], v[84:87], v[108:111], v[220:223]
    ds_read_b128 v[84:87], v24 offset:8192
    s_add_u32 m0, s41, 67584
    s_mov_b32 s47, 16640
    buffer_load_dwordx4 v5, s[16:19], s47 offen lds
    s_add_u32 m0, s41, 68608
    s_waitcnt lgkmcnt(15)
    v_mfma_f32_16x16x32_bf16 v[224:227], v[88:91], v[96:99], v[224:227]
    v_mfma_f32_16x16x32_bf16 v[228:231], v[88:91], v[100:103], v[228:231]
    v_mfma_f32_16x16x32_bf16 v[232:235], v[88:91], v[104:107], v[232:235]
    v_mfma_f32_16x16x32_bf16 v[236:239], v[88:91], v[108:111], v[236:239]
    ds_read_b128 v[88:91], v23 offset:12288
    s_mov_b32 s47, 24832
    buffer_load_dwordx4 v8, s[16:19], s47 offen lds
    s_waitcnt lgkmcnt(15)
    v_mfma_f32_16x16x32_bf16 v[240:243], v[92:95], v[96:99], v[240:243]
    v_mfma_f32_16x16x32_bf16 v[244:247], v[92:95], v[100:103], v[244:247]
    v_mfma_f32_16x16x32_bf16 v[248:251], v[92:95], v[104:107], v[248:251]
    v_mfma_f32_16x16x32_bf16 v[252:255], v[92:95], v[108:111], v[252:255]
    ds_read_b128 v[92:95], v24 offset:12288
    s_waitcnt vmcnt(6)
    s_barrier
    s_waitcnt lgkmcnt(13)
    v_mfma_f32_16x16x32_bf16 v[128:131], v[64:67], v[112:115], v[128:131]
    s_waitcnt lgkmcnt(11)
    v_mfma_f32_16x16x32_bf16 v[132:135], v[64:67], v[116:119], v[132:135]
    s_waitcnt lgkmcnt(8)
    v_mfma_f32_16x16x32_bf16 v[136:139], v[64:67], v[120:123], v[136:139]
    s_waitcnt lgkmcnt(6)
    v_mfma_f32_16x16x32_bf16 v[140:143], v[64:67], v[124:127], v[140:143]
    ds_read_b128 v[64:67], v9 offset:32768
    ds_read_b64_tr_b16 v[96:97], v25 offset:32768
    ds_read_b64_tr_b16 v[98:99], v25 offset:34816
    v_mfma_f32_16x16x32_bf16 v[144:147], v[68:71], v[112:115], v[144:147]
    v_mfma_f32_16x16x32_bf16 v[148:151], v[68:71], v[116:119], v[148:151]
    v_mfma_f32_16x16x32_bf16 v[152:155], v[68:71], v[120:123], v[152:155]
    v_mfma_f32_16x16x32_bf16 v[156:159], v[68:71], v[124:127], v[156:159]
    ds_read_b128 v[68:71], v10 offset:32768
    ds_read_b64_tr_b16 v[100:101], v26 offset:32768
    ds_read_b64_tr_b16 v[102:103], v26 offset:34816
    s_waitcnt lgkmcnt(11)
    v_mfma_f32_16x16x32_bf16 v[160:163], v[72:75], v[112:115], v[160:163]
    v_mfma_f32_16x16x32_bf16 v[164:167], v[72:75], v[116:119], v[164:167]
    v_mfma_f32_16x16x32_bf16 v[168:171], v[72:75], v[120:123], v[168:171]
    v_mfma_f32_16x16x32_bf16 v[172:175], v[72:75], v[124:127], v[172:175]
    ds_read_b128 v[72:75], v9 offset:36864
    ds_read_b64_tr_b16 v[104:105], v27 offset:32768
    ds_read_b64_tr_b16 v[106:107], v27 offset:34816
    s_waitcnt lgkmcnt(13)
    v_mfma_f32_16x16x32_bf16 v[176:179], v[76:79], v[112:115], v[176:179]
    v_mfma_f32_16x16x32_bf16 v[180:183], v[76:79], v[116:119], v[180:183]
    v_mfma_f32_16x16x32_bf16 v[184:187], v[76:79], v[120:123], v[184:187]
    v_mfma_f32_16x16x32_bf16 v[188:191], v[76:79], v[124:127], v[188:191]
    ds_read_b128 v[76:79], v10 offset:36864
    ds_read_b64_tr_b16 v[108:109], v28 offset:32768
    ds_read_b64_tr_b16 v[110:111], v28 offset:34816
    s_waitcnt lgkmcnt(15)
    v_mfma_f32_16x16x32_bf16 v[192:195], v[80:83], v[112:115], v[192:195]
    v_mfma_f32_16x16x32_bf16 v[196:199], v[80:83], v[116:119], v[196:199]
    v_mfma_f32_16x16x32_bf16 v[200:203], v[80:83], v[120:123], v[200:203]
    v_mfma_f32_16x16x32_bf16 v[204:207], v[80:83], v[124:127], v[204:207]
    ds_read_b128 v[80:83], v9 offset:40960
    s_add_u32 m0, s42, 98304
    s_mov_b32 s47, 1048576
    s_waitcnt lgkmcnt(15)
    v_mfma_f32_16x16x32_bf16 v[208:211], v[84:87], v[112:115], v[208:211]
    v_mfma_f32_16x16x32_bf16 v[212:215], v[84:87], v[116:119], v[212:215]
    v_mfma_f32_16x16x32_bf16 v[216:219], v[84:87], v[120:123], v[216:219]
    v_mfma_f32_16x16x32_bf16 v[220:223], v[84:87], v[124:127], v[220:223]
    ds_read_b128 v[84:87], v10 offset:40960
    buffer_load_dwordx4 v6, s[20:23], s47 offen lds
    s_add_u32 m0, s42, 99328
    s_waitcnt lgkmcnt(15)
    v_mfma_f32_16x16x32_bf16 v[224:227], v[88:91], v[112:115], v[224:227]
    v_mfma_f32_16x16x32_bf16 v[228:231], v[88:91], v[116:119], v[228:231]
    v_mfma_f32_16x16x32_bf16 v[232:235], v[88:91], v[120:123], v[232:235]
    v_mfma_f32_16x16x32_bf16 v[236:239], v[88:91], v[124:127], v[236:239]
    ds_read_b128 v[88:91], v9 offset:45056
    s_mov_b32 s47, 1048576
    buffer_load_dwordx4 v7, s[20:23], s47 offen lds
    s_waitcnt lgkmcnt(15)
    v_mfma_f32_16x16x32_bf16 v[240:243], v[92:95], v[112:115], v[240:243]
    v_mfma_f32_16x16x32_bf16 v[244:247], v[92:95], v[116:119], v[244:247]
    v_mfma_f32_16x16x32_bf16 v[248:251], v[92:95], v[120:123], v[248:251]
    v_mfma_f32_16x16x32_bf16 v[252:255], v[92:95], v[124:127], v[252:255]
    ds_read_b128 v[92:95], v10 offset:45056
    s_waitcnt vmcnt(6)
    s_barrier
    s_waitcnt lgkmcnt(13)
    v_mfma_f32_16x16x32_bf16 v[128:131], v[64:67], v[96:99], v[128:131]
    s_waitcnt lgkmcnt(10)
    v_mfma_f32_16x16x32_bf16 v[132:135], v[64:67], v[100:103], v[132:135]
    s_waitcnt lgkmcnt(7)
    v_mfma_f32_16x16x32_bf16 v[136:139], v[64:67], v[104:107], v[136:139]
    s_waitcnt lgkmcnt(4)
    v_mfma_f32_16x16x32_bf16 v[140:143], v[64:67], v[108:111], v[140:143]
    ds_read_b128 v[64:67], v23 offset:32768
    ds_read_b64_tr_b16 v[112:113], v25 offset:49152
    ds_read_b64_tr_b16 v[114:115], v25 offset:51200
    ds_read_b64_tr_b16 v[116:117], v26 offset:49152
    ds_read_b64_tr_b16 v[118:119], v26 offset:51200
    v_mfma_f32_16x16x32_bf16 v[144:147], v[68:71], v[96:99], v[144:147]
    v_mfma_f32_16x16x32_bf16 v[148:151], v[68:71], v[100:103], v[148:151]
    v_mfma_f32_16x16x32_bf16 v[152:155], v[68:71], v[104:107], v[152:155]
    v_mfma_f32_16x16x32_bf16 v[156:159], v[68:71], v[108:111], v[156:159]
    ds_read_b128 v[68:71], v24 offset:32768
    ds_read_b64_tr_b16 v[120:121], v27 offset:49152
    ds_read_b64_tr_b16 v[122:123], v27 offset:51200
    ds_read_b64_tr_b16 v[124:125], v28 offset:49152
    ds_read_b64_tr_b16 v[126:127], v28 offset:51200
    v_mfma_f32_16x16x32_bf16 v[160:163], v[72:75], v[96:99], v[160:163]
    v_mfma_f32_16x16x32_bf16 v[164:167], v[72:75], v[100:103], v[164:167]
    v_mfma_f32_16x16x32_bf16 v[168:171], v[72:75], v[104:107], v[168:171]
    v_mfma_f32_16x16x32_bf16 v[172:175], v[72:75], v[108:111], v[172:175]
    ds_read_b128 v[72:75], v23 offset:36864
    s_add_u32 m0, s42, 114688
    s_mov_b32 s47, 1310720
    buffer_load_dwordx4 v6, s[20:23], s47 offen lds
    s_add_u32 m0, s42, 115712
    v_mfma_f32_16x16x32_bf16 v[176:179], v[76:79], v[96:99], v[176:179]
    v_mfma_f32_16x16x32_bf16 v[180:183], v[76:79], v[100:103], v[180:183]
    v_mfma_f32_16x16x32_bf16 v[184:187], v[76:79], v[104:107], v[184:187]
    v_mfma_f32_16x16x32_bf16 v[188:191], v[76:79], v[108:111], v[188:191]
    ds_read_b128 v[76:79], v24 offset:36864
    s_mov_b32 s47, 1310720
    buffer_load_dwordx4 v7, s[20:23], s47 offen lds
    s_add_u32 m0, s41, 0
    s_mov_b32 s47, 384
    s_waitcnt lgkmcnt(15)
    v_mfma_f32_16x16x32_bf16 v[192:195], v[80:83], v[96:99], v[192:195]
    v_mfma_f32_16x16x32_bf16 v[196:199], v[80:83], v[100:103], v[196:199]
    v_mfma_f32_16x16x32_bf16 v[200:203], v[80:83], v[104:107], v[200:203]
    v_mfma_f32_16x16x32_bf16 v[204:207], v[80:83], v[108:111], v[204:207]
    ds_read_b128 v[80:83], v23 offset:40960
    buffer_load_dwordx4 v5, s[16:19], s47 offen lds
    s_add_u32 m0, s41, 1024
    s_mov_b32 s47, 8576
    buffer_load_dwordx4 v8, s[16:19], s47 offen lds
    s_waitcnt lgkmcnt(15)
    v_mfma_f32_16x16x32_bf16 v[208:211], v[84:87], v[96:99], v[208:211]
    v_mfma_f32_16x16x32_bf16 v[212:215], v[84:87], v[100:103], v[212:215]
    v_mfma_f32_16x16x32_bf16 v[216:219], v[84:87], v[104:107], v[216:219]
    v_mfma_f32_16x16x32_bf16 v[220:223], v[84:87], v[108:111], v[220:223]
    ds_read_b128 v[84:87], v24 offset:40960
    s_add_u32 m0, s41, 2048
    s_mov_b32 s47, 16768
    buffer_load_dwordx4 v5, s[16:19], s47 offen lds
    s_add_u32 m0, s41, 3072
    s_waitcnt lgkmcnt(15)
    v_mfma_f32_16x16x32_bf16 v[224:227], v[88:91], v[96:99], v[224:227]
    v_mfma_f32_16x16x32_bf16 v[228:231], v[88:91], v[100:103], v[228:231]
    v_mfma_f32_16x16x32_bf16 v[232:235], v[88:91], v[104:107], v[232:235]
    v_mfma_f32_16x16x32_bf16 v[236:239], v[88:91], v[108:111], v[236:239]
    ds_read_b128 v[88:91], v23 offset:45056
    s_mov_b32 s47, 24960
    buffer_load_dwordx4 v8, s[16:19], s47 offen lds
    s_waitcnt lgkmcnt(15)
    v_mfma_f32_16x16x32_bf16 v[240:243], v[92:95], v[96:99], v[240:243]
    v_mfma_f32_16x16x32_bf16 v[244:247], v[92:95], v[100:103], v[244:247]
    v_mfma_f32_16x16x32_bf16 v[248:251], v[92:95], v[104:107], v[248:251]
    v_mfma_f32_16x16x32_bf16 v[252:255], v[92:95], v[108:111], v[252:255]
    ds_read_b128 v[92:95], v24 offset:45056
    s_waitcnt vmcnt(6)
    s_barrier
    s_waitcnt lgkmcnt(13)
    v_mfma_f32_16x16x32_bf16 v[128:131], v[64:67], v[112:115], v[128:131]
    s_waitcnt lgkmcnt(11)
    v_mfma_f32_16x16x32_bf16 v[132:135], v[64:67], v[116:119], v[132:135]
    s_waitcnt lgkmcnt(8)
    v_mfma_f32_16x16x32_bf16 v[136:139], v[64:67], v[120:123], v[136:139]
    s_waitcnt lgkmcnt(6)
    v_mfma_f32_16x16x32_bf16 v[140:143], v[64:67], v[124:127], v[140:143]
    ds_read_b128 v[64:67], v29 offset:0
    ds_read_b64_tr_b16 v[96:97], v25 offset:0
    ds_read_b64_tr_b16 v[98:99], v25 offset:2048
    v_mfma_f32_16x16x32_bf16 v[144:147], v[68:71], v[112:115], v[144:147]
    v_mfma_f32_16x16x32_bf16 v[148:151], v[68:71], v[116:119], v[148:151]
    v_mfma_f32_16x16x32_bf16 v[152:155], v[68:71], v[120:123], v[152:155]
    v_mfma_f32_16x16x32_bf16 v[156:159], v[68:71], v[124:127], v[156:159]
    ds_read_b128 v[68:71], v30 offset:0
    ds_read_b64_tr_b16 v[100:101], v26 offset:0
    ds_read_b64_tr_b16 v[102:103], v26 offset:2048
    s_waitcnt lgkmcnt(11)
    v_mfma_f32_16x16x32_bf16 v[160:163], v[72:75], v[112:115], v[160:163]
    v_mfma_f32_16x16x32_bf16 v[164:167], v[72:75], v[116:119], v[164:167]
    v_mfma_f32_16x16x32_bf16 v[168:171], v[72:75], v[120:123], v[168:171]
    v_mfma_f32_16x16x32_bf16 v[172:175], v[72:75], v[124:127], v[172:175]
    ds_read_b128 v[72:75], v29 offset:4096
    ds_read_b64_tr_b16 v[104:105], v27 offset:0
    ds_read_b64_tr_b16 v[106:107], v27 offset:2048
    s_waitcnt lgkmcnt(13)
    v_mfma_f32_16x16x32_bf16 v[176:179], v[76:79], v[112:115], v[176:179]
    v_mfma_f32_16x16x32_bf16 v[180:183], v[76:79], v[116:119], v[180:183]
    v_mfma_f32_16x16x32_bf16 v[184:187], v[76:79], v[120:123], v[184:187]
    v_mfma_f32_16x16x32_bf16 v[188:191], v[76:79], v[124:127], v[188:191]
    ds_read_b128 v[76:79], v30 offset:4096
    ds_read_b64_tr_b16 v[108:109], v28 offset:0
    ds_read_b64_tr_b16 v[110:111], v28 offset:2048
    s_waitcnt lgkmcnt(15)
    v_mfma_f32_16x16x32_bf16 v[192:195], v[80:83], v[112:115], v[192:195]
    v_mfma_f32_16x16x32_bf16 v[196:199], v[80:83], v[116:119], v[196:199]
    v_mfma_f32_16x16x32_bf16 v[200:203], v[80:83], v[120:123], v[200:203]
    v_mfma_f32_16x16x32_bf16 v[204:207], v[80:83], v[124:127], v[204:207]
    ds_read_b128 v[80:83], v29 offset:8192
    s_add_u32 m0, s42, 131072
    s_mov_b32 s47, 1572864
    s_waitcnt lgkmcnt(15)
    v_mfma_f32_16x16x32_bf16 v[208:211], v[84:87], v[112:115], v[208:211]
    v_mfma_f32_16x16x32_bf16 v[212:215], v[84:87], v[116:119], v[212:215]
    v_mfma_f32_16x16x32_bf16 v[216:219], v[84:87], v[120:123], v[216:219]
    v_mfma_f32_16x16x32_bf16 v[220:223], v[84:87], v[124:127], v[220:223]
    ds_read_b128 v[84:87], v30 offset:8192
    buffer_load_dwordx4 v6, s[20:23], s47 offen lds
    s_add_u32 m0, s42, 132096
    s_waitcnt lgkmcnt(15)
    v_mfma_f32_16x16x32_bf16 v[224:227], v[88:91], v[112:115], v[224:227]
    v_mfma_f32_16x16x32_bf16 v[228:231], v[88:91], v[116:119], v[228:231]
    v_mfma_f32_16x16x32_bf16 v[232:235], v[88:91], v[120:123], v[232:235]
    v_mfma_f32_16x16x32_bf16 v[236:239], v[88:91], v[124:127], v[236:239]
    ds_read_b128 v[88:91], v29 offset:12288
    s_mov_b32 s47, 1572864
    buffer_load_dwordx4 v7, s[20:23], s47 offen lds
    s_waitcnt lgkmcnt(15)
    v_mfma_f32_16x16x32_bf16 v[240:243], v[92:95], v[112:115], v[240:243]
    v_mfma_f32_16x16x32_bf16 v[244:247], v[92:95], v[116:119], v[244:247]
    v_mfma_f32_16x16x32_bf16 v[248:251], v[92:95], v[120:123], v[248:251]
    v_mfma_f32_16x16x32_bf16 v[252:255], v[92:95], v[124:127], v[252:255]
    ds_read_b128 v[92:95], v30 offset:12288
    s_waitcnt vmcnt(6)
    s_barrier
    s_waitcnt lgkmcnt(13)
    v_mfma_f32_16x16x32_bf16 v[128:131], v[64:67], v[96:99], v[128:131]
    s_waitcnt lgkmcnt(10)
    v_mfma_f32_16x16x32_bf16 v[132:135], v[64:67], v[100:103], v[132:135]
    s_waitcnt lgkmcnt(7)
    v_mfma_f32_16x16x32_bf16 v[136:139], v[64:67], v[104:107], v[136:139]
    s_waitcnt lgkmcnt(4)
    v_mfma_f32_16x16x32_bf16 v[140:143], v[64:67], v[108:111], v[140:143]
    ds_read_b128 v[64:67], v31 offset:0
    ds_read_b64_tr_b16 v[112:113], v25 offset:16384
    ds_read_b64_tr_b16 v[114:115], v25 offset:18432
    ds_read_b64_tr_b16 v[116:117], v26 offset:16384
    ds_read_b64_tr_b16 v[118:119], v26 offset:18432
    v_mfma_f32_16x16x32_bf16 v[144:147], v[68:71], v[96:99], v[144:147]
    v_mfma_f32_16x16x32_bf16 v[148:151], v[68:71], v[100:103], v[148:151]
    v_mfma_f32_16x16x32_bf16 v[152:155], v[68:71], v[104:107], v[152:155]
    v_mfma_f32_16x16x32_bf16 v[156:159], v[68:71], v[108:111], v[156:159]
    ds_read_b128 v[68:71], v32 offset:0
    ds_read_b64_tr_b16 v[120:121], v27 offset:16384
    ds_read_b64_tr_b16 v[122:123], v27 offset:18432
    ds_read_b64_tr_b16 v[124:125], v28 offset:16384
    ds_read_b64_tr_b16 v[126:127], v28 offset:18432
    v_mfma_f32_16x16x32_bf16 v[160:163], v[72:75], v[96:99], v[160:163]
    v_mfma_f32_16x16x32_bf16 v[164:167], v[72:75], v[100:103], v[164:167]
    v_mfma_f32_16x16x32_bf16 v[168:171], v[72:75], v[104:107], v[168:171]
    v_mfma_f32_16x16x32_bf16 v[172:175], v[72:75], v[108:111], v[172:175]
    ds_read_b128 v[72:75], v31 offset:4096
    s_add_u32 m0, s42, 147456
    s_mov_b32 s47, 1835008
    buffer_load_dwordx4 v6, s[20:23], s47 offen lds
    s_add_u32 m0, s42, 148480
    v_mfma_f32_16x16x32_bf16 v[176:179], v[76:79], v[96:99], v[176:179]
    v_mfma_f32_16x16x32_bf16 v[180:183], v[76:79], v[100:103], v[180:183]
    v_mfma_f32_16x16x32_bf16 v[184:187], v[76:79], v[104:107], v[184:187]
    v_mfma_f32_16x16x32_bf16 v[188:191], v[76:79], v[108:111], v[188:191]
    ds_read_b128 v[76:79], v32 offset:4096
    s_mov_b32 s47, 1835008
    buffer_load_dwordx4 v7, s[20:23], s47 offen lds
    s_add_u32 m0, s41, 32768
    s_mov_b32 s47, 512
    s_waitcnt lgkmcnt(15)
    v_mfma_f32_16x16x32_bf16 v[192:195], v[80:83], v[96:99], v[192:195]
    v_mfma_f32_16x16x32_bf16 v[196:199], v[80:83], v[100:103], v[196:199]
    v_mfma_f32_16x16x32_bf16 v[200:203], v[80:83], v[104:107], v[200:203]
    v_mfma_f32_16x16x32_bf16 v[204:207], v[80:83], v[108:111], v[204:207]
    ds_read_b128 v[80:83], v31 offset:8192
    buffer_load_dwordx4 v5, s[16:19], s47 offen lds
    s_add_u32 m0, s41, 33792
    s_mov_b32 s47, 8704
    buffer_load_dwordx4 v8, s[16:19], s47 offen lds
    s_waitcnt lgkmcnt(15)
    v_mfma_f32_16x16x32_bf16 v[208:211], v[84:87], v[96:99], v[208:211]
    v_mfma_f32_16x16x32_bf16 v[212:215], v[84:87], v[100:103], v[212:215]
    v_mfma_f32_16x16x32_bf16 v[216:219], v[84:87], v[104:107], v[216:219]
    v_mfma_f32_16x16x32_bf16 v[220:223], v[84:87], v[108:111], v[220:223]
    ds_read_b128 v[84:87], v32 offset:8192
    s_add_u32 m0, s41, 34816
    s_mov_b32 s47, 16896
    buffer_load_dwordx4 v5, s[16:19], s47 offen lds
    s_add_u32 m0, s41, 35840
    s_waitcnt lgkmcnt(15)
    v_mfma_f32_16x16x32_bf16 v[224:227], v[88:91], v[96:99], v[224:227]
    v_mfma_f32_16x16x32_bf16 v[228:231], v[88:91], v[100:103], v[228:231]
    v_mfma_f32_16x16x32_bf16 v[232:235], v[88:91], v[104:107], v[232:235]
    v_mfma_f32_16x16x32_bf16 v[236:239], v[88:91], v[108:111], v[236:239]
    ds_read_b128 v[88:91], v31 offset:12288
    s_mov_b32 s47, 25088
    buffer_load_dwordx4 v8, s[16:19], s47 offen lds
    s_waitcnt lgkmcnt(15)
    v_mfma_f32_16x16x32_bf16 v[240:243], v[92:95], v[96:99], v[240:243]
    v_mfma_f32_16x16x32_bf16 v[244:247], v[92:95], v[100:103], v[244:247]
    v_mfma_f32_16x16x32_bf16 v[248:251], v[92:95], v[104:107], v[248:251]
    v_mfma_f32_16x16x32_bf16 v[252:255], v[92:95], v[108:111], v[252:255]
    ds_read_b128 v[92:95], v32 offset:12288
    s_waitcnt vmcnt(6)
    s_barrier
    s_waitcnt lgkmcnt(13)
    v_mfma_f32_16x16x32_bf16 v[128:131], v[64:67], v[112:115], v[128:131]
    s_waitcnt lgkmcnt(11)
    v_mfma_f32_16x16x32_bf16 v[132:135], v[64:67], v[116:119], v[132:135]
    s_waitcnt lgkmcnt(8)
    v_mfma_f32_16x16x32_bf16 v[136:139], v[64:67], v[120:123], v[136:139]
    s_waitcnt lgkmcnt(6)
    v_mfma_f32_16x16x32_bf16 v[140:143], v[64:67], v[124:127], v[140:143]
    ds_read_b128 v[64:67], v9 offset:0
    ds_read_b64_tr_b16 v[96:97], v25 offset:32768
    ds_read_b64_tr_b16 v[98:99], v25 offset:34816
    v_mfma_f32_16x16x32_bf16 v[144:147], v[68:71], v[112:115], v[144:147]
    v_mfma_f32_16x16x32_bf16 v[148:151], v[68:71], v[116:119], v[148:151]
    v_mfma_f32_16x16x32_bf16 v[152:155], v[68:71], v[120:123], v[152:155]
    v_mfma_f32_16x16x32_bf16 v[156:159], v[68:71], v[124:127], v[156:159]
    ds_read_b128 v[68:71], v10 offset:0
    ds_read_b64_tr_b16 v[100:101], v26 offset:32768
    ds_read_b64_tr_b16 v[102:103], v26 offset:34816
    s_waitcnt lgkmcnt(11)
    v_mfma_f32_16x16x32_bf16 v[160:163], v[72:75], v[112:115], v[160:163]
    v_mfma_f32_16x16x32_bf16 v[164:167], v[72:75], v[116:119], v[164:167]
    v_mfma_f32_16x16x32_bf16 v[168:171], v[72:75], v[120:123], v[168:171]
    v_mfma_f32_16x16x32_bf16 v[172:175], v[72:75], v[124:127], v[172:175]
    ds_read_b128 v[72:75], v9 offset:4096
    ds_read_b64_tr_b16 v[104:105], v27 offset:32768
    ds_read_b64_tr_b16 v[106:107], v27 offset:34816
    s_waitcnt lgkmcnt(13)
    v_mfma_f32_16x16x32_bf16 v[176:179], v[76:79], v[112:115], v[176:179]
    v_mfma_f32_16x16x32_bf16 v[180:183], v[76:79], v[116:119], v[180:183]
    v_mfma_f32_16x16x32_bf16 v[184:187], v[76:79], v[120:123], v[184:187]
    v_mfma_f32_16x16x32_bf16 v[188:191], v[76:79], v[124:127], v[188:191]
    ds_read_b128 v[76:79], v10 offset:4096
    ds_read_b64_tr_b16 v[108:109], v28 offset:32768
    ds_read_b64_tr_b16 v[110:111], v28 offset:34816
    s_waitcnt lgkmcnt(15)
    v_mfma_f32_16x16x32_bf16 v[192:195], v[80:83], v[112:115], v[192:195]
    v_mfma_f32_16x16x32_bf16 v[196:199], v[80:83], v[116:119], v[196:199]
    v_mfma_f32_16x16x32_bf16 v[200:203], v[80:83], v[120:123], v[200:203]
    v_mfma_f32_16x16x32_bf16 v[204:207], v[80:83], v[124:127], v[204:207]
    ds_read_b128 v[80:83], v9 offset:8192
    s_add_u32 m0, s42, 98304
    s_mov_b32 s47, 2097152
    s_waitcnt lgkmcnt(15)
    v_mfma_f32_16x16x32_bf16 v[208:211], v[84:87], v[112:115], v[208:211]
    v_mfma_f32_16x16x32_bf16 v[212:215], v[84:87], v[116:119], v[212:215]
    v_mfma_f32_16x16x32_bf16 v[216:219], v[84:87], v[120:123], v[216:219]
    v_mfma_f32_16x16x32_bf16 v[220:223], v[84:87], v[124:127], v[220:223]
    ds_read_b128 v[84:87], v10 offset:8192
    buffer_load_dwordx4 v6, s[20:23], s47 offen lds
    s_add_u32 m0, s42, 99328
    s_waitcnt lgkmcnt(15)
    v_mfma_f32_16x16x32_bf16 v[224:227], v[88:91], v[112:115], v[224:227]
    v_mfma_f32_16x16x32_bf16 v[228:231], v[88:91], v[116:119], v[228:231]
    v_mfma_f32_16x16x32_bf16 v[232:235], v[88:91], v[120:123], v[232:235]
    v_mfma_f32_16x16x32_bf16 v[236:239], v[88:91], v[124:127], v[236:239]
    ds_read_b128 v[88:91], v9 offset:12288
    s_mov_b32 s47, 2097152
    buffer_load_dwordx4 v7, s[20:23], s47 offen lds
    s_waitcnt lgkmcnt(15)
    v_mfma_f32_16x16x32_bf16 v[240:243], v[92:95], v[112:115], v[240:243]
    v_mfma_f32_16x16x32_bf16 v[244:247], v[92:95], v[116:119], v[244:247]
    v_mfma_f32_16x16x32_bf16 v[248:251], v[92:95], v[120:123], v[248:251]
    v_mfma_f32_16x16x32_bf16 v[252:255], v[92:95], v[124:127], v[252:255]
    ds_read_b128 v[92:95], v10 offset:12288
    s_waitcnt vmcnt(6)
    s_barrier
    s_waitcnt lgkmcnt(13)
    v_mfma_f32_16x16x32_bf16 v[128:131], v[64:67], v[96:99], v[128:131]
    s_waitcnt lgkmcnt(10)
    v_mfma_f32_16x16x32_bf16 v[132:135], v[64:67], v[100:103], v[132:135]
    s_waitcnt lgkmcnt(7)
    v_mfma_f32_16x16x32_bf16 v[136:139], v[64:67], v[104:107], v[136:139]
    s_waitcnt lgkmcnt(4)
    v_mfma_f32_16x16x32_bf16 v[140:143], v[64:67], v[108:111], v[140:143]
    ds_read_b128 v[64:67], v23 offset:0
    ds_read_b64_tr_b16 v[112:113], v25 offset:49152
    ds_read_b64_tr_b16 v[114:115], v25 offset:51200
    ds_read_b64_tr_b16 v[116:117], v26 offset:49152
    ds_read_b64_tr_b16 v[118:119], v26 offset:51200
    v_mfma_f32_16x16x32_bf16 v[144:147], v[68:71], v[96:99], v[144:147]
    v_mfma_f32_16x16x32_bf16 v[148:151], v[68:71], v[100:103], v[148:151]
    v_mfma_f32_16x16x32_bf16 v[152:155], v[68:71], v[104:107], v[152:155]
    v_mfma_f32_16x16x32_bf16 v[156:159], v[68:71], v[108:111], v[156:159]
    ds_read_b128 v[68:71], v24 offset:0
    ds_read_b64_tr_b16 v[120:121], v27 offset:49152
    ds_read_b64_tr_b16 v[122:123], v27 offset:51200
    ds_read_b64_tr_b16 v[124:125], v28 offset:49152
    ds_read_b64_tr_b16 v[126:127], v28 offset:51200
    v_mfma_f32_16x16x32_bf16 v[160:163], v[72:75], v[96:99], v[160:163]
    v_mfma_f32_16x16x32_bf16 v[164:167], v[72:75], v[100:103], v[164:167]
    v_mfma_f32_16x16x32_bf16 v[168:171], v[72:75], v[104:107], v[168:171]
    v_mfma_f32_16x16x32_bf16 v[172:175], v[72:75], v[108:111], v[172:175]
    ds_read_b128 v[72:75], v23 offset:4096
    s_add_u32 m0, s42, 114688
    s_mov_b32 s47, 2359296
    buffer_load_dwordx4 v6, s[20:23], s47 offen lds
    s_add_u32 m0, s42, 115712
    v_mfma_f32_16x16x32_bf16 v[176:179], v[76:79], v[96:99], v[176:179]
    v_mfma_f32_16x16x32_bf16 v[180:183], v[76:79], v[100:103], v[180:183]
    v_mfma_f32_16x16x32_bf16 v[184:187], v[76:79], v[104:107], v[184:187]
    v_mfma_f32_16x16x32_bf16 v[188:191], v[76:79], v[108:111], v[188:191]
    ds_read_b128 v[76:79], v24 offset:4096
    s_mov_b32 s47, 2359296
    buffer_load_dwordx4 v7, s[20:23], s47 offen lds
    s_add_u32 m0, s41, 65536
    s_mov_b32 s47, 640
    s_waitcnt lgkmcnt(15)
    v_mfma_f32_16x16x32_bf16 v[192:195], v[80:83], v[96:99], v[192:195]
    v_mfma_f32_16x16x32_bf16 v[196:199], v[80:83], v[100:103], v[196:199]
    v_mfma_f32_16x16x32_bf16 v[200:203], v[80:83], v[104:107], v[200:203]
    v_mfma_f32_16x16x32_bf16 v[204:207], v[80:83], v[108:111], v[204:207]
    ds_read_b128 v[80:83], v23 offset:8192
    buffer_load_dwordx4 v5, s[16:19], s47 offen lds
    s_add_u32 m0, s41, 66560
    s_mov_b32 s47, 8832
    buffer_load_dwordx4 v8, s[16:19], s47 offen lds
    s_waitcnt lgkmcnt(15)
    v_mfma_f32_16x16x32_bf16 v[208:211], v[84:87], v[96:99], v[208:211]
    v_mfma_f32_16x16x32_bf16 v[212:215], v[84:87], v[100:103], v[212:215]
    v_mfma_f32_16x16x32_bf16 v[216:219], v[84:87], v[104:107], v[216:219]
    v_mfma_f32_16x16x32_bf16 v[220:223], v[84:87], v[108:111], v[220:223]
    ds_read_b128 v[84:87], v24 offset:8192
    s_add_u32 m0, s41, 67584
    s_mov_b32 s47, 17024
    buffer_load_dwordx4 v5, s[16:19], s47 offen lds
    s_add_u32 m0, s41, 68608
    s_waitcnt lgkmcnt(15)
    v_mfma_f32_16x16x32_bf16 v[224:227], v[88:91], v[96:99], v[224:227]
    v_mfma_f32_16x16x32_bf16 v[228:231], v[88:91], v[100:103], v[228:231]
    v_mfma_f32_16x16x32_bf16 v[232:235], v[88:91], v[104:107], v[232:235]
    v_mfma_f32_16x16x32_bf16 v[236:239], v[88:91], v[108:111], v[236:239]
    ds_read_b128 v[88:91], v23 offset:12288
    s_mov_b32 s47, 25216
    buffer_load_dwordx4 v8, s[16:19], s47 offen lds
    s_waitcnt lgkmcnt(15)
    v_mfma_f32_16x16x32_bf16 v[240:243], v[92:95], v[96:99], v[240:243]
    v_mfma_f32_16x16x32_bf16 v[244:247], v[92:95], v[100:103], v[244:247]
    v_mfma_f32_16x16x32_bf16 v[248:251], v[92:95], v[104:107], v[248:251]
    v_mfma_f32_16x16x32_bf16 v[252:255], v[92:95], v[108:111], v[252:255]
    ds_read_b128 v[92:95], v24 offset:12288
    s_waitcnt vmcnt(6)
    s_barrier
    s_waitcnt lgkmcnt(13)
    v_mfma_f32_16x16x32_bf16 v[128:131], v[64:67], v[112:115], v[128:131]
    s_waitcnt lgkmcnt(11)
    v_mfma_f32_16x16x32_bf16 v[132:135], v[64:67], v[116:119], v[132:135]
    s_waitcnt lgkmcnt(8)
    v_mfma_f32_16x16x32_bf16 v[136:139], v[64:67], v[120:123], v[136:139]
    s_waitcnt lgkmcnt(6)
    v_mfma_f32_16x16x32_bf16 v[140:143], v[64:67], v[124:127], v[140:143]
    ds_read_b128 v[64:67], v9 offset:32768
    ds_read_b64_tr_b16 v[96:97], v25 offset:0
    ds_read_b64_tr_b16 v[98:99], v25 offset:2048
    v_mfma_f32_16x16x32_bf16 v[144:147], v[68:71], v[112:115], v[144:147]
    v_mfma_f32_16x16x32_bf16 v[148:151], v[68:71], v[116:119], v[148:151]
    v_mfma_f32_16x16x32_bf16 v[152:155], v[68:71], v[120:123], v[152:155]
    v_mfma_f32_16x16x32_bf16 v[156:159], v[68:71], v[124:127], v[156:159]
    ds_read_b128 v[68:71], v10 offset:32768
    ds_read_b64_tr_b16 v[100:101], v26 offset:0
    ds_read_b64_tr_b16 v[102:103], v26 offset:2048
    s_waitcnt lgkmcnt(11)
    v_mfma_f32_16x16x32_bf16 v[160:163], v[72:75], v[112:115], v[160:163]
    v_mfma_f32_16x16x32_bf16 v[164:167], v[72:75], v[116:119], v[164:167]
    v_mfma_f32_16x16x32_bf16 v[168:171], v[72:75], v[120:123], v[168:171]
    v_mfma_f32_16x16x32_bf16 v[172:175], v[72:75], v[124:127], v[172:175]
    ds_read_b128 v[72:75], v9 offset:36864
    ds_read_b64_tr_b16 v[104:105], v27 offset:0
    ds_read_b64_tr_b16 v[106:107], v27 offset:2048
    s_waitcnt lgkmcnt(13)
    v_mfma_f32_16x16x32_bf16 v[176:179], v[76:79], v[112:115], v[176:179]
    v_mfma_f32_16x16x32_bf16 v[180:183], v[76:79], v[116:119], v[180:183]
    v_mfma_f32_16x16x32_bf16 v[184:187], v[76:79], v[120:123], v[184:187]
    v_mfma_f32_16x16x32_bf16 v[188:191], v[76:79], v[124:127], v[188:191]
    ds_read_b128 v[76:79], v10 offset:36864
    ds_read_b64_tr_b16 v[108:109], v28 offset:0
    ds_read_b64_tr_b16 v[110:111], v28 offset:2048
    s_waitcnt lgkmcnt(15)
    v_mfma_f32_16x16x32_bf16 v[192:195], v[80:83], v[112:115], v[192:195]
    v_mfma_f32_16x16x32_bf16 v[196:199], v[80:83], v[116:119], v[196:199]
    v_mfma_f32_16x16x32_bf16 v[200:203], v[80:83], v[120:123], v[200:203]
    v_mfma_f32_16x16x32_bf16 v[204:207], v[80:83], v[124:127], v[204:207]
    ds_read_b128 v[80:83], v9 offset:40960
    s_add_u32 m0, s42, 131072
    s_mov_b32 s47, 2621440
    s_waitcnt lgkmcnt(15)
    v_mfma_f32_16x16x32_bf16 v[208:211], v[84:87], v[112:115], v[208:211]
    v_mfma_f32_16x16x32_bf16 v[212:215], v[84:87], v[116:119], v[212:215]
    v_mfma_f32_16x16x32_bf16 v[216:219], v[84:87], v[120:123], v[216:219]
    v_mfma_f32_16x16x32_bf16 v[220:223], v[84:87], v[124:127], v[220:223]
    ds_read_b128 v[84:87], v10 offset:40960
    buffer_load_dwordx4 v6, s[20:23], s47 offen lds
    s_add_u32 m0, s42, 132096
    s_waitcnt lgkmcnt(15)
    v_mfma_f32_16x16x32_bf16 v[224:227], v[88:91], v[112:115], v[224:227]
    v_mfma_f32_16x16x32_bf16 v[228:231], v[88:91], v[116:119], v[228:231]
    v_mfma_f32_16x16x32_bf16 v[232:235], v[88:91], v[120:123], v[232:235]
    v_mfma_f32_16x16x32_bf16 v[236:239], v[88:91], v[124:127], v[236:239]
    ds_read_b128 v[88:91], v9 offset:45056
    s_mov_b32 s47, 2621440
    buffer_load_dwordx4 v7, s[20:23], s47 offen lds
    s_waitcnt lgkmcnt(15)
    v_mfma_f32_16x16x32_bf16 v[240:243], v[92:95], v[112:115], v[240:243]
    v_mfma_f32_16x16x32_bf16 v[244:247], v[92:95], v[116:119], v[244:247]
    v_mfma_f32_16x16x32_bf16 v[248:251], v[92:95], v[120:123], v[248:251]
    v_mfma_f32_16x16x32_bf16 v[252:255], v[92:95], v[124:127], v[252:255]
    ds_read_b128 v[92:95], v10 offset:45056
    s_waitcnt vmcnt(6)
    s_barrier
    s_waitcnt lgkmcnt(13)
    v_mfma_f32_16x16x32_bf16 v[128:131], v[64:67], v[96:99], v[128:131]
    s_waitcnt lgkmcnt(10)
    v_mfma_f32_16x16x32_bf16 v[132:135], v[64:67], v[100:103], v[132:135]
    s_waitcnt lgkmcnt(7)
    v_mfma_f32_16x16x32_bf16 v[136:139], v[64:67], v[104:107], v[136:139]
    s_waitcnt lgkmcnt(4)
    v_mfma_f32_16x16x32_bf16 v[140:143], v[64:67], v[108:111], v[140:143]
    ds_read_b128 v[64:67], v23 offset:32768
    ds_read_b64_tr_b16 v[112:113], v25 offset:16384
    ds_read_b64_tr_b16 v[114:115], v25 offset:18432
    ds_read_b64_tr_b16 v[116:117], v26 offset:16384
    ds_read_b64_tr_b16 v[118:119], v26 offset:18432
    v_mfma_f32_16x16x32_bf16 v[144:147], v[68:71], v[96:99], v[144:147]
    v_mfma_f32_16x16x32_bf16 v[148:151], v[68:71], v[100:103], v[148:151]
    v_mfma_f32_16x16x32_bf16 v[152:155], v[68:71], v[104:107], v[152:155]
    v_mfma_f32_16x16x32_bf16 v[156:159], v[68:71], v[108:111], v[156:159]
    ds_read_b128 v[68:71], v24 offset:32768
    ds_read_b64_tr_b16 v[120:121], v27 offset:16384
    ds_read_b64_tr_b16 v[122:123], v27 offset:18432
    ds_read_b64_tr_b16 v[124:125], v28 offset:16384
    ds_read_b64_tr_b16 v[126:127], v28 offset:18432
    v_mfma_f32_16x16x32_bf16 v[160:163], v[72:75], v[96:99], v[160:163]
    v_mfma_f32_16x16x32_bf16 v[164:167], v[72:75], v[100:103], v[164:167]
    v_mfma_f32_16x16x32_bf16 v[168:171], v[72:75], v[104:107], v[168:171]
    v_mfma_f32_16x16x32_bf16 v[172:175], v[72:75], v[108:111], v[172:175]
    ds_read_b128 v[72:75], v23 offset:36864
    s_add_u32 m0, s42, 147456
    s_mov_b32 s47, 2883584
    buffer_load_dwordx4 v6, s[20:23], s47 offen lds
    s_add_u32 m0, s42, 148480
    v_mfma_f32_16x16x32_bf16 v[176:179], v[76:79], v[96:99], v[176:179]
    v_mfma_f32_16x16x32_bf16 v[180:183], v[76:79], v[100:103], v[180:183]
    v_mfma_f32_16x16x32_bf16 v[184:187], v[76:79], v[104:107], v[184:187]
    v_mfma_f32_16x16x32_bf16 v[188:191], v[76:79], v[108:111], v[188:191]
    ds_read_b128 v[76:79], v24 offset:36864
    s_mov_b32 s47, 2883584
    buffer_load_dwordx4 v7, s[20:23], s47 offen lds
    s_add_u32 m0, s41, 0
    s_mov_b32 s47, 768
    s_waitcnt lgkmcnt(15)
    v_mfma_f32_16x16x32_bf16 v[192:195], v[80:83], v[96:99], v[192:195]
    v_mfma_f32_16x16x32_bf16 v[196:199], v[80:83], v[100:103], v[196:199]
    v_mfma_f32_16x16x32_bf16 v[200:203], v[80:83], v[104:107], v[200:203]
    v_mfma_f32_16x16x32_bf16 v[204:207], v[80:83], v[108:111], v[204:207]
    ds_read_b128 v[80:83], v23 offset:40960
    buffer_load_dwordx4 v5, s[16:19], s47 offen lds
    s_add_u32 m0, s41, 1024
    s_mov_b32 s47, 8960
    buffer_load_dwordx4 v8, s[16:19], s47 offen lds
    s_waitcnt lgkmcnt(15)
    v_mfma_f32_16x16x32_bf16 v[208:211], v[84:87], v[96:99], v[208:211]
    v_mfma_f32_16x16x32_bf16 v[212:215], v[84:87], v[100:103], v[212:215]
    v_mfma_f32_16x16x32_bf16 v[216:219], v[84:87], v[104:107], v[216:219]
    v_mfma_f32_16x16x32_bf16 v[220:223], v[84:87], v[108:111], v[220:223]
    ds_read_b128 v[84:87], v24 offset:40960
    s_add_u32 m0, s41, 2048
    s_mov_b32 s47, 17152
    buffer_load_dwordx4 v5, s[16:19], s47 offen lds
    s_add_u32 m0, s41, 3072
    s_waitcnt lgkmcnt(15)
    v_mfma_f32_16x16x32_bf16 v[224:227], v[88:91], v[96:99], v[224:227]
    v_mfma_f32_16x16x32_bf16 v[228:231], v[88:91], v[100:103], v[228:231]
    v_mfma_f32_16x16x32_bf16 v[232:235], v[88:91], v[104:107], v[232:235]
    v_mfma_f32_16x16x32_bf16 v[236:239], v[88:91], v[108:111], v[236:239]
    ds_read_b128 v[88:91], v23 offset:45056
    s_mov_b32 s47, 25344
    buffer_load_dwordx4 v8, s[16:19], s47 offen lds
    s_waitcnt lgkmcnt(15)
    v_mfma_f32_16x16x32_bf16 v[240:243], v[92:95], v[96:99], v[240:243]
    v_mfma_f32_16x16x32_bf16 v[244:247], v[92:95], v[100:103], v[244:247]
    v_mfma_f32_16x16x32_bf16 v[248:251], v[92:95], v[104:107], v[248:251]
    v_mfma_f32_16x16x32_bf16 v[252:255], v[92:95], v[108:111], v[252:255]
    ds_read_b128 v[92:95], v24 offset:45056
    s_waitcnt vmcnt(6)
    s_barrier
    s_waitcnt lgkmcnt(13)
    v_mfma_f32_16x16x32_bf16 v[128:131], v[64:67], v[112:115], v[128:131]
    s_waitcnt lgkmcnt(11)
    v_mfma_f32_16x16x32_bf16 v[132:135], v[64:67], v[116:119], v[132:135]
    s_waitcnt lgkmcnt(8)
    v_mfma_f32_16x16x32_bf16 v[136:139], v[64:67], v[120:123], v[136:139]
    s_waitcnt lgkmcnt(6)
    v_mfma_f32_16x16x32_bf16 v[140:143], v[64:67], v[124:127], v[140:143]
    ds_read_b128 v[64:67], v29 offset:0
    ds_read_b64_tr_b16 v[96:97], v25 offset:32768
    ds_read_b64_tr_b16 v[98:99], v25 offset:34816
    v_mfma_f32_16x16x32_bf16 v[144:147], v[68:71], v[112:115], v[144:147]
    v_mfma_f32_16x16x32_bf16 v[148:151], v[68:71], v[116:119], v[148:151]
    v_mfma_f32_16x16x32_bf16 v[152:155], v[68:71], v[120:123], v[152:155]
    v_mfma_f32_16x16x32_bf16 v[156:159], v[68:71], v[124:127], v[156:159]
    ds_read_b128 v[68:71], v30 offset:0
    ds_read_b64_tr_b16 v[100:101], v26 offset:32768
    ds_read_b64_tr_b16 v[102:103], v26 offset:34816
    s_waitcnt lgkmcnt(11)
    v_mfma_f32_16x16x32_bf16 v[160:163], v[72:75], v[112:115], v[160:163]
    v_mfma_f32_16x16x32_bf16 v[164:167], v[72:75], v[116:119], v[164:167]
    v_mfma_f32_16x16x32_bf16 v[168:171], v[72:75], v[120:123], v[168:171]
    v_mfma_f32_16x16x32_bf16 v[172:175], v[72:75], v[124:127], v[172:175]
    ds_read_b128 v[72:75], v29 offset:4096
    ds_read_b64_tr_b16 v[104:105], v27 offset:32768
    ds_read_b64_tr_b16 v[106:107], v27 offset:34816
    s_waitcnt lgkmcnt(13)
    v_mfma_f32_16x16x32_bf16 v[176:179], v[76:79], v[112:115], v[176:179]
    v_mfma_f32_16x16x32_bf16 v[180:183], v[76:79], v[116:119], v[180:183]
    v_mfma_f32_16x16x32_bf16 v[184:187], v[76:79], v[120:123], v[184:187]
    v_mfma_f32_16x16x32_bf16 v[188:191], v[76:79], v[124:127], v[188:191]
    ds_read_b128 v[76:79], v30 offset:4096
    ds_read_b64_tr_b16 v[108:109], v28 offset:32768
    ds_read_b64_tr_b16 v[110:111], v28 offset:34816
    s_waitcnt lgkmcnt(15)
    v_mfma_f32_16x16x32_bf16 v[192:195], v[80:83], v[112:115], v[192:195]
    v_mfma_f32_16x16x32_bf16 v[196:199], v[80:83], v[116:119], v[196:199]
    v_mfma_f32_16x16x32_bf16 v[200:203], v[80:83], v[120:123], v[200:203]
    v_mfma_f32_16x16x32_bf16 v[204:207], v[80:83], v[124:127], v[204:207]
    ds_read_b128 v[80:83], v29 offset:8192
    s_add_u32 m0, s42, 98304
    s_mov_b32 s47, 3145728
    s_waitcnt lgkmcnt(15)
    v_mfma_f32_16x16x32_bf16 v[208:211], v[84:87], v[112:115], v[208:211]
    v_mfma_f32_16x16x32_bf16 v[212:215], v[84:87], v[116:119], v[212:215]
    v_mfma_f32_16x16x32_bf16 v[216:219], v[84:87], v[120:123], v[216:219]
    v_mfma_f32_16x16x32_bf16 v[220:223], v[84:87], v[124:127], v[220:223]
    ds_read_b128 v[84:87], v30 offset:8192
    buffer_load_dwordx4 v6, s[20:23], s47 offen lds
    s_add_u32 m0, s42, 99328
    s_waitcnt lgkmcnt(15)
    v_mfma_f32_16x16x32_bf16 v[224:227], v[88:91], v[112:115], v[224:227]
    v_mfma_f32_16x16x32_bf16 v[228:231], v[88:91], v[116:119], v[228:231]
    v_mfma_f32_16x16x32_bf16 v[232:235], v[88:91], v[120:123], v[232:235]
    v_mfma_f32_16x16x32_bf16 v[236:239], v[88:91], v[124:127], v[236:239]
    ds_read_b128 v[88:91], v29 offset:12288
    s_mov_b32 s47, 3145728
    buffer_load_dwordx4 v7, s[20:23], s47 offen lds
    s_waitcnt lgkmcnt(15)
    v_mfma_f32_16x16x32_bf16 v[240:243], v[92:95], v[112:115], v[240:243]
    v_mfma_f32_16x16x32_bf16 v[244:247], v[92:95], v[116:119], v[244:247]
    v_mfma_f32_16x16x32_bf16 v[248:251], v[92:95], v[120:123], v[248:251]
    v_mfma_f32_16x16x32_bf16 v[252:255], v[92:95], v[124:127], v[252:255]
    ds_read_b128 v[92:95], v30 offset:12288
    s_waitcnt vmcnt(6)
    s_barrier
    s_waitcnt lgkmcnt(13)
    v_mfma_f32_16x16x32_bf16 v[128:131], v[64:67], v[96:99], v[128:131]
    s_waitcnt lgkmcnt(10)
    v_mfma_f32_16x16x32_bf16 v[132:135], v[64:67], v[100:103], v[132:135]
    s_waitcnt lgkmcnt(7)
    v_mfma_f32_16x16x32_bf16 v[136:139], v[64:67], v[104:107], v[136:139]
    s_waitcnt lgkmcnt(4)
    v_mfma_f32_16x16x32_bf16 v[140:143], v[64:67], v[108:111], v[140:143]
    ds_read_b128 v[64:67], v31 offset:0
    ds_read_b64_tr_b16 v[112:113], v25 offset:49152
    ds_read_b64_tr_b16 v[114:115], v25 offset:51200
    ds_read_b64_tr_b16 v[116:117], v26 offset:49152
    ds_read_b64_tr_b16 v[118:119], v26 offset:51200
    v_mfma_f32_16x16x32_bf16 v[144:147], v[68:71], v[96:99], v[144:147]
    v_mfma_f32_16x16x32_bf16 v[148:151], v[68:71], v[100:103], v[148:151]
    v_mfma_f32_16x16x32_bf16 v[152:155], v[68:71], v[104:107], v[152:155]
    v_mfma_f32_16x16x32_bf16 v[156:159], v[68:71], v[108:111], v[156:159]
    ds_read_b128 v[68:71], v32 offset:0
    ds_read_b64_tr_b16 v[120:121], v27 offset:49152
    ds_read_b64_tr_b16 v[122:123], v27 offset:51200
    ds_read_b64_tr_b16 v[124:125], v28 offset:49152
    ds_read_b64_tr_b16 v[126:127], v28 offset:51200
    v_mfma_f32_16x16x32_bf16 v[160:163], v[72:75], v[96:99], v[160:163]
    v_mfma_f32_16x16x32_bf16 v[164:167], v[72:75], v[100:103], v[164:167]
    v_mfma_f32_16x16x32_bf16 v[168:171], v[72:75], v[104:107], v[168:171]
    v_mfma_f32_16x16x32_bf16 v[172:175], v[72:75], v[108:111], v[172:175]
    ds_read_b128 v[72:75], v31 offset:4096
    s_add_u32 m0, s42, 114688
    s_mov_b32 s47, 3407872
    buffer_load_dwordx4 v6, s[20:23], s47 offen lds
    s_add_u32 m0, s42, 115712
    v_mfma_f32_16x16x32_bf16 v[176:179], v[76:79], v[96:99], v[176:179]
    v_mfma_f32_16x16x32_bf16 v[180:183], v[76:79], v[100:103], v[180:183]
    v_mfma_f32_16x16x32_bf16 v[184:187], v[76:79], v[104:107], v[184:187]
    v_mfma_f32_16x16x32_bf16 v[188:191], v[76:79], v[108:111], v[188:191]
    ds_read_b128 v[76:79], v32 offset:4096
    s_mov_b32 s47, 3407872
    buffer_load_dwordx4 v7, s[20:23], s47 offen lds
    s_add_u32 m0, s41, 32768
    s_mov_b32 s47, 896
    s_waitcnt lgkmcnt(15)
    v_mfma_f32_16x16x32_bf16 v[192:195], v[80:83], v[96:99], v[192:195]
    v_mfma_f32_16x16x32_bf16 v[196:199], v[80:83], v[100:103], v[196:199]
    v_mfma_f32_16x16x32_bf16 v[200:203], v[80:83], v[104:107], v[200:203]
    v_mfma_f32_16x16x32_bf16 v[204:207], v[80:83], v[108:111], v[204:207]
    ds_read_b128 v[80:83], v31 offset:8192
    buffer_load_dwordx4 v5, s[16:19], s47 offen lds
    s_add_u32 m0, s41, 33792
    s_mov_b32 s47, 9088
    buffer_load_dwordx4 v8, s[16:19], s47 offen lds
    s_waitcnt lgkmcnt(15)
    v_mfma_f32_16x16x32_bf16 v[208:211], v[84:87], v[96:99], v[208:211]
    v_mfma_f32_16x16x32_bf16 v[212:215], v[84:87], v[100:103], v[212:215]
    v_mfma_f32_16x16x32_bf16 v[216:219], v[84:87], v[104:107], v[216:219]
    v_mfma_f32_16x16x32_bf16 v[220:223], v[84:87], v[108:111], v[220:223]
    ds_read_b128 v[84:87], v32 offset:8192
    s_add_u32 m0, s41, 34816
    s_mov_b32 s47, 17280
    buffer_load_dwordx4 v5, s[16:19], s47 offen lds
    s_add_u32 m0, s41, 35840
    s_waitcnt lgkmcnt(15)
    v_mfma_f32_16x16x32_bf16 v[224:227], v[88:91], v[96:99], v[224:227]
    v_mfma_f32_16x16x32_bf16 v[228:231], v[88:91], v[100:103], v[228:231]
    v_mfma_f32_16x16x32_bf16 v[232:235], v[88:91], v[104:107], v[232:235]
    v_mfma_f32_16x16x32_bf16 v[236:239], v[88:91], v[108:111], v[236:239]
    ds_read_b128 v[88:91], v31 offset:12288
    s_mov_b32 s47, 25472
    buffer_load_dwordx4 v8, s[16:19], s47 offen lds
    s_waitcnt lgkmcnt(15)
    v_mfma_f32_16x16x32_bf16 v[240:243], v[92:95], v[96:99], v[240:243]
    v_mfma_f32_16x16x32_bf16 v[244:247], v[92:95], v[100:103], v[244:247]
    v_mfma_f32_16x16x32_bf16 v[248:251], v[92:95], v[104:107], v[248:251]
    v_mfma_f32_16x16x32_bf16 v[252:255], v[92:95], v[108:111], v[252:255]
    ds_read_b128 v[92:95], v32 offset:12288
    s_waitcnt vmcnt(6)
    s_barrier
    s_waitcnt lgkmcnt(13)
    v_mfma_f32_16x16x32_bf16 v[128:131], v[64:67], v[112:115], v[128:131]
    s_waitcnt lgkmcnt(11)
    v_mfma_f32_16x16x32_bf16 v[132:135], v[64:67], v[116:119], v[132:135]
    s_waitcnt lgkmcnt(8)
    v_mfma_f32_16x16x32_bf16 v[136:139], v[64:67], v[120:123], v[136:139]
    s_waitcnt lgkmcnt(6)
    v_mfma_f32_16x16x32_bf16 v[140:143], v[64:67], v[124:127], v[140:143]
    ds_read_b128 v[64:67], v9 offset:0
    ds_read_b64_tr_b16 v[96:97], v25 offset:0
    ds_read_b64_tr_b16 v[98:99], v25 offset:2048
    v_mfma_f32_16x16x32_bf16 v[144:147], v[68:71], v[112:115], v[144:147]
    v_mfma_f32_16x16x32_bf16 v[148:151], v[68:71], v[116:119], v[148:151]
    v_mfma_f32_16x16x32_bf16 v[152:155], v[68:71], v[120:123], v[152:155]
    v_mfma_f32_16x16x32_bf16 v[156:159], v[68:71], v[124:127], v[156:159]
    ds_read_b128 v[68:71], v10 offset:0
    ds_read_b64_tr_b16 v[100:101], v26 offset:0
    ds_read_b64_tr_b16 v[102:103], v26 offset:2048
    s_waitcnt lgkmcnt(11)
    v_mfma_f32_16x16x32_bf16 v[160:163], v[72:75], v[112:115], v[160:163]
    v_mfma_f32_16x16x32_bf16 v[164:167], v[72:75], v[116:119], v[164:167]
    v_mfma_f32_16x16x32_bf16 v[168:171], v[72:75], v[120:123], v[168:171]
    v_mfma_f32_16x16x32_bf16 v[172:175], v[72:75], v[124:127], v[172:175]
    ds_read_b128 v[72:75], v9 offset:4096
    ds_read_b64_tr_b16 v[104:105], v27 offset:0
    ds_read_b64_tr_b16 v[106:107], v27 offset:2048
    s_waitcnt lgkmcnt(13)
    v_mfma_f32_16x16x32_bf16 v[176:179], v[76:79], v[112:115], v[176:179]
    v_mfma_f32_16x16x32_bf16 v[180:183], v[76:79], v[116:119], v[180:183]
    v_mfma_f32_16x16x32_bf16 v[184:187], v[76:79], v[120:123], v[184:187]
    v_mfma_f32_16x16x32_bf16 v[188:191], v[76:79], v[124:127], v[188:191]
    ds_read_b128 v[76:79], v10 offset:4096
    ds_read_b64_tr_b16 v[108:109], v28 offset:0
    ds_read_b64_tr_b16 v[110:111], v28 offset:2048
    s_waitcnt lgkmcnt(15)
    v_mfma_f32_16x16x32_bf16 v[192:195], v[80:83], v[112:115], v[192:195]
    v_mfma_f32_16x16x32_bf16 v[196:199], v[80:83], v[116:119], v[196:199]
    v_mfma_f32_16x16x32_bf16 v[200:203], v[80:83], v[120:123], v[200:203]
    v_mfma_f32_16x16x32_bf16 v[204:207], v[80:83], v[124:127], v[204:207]
    ds_read_b128 v[80:83], v9 offset:8192
    s_add_u32 m0, s42, 131072
    s_mov_b32 s47, 3670016
    s_waitcnt lgkmcnt(15)
    v_mfma_f32_16x16x32_bf16 v[208:211], v[84:87], v[112:115], v[208:211]
    v_mfma_f32_16x16x32_bf16 v[212:215], v[84:87], v[116:119], v[212:215]
    v_mfma_f32_16x16x32_bf16 v[216:219], v[84:87], v[120:123], v[216:219]
    v_mfma_f32_16x16x32_bf16 v[220:223], v[84:87], v[124:127], v[220:223]
    ds_read_b128 v[84:87], v10 offset:8192
    buffer_load_dwordx4 v6, s[20:23], s47 offen lds
    s_add_u32 m0, s42, 132096
    s_waitcnt lgkmcnt(15)
    v_mfma_f32_16x16x32_bf16 v[224:227], v[88:91], v[112:115], v[224:227]
    v_mfma_f32_16x16x32_bf16 v[228:231], v[88:91], v[116:119], v[228:231]
    v_mfma_f32_16x16x32_bf16 v[232:235], v[88:91], v[120:123], v[232:235]
    v_mfma_f32_16x16x32_bf16 v[236:239], v[88:91], v[124:127], v[236:239]
    ds_read_b128 v[88:91], v9 offset:12288
    s_mov_b32 s47, 3670016
    buffer_load_dwordx4 v7, s[20:23], s47 offen lds
    s_waitcnt lgkmcnt(15)
    v_mfma_f32_16x16x32_bf16 v[240:243], v[92:95], v[112:115], v[240:243]
    v_mfma_f32_16x16x32_bf16 v[244:247], v[92:95], v[116:119], v[244:247]
    v_mfma_f32_16x16x32_bf16 v[248:251], v[92:95], v[120:123], v[248:251]
    v_mfma_f32_16x16x32_bf16 v[252:255], v[92:95], v[124:127], v[252:255]
    ds_read_b128 v[92:95], v10 offset:12288
    s_waitcnt vmcnt(6)
    s_barrier
    s_waitcnt lgkmcnt(13)
    v_mfma_f32_16x16x32_bf16 v[128:131], v[64:67], v[96:99], v[128:131]
    s_waitcnt lgkmcnt(10)
    v_mfma_f32_16x16x32_bf16 v[132:135], v[64:67], v[100:103], v[132:135]
    s_waitcnt lgkmcnt(7)
    v_mfma_f32_16x16x32_bf16 v[136:139], v[64:67], v[104:107], v[136:139]
    s_waitcnt lgkmcnt(4)
    v_mfma_f32_16x16x32_bf16 v[140:143], v[64:67], v[108:111], v[140:143]
    ds_read_b128 v[64:67], v23 offset:0
    ds_read_b64_tr_b16 v[112:113], v25 offset:16384
    ds_read_b64_tr_b16 v[114:115], v25 offset:18432
    v_mfma_f32_16x16x32_bf16 v[144:147], v[68:71], v[96:99], v[144:147]
    v_mfma_f32_16x16x32_bf16 v[148:151], v[68:71], v[100:103], v[148:151]
    v_mfma_f32_16x16x32_bf16 v[152:155], v[68:71], v[104:107], v[152:155]
    v_mfma_f32_16x16x32_bf16 v[156:159], v[68:71], v[108:111], v[156:159]
    ds_read_b128 v[68:71], v24 offset:0
    ds_read_b64_tr_b16 v[116:117], v26 offset:16384
    ds_read_b64_tr_b16 v[118:119], v26 offset:18432
    v_mfma_f32_16x16x32_bf16 v[160:163], v[72:75], v[96:99], v[160:163]
    v_mfma_f32_16x16x32_bf16 v[164:167], v[72:75], v[100:103], v[164:167]
    v_mfma_f32_16x16x32_bf16 v[168:171], v[72:75], v[104:107], v[168:171]
    v_mfma_f32_16x16x32_bf16 v[172:175], v[72:75], v[108:111], v[172:175]
    ds_read_b128 v[72:75], v23 offset:4096
    ds_read_b64_tr_b16 v[120:121], v27 offset:16384
    ds_read_b64_tr_b16 v[122:123], v27 offset:18432
    v_mfma_f32_16x16x32_bf16 v[176:179], v[76:79], v[96:99], v[176:179]
    v_mfma_f32_16x16x32_bf16 v[180:183], v[76:79], v[100:103], v[180:183]
    v_mfma_f32_16x16x32_bf16 v[184:187], v[76:79], v[104:107], v[184:187]
    v_mfma_f32_16x16x32_bf16 v[188:191], v[76:79], v[108:111], v[188:191]
    ds_read_b128 v[76:79], v24 offset:4096
    ds_read_b64_tr_b16 v[124:125], v28 offset:16384
    ds_read_b64_tr_b16 v[126:127], v28 offset:18432
    s_waitcnt lgkmcnt(15)
    v_mfma_f32_16x16x32_bf16 v[192:195], v[80:83], v[96:99], v[192:195]
    v_mfma_f32_16x16x32_bf16 v[196:199], v[80:83], v[100:103], v[196:199]
    v_mfma_f32_16x16x32_bf16 v[200:203], v[80:83], v[104:107], v[200:203]
    v_mfma_f32_16x16x32_bf16 v[204:207], v[80:83], v[108:111], v[204:207]
    ds_read_b128 v[80:83], v23 offset:8192
    s_add_u32 m0, s42, 147456
    s_mov_b32 s47, 3932160
    s_waitcnt lgkmcnt(15)
    v_mfma_f32_16x16x32_bf16 v[208:211], v[84:87], v[96:99], v[208:211]
    v_mfma_f32_16x16x32_bf16 v[212:215], v[84:87], v[100:103], v[212:215]
    v_mfma_f32_16x16x32_bf16 v[216:219], v[84:87], v[104:107], v[216:219]
    v_mfma_f32_16x16x32_bf16 v[220:223], v[84:87], v[108:111], v[220:223]
    ds_read_b128 v[84:87], v24 offset:8192
    buffer_load_dwordx4 v6, s[20:23], s47 offen lds
    s_add_u32 m0, s42, 148480
    s_waitcnt lgkmcnt(15)
    v_mfma_f32_16x16x32_bf16 v[224:227], v[88:91], v[96:99], v[224:227]
    v_mfma_f32_16x16x32_bf16 v[228:231], v[88:91], v[100:103], v[228:231]
    v_mfma_f32_16x16x32_bf16 v[232:235], v[88:91], v[104:107], v[232:235]
    v_mfma_f32_16x16x32_bf16 v[236:239], v[88:91], v[108:111], v[236:239]
    ds_read_b128 v[88:91], v23 offset:12288
    s_mov_b32 s47, 3932160
    buffer_load_dwordx4 v7, s[20:23], s47 offen lds
    s_waitcnt lgkmcnt(15)
    v_mfma_f32_16x16x32_bf16 v[240:243], v[92:95], v[96:99], v[240:243]
    v_mfma_f32_16x16x32_bf16 v[244:247], v[92:95], v[100:103], v[244:247]
    v_mfma_f32_16x16x32_bf16 v[248:251], v[92:95], v[104:107], v[248:251]
    v_mfma_f32_16x16x32_bf16 v[252:255], v[92:95], v[108:111], v[252:255]
    ds_read_b128 v[92:95], v24 offset:12288
    s_waitcnt vmcnt(2)
    s_barrier
    s_waitcnt lgkmcnt(13)
    v_mfma_f32_16x16x32_bf16 v[128:131], v[64:67], v[112:115], v[128:131]
    s_waitcnt lgkmcnt(10)
    v_mfma_f32_16x16x32_bf16 v[132:135], v[64:67], v[116:119], v[132:135]
    s_waitcnt lgkmcnt(7)
    v_mfma_f32_16x16x32_bf16 v[136:139], v[64:67], v[120:123], v[136:139]
    s_waitcnt lgkmcnt(4)
    v_mfma_f32_16x16x32_bf16 v[140:143], v[64:67], v[124:127], v[140:143]
    ds_read_b128 v[64:67], v9 offset:32768
    ds_read_b64_tr_b16 v[96:97], v25 offset:32768
    v_mfma_f32_16x16x32_bf16 v[144:147], v[68:71], v[112:115], v[144:147]
    v_mfma_f32_16x16x32_bf16 v[148:151], v[68:71], v[116:119], v[148:151]
    v_mfma_f32_16x16x32_bf16 v[152:155], v[68:71], v[120:123], v[152:155]
    v_mfma_f32_16x16x32_bf16 v[156:159], v[68:71], v[124:127], v[156:159]
    ds_read_b128 v[68:71], v10 offset:32768
    ds_read_b64_tr_b16 v[98:99], v25 offset:34816
    v_mfma_f32_16x16x32_bf16 v[160:163], v[72:75], v[112:115], v[160:163]
    v_mfma_f32_16x16x32_bf16 v[164:167], v[72:75], v[116:119], v[164:167]
    v_mfma_f32_16x16x32_bf16 v[168:171], v[72:75], v[120:123], v[168:171]
    v_mfma_f32_16x16x32_bf16 v[172:175], v[72:75], v[124:127], v[172:175]
    ds_read_b128 v[72:75], v9 offset:36864
    ds_read_b64_tr_b16 v[100:101], v26 offset:32768
    v_mfma_f32_16x16x32_bf16 v[176:179], v[76:79], v[112:115], v[176:179]
    v_mfma_f32_16x16x32_bf16 v[180:183], v[76:79], v[116:119], v[180:183]
    v_mfma_f32_16x16x32_bf16 v[184:187], v[76:79], v[120:123], v[184:187]
    v_mfma_f32_16x16x32_bf16 v[188:191], v[76:79], v[124:127], v[188:191]
    ds_read_b128 v[76:79], v10 offset:36864
    ds_read_b64_tr_b16 v[102:103], v26 offset:34816
    s_waitcnt lgkmcnt(11)
    v_mfma_f32_16x16x32_bf16 v[192:195], v[80:83], v[112:115], v[192:195]
    v_mfma_f32_16x16x32_bf16 v[196:199], v[80:83], v[116:119], v[196:199]
    v_mfma_f32_16x16x32_bf16 v[200:203], v[80:83], v[120:123], v[200:203]
    v_mfma_f32_16x16x32_bf16 v[204:207], v[80:83], v[124:127], v[204:207]
    ds_read_b128 v[80:83], v9 offset:40960
    ds_read_b64_tr_b16 v[104:105], v27 offset:32768
    s_waitcnt lgkmcnt(12)
    v_mfma_f32_16x16x32_bf16 v[208:211], v[84:87], v[112:115], v[208:211]
    v_mfma_f32_16x16x32_bf16 v[212:215], v[84:87], v[116:119], v[212:215]
    v_mfma_f32_16x16x32_bf16 v[216:219], v[84:87], v[120:123], v[216:219]
    v_mfma_f32_16x16x32_bf16 v[220:223], v[84:87], v[124:127], v[220:223]
    ds_read_b128 v[84:87], v10 offset:40960
    ds_read_b64_tr_b16 v[106:107], v27 offset:34816
    s_waitcnt lgkmcnt(13)
    v_mfma_f32_16x16x32_bf16 v[224:227], v[88:91], v[112:115], v[224:227]
    v_mfma_f32_16x16x32_bf16 v[228:231], v[88:91], v[116:119], v[228:231]
    v_mfma_f32_16x16x32_bf16 v[232:235], v[88:91], v[120:123], v[232:235]
    v_mfma_f32_16x16x32_bf16 v[236:239], v[88:91], v[124:127], v[236:239]
    ds_read_b128 v[88:91], v9 offset:45056
    ds_read_b64_tr_b16 v[108:109], v28 offset:32768
    s_waitcnt lgkmcnt(14)
    v_mfma_f32_16x16x32_bf16 v[240:243], v[92:95], v[112:115], v[240:243]
    v_mfma_f32_16x16x32_bf16 v[244:247], v[92:95], v[116:119], v[244:247]
    v_mfma_f32_16x16x32_bf16 v[248:251], v[92:95], v[120:123], v[248:251]
    v_mfma_f32_16x16x32_bf16 v[252:255], v[92:95], v[124:127], v[252:255]
    ds_read_b128 v[92:95], v10 offset:45056
    ds_read_b64_tr_b16 v[110:111], v28 offset:34816
    s_waitcnt vmcnt(0)
    s_barrier
    s_waitcnt lgkmcnt(12)
    v_mfma_f32_16x16x32_bf16 v[128:131], v[64:67], v[96:99], v[128:131]
    s_waitcnt lgkmcnt(8)
    v_mfma_f32_16x16x32_bf16 v[132:135], v[64:67], v[100:103], v[132:135]
    s_waitcnt lgkmcnt(4)
    v_mfma_f32_16x16x32_bf16 v[136:139], v[64:67], v[104:107], v[136:139]
    s_waitcnt lgkmcnt(0)
    v_mfma_f32_16x16x32_bf16 v[140:143], v[64:67], v[108:111], v[140:143]
    ds_read_b128 v[64:67], v23 offset:32768
    ds_read_b64_tr_b16 v[112:113], v25 offset:49152
    v_mfma_f32_16x16x32_bf16 v[144:147], v[68:71], v[96:99], v[144:147]
    v_mfma_f32_16x16x32_bf16 v[148:151], v[68:71], v[100:103], v[148:151]
    v_mfma_f32_16x16x32_bf16 v[152:155], v[68:71], v[104:107], v[152:155]
    v_mfma_f32_16x16x32_bf16 v[156:159], v[68:71], v[108:111], v[156:159]
    ds_read_b128 v[68:71], v24 offset:32768
    ds_read_b64_tr_b16 v[114:115], v25 offset:51200
    v_mfma_f32_16x16x32_bf16 v[160:163], v[72:75], v[96:99], v[160:163]
    v_mfma_f32_16x16x32_bf16 v[164:167], v[72:75], v[100:103], v[164:167]
    v_mfma_f32_16x16x32_bf16 v[168:171], v[72:75], v[104:107], v[168:171]
    v_mfma_f32_16x16x32_bf16 v[172:175], v[72:75], v[108:111], v[172:175]
    ds_read_b128 v[72:75], v23 offset:36864
    ds_read_b64_tr_b16 v[116:117], v26 offset:49152
    v_mfma_f32_16x16x32_bf16 v[176:179], v[76:79], v[96:99], v[176:179]
    v_mfma_f32_16x16x32_bf16 v[180:183], v[76:79], v[100:103], v[180:183]
    v_mfma_f32_16x16x32_bf16 v[184:187], v[76:79], v[104:107], v[184:187]
    v_mfma_f32_16x16x32_bf16 v[188:191], v[76:79], v[108:111], v[188:191]
    ds_read_b128 v[76:79], v24 offset:36864
    ds_read_b64_tr_b16 v[118:119], v26 offset:51200
    v_mfma_f32_16x16x32_bf16 v[192:195], v[80:83], v[96:99], v[192:195]
    v_mfma_f32_16x16x32_bf16 v[196:199], v[80:83], v[100:103], v[196:199]
    v_mfma_f32_16x16x32_bf16 v[200:203], v[80:83], v[104:107], v[200:203]
    v_mfma_f32_16x16x32_bf16 v[204:207], v[80:83], v[108:111], v[204:207]
    ds_read_b128 v[80:83], v23 offset:40960
    ds_read_b64_tr_b16 v[120:121], v27 offset:49152
    v_mfma_f32_16x16x32_bf16 v[208:211], v[84:87], v[96:99], v[208:211]
    v_mfma_f32_16x16x32_bf16 v[212:215], v[84:87], v[100:103], v[212:215]
    v_mfma_f32_16x16x32_bf16 v[216:219], v[84:87], v[104:107], v[216:219]
    v_mfma_f32_16x16x32_bf16 v[220:223], v[84:87], v[108:111], v[220:223]
    ds_read_b128 v[84:87], v24 offset:40960
    ds_read_b64_tr_b16 v[122:123], v27 offset:51200
    v_mfma_f32_16x16x32_bf16 v[224:227], v[88:91], v[96:99], v[224:227]
    v_mfma_f32_16x16x32_bf16 v[228:231], v[88:91], v[100:103], v[228:231]
    v_mfma_f32_16x16x32_bf16 v[232:235], v[88:91], v[104:107], v[232:235]
    v_mfma_f32_16x16x32_bf16 v[236:239], v[88:91], v[108:111], v[236:239]
    ds_read_b128 v[88:91], v23 offset:45056
    ds_read_b64_tr_b16 v[124:125], v28 offset:49152
    v_mfma_f32_16x16x32_bf16 v[240:243], v[92:95], v[96:99], v[240:243]
    v_mfma_f32_16x16x32_bf16 v[244:247], v[92:95], v[100:103], v[244:247]
    v_mfma_f32_16x16x32_bf16 v[248:251], v[92:95], v[104:107], v[248:251]
    v_mfma_f32_16x16x32_bf16 v[252:255], v[92:95], v[108:111], v[252:255]
    ds_read_b128 v[92:95], v24 offset:45056
    ds_read_b64_tr_b16 v[126:127], v28 offset:51200
    s_waitcnt lgkmcnt(12)
    v_mfma_f32_16x16x32_bf16 v[128:131], v[64:67], v[112:115], v[128:131]
    s_waitcnt lgkmcnt(8)
    v_mfma_f32_16x16x32_bf16 v[132:135], v[64:67], v[116:119], v[132:135]
    s_waitcnt lgkmcnt(4)
    v_mfma_f32_16x16x32_bf16 v[136:139], v[64:67], v[120:123], v[136:139]
    s_waitcnt lgkmcnt(0)
    v_mfma_f32_16x16x32_bf16 v[140:143], v[64:67], v[124:127], v[140:143]
    v_mfma_f32_16x16x32_bf16 v[144:147], v[68:71], v[112:115], v[144:147]
    v_mfma_f32_16x16x32_bf16 v[148:151], v[68:71], v[116:119], v[148:151]
    v_mfma_f32_16x16x32_bf16 v[152:155], v[68:71], v[120:123], v[152:155]
    v_mfma_f32_16x16x32_bf16 v[156:159], v[68:71], v[124:127], v[156:159]
    v_mfma_f32_16x16x32_bf16 v[160:163], v[72:75], v[112:115], v[160:163]
    v_mfma_f32_16x16x32_bf16 v[164:167], v[72:75], v[116:119], v[164:167]
    v_mfma_f32_16x16x32_bf16 v[168:171], v[72:75], v[120:123], v[168:171]
    v_mfma_f32_16x16x32_bf16 v[172:175], v[72:75], v[124:127], v[172:175]
    v_mfma_f32_16x16x32_bf16 v[176:179], v[76:79], v[112:115], v[176:179]
    v_mfma_f32_16x16x32_bf16 v[180:183], v[76:79], v[116:119], v[180:183]
    v_mfma_f32_16x16x32_bf16 v[184:187], v[76:79], v[120:123], v[184:187]
    v_mfma_f32_16x16x32_bf16 v[188:191], v[76:79], v[124:127], v[188:191]
    v_mfma_f32_16x16x32_bf16 v[192:195], v[80:83], v[112:115], v[192:195]
    v_mfma_f32_16x16x32_bf16 v[196:199], v[80:83], v[116:119], v[196:199]
    v_mfma_f32_16x16x32_bf16 v[200:203], v[80:83], v[120:123], v[200:203]
    v_mfma_f32_16x16x32_bf16 v[204:207], v[80:83], v[124:127], v[204:207]
    v_mfma_f32_16x16x32_bf16 v[208:211], v[84:87], v[112:115], v[208:211]
    v_mfma_f32_16x16x32_bf16 v[212:215], v[84:87], v[116:119], v[212:215]
    v_mfma_f32_16x16x32_bf16 v[216:219], v[84:87], v[120:123], v[216:219]
    v_mfma_f32_16x16x32_bf16 v[220:223], v[84:87], v[124:127], v[220:223]
    v_mfma_f32_16x16x32_bf16 v[224:227], v[88:91], v[112:115], v[224:227]
    v_mfma_f32_16x16x32_bf16 v[228:231], v[88:91], v[116:119], v[228:231]
    v_mfma_f32_16x16x32_bf16 v[232:235], v[88:91], v[120:123], v[232:235]
    v_mfma_f32_16x16x32_bf16 v[236:239], v[88:91], v[124:127], v[236:239]
    v_mfma_f32_16x16x32_bf16 v[240:243], v[92:95], v[112:115], v[240:243]
    v_mfma_f32_16x16x32_bf16 v[244:247], v[92:95], v[116:119], v[244:247]
    v_mfma_f32_16x16x32_bf16 v[248:251], v[92:95], v[120:123], v[248:251]
    v_mfma_f32_16x16x32_bf16 v[252:255], v[92:95], v[124:127], v[252:255]
    s_lshl_b32 s45, s43, 1
    s_lshr_b32 s46, s40, 1
    s_add_u32 s45, s45, s46
    s_lshl_b32 s45, s45, 19
    s_lshl_b32 s46, s37, 3
    s_lshl_b32 s48, s39, 2
    s_add_u32 s46, s46, s48
    s_lshl_b32 s46, s46, 13
    s_add_u32 s45, s45, s46
    s_and_b32 s46, s40, 1
    s_lshl_b32 s46, s46, 12
    s_add_u32 s49, s45, s46
    v_cvt_pk_bf16_f32 v64, v128, v129
    v_cvt_pk_bf16_f32 v65, v130, v131
    v_cvt_pk_bf16_f32 v66, v144, v145
    v_cvt_pk_bf16_f32 v67, v146, v147
    s_add_u32 s48, s49, 0
    buffer_store_dwordx4 v[64:67], v11, s[24:27], s48 offen offset:0
    v_cvt_pk_bf16_f32 v68, v160, v161
    v_cvt_pk_bf16_f32 v69, v162, v163
    v_cvt_pk_bf16_f32 v70, v176, v177
    v_cvt_pk_bf16_f32 v71, v178, v179
    s_add_u32 s48, s49, 8192
    buffer_store_dwordx4 v[68:71], v11, s[24:27], s48 offen offset:0
    v_cvt_pk_bf16_f32 v72, v192, v193
    v_cvt_pk_bf16_f32 v73, v194, v195
    v_cvt_pk_bf16_f32 v74, v208, v209
    v_cvt_pk_bf16_f32 v75, v210, v211
    s_add_u32 s48, s49, 16384
    buffer_store_dwordx4 v[72:75], v11, s[24:27], s48 offen offset:0
    v_cvt_pk_bf16_f32 v76, v224, v225
    v_cvt_pk_bf16_f32 v77, v226, v227
    v_cvt_pk_bf16_f32 v78, v240, v241
    v_cvt_pk_bf16_f32 v79, v242, v243
    s_add_u32 s48, s49, 24576
    buffer_store_dwordx4 v[76:79], v11, s[24:27], s48 offen offset:0
    v_cvt_pk_bf16_f32 v80, v132, v133
    v_cvt_pk_bf16_f32 v81, v134, v135
    v_cvt_pk_bf16_f32 v82, v148, v149
    v_cvt_pk_bf16_f32 v83, v150, v151
    s_add_u32 s48, s49, 0
    buffer_store_dwordx4 v[80:83], v11, s[24:27], s48 offen offset:256
    v_cvt_pk_bf16_f32 v84, v164, v165
    v_cvt_pk_bf16_f32 v85, v166, v167
    v_cvt_pk_bf16_f32 v86, v180, v181
    v_cvt_pk_bf16_f32 v87, v182, v183
    s_add_u32 s48, s49, 8192
    buffer_store_dwordx4 v[84:87], v11, s[24:27], s48 offen offset:256
    v_cvt_pk_bf16_f32 v88, v196, v197
    v_cvt_pk_bf16_f32 v89, v198, v199
    v_cvt_pk_bf16_f32 v90, v212, v213
    v_cvt_pk_bf16_f32 v91, v214, v215
    s_add_u32 s48, s49, 16384
    buffer_store_dwordx4 v[88:91], v11, s[24:27], s48 offen offset:256
    v_cvt_pk_bf16_f32 v92, v228, v229
    v_cvt_pk_bf16_f32 v93, v230, v231
    v_cvt_pk_bf16_f32 v94, v244, v245
    v_cvt_pk_bf16_f32 v95, v246, v247
    s_add_u32 s48, s49, 24576
    buffer_store_dwordx4 v[92:95], v11, s[24:27], s48 offen offset:256
    v_cvt_pk_bf16_f32 v64, v136, v137
    v_cvt_pk_bf16_f32 v65, v138, v139
    v_cvt_pk_bf16_f32 v66, v152, v153
    v_cvt_pk_bf16_f32 v67, v154, v155
    s_add_u32 s48, s49, 2048
    buffer_store_dwordx4 v[64:67], v11, s[24:27], s48 offen offset:0
    v_cvt_pk_bf16_f32 v68, v168, v169
    v_cvt_pk_bf16_f32 v69, v170, v171
    v_cvt_pk_bf16_f32 v70, v184, v185
    v_cvt_pk_bf16_f32 v71, v186, v187
    s_add_u32 s48, s49, 10240
    buffer_store_dwordx4 v[68:71], v11, s[24:27], s48 offen offset:0
    v_cvt_pk_bf16_f32 v72, v200, v201
    v_cvt_pk_bf16_f32 v73, v202, v203
    v_cvt_pk_bf16_f32 v74, v216, v217
    v_cvt_pk_bf16_f32 v75, v218, v219
    s_add_u32 s48, s49, 18432
    buffer_store_dwordx4 v[72:75], v11, s[24:27], s48 offen offset:0
    v_cvt_pk_bf16_f32 v76, v232, v233
    v_cvt_pk_bf16_f32 v77, v234, v235
    v_cvt_pk_bf16_f32 v78, v248, v249
    v_cvt_pk_bf16_f32 v79, v250, v251
    s_add_u32 s48, s49, 26624
    buffer_store_dwordx4 v[76:79], v11, s[24:27], s48 offen offset:0
    v_cvt_pk_bf16_f32 v80, v140, v141
    v_cvt_pk_bf16_f32 v81, v142, v143
    v_cvt_pk_bf16_f32 v82, v156, v157
    v_cvt_pk_bf16_f32 v83, v158, v159
    s_add_u32 s48, s49, 2048
    buffer_store_dwordx4 v[80:83], v11, s[24:27], s48 offen offset:256
    v_cvt_pk_bf16_f32 v84, v172, v173
    v_cvt_pk_bf16_f32 v85, v174, v175
    v_cvt_pk_bf16_f32 v86, v188, v189
    v_cvt_pk_bf16_f32 v87, v190, v191
    s_add_u32 s48, s49, 10240
    buffer_store_dwordx4 v[84:87], v11, s[24:27], s48 offen offset:256
    v_cvt_pk_bf16_f32 v88, v204, v205
    v_cvt_pk_bf16_f32 v89, v206, v207
    v_cvt_pk_bf16_f32 v90, v220, v221
    v_cvt_pk_bf16_f32 v91, v222, v223
    s_add_u32 s48, s49, 18432
    buffer_store_dwordx4 v[88:91], v11, s[24:27], s48 offen offset:256
    v_cvt_pk_bf16_f32 v92, v236, v237
    v_cvt_pk_bf16_f32 v93, v238, v239
    v_cvt_pk_bf16_f32 v94, v252, v253
    v_cvt_pk_bf16_f32 v95, v254, v255
    s_add_u32 s48, s49, 26624
    buffer_store_dwordx4 v[92:95], v11, s[24:27], s48 offen offset:256
K1_LN:
    s_cmp_ge_u32 s3, 2
    s_cbranch_scc1 K1_END
    s_waitcnt vmcnt(16)
    v_lshlrev_b32 v64, 16, v40
    v_and_b32 v65, 0xffff0000, v40
    v_lshlrev_b32 v66, 16, v41
    v_and_b32 v67, 0xffff0000, v41
    v_lshlrev_b32 v68, 16, v42
    v_and_b32 v69, 0xffff0000, v42
    v_lshlrev_b32 v70, 16, v43
    v_and_b32 v71, 0xffff0000, v43
    v_lshlrev_b32 v72, 16, v44
    v_and_b32 v73, 0xffff0000, v44
    v_lshlrev_b32 v74, 16, v45
    v_and_b32 v75, 0xffff0000, v45
    v_lshlrev_b32 v76, 16, v46
    v_and_b32 v77, 0xffff0000, v46
    v_lshlrev_b32 v78, 16, v47
    v_and_b32 v79, 0xffff0000, v47
    v_lshlrev_b32 v80, 16, v48
    v_and_b32 v81, 0xffff0000, v48
    v_lshlrev_b32 v82, 16, v49
    v_and_b32 v83, 0xffff0000, v49
    v_lshlrev_b32 v84, 16, v50
    v_and_b32 v85, 0xffff0000, v50
    v_lshlrev_b32 v86, 16, v51
    v_and_b32 v87, 0xffff0000, v51
    v_lshlrev_b32 v88, 16, v52
    v_and_b32 v89, 0xffff0000, v52
    v_lshlrev_b32 v90, 16, v53
    v_and_b32 v91, 0xffff0000, v53
    v_lshlrev_b32 v92, 16, v54
    v_and_b32 v93, 0xffff0000, v54
    v_lshlrev_b32 v94, 16, v55
    v_and_b32 v95, 0xffff0000, v55
    v_lshlrev_b32 v96, 16, v56
    v_and_b32 v97, 0xffff0000, v56
    v_lshlrev_b32 v98, 16, v57
    v_and_b32 v99, 0xffff0000, v57
    v_lshlrev_b32 v100, 16, v58
    v_and_b32 v101, 0xffff0000, v58
    v_lshlrev_b32 v102, 16, v59
    v_and_b32 v103, 0xffff0000, v59
    v_add_f32 v2, v64, v65
    v_add_f32 v2, v2, v66
    v_add_f32 v2, v2, v67
    v_add_f32 v2, v2, v68
    v_add_f32 v2, v2, v69
    v_add_f32 v2, v2, v70
    v_add_f32 v2, v2, v71
    v_add_f32 v2, v2, v72
    v_add_f32 v2, v2, v73
    v_add_f32 v2, v2, v74
    v_add_f32 v2, v2, v75
    v_add_f32 v2, v2, v76
    v_add_f32 v2, v2, v77
    v_add_f32 v2, v2, v78
    v_add_f32 v2, v2, v79
    v_add_f32 v2, v2, v80
    v_add_f32 v2, v2, v81
    v_add_f32 v2, v2, v82
    v_add_f32 v2, v2, v83
    v_add_f32 v2, v2, v84
    v_add_f32 v2, v2, v85
    v_add_f32 v2, v2, v86
    v_add_f32 v2, v2, v87
    v_add_f32 v2, v2, v88
    v_add_f32 v2, v2, v89
    v_add_f32 v2, v2, v90
    v_add_f32 v2, v2, v91
    v_add_f32 v2, v2, v92
    v_add_f32 v2, v2, v93
    v_add_f32 v2, v2, v94
    v_add_f32 v2, v2, v95
    v_add_f32 v2, v2, v96
    v_add_f32 v2, v2, v97
    v_add_f32 v2, v2, v98
    v_add_f32 v2, v2, v99
    v_add_f32 v2, v2, v100
    v_add_f32 v2, v2, v101
    v_add_f32 v2, v2, v102
    v_add_f32 v2, v2, v103
    s_nop 1
    v_add_f32_dpp v3, v2, v2 row_ror:8 row_mask:0xf bank_mask:0xf
    v_mov_b32 v2, v3
    s_nop 1
    v_add_f32_dpp v3, v2, v2 row_ror:4 row_mask:0xf bank_mask:0xf
    v_mov_b32 v2, v3
    s_nop 1
    v_add_f32_dpp v3, v2, v2 row_ror:2 row_mask:0xf bank_mask:0xf
    v_mov_b32 v2, v3
    s_nop 1
    v_add_f32_dpp v3, v2, v2 row_ror:1 row_mask:0xf bank_mask:0xf
    v_mov_b32 v2, v3
    v_mul_f32 v2, 0x3acccccd, v2
    v_sub_f32 v64, v64, v2
    v_sub_f32 v65, v65, v2
    v_sub_f32 v66, v66, v2
    v_sub_f32 v67, v67, v2
    v_sub_f32 v68, v68, v2
    v_sub_f32 v69, v69, v2
    v_sub_f32 v70, v70, v2
    v_sub_f32 v71, v71, v2
    v_sub_f32 v72, v72, v2
    v_sub_f32 v73, v73, v2
    v_sub_f32 v74, v74, v2
    v_sub_f32 v75, v75, v2
    v_sub_f32 v76, v76, v2
    v_sub_f32 v77, v77, v2
    v_sub_f32 v78, v78, v2
    v_sub_f32 v79, v79, v2
    v_sub_f32 v80, v80, v2
    v_sub_f32 v81, v81, v2
    v_sub_f32 v82, v82, v2
    v_sub_f32 v83, v83, v2
    v_sub_f32 v84, v84, v2
    v_sub_f32 v85, v85, v2
    v_sub_f32 v86, v86, v2
    v_sub_f32 v87, v87, v2
    v_sub_f32 v88, v88, v2
    v_sub_f32 v89, v89, v2
    v_sub_f32 v90, v90, v2
    v_sub_f32 v91, v91, v2
    v_sub_f32 v92, v92, v2
    v_sub_f32 v93, v93, v2
    v_sub_f32 v94, v94, v2
    v_sub_f32 v95, v95, v2
    v_sub_f32 v96, v96, v2
    v_sub_f32 v97, v97, v2
    v_sub_f32 v98, v98, v2
    v_sub_f32 v99, v99, v2
    v_sub_f32 v100, v100, v2
    v_sub_f32 v101, v101, v2
    v_sub_f32 v102, v102, v2
    v_sub_f32 v103, v103, v2
    v_mul_f32 v2, v64, v64
    v_fmac_f32 v2, v65, v65
    v_fmac_f32 v2, v66, v66
    v_fmac_f32 v2, v67, v67
    v_fmac_f32 v2, v68, v68
    v_fmac_f32 v2, v69, v69
    v_fmac_f32 v2, v70, v70
    v_fmac_f32 v2, v71, v71
    v_fmac_f32 v2, v72, v72
    v_fmac_f32 v2, v73, v73
    v_fmac_f32 v2, v74, v74
    v_fmac_f32 v2, v75, v75
    v_fmac_f32 v2, v76, v76
    v_fmac_f32 v2, v77, v77
    v_fmac_f32 v2, v78, v78
    v_fmac_f32 v2, v79, v79
    v_fmac_f32 v2, v80, v80
    v_fmac_f32 v2, v81, v81
    v_fmac_f32 v2, v82, v82
    v_fmac_f32 v2, v83, v83
    v_fmac_f32 v2, v84, v84
    v_fmac_f32 v2, v85, v85
    v_fmac_f32 v2, v86, v86
    v_fmac_f32 v2, v87, v87
    v_fmac_f32 v2, v88, v88
    v_fmac_f32 v2, v89, v89
    v_fmac_f32 v2, v90, v90
    v_fmac_f32 v2, v91, v91
    v_fmac_f32 v2, v92, v92
    v_fmac_f32 v2, v93, v93
    v_fmac_f32 v2, v94, v94
    v_fmac_f32 v2, v95, v95
    v_fmac_f32 v2, v96, v96
    v_fmac_f32 v2, v97, v97
    v_fmac_f32 v2, v98, v98
    v_fmac_f32 v2, v99, v99
    v_fmac_f32 v2, v100, v100
    v_fmac_f32 v2, v101, v101
    v_fmac_f32 v2, v102, v102
    v_fmac_f32 v2, v103, v103
    s_nop 1
    v_add_f32_dpp v3, v2, v2 row_ror:8 row_mask:0xf bank_mask:0xf
    v_mov_b32 v2, v3
    s_nop 1
    v_add_f32_dpp v3, v2, v2 row_ror:4 row_mask:0xf bank_mask:0xf
    v_mov_b32 v2, v3
    s_nop 1
    v_add_f32_dpp v3, v2, v2 row_ror:2 row_mask:0xf bank_mask:0xf
    v_mov_b32 v2, v3
    s_nop 1
    v_add_f32_dpp v3, v2, v2 row_ror:1 row_mask:0xf bank_mask:0xf
    v_mov_b32 v2, v3
    v_mov_b32 v3, 0x3727c5ac
    v_fmac_f32 v3, 0x3acccccd, v2
    v_rsq_f32 v2, v3
    s_nop 0
    v_mul_f32 v64, v64, v2
    v_mul_f32 v65, v65, v2
    v_mul_f32 v66, v66, v2
    v_mul_f32 v67, v67, v2
    v_mul_f32 v68, v68, v2
    v_mul_f32 v69, v69, v2
    v_mul_f32 v70, v70, v2
    v_mul_f32 v71, v71, v2
    v_mul_f32 v72, v72, v2
    v_mul_f32 v73, v73, v2
    v_mul_f32 v74, v74, v2
    v_mul_f32 v75, v75, v2
    v_mul_f32 v76, v76, v2
    v_mul_f32 v77, v77, v2
    v_mul_f32 v78, v78, v2
    v_mul_f32 v79, v79, v2
    v_mul_f32 v80, v80, v2
    v_mul_f32 v81, v81, v2
    v_mul_f32 v82, v82, v2
    v_mul_f32 v83, v83, v2
    v_mul_f32 v84, v84, v2
    v_mul_f32 v85, v85, v2
    v_mul_f32 v86, v86, v2
    v_mul_f32 v87, v87, v2
    v_mul_f32 v88, v88, v2
    v_mul_f32 v89, v89, v2
    v_mul_f32 v90, v90, v2
    v_mul_f32 v91, v91, v2
    v_mul_f32 v92, v92, v2
    v_mul_f32 v93, v93, v2
    v_mul_f32 v94, v94, v2
    v_mul_f32 v95, v95, v2
    v_mul_f32 v96, v96, v2
    v_mul_f32 v97, v97, v2
    v_mul_f32 v98, v98, v2
    v_mul_f32 v99, v99, v2
    v_mul_f32 v100, v100, v2
    v_mul_f32 v101, v101, v2
    v_mul_f32 v102, v102, v2
    v_mul_f32 v103, v103, v2
    v_lshrrev_b32 v2, 5, v37
    s_mov_b32 s46, 40960
    v_mul_lo_u32 v2, v2, s46
    v_and_b32 v3, 31, v37
    v_lshl_add_u32 v2, v3, 4, v2
    v_and_b32 v3, 15, v0
    v_lshrrev_b32 v3, 1, v3
    v_lshl_add_u32 v2, v3, 10, v2
    v_and_b32 v3, 1, v0
    v_lshl_add_u32 v2, v3, 9, v2
    v_cvt_pk_bf16_f32 v40, v64, v65
    v_cvt_pk_bf16_f32 v41, v66, v67
    v_cvt_pk_bf16_f32 v42, v68, v69
    v_cvt_pk_bf16_f32 v43, v70, v71
    s_mov_b32 s46, 0
    buffer_store_dwordx4 v[40:43], v2, s[32:35], s46 offen
    v_cvt_pk_bf16_f32 v44, v72, v73
    v_cvt_pk_bf16_f32 v45, v74, v75
    v_cvt_pk_bf16_f32 v46, v76, v77
    v_cvt_pk_bf16_f32 v47, v78, v79
    s_mov_b32 s46, 8192
    buffer_store_dwordx4 v[44:47], v2, s[32:35], s46 offen
    v_cvt_pk_bf16_f32 v48, v80, v81
    v_cvt_pk_bf16_f32 v49, v82, v83
    v_cvt_pk_bf16_f32 v50, v84, v85
    v_cvt_pk_bf16_f32 v51, v86, v87
    s_mov_b32 s46, 16384
    buffer_store_dwordx4 v[48:51], v2, s[32:35], s46 offen
    v_cvt_pk_bf16_f32 v52, v88, v89
    v_cvt_pk_bf16_f32 v53, v90, v91
    v_cvt_pk_bf16_f32 v54, v92, v93
    v_cvt_pk_bf16_f32 v55, v94, v95
    s_mov_b32 s46, 24576
    buffer_store_dwordx4 v[52:55], v2, s[32:35], s46 offen
    v_cvt_pk_bf16_f32 v56, v96, v97
    v_cvt_pk_bf16_f32 v57, v98, v99
    v_cvt_pk_bf16_f32 v58, v100, v101
    v_cvt_pk_bf16_f32 v59, v102, v103
    s_mov_b32 s46, 32768
    buffer_store_dwordx4 v[56:59], v2, s[32:35], s46 offen
K1_END:
    s_endpgm
.globl k2_kernel
.p2align 8
.type k2_kernel,@function
k2_kernel:
    s_cmp_ge_u32 s2, 256
    s_cbranch_scc1 K2_END
    s_load_dwordx2 s[42:43], s[0:1], 16
    s_load_dwordx2 s[44:45], s[0:1], 104
    s_load_dwordx2 s[80:81], s[0:1], 40
    s_load_dwordx2 s[82:83], s[0:1], 72
    s_load_dwordx2 s[84:85], s[0:1], 56
    v_lshrrev_b32 v1, 6, v0
    v_and_b32 v0, 63, v0
    v_readfirstlane_b32 s3, v1
    s_lshr_b32 s4, s3, 2
    s_and_b32 s5, s3, 3
    s_and_b32 s6, s2, 7
    s_lshl_b32 s6, s6, 2
    s_lshr_b32 s7, s2, 3
    s_and_b32 s46, s7, 3
    s_add_u32 s6, s6, s46
    s_lshr_b32 s7, s2, 5
    s_lshl_b32 s40, s3, 11
    s_mov_b32 s36, 0x3e0293ee
    s_mov_b32 s37, 0x5d800000
    s_waitcnt lgkmcnt(0)
    s_mov_b32 s8, s44
    s_mov_b32 s9, s45
    s_mov_b32 s10, 2621440
    s_mov_b32 s11, 0x00020000
    s_mov_b32 s12, s42
    s_mov_b32 s13, s43
    s_mov_b32 s14, 5242880
    s_mov_b32 s15, 0x00020000
    s_add_u32 s16, s44, 4194304
    s_addc_u32 s17, s45, 0
    s_mov_b32 s18, 16777216
    s_mov_b32 s19, 0x00020000
    s_add_u32 s20, s44, 20971520
    s_addc_u32 s21, s45, 0
    s_mov_b32 s22, 16777216
    s_mov_b32 s23, 0x00020000
    s_add_u32 s24, s44, 37748736
    s_addc_u32 s25, s45, 0
    s_mov_b32 s26, 16777216
    s_mov_b32 s27, 0x00020000
    v_lshlrev_b32 v1, 4, v0
    s_sub_u32 s47, 15, s7
    s_cmp_eq_u32 s4, 0
    s_cselect_b32 s46, s47, s7
    s_lshl_b32 s46, s46, 2
    s_add_u32 s46, s46, s5
    s_mul_i32 s46, s46, 40960
    v_lshrrev_b32 v11, 4, v0
    v_and_b32 v12, 15, v0
    v_lshlrev_b32 v13, 2, v11
    v_xor_b32 v12, v12, v13
    v_lshlrev_b32 v12, 4, v12
    s_lshl_b32 s47, s3, 3
    v_add_u32 v11, s47, v11
    v_lshlrev_b32 v11, 13, v11
    s_lshl_b32 s47, s6, 8
    v_add3_u32 v10, v11, v12, s47
    v_and_b32 v11, 15, v0
    v_lshrrev_b32 v12, 2, v11
    v_and_b32 v13, 3, v11
    v_lshrrev_b32 v14, 5, v0
    v_lshlrev_b32 v14, 3, v14
    v_add_u32 v14, v14, v12
    v_lshlrev_b32 v14, 8, v14
    v_lshrrev_b32 v15, 4, v0
    v_and_b32 v15, 1, v15
    v_lshlrev_b32 v15, 1, v15
    v_and_b32 v11, 1, v13
    v_add_u32 v15, v15, v11
    v_lshlrev_b32 v12, 2, v12
    v_xor_b32 v15, v15, v12
    v_lshlrev_b32 v15, 4, v15
    v_lshrrev_b32 v13, 1, v13
    v_lshlrev_b32 v13, 3, v13
    v_add3_u32 v14, v14, v15, v13
    v_add_u32 v4, 98304, v14
    v_xor_b32 v5, 64, v4
    v_xor_b32 v8, 128, v4
    v_xor_b32 v9, 192, v4
    s_add_u32 m0, s40, 98304
    s_mov_b32 s47, 0
    buffer_load_dwordx4 v10, s[12:15], s47 offen lds
    s_add_u32 m0, s40, 99328
    s_mov_b32 s47, 32768
    buffer_load_dwordx4 v10, s[12:15], s47 offen lds
    s_add_u32 m0, s40, 114688
    s_mov_b32 s47, 524288
    buffer_load_dwordx4 v10, s[12:15], s47 offen lds
    s_add_u32 m0, s40, 115712
    s_mov_b32 s47, 557056
    buffer_load_dwordx4 v10, s[12:15], s47 offen lds
    s_add_u32 m0, s40, 131072
    s_mov_b32 s47, 1048576
    buffer_load_dwordx4 v10, s[12:15], s47 offen lds
    s_add_u32 m0, s40, 132096
    s_mov_b32 s47, 1081344
    buffer_load_dwordx4 v10, s[12:15], s47 offen lds
    s_add_u32 s47, s46, 0
    buffer_load_dwordx4 v[96:99], v1, s[8:11], s47 offen
    s_add_u32 s47, s46, 1024
    buffer_load_dwordx4 v[100:103], v1, s[8:11], s47 offen
    s_add_u32 s47, s46, 2048
    buffer_load_dwordx4 v[104:107], v1, s[8:11], s47 offen
    s_add_u32 s47, s46, 3072
    buffer_load_dwordx4 v[108:111], v1, s[8:11], s47 offen
    s_add_u32 s47, s46, 4096
    buffer_load_dwordx4 v[112:115], v1, s[8:11], s47 offen
    s_add_u32 s47, s46, 5120
    buffer_load_dwordx4 v[116:119], v1, s[8:11], s47 offen
    s_add_u32 s47, s46, 6144
    buffer_load_dwordx4 v[120:123], v1, s[8:11], s47 offen
    s_lshl_b32 s61, s2, 3
    s_add_u32 s61, s61, s3
    s_mul_i32 s62, s3, 5120
    s_add_u32 s62, s62, 114688
    v_mov_b32 v192, 0
    v_mov_b32 v193, 0
    v_mov_b32 v194, 0
    v_mov_b32 v195, 0
    v_mov_b32 v196, 0
    v_mov_b32 v197, 0
    v_mov_b32 v198, 0
    v_mov_b32 v199, 0
    v_mov_b32 v200, 0
    v_mov_b32 v201, 0
    v_mov_b32 v202, 0
    v_mov_b32 v203, 0
    v_mov_b32 v204, 0
    v_mov_b32 v205, 0
    v_mov_b32 v206, 0
    v_mov_b32 v207, 0
    v_mov_b32 v208, 0
    v_mov_b32 v209, 0
    v_mov_b32 v210, 0
    v_mov_b32 v211, 0
    v_mov_b32 v212, 0
    v_mov_b32 v213, 0
    v_mov_b32 v214, 0
    v_mov_b32 v215, 0
    v_mov_b32 v216, 0
    v_mov_b32 v217, 0
    v_mov_b32 v218, 0
    v_mov_b32 v219, 0
    v_mov_b32 v220, 0
    v_mov_b32 v221, 0
    v_mov_b32 v222, 0
    v_mov_b32 v223, 0
    v_mov_b32 v224, 0
    v_mov_b32 v225, 0
    v_mov_b32 v226, 0
    v_mov_b32 v227, 0
    v_mov_b32 v228, 0
    v_mov_b32 v229, 0
    v_mov_b32 v230, 0
    v_mov_b32 v231, 0
    v_mov_b32 v232, 0
    v_mov_b32 v233, 0
    v_mov_b32 v234, 0
    v_mov_b32 v235, 0
    v_mov_b32 v236, 0
    v_mov_b32 v237, 0
    v_mov_b32 v238, 0
    v_mov_b32 v239, 0
    v_mov_b32 v240, 0
    v_mov_b32 v241, 0
    v_mov_b32 v242, 0
    v_mov_b32 v243, 0
    v_mov_b32 v244, 0
    v_mov_b32 v245, 0
    v_mov_b32 v246, 0
    v_mov_b32 v247, 0
    v_mov_b32 v248, 0
    v_mov_b32 v249, 0
    v_mov_b32 v250, 0
    v_mov_b32 v251, 0
    v_mov_b32 v252, 0
    v_mov_b32 v253, 0
    v_mov_b32 v254, 0
    v_mov_b32 v255, 0
    v_add_u32 v15, s40, v1
    s_lshl_b32 s48, s6, 19
    s_mov_b32 s32, 0
    s_mov_b32 s33, 49152
    s_mov_b32 s34, s48
    s_mov_b32 s35, s48
    s_waitcnt vmcnt(11)
    s_barrier
    ds_read_b64_tr_b16 v[32:33], v4 offset:0
    ds_read_b64_tr_b16 v[34:35], v4 offset:1024
    ds_read_b64_tr_b16 v[36:37], v5 offset:0
    ds_read_b64_tr_b16 v[38:39], v5 offset:1024
    ds_read_b64_tr_b16 v[40:41], v8 offset:0
    ds_read_b64_tr_b16 v[42:43], v8 offset:1024
    ds_read_b64_tr_b16 v[44:45], v9 offset:0
    ds_read_b64_tr_b16 v[46:47], v9 offset:1024
    s_waitcnt vmcnt(9)
    s_barrier
    s_waitcnt vmcnt(6)
    s_waitcnt lgkmcnt(6)
    v_mfma_f32_32x32x16_bf16 v[192:207], v[32:35], v[96:99], v[192:207]
    s_add_u32 m0, s40, 147456
    s_mov_b32 s47, 1572864
    buffer_load_dwordx4 v10, s[12:15], s47 offen lds
    s_add_u32 m0, s40, 148480
    s_waitcnt lgkmcnt(4)
    v_mfma_f32_32x32x16_bf16 v[208:223], v[36:39], v[96:99], v[208:223]
    s_mov_b32 s47, 1605632
    buffer_load_dwordx4 v10, s[12:15], s47 offen lds
    ds_read_b64_tr_b16 v[48:49], v4 offset:4096
    ds_read_b64_tr_b16 v[50:51], v4 offset:5120
    s_waitcnt lgkmcnt(4)
    v_mfma_f32_32x32x16_bf16 v[224:239], v[40:43], v[96:99], v[224:239]
    ds_read_b64_tr_b16 v[52:53], v5 offset:4096
    ds_read_b64_tr_b16 v[54:55], v5 offset:5120
    ds_read_b64_tr_b16 v[56:57], v8 offset:4096
    ds_read_b64_tr_b16 v[58:59], v8 offset:5120
    s_waitcnt lgkmcnt(6)
    v_mfma_f32_32x32x16_bf16 v[240:255], v[44:47], v[96:99], v[240:255]
    ds_read_b64_tr_b16 v[60:61], v9 offset:4096
    ds_read_b64_tr_b16 v[62:63], v9 offset:5120
    s_add_u32 s47, s46, 7168
    buffer_load_dwordx4 v[124:127], v1, s[8:11], s47 offen
    s_waitcnt vmcnt(8)
    s_waitcnt lgkmcnt(6)
    v_mfma_f32_32x32x16_bf16 v[192:207], v[48:51], v[100:103], v[192:207]
    ds_read_b64_tr_b16 v[32:33], v4 offset:8192
    ds_read_b64_tr_b16 v[34:35], v4 offset:9216
    s_waitcnt lgkmcnt(6)
    v_mfma_f32_32x32x16_bf16 v[208:223], v[52:55], v[100:103], v[208:223]
    ds_read_b64_tr_b16 v[36:37], v5 offset:8192
    ds_read_b64_tr_b16 v[38:39], v5 offset:9216
    ds_read_b64_tr_b16 v[40:41], v8 offset:8192
    s_waitcnt lgkmcnt(7)
    v_mfma_f32_32x32x16_bf16 v[224:239], v[56:59], v[100:103], v[224:239]
    ds_read_b64_tr_b16 v[42:43], v8 offset:9216
    ds_read_b64_tr_b16 v[44:45], v9 offset:8192
    s_waitcnt lgkmcnt(7)
    v_mfma_f32_32x32x16_bf16 v[240:255], v[60:63], v[100:103], v[240:255]
    ds_read_b64_tr_b16 v[46:47], v9 offset:9216
    s_add_u32 s47, s46, 8192
    buffer_load_dwordx4 v[96:99], v1, s[8:11], s47 offen
    s_waitcnt vmcnt(8)
    s_waitcnt lgkmcnt(6)
    v_mfma_f32_32x32x16_bf16 v[192:207], v[32:35], v[104:107], v[192:207]
    ds_read_b64_tr_b16 v[48:49], v4 offset:12288
    ds_read_b64_tr_b16 v[50:51], v4 offset:13312
    s_waitcnt lgkmcnt(6)
    v_mfma_f32_32x32x16_bf16 v[208:223], v[36:39], v[104:107], v[208:223]
    ds_read_b64_tr_b16 v[52:53], v5 offset:12288
    ds_read_b64_tr_b16 v[54:55], v5 offset:13312
    ds_read_b64_tr_b16 v[56:57], v8 offset:12288
    s_waitcnt lgkmcnt(7)
    v_mfma_f32_32x32x16_bf16 v[224:239], v[40:43], v[104:107], v[224:239]
    ds_read_b64_tr_b16 v[58:59], v8 offset:13312
    ds_read_b64_tr_b16 v[60:61], v9 offset:12288
    s_waitcnt lgkmcnt(7)
    v_mfma_f32_32x32x16_bf16 v[240:255], v[44:47], v[104:107], v[240:255]
    ds_read_b64_tr_b16 v[62:63], v9 offset:13312
    s_add_u32 s47, s46, 9216
    buffer_load_dwordx4 v[100:103], v1, s[8:11], s47 offen
    s_waitcnt vmcnt(8)
    s_waitcnt lgkmcnt(6)
    v_mfma_f32_32x32x16_bf16 v[192:207], v[48:51], v[108:111], v[192:207]
    ds_read_b64_tr_b16 v[32:33], v4 offset:16384
    ds_read_b64_tr_b16 v[34:35], v4 offset:17408
    s_waitcnt lgkmcnt(6)
    v_mfma_f32_32x32x16_bf16 v[208:223], v[52:55], v[108:111], v[208:223]
    ds_read_b64_tr_b16 v[36:37], v5 offset:16384
    ds_read_b64_tr_b16 v[38:39], v5 offset:17408
    ds_read_b64_tr_b16 v[40:41], v8 offset:16384
    s_waitcnt lgkmcnt(7)
    v_mfma_f32_32x32x16_bf16 v[224:239], v[56:59], v[108:111], v[224:239]
    ds_read_b64_tr_b16 v[42:43], v8 offset:17408
    ds_read_b64_tr_b16 v[44:45], v9 offset:16384
    s_waitcnt lgkmcnt(7)
    v_mfma_f32_32x32x16_bf16 v[240:255], v[60:63], v[108:111], v[240:255]
    ds_read_b64_tr_b16 v[46:47], v9 offset:17408
    s_add_u32 s47, s46, 10240
    buffer_load_dwordx4 v[104:107], v1, s[8:11], s47 offen
    s_waitcnt vmcnt(13)
    s_barrier
    s_waitcnt vmcnt(8)
    s_waitcnt lgkmcnt(6)
    v_mfma_f32_32x32x16_bf16 v[192:207], v[32:35], v[112:115], v[192:207]
    s_add_u32 m0, s40, 98304
    s_mov_b32 s47, 2097152
    buffer_load_dwordx4 v10, s[12:15], s47 offen lds
    s_add_u32 m0, s40, 99328
    s_waitcnt lgkmcnt(4)
    v_mfma_f32_32x32x16_bf16 v[208:223], v[36:39], v[112:115], v[208:223]
    s_mov_b32 s47, 2129920
    buffer_load_dwordx4 v10, s[12:15], s47 offen lds
    ds_read_b64_tr_b16 v[48:49], v4 offset:20480
    ds_read_b64_tr_b16 v[50:51], v4 offset:21504
    s_waitcnt lgkmcnt(4)
    v_mfma_f32_32x32x16_bf16 v[224:239], v[40:43], v[112:115], v[224:239]
    ds_read_b64_tr_b16 v[52:53], v5 offset:20480
    ds_read_b64_tr_b16 v[54:55], v5 offset:21504
    ds_read_b64_tr_b16 v[56:57], v8 offset:20480
    ds_read_b64_tr_b16 v[58:59], v8 offset:21504
    s_waitcnt lgkmcnt(6)
    v_mfma_f32_32x32x16_bf16 v[240:255], v[44:47], v[112:115], v[240:255]
    ds_read_b64_tr_b16 v[60:61], v9 offset:20480
    ds_read_b64_tr_b16 v[62:63], v9 offset:21504
    s_add_u32 s47, s46, 11264
    buffer_load_dwordx4 v[108:111], v1, s[8:11], s47 offen
    s_waitcnt vmcnt(10)
    s_waitcnt lgkmcnt(6)
    v_mfma_f32_32x32x16_bf16 v[192:207], v[48:51], v[116:119], v[192:207]
    ds_read_b64_tr_b16 v[32:33], v4 offset:24576
    ds_read_b64_tr_b16 v[34:35], v4 offset:25600
    s_waitcnt lgkmcnt(6)
    v_mfma_f32_32x32x16_bf16 v[208:223], v[52:55], v[116:119], v[208:223]
    ds_read_b64_tr_b16 v[36:37], v5 offset:24576
    ds_read_b64_tr_b16 v[38:39], v5 offset:25600
    ds_read_b64_tr_b16 v[40:41], v8 offset:24576
    s_waitcnt lgkmcnt(7)
    v_mfma_f32_32x32x16_bf16 v[224:239], v[56:59], v[116:119], v[224:239]
    ds_read_b64_tr_b16 v[42:43], v8 offset:25600
    ds_read_b64_tr_b16 v[44:45], v9 offset:24576
    s_waitcnt lgkmcnt(7)
    v_mfma_f32_32x32x16_bf16 v[240:255], v[60:63], v[116:119], v[240:255]
    ds_read_b64_tr_b16 v[46:47], v9 offset:25600
    s_add_u32 s47, s46, 12288
    buffer_load_dwordx4 v[112:115], v1, s[8:11], s47 offen
    s_waitcnt vmcnt(10)
    s_waitcnt lgkmcnt(6)
    v_mfma_f32_32x32x16_bf16 v[192:207], v[32:35], v[120:123], v[192:207]
    ds_read_b64_tr_b16 v[48:49], v4 offset:28672
    ds_read_b64_tr_b16 v[50:51], v4 offset:29696
    s_waitcnt lgkmcnt(6)
    v_mfma_f32_32x32x16_bf16 v[208:223], v[36:39], v[120:123], v[208:223]
    ds_read_b64_tr_b16 v[52:53], v5 offset:28672
    ds_read_b64_tr_b16 v[54:55], v5 offset:29696
    ds_read_b64_tr_b16 v[56:57], v8 offset:28672
    s_waitcnt lgkmcnt(7)
    v_mfma_f32_32x32x16_bf16 v[224:239], v[40:43], v[120:123], v[224:239]
    ds_read_b64_tr_b16 v[58:59], v8 offset:29696
    ds_read_b64_tr_b16 v[60:61], v9 offset:28672
    s_waitcnt lgkmcnt(7)
    v_mfma_f32_32x32x16_bf16 v[240:255], v[44:47], v[120:123], v[240:255]
    ds_read_b64_tr_b16 v[62:63], v9 offset:29696
    s_add_u32 s47, s46, 13312
    buffer_load_dwordx4 v[116:119], v1, s[8:11], s47 offen
    s_waitcnt vmcnt(8)
    s_waitcnt lgkmcnt(6)
    v_mfma_f32_32x32x16_bf16 v[192:207], v[48:51], v[124:127], v[192:207]
    ds_read_b64_tr_b16 v[32:33], v4 offset:32768
    ds_read_b64_tr_b16 v[34:35], v4 offset:33792
    s_waitcnt lgkmcnt(6)
    v_mfma_f32_32x32x16_bf16 v[208:223], v[52:55], v[124:127], v[208:223]
    ds_read_b64_tr_b16 v[36:37], v5 offset:32768
    ds_read_b64_tr_b16 v[38:39], v5 offset:33792
    ds_read_b64_tr_b16 v[40:41], v8 offset:32768
    s_waitcnt lgkmcnt(7)
    v_mfma_f32_32x32x16_bf16 v[224:239], v[56:59], v[124:127], v[224:239]
    ds_read_b64_tr_b16 v[42:43], v8 offset:33792
    ds_read_b64_tr_b16 v[44:45], v9 offset:32768
    s_waitcnt lgkmcnt(7)
    v_mfma_f32_32x32x16_bf16 v[240:255], v[60:63], v[124:127], v[240:255]
    ds_read_b64_tr_b16 v[46:47], v9 offset:33792
    s_add_u32 s47, s46, 14336
    buffer_load_dwordx4 v[120:123], v1, s[8:11], s47 offen
    s_waitcnt vmcnt(10)
    s_barrier
    s_waitcnt vmcnt(8)
    s_waitcnt lgkmcnt(6)
    v_mfma_f32_32x32x16_bf16 v[192:207], v[32:35], v[96:99], v[192:207]
    s_add_u32 m0, s40, 114688
    s_mov_b32 s47, 2621440
    buffer_load_dwordx4 v10, s[12:15], s47 offen lds
    s_add_u32 m0, s40, 115712
    s_waitcnt lgkmcnt(4)
    v_mfma_f32_32x32x16_bf16 v[208:223], v[36:39], v[96:99], v[208:223]
    s_mov_b32 s47, 2654208
    buffer_load_dwordx4 v10, s[12:15], s47 offen lds
    ds_read_b64_tr_b16 v[48:49], v4 offset:36864
    ds_read_b64_tr_b16 v[50:51], v4 offset:37888
    s_waitcnt lgkmcnt(4)
    v_mfma_f32_32x32x16_bf16 v[224:239], v[40:43], v[96:99], v[224:239]
    ds_read_b64_tr_b16 v[52:53], v5 offset:36864
    ds_read_b64_tr_b16 v[54:55], v5 offset:37888
    ds_read_b64_tr_b16 v[56:57], v8 offset:36864
    ds_read_b64_tr_b16 v[58:59], v8 offset:37888
    s_waitcnt lgkmcnt(6)
    v_mfma_f32_32x32x16_bf16 v[240:255], v[44:47], v[96:99], v[240:255]
    ds_read_b64_tr_b16 v[60:61], v9 offset:36864
    ds_read_b64_tr_b16 v[62:63], v9 offset:37888
    s_add_u32 s47, s46, 15360
    buffer_load_dwordx4 v[124:127], v1, s[8:11], s47 offen
    s_waitcnt vmcnt(10)
    s_waitcnt lgkmcnt(6)
    v_mfma_f32_32x32x16_bf16 v[192:207], v[48:51], v[100:103], v[192:207]
    ds_read_b64_tr_b16 v[32:33], v4 offset:40960
    ds_read_b64_tr_b16 v[34:35], v4 offset:41984
    s_waitcnt lgkmcnt(6)
    v_mfma_f32_32x32x16_bf16 v[208:223], v[52:55], v[100:103], v[208:223]
    ds_read_b64_tr_b16 v[36:37], v5 offset:40960
    ds_read_b64_tr_b16 v[38:39], v5 offset:41984
    ds_read_b64_tr_b16 v[40:41], v8 offset:40960
    s_waitcnt lgkmcnt(7)
    v_mfma_f32_32x32x16_bf16 v[224:239], v[56:59], v[100:103], v[224:239]
    ds_read_b64_tr_b16 v[42:43], v8 offset:41984
    ds_read_b64_tr_b16 v[44:45], v9 offset:40960
    s_waitcnt lgkmcnt(7)
    v_mfma_f32_32x32x16_bf16 v[240:255], v[60:63], v[100:103], v[240:255]
    ds_read_b64_tr_b16 v[46:47], v9 offset:41984
    s_add_u32 s47, s46, 16384
    buffer_load_dwordx4 v[96:99], v1, s[8:11], s47 offen
    s_waitcnt vmcnt(10)
    s_waitcnt lgkmcnt(6)
    v_mfma_f32_32x32x16_bf16 v[192:207], v[32:35], v[104:107], v[192:207]
    ds_read_b64_tr_b16 v[48:49], v4 offset:45056
    ds_read_b64_tr_b16 v[50:51], v4 offset:46080
    s_waitcnt lgkmcnt(6)
    v_mfma_f32_32x32x16_bf16 v[208:223], v[36:39], v[104:107], v[208:223]
    ds_read_b64_tr_b16 v[52:53], v5 offset:45056
    ds_read_b64_tr_b16 v[54:55], v5 offset:46080
    ds_read_b64_tr_b16 v[56:57], v8 offset:45056
    s_waitcnt lgkmcnt(7)
    v_mfma_f32_32x32x16_bf16 v[224:239], v[40:43], v[104:107], v[224:239]
    ds_read_b64_tr_b16 v[58:59], v8 offset:46080
    ds_read_b64_tr_b16 v[60:61], v9 offset:45056
    s_waitcnt lgkmcnt(7)
    v_mfma_f32_32x32x16_bf16 v[240:255], v[44:47], v[104:107], v[240:255]
    ds_read_b64_tr_b16 v[62:63], v9 offset:46080
    s_add_u32 s47, s46, 17408
    buffer_load_dwordx4 v[100:103], v1, s[8:11], s47 offen
    s_waitcnt vmcnt(8)
    s_waitcnt lgkmcnt(6)
    v_mfma_f32_32x32x16_bf16 v[192:207], v[48:51], v[108:111], v[192:207]
    ds_read_b64_tr_b16 v[32:33], v4 offset:49152
    ds_read_b64_tr_b16 v[34:35], v4 offset:50176
    s_waitcnt lgkmcnt(6)
    v_mfma_f32_32x32x16_bf16 v[208:223], v[52:55], v[108:111], v[208:223]
    ds_read_b64_tr_b16 v[36:37], v5 offset:49152
    ds_read_b64_tr_b16 v[38:39], v5 offset:50176
    ds_read_b64_tr_b16 v[40:41], v8 offset:49152
    s_waitcnt lgkmcnt(7)
    v_mfma_f32_32x32x16_bf16 v[224:239], v[56:59], v[108:111], v[224:239]
    ds_read_b64_tr_b16 v[42:43], v8 offset:50176
    ds_read_b64_tr_b16 v[44:45], v9 offset:49152
    s_waitcnt lgkmcnt(7)
    v_mfma_f32_32x32x16_bf16 v[240:255], v[60:63], v[108:111], v[240:255]
    ds_read_b64_tr_b16 v[46:47], v9 offset:50176
    s_add_u32 s47, s46, 18432
    buffer_load_dwordx4 v[104:107], v1, s[8:11], s47 offen
    s_waitcnt vmcnt(10)
    s_barrier
    s_waitcnt vmcnt(8)
    s_waitcnt lgkmcnt(6)
    v_mfma_f32_32x32x16_bf16 v[192:207], v[32:35], v[112:115], v[192:207]
    s_add_u32 m0, s40, 131072
    s_mov_b32 s47, 3145728
    buffer_load_dwordx4 v10, s[12:15], s47 offen lds
    s_add_u32 m0, s40, 132096
    s_waitcnt lgkmcnt(4)
    v_mfma_f32_32x32x16_bf16 v[208:223], v[36:39], v[112:115], v[208:223]
    s_mov_b32 s47, 3178496
    buffer_load_dwordx4 v10, s[12:15], s47 offen lds
    ds_read_b64_tr_b16 v[48:49], v4 offset:53248
    ds_read_b64_tr_b16 v[50:51], v4 offset:54272
    s_waitcnt lgkmcnt(4)
    v_mfma_f32_32x32x16_bf16 v[224:239], v[40:43], v[112:115], v[224:239]
    ds_read_b64_tr_b16 v[52:53], v5 offset:53248
    ds_read_b64_tr_b16 v[54:55], v5 offset:54272
    ds_read_b64_tr_b16 v[56:57], v8 offset:53248
    ds_read_b64_tr_b16 v[58:59], v8 offset:54272
    s_waitcnt lgkmcnt(6)
    v_mfma_f32_32x32x16_bf16 v[240:255], v[44:47], v[112:115], v[240:255]
    ds_read_b64_tr_b16 v[60:61], v9 offset:53248
    ds_read_b64_tr_b16 v[62:63], v9 offset:54272
    s_add_u32 s47, s46, 19456
    buffer_load_dwordx4 v[108:111], v1, s[8:11], s47 offen
    s_waitcnt vmcnt(10)
    s_waitcnt lgkmcnt(6)
    v_mfma_f32_32x32x16_bf16 v[192:207], v[48:51], v[116:119], v[192:207]
    ds_read_b64_tr_b16 v[32:33], v4 offset:57344
    ds_read_b64_tr_b16 v[34:35], v4 offset:58368
    s_waitcnt lgkmcnt(6)
    v_mfma_f32_32x32x16_bf16 v[208:223], v[52:55], v[116:119], v[208:223]
    ds_read_b64_tr_b16 v[36:37], v5 offset:57344
    ds_read_b64_tr_b16 v[38:39], v5 offset:58368
    ds_read_b64_tr_b16 v[40:41], v8 offset:57344
    s_waitcnt lgkmcnt(7)
    v_mfma_f32_32x32x16_bf16 v[224:239], v[56:59], v[116:119], v[224:239]
    ds_read_b64_tr_b16 v[42:43], v8 offset:58368
    ds_read_b64_tr_b16 v[44:45], v9 offset:57344
    s_waitcnt lgkmcnt(7)
    v_mfma_f32_32x32x16_bf16 v[240:255], v[60:63], v[116:119], v[240:255]
    ds_read_b64_tr_b16 v[46:47], v9 offset:58368
    s_add_u32 s47, s46, 20480
    buffer_load_dwordx4 v[112:115], v1, s[8:11], s47 offen
    s_waitcnt vmcnt(10)
    s_waitcnt lgkmcnt(6)
    v_mfma_f32_32x32x16_bf16 v[192:207], v[32:35], v[120:123], v[192:207]
    ds_read_b64_tr_b16 v[48:49], v4 offset:61440
    ds_read_b64_tr_b16 v[50:51], v4 offset:62464
    s_waitcnt lgkmcnt(6)
    v_mfma_f32_32x32x16_bf16 v[208:223], v[36:39], v[120:123], v[208:223]
    ds_read_b64_tr_b16 v[52:53], v5 offset:61440
    ds_read_b64_tr_b16 v[54:55], v5 offset:62464
    ds_read_b64_tr_b16 v[56:57], v8 offset:61440
    s_waitcnt lgkmcnt(7)
    v_mfma_f32_32x32x16_bf16 v[224:239], v[40:43], v[120:123], v[224:239]
    ds_read_b64_tr_b16 v[58:59], v8 offset:62464
    ds_read_b64_tr_b16 v[60:61], v9 offset:61440
    s_waitcnt lgkmcnt(7)
    v_mfma_f32_32x32x16_bf16 v[240:255], v[44:47], v[120:123], v[240:255]
    ds_read_b64_tr_b16 v[62:63], v9 offset:62464
    s_add_u32 s47, s46, 21504
    buffer_load_dwordx4 v[116:119], v1, s[8:11], s47 offen
    s_waitcnt vmcnt(8)
    s_waitcnt lgkmcnt(6)
    v_mfma_f32_32x32x16_bf16 v[192:207], v[48:51], v[124:127], v[192:207]
    ds_read_b64_tr_b16 v[32:33], v4 offset:0
    ds_read_b64_tr_b16 v[34:35], v4 offset:1024
    s_waitcnt lgkmcnt(6)
    v_mfma_f32_32x32x16_bf16 v[208:223], v[52:55], v[124:127], v[208:223]
    ds_read_b64_tr_b16 v[36:37], v5 offset:0
    ds_read_b64_tr_b16 v[38:39], v5 offset:1024
    ds_read_b64_tr_b16 v[40:41], v8 offset:0
    s_waitcnt lgkmcnt(7)
    v_mfma_f32_32x32x16_bf16 v[224:239], v[56:59], v[124:127], v[224:239]
    ds_read_b64_tr_b16 v[42:43], v8 offset:1024
    ds_read_b64_tr_b16 v[44:45], v9 offset:0
    s_waitcnt lgkmcnt(7)
    v_mfma_f32_32x32x16_bf16 v[240:255], v[60:63], v[124:127], v[240:255]
    ds_read_b64_tr_b16 v[46:47], v9 offset:1024
    s_add_u32 s47, s46, 22528
    buffer_load_dwordx4 v[120:123], v1, s[8:11], s47 offen
    s_waitcnt vmcnt(10)
    s_barrier
    s_waitcnt vmcnt(8)
    s_waitcnt lgkmcnt(6)
    v_mfma_f32_32x32x16_bf16 v[192:207], v[32:35], v[96:99], v[192:207]
    s_add_u32 m0, s40, 147456
    s_mov_b32 s47, 3670016
    buffer_load_dwordx4 v10, s[12:15], s47 offen lds
    s_add_u32 m0, s40, 148480
    s_waitcnt lgkmcnt(4)
    v_mfma_f32_32x32x16_bf16 v[208:223], v[36:39], v[96:99], v[208:223]
    s_mov_b32 s47, 3702784
    buffer_load_dwordx4 v10, s[12:15], s47 offen lds
    ds_read_b64_tr_b16 v[48:49], v4 offset:4096
    ds_read_b64_tr_b16 v[50:51], v4 offset:5120
    s_waitcnt lgkmcnt(4)
    v_mfma_f32_32x32x16_bf16 v[224:239], v[40:43], v[96:99], v[224:239]
    ds_read_b64_tr_b16 v[52:53], v5 offset:4096
    ds_read_b64_tr_b16 v[54:55], v5 offset:5120
    ds_read_b64_tr_b16 v[56:57], v8 offset:4096
    ds_read_b64_tr_b16 v[58:59], v8 offset:5120
    s_waitcnt lgkmcnt(6)
    v_mfma_f32_32x32x16_bf16 v[240:255], v[44:47], v[96:99], v[240:255]
    ds_read_b64_tr_b16 v[60:61], v9 offset:4096
    ds_read_b64_tr_b16 v[62:63], v9 offset:5120
    s_add_u32 s47, s46, 23552
    buffer_load_dwordx4 v[124:127], v1, s[8:11], s47 offen
    s_waitcnt vmcnt(10)
    s_waitcnt lgkmcnt(6)
    v_mfma_f32_32x32x16_bf16 v[192:207], v[48:51], v[100:103], v[192:207]
    ds_read_b64_tr_b16 v[32:33], v4 offset:8192
    ds_read_b64_tr_b16 v[34:35], v4 offset:9216
    s_waitcnt lgkmcnt(6)
    v_mfma_f32_32x32x16_bf16 v[208:223], v[52:55], v[100:103], v[208:223]
    ds_read_b64_tr_b16 v[36:37], v5 offset:8192
    ds_read_b64_tr_b16 v[38:39], v5 offset:9216
    ds_read_b64_tr_b16 v[40:41], v8 offset:8192
    s_waitcnt lgkmcnt(7)
    v_mfma_f32_32x32x16_bf16 v[224:239], v[56:59], v[100:103], v[224:239]
    ds_read_b64_tr_b16 v[42:43], v8 offset:9216
    ds_read_b64_tr_b16 v[44:45], v9 offset:8192
    s_waitcnt lgkmcnt(7)
    v_mfma_f32_32x32x16_bf16 v[240:255], v[60:63], v[100:103], v[240:255]
    ds_read_b64_tr_b16 v[46:47], v9 offset:9216
    s_add_u32 s47, s46, 24576
    buffer_load_dwordx4 v[96:99], v1, s[8:11], s47 offen
    s_waitcnt vmcnt(10)
    s_waitcnt lgkmcnt(6)
    v_mfma_f32_32x32x16_bf16 v[192:207], v[32:35], v[104:107], v[192:207]
    ds_read_b64_tr_b16 v[48:49], v4 offset:12288
    ds_read_b64_tr_b16 v[50:51], v4 offset:13312
    s_waitcnt lgkmcnt(6)
    v_mfma_f32_32x32x16_bf16 v[208:223], v[36:39], v[104:107], v[208:223]
    ds_read_b64_tr_b16 v[52:53], v5 offset:12288
    ds_read_b64_tr_b16 v[54:55], v5 offset:13312
    ds_read_b64_tr_b16 v[56:57], v8 offset:12288
    s_waitcnt lgkmcnt(7)
    v_mfma_f32_32x32x16_bf16 v[224:239], v[40:43], v[104:107], v[224:239]
    ds_read_b64_tr_b16 v[58:59], v8 offset:13312
    ds_read_b64_tr_b16 v[60:61], v9 offset:12288
    s_waitcnt lgkmcnt(7)
    v_mfma_f32_32x32x16_bf16 v[240:255], v[44:47], v[104:107], v[240:255]
    ds_read_b64_tr_b16 v[62:63], v9 offset:13312
    s_add_u32 s47, s46, 25600
    buffer_load_dwordx4 v[100:103], v1, s[8:11], s47 offen
    s_waitcnt vmcnt(8)
    s_waitcnt lgkmcnt(6)
    v_mfma_f32_32x32x16_bf16 v[192:207], v[48:51], v[108:111], v[192:207]
    ds_read_b64_tr_b16 v[32:33], v4 offset:16384
    ds_read_b64_tr_b16 v[34:35], v4 offset:17408
    s_waitcnt lgkmcnt(6)
    v_mfma_f32_32x32x16_bf16 v[208:223], v[52:55], v[108:111], v[208:223]
    ds_read_b64_tr_b16 v[36:37], v5 offset:16384
    ds_read_b64_tr_b16 v[38:39], v5 offset:17408
    ds_read_b64_tr_b16 v[40:41], v8 offset:16384
    s_waitcnt lgkmcnt(7)
    v_mfma_f32_32x32x16_bf16 v[224:239], v[56:59], v[108:111], v[224:239]
    ds_read_b64_tr_b16 v[42:43], v8 offset:17408
    ds_read_b64_tr_b16 v[44:45], v9 offset:16384
    s_waitcnt lgkmcnt(7)
    v_mfma_f32_32x32x16_bf16 v[240:255], v[60:63], v[108:111], v[240:255]
    ds_read_b64_tr_b16 v[46:47], v9 offset:17408
    s_add_u32 s47, s46, 26624
    buffer_load_dwordx4 v[104:107], v1, s[8:11], s47 offen
    s_waitcnt vmcnt(10)
    s_barrier
    s_waitcnt vmcnt(8)
    s_waitcnt lgkmcnt(6)
    v_mfma_f32_32x32x16_bf16 v[192:207], v[32:35], v[112:115], v[192:207]
    s_add_u32 m0, s40, 98304
    s_mov_b32 s47, 4194304
    buffer_load_dwordx4 v10, s[12:15], s47 offen lds
    s_add_u32 m0, s40, 99328
    s_waitcnt lgkmcnt(4)
    v_mfma_f32_32x32x16_bf16 v[208:223], v[36:39], v[112:115], v[208:223]
    s_mov_b32 s47, 4227072
    buffer_load_dwordx4 v10, s[12:15], s47 offen lds
    ds_read_b64_tr_b16 v[48:49], v4 offset:20480
    ds_read_b64_tr_b16 v[50:51], v4 offset:21504
    s_waitcnt lgkmcnt(4)
    v_mfma_f32_32x32x16_bf16 v[224:239], v[40:43], v[112:115], v[224:239]
    ds_read_b64_tr_b16 v[52:53], v5 offset:20480
    ds_read_b64_tr_b16 v[54:55], v5 offset:21504
    ds_read_b64_tr_b16 v[56:57], v8 offset:20480
    ds_read_b64_tr_b16 v[58:59], v8 offset:21504
    s_waitcnt lgkmcnt(6)
    v_mfma_f32_32x32x16_bf16 v[240:255], v[44:47], v[112:115], v[240:255]
    ds_read_b64_tr_b16 v[60:61], v9 offset:20480
    ds_read_b64_tr_b16 v[62:63], v9 offset:21504
    s_add_u32 s47, s46, 27648
    buffer_load_dwordx4 v[108:111], v1, s[8:11], s47 offen
    s_waitcnt vmcnt(10)
    s_waitcnt lgkmcnt(6)
    v_mfma_f32_32x32x16_bf16 v[192:207], v[48:51], v[116:119], v[192:207]
    ds_read_b64_tr_b16 v[32:33], v4 offset:24576
    ds_read_b64_tr_b16 v[34:35], v4 offset:25600
    s_waitcnt lgkmcnt(6)
    v_mfma_f32_32x32x16_bf16 v[208:223], v[52:55], v[116:119], v[208:223]
    ds_read_b64_tr_b16 v[36:37], v5 offset:24576
    ds_read_b64_tr_b16 v[38:39], v5 offset:25600
    ds_read_b64_tr_b16 v[40:41], v8 offset:24576
    s_waitcnt lgkmcnt(7)
    v_mfma_f32_32x32x16_bf16 v[224:239], v[56:59], v[116:119], v[224:239]
    ds_read_b64_tr_b16 v[42:43], v8 offset:25600
    ds_read_b64_tr_b16 v[44:45], v9 offset:24576
    s_waitcnt lgkmcnt(7)
    v_mfma_f32_32x32x16_bf16 v[240:255], v[60:63], v[116:119], v[240:255]
    ds_read_b64_tr_b16 v[46:47], v9 offset:25600
    s_add_u32 s47, s46, 28672
    buffer_load_dwordx4 v[112:115], v1, s[8:11], s47 offen
    s_waitcnt vmcnt(10)
    s_waitcnt lgkmcnt(6)
    v_mfma_f32_32x32x16_bf16 v[192:207], v[32:35], v[120:123], v[192:207]
    ds_read_b64_tr_b16 v[48:49], v4 offset:28672
    ds_read_b64_tr_b16 v[50:51], v4 offset:29696
    s_waitcnt lgkmcnt(6)
    v_mfma_f32_32x32x16_bf16 v[208:223], v[36:39], v[120:123], v[208:223]
    ds_read_b64_tr_b16 v[52:53], v5 offset:28672
    ds_read_b64_tr_b16 v[54:55], v5 offset:29696
    ds_read_b64_tr_b16 v[56:57], v8 offset:28672
    s_waitcnt lgkmcnt(7)
    v_mfma_f32_32x32x16_bf16 v[224:239], v[40:43], v[120:123], v[224:239]
    ds_read_b64_tr_b16 v[58:59], v8 offset:29696
    ds_read_b64_tr_b16 v[60:61], v9 offset:28672
    s_waitcnt lgkmcnt(7)
    v_mfma_f32_32x32x16_bf16 v[240:255], v[44:47], v[120:123], v[240:255]
    ds_read_b64_tr_b16 v[62:63], v9 offset:29696
    s_add_u32 s47, s46, 29696
    buffer_load_dwordx4 v[116:119], v1, s[8:11], s47 offen
    s_waitcnt vmcnt(8)
    s_waitcnt lgkmcnt(6)
    v_mfma_f32_32x32x16_bf16 v[192:207], v[48:51], v[124:127], v[192:207]
    ds_read_b64_tr_b16 v[32:33], v4 offset:32768
    ds_read_b64_tr_b16 v[34:35], v4 offset:33792
    s_waitcnt lgkmcnt(6)
    v_mfma_f32_32x32x16_bf16 v[208:223], v[52:55], v[124:127], v[208:223]
    ds_read_b64_tr_b16 v[36:37], v5 offset:32768
    ds_read_b64_tr_b16 v[38:39], v5 offset:33792
    ds_read_b64_tr_b16 v[40:41], v8 offset:32768
    s_waitcnt lgkmcnt(7)
    v_mfma_f32_32x32x16_bf16 v[224:239], v[56:59], v[124:127], v[224:239]
    ds_read_b64_tr_b16 v[42:43], v8 offset:33792
    ds_read_b64_tr_b16 v[44:45], v9 offset:32768
    s_waitcnt lgkmcnt(7)
    v_mfma_f32_32x32x16_bf16 v[240:255], v[60:63], v[124:127], v[240:255]
    ds_read_b64_tr_b16 v[46:47], v9 offset:33792
    s_add_u32 s47, s46, 30720
    buffer_load_dwordx4 v[120:123], v1, s[8:11], s47 offen
    s_waitcnt vmcnt(10)
    s_barrier
    s_waitcnt vmcnt(8)
    s_waitcnt lgkmcnt(6)
    v_mfma_f32_32x32x16_bf16 v[192:207], v[32:35], v[96:99], v[192:207]
    s_add_u32 m0, s40, 114688
    s_mov_b32 s47, 4718592
    buffer_load_dwordx4 v10, s[12:15], s47 offen lds
    s_add_u32 m0, s40, 115712
    s_waitcnt lgkmcnt(4)
    v_mfma_f32_32x32x16_bf16 v[208:223], v[36:39], v[96:99], v[208:223]
    s_mov_b32 s47, 4751360
    buffer_load_dwordx4 v10, s[12:15], s47 offen lds
    ds_read_b64_tr_b16 v[48:49], v4 offset:36864
    ds_read_b64_tr_b16 v[50:51], v4 offset:37888
    s_waitcnt lgkmcnt(4)
    v_mfma_f32_32x32x16_bf16 v[224:239], v[40:43], v[96:99], v[224:239]
    ds_read_b64_tr_b16 v[52:53], v5 offset:36864
    ds_read_b64_tr_b16 v[54:55], v5 offset:37888
    ds_read_b64_tr_b16 v[56:57], v8 offset:36864
    ds_read_b64_tr_b16 v[58:59], v8 offset:37888
    s_waitcnt lgkmcnt(6)
    v_mfma_f32_32x32x16_bf16 v[240:255], v[44:47], v[96:99], v[240:255]
    ds_read_b64_tr_b16 v[60:61], v9 offset:36864
    ds_read_b64_tr_b16 v[62:63], v9 offset:37888
    s_add_u32 s47, s46, 31744
    buffer_load_dwordx4 v[124:127], v1, s[8:11], s47 offen
    s_waitcnt vmcnt(10)
    s_waitcnt lgkmcnt(6)
    v_mfma_f32_32x32x16_bf16 v[192:207], v[48:51], v[100:103], v[192:207]
    ds_read_b64_tr_b16 v[32:33], v4 offset:40960
    ds_read_b64_tr_b16 v[34:35], v4 offset:41984
    s_waitcnt lgkmcnt(6)
    v_mfma_f32_32x32x16_bf16 v[208:223], v[52:55], v[100:103], v[208:223]
    ds_read_b64_tr_b16 v[36:37], v5 offset:40960
    ds_read_b64_tr_b16 v[38:39], v5 offset:41984
    ds_read_b64_tr_b16 v[40:41], v8 offset:40960
    s_waitcnt lgkmcnt(7)
    v_mfma_f32_32x32x16_bf16 v[224:239], v[56:59], v[100:103], v[224:239]
    ds_read_b64_tr_b16 v[42:43], v8 offset:41984
    ds_read_b64_tr_b16 v[44:45], v9 offset:40960
    s_waitcnt lgkmcnt(7)
    v_mfma_f32_32x32x16_bf16 v[240:255], v[60:63], v[100:103], v[240:255]
    ds_read_b64_tr_b16 v[46:47], v9 offset:41984
    s_add_u32 s47, s46, 32768
    buffer_load_dwordx4 v[96:99], v1, s[8:11], s47 offen
    s_waitcnt vmcnt(10)
    s_waitcnt lgkmcnt(6)
    v_mfma_f32_32x32x16_bf16 v[192:207], v[32:35], v[104:107], v[192:207]
    ds_read_b64_tr_b16 v[48:49], v4 offset:45056
    ds_read_b64_tr_b16 v[50:51], v4 offset:46080
    s_waitcnt lgkmcnt(6)
    v_mfma_f32_32x32x16_bf16 v[208:223], v[36:39], v[104:107], v[208:223]
    ds_read_b64_tr_b16 v[52:53], v5 offset:45056
    ds_read_b64_tr_b16 v[54:55], v5 offset:46080
    ds_read_b64_tr_b16 v[56:57], v8 offset:45056
    s_waitcnt lgkmcnt(7)
    v_mfma_f32_32x32x16_bf16 v[224:239], v[40:43], v[104:107], v[224:239]
    ds_read_b64_tr_b16 v[58:59], v8 offset:46080
    ds_read_b64_tr_b16 v[60:61], v9 offset:45056
    s_waitcnt lgkmcnt(7)
    v_mfma_f32_32x32x16_bf16 v[240:255], v[44:47], v[104:107], v[240:255]
    ds_read_b64_tr_b16 v[62:63], v9 offset:46080
    s_add_u32 s47, s46, 33792
    buffer_load_dwordx4 v[100:103], v1, s[8:11], s47 offen
    s_waitcnt vmcnt(8)
    s_waitcnt lgkmcnt(6)
    v_mfma_f32_32x32x16_bf16 v[192:207], v[48:51], v[108:111], v[192:207]
    ds_read_b64_tr_b16 v[32:33], v4 offset:49152
    ds_read_b64_tr_b16 v[34:35], v4 offset:50176
    s_waitcnt lgkmcnt(6)
    v_mfma_f32_32x32x16_bf16 v[208:223], v[52:55], v[108:111], v[208:223]
    ds_read_b64_tr_b16 v[36:37], v5 offset:49152
    ds_read_b64_tr_b16 v[38:39], v5 offset:50176
    ds_read_b64_tr_b16 v[40:41], v8 offset:49152
    s_waitcnt lgkmcnt(7)
    v_mfma_f32_32x32x16_bf16 v[224:239], v[56:59], v[108:111], v[224:239]
    ds_read_b64_tr_b16 v[42:43], v8 offset:50176
    ds_read_b64_tr_b16 v[44:45], v9 offset:49152
    s_waitcnt lgkmcnt(7)
    v_mfma_f32_32x32x16_bf16 v[240:255], v[60:63], v[108:111], v[240:255]
    ds_read_b64_tr_b16 v[46:47], v9 offset:50176
    s_add_u32 s47, s46, 34816
    buffer_load_dwordx4 v[104:107], v1, s[8:11], s47 offen
    s_waitcnt vmcnt(10)
    s_barrier
    s_waitcnt vmcnt(8)
    s_waitcnt lgkmcnt(6)
    v_mfma_f32_32x32x16_bf16 v[192:207], v[32:35], v[112:115], v[192:207]
    ds_read_b64_tr_b16 v[48:49], v4 offset:53248
    ds_read_b64_tr_b16 v[50:51], v4 offset:54272
    s_waitcnt lgkmcnt(6)
    v_mfma_f32_32x32x16_bf16 v[208:223], v[36:39], v[112:115], v[208:223]
    ds_read_b64_tr_b16 v[52:53], v5 offset:53248
    ds_read_b64_tr_b16 v[54:55], v5 offset:54272
    ds_read_b64_tr_b16 v[56:57], v8 offset:53248
    s_waitcnt lgkmcnt(7)
    v_mfma_f32_32x32x16_bf16 v[224:239], v[40:43], v[112:115], v[224:239]
    ds_read_b64_tr_b16 v[58:59], v8 offset:54272
    ds_read_b64_tr_b16 v[60:61], v9 offset:53248
    s_waitcnt lgkmcnt(7)
    v_mfma_f32_32x32x16_bf16 v[240:255], v[44:47], v[112:115], v[240:255]
    ds_read_b64_tr_b16 v[62:63], v9 offset:54272
    s_add_u32 s47, s46, 35840
    buffer_load_dwordx4 v[108:111], v1, s[8:11], s47 offen
    s_waitcnt vmcnt(8)
    s_waitcnt lgkmcnt(6)
    v_mfma_f32_32x32x16_bf16 v[192:207], v[48:51], v[116:119], v[192:207]
    s_add_u32 m0, s32, s40
    s_add_u32 s32, s32, 16384
    buffer_load_dwordx4 v15, s[16:19], s34 offen lds
    buffer_load_dwordx4 v15, s[16:19], s34 offen offset:1024 lds
    s_add_u32 s34, s34, 16384
    s_cmp_eq_u32 s32, 49152
    s_cselect_b32 s32, 0, s32
    s_waitcnt lgkmcnt(4)
    v_mfma_f32_32x32x16_bf16 v[208:223], v[52:55], v[116:119], v[208:223]
    s_add_u32 m0, s32, s40
    s_add_u32 s32, s32, 16384
    buffer_load_dwordx4 v15, s[16:19], s34 offen lds
    buffer_load_dwordx4 v15, s[16:19], s34 offen offset:1024 lds
    s_add_u32 s34, s34, 16384
    s_cmp_eq_u32 s32, 49152
    s_cselect_b32 s32, 0, s32
    s_add_u32 m0, s33, s40
    s_waitcnt lgkmcnt(2)
    v_mfma_f32_32x32x16_bf16 v[224:239], v[56:59], v[116:119], v[224:239]
    s_add_u32 s33, s33, 16384
    buffer_load_dwordx4 v15, s[20:23], s35 offen lds
    buffer_load_dwordx4 v15, s[20:23], s35 offen offset:1024 lds
    s_add_u32 s35, s35, 16384
    s_cmp_eq_u32 s33, 114688
    s_cselect_b32 s33, 49152, s33
    ds_read_b64_tr_b16 v[32:33], v4 offset:57344
    ds_read_b64_tr_b16 v[34:35], v4 offset:58368
    s_waitcnt lgkmcnt(2)
    v_mfma_f32_32x32x16_bf16 v[240:255], v[60:63], v[116:119], v[240:255]
    ds_read_b64_tr_b16 v[36:37], v5 offset:57344
    ds_read_b64_tr_b16 v[38:39], v5 offset:58368
    ds_read_b64_tr_b16 v[40:41], v8 offset:57344
    ds_read_b64_tr_b16 v[42:43], v8 offset:58368
    ds_read_b64_tr_b16 v[44:45], v9 offset:57344
    ds_read_b64_tr_b16 v[46:47], v9 offset:58368
    s_add_u32 s47, s46, 36864
    buffer_load_dwordx4 v[112:115], v1, s[8:11], s47 offen
    s_waitcnt vmcnt(14)
    s_waitcnt lgkmcnt(6)
    v_mfma_f32_32x32x16_bf16 v[192:207], v[32:35], v[120:123], v[192:207]
    ds_read_b64_tr_b16 v[48:49], v4 offset:61440
    ds_read_b64_tr_b16 v[50:51], v4 offset:62464
    s_waitcnt lgkmcnt(6)
    v_mfma_f32_32x32x16_bf16 v[208:223], v[36:39], v[120:123], v[208:223]
    ds_read_b64_tr_b16 v[52:53], v5 offset:61440
    ds_read_b64_tr_b16 v[54:55], v5 offset:62464
    ds_read_b64_tr_b16 v[56:57], v8 offset:61440
    s_waitcnt lgkmcnt(7)
    v_mfma_f32_32x32x16_bf16 v[224:239], v[40:43], v[120:123], v[224:239]
    ds_read_b64_tr_b16 v[58:59], v8 offset:62464
    ds_read_b64_tr_b16 v[60:61], v9 offset:61440
    s_waitcnt lgkmcnt(7)
    v_mfma_f32_32x32x16_bf16 v[240:255], v[44:47], v[120:123], v[240:255]
    ds_read_b64_tr_b16 v[62:63], v9 offset:62464
    s_add_u32 s47, s46, 37888
    buffer_load_dwordx4 v[116:119], v1, s[8:11], s47 offen
    s_waitcnt vmcnt(12)
    s_waitcnt lgkmcnt(6)
    v_mfma_f32_32x32x16_bf16 v[192:207], v[48:51], v[124:127], v[192:207]
    ds_read_b64_tr_b16 v[32:33], v4 offset:0
    ds_read_b64_tr_b16 v[34:35], v4 offset:1024
    s_waitcnt lgkmcnt(6)
    v_mfma_f32_32x32x16_bf16 v[208:223], v[52:55], v[124:127], v[208:223]
    ds_read_b64_tr_b16 v[36:37], v5 offset:0
    ds_read_b64_tr_b16 v[38:39], v5 offset:1024
    ds_read_b64_tr_b16 v[40:41], v8 offset:0
    s_waitcnt lgkmcnt(7)
    v_mfma_f32_32x32x16_bf16 v[224:239], v[56:59], v[124:127], v[224:239]
    ds_read_b64_tr_b16 v[42:43], v8 offset:1024
    ds_read_b64_tr_b16 v[44:45], v9 offset:0
    s_waitcnt lgkmcnt(7)
    v_mfma_f32_32x32x16_bf16 v[240:255], v[60:63], v[124:127], v[240:255]
    ds_read_b64_tr_b16 v[46:47], v9 offset:1024
    s_add_u32 s47, s46, 38912
    buffer_load_dwordx4 v[120:123], v1, s[8:11], s47 offen
    s_waitcnt vmcnt(14)
    s_barrier
    s_waitcnt vmcnt(12)
    s_waitcnt lgkmcnt(6)
    v_mfma_f32_32x32x16_bf16 v[192:207], v[32:35], v[96:99], v[192:207]
    ds_read_b64_tr_b16 v[48:49], v4 offset:4096
    ds_read_b64_tr_b16 v[50:51], v4 offset:5120
    s_waitcnt lgkmcnt(6)
    v_mfma_f32_32x32x16_bf16 v[208:223], v[36:39], v[96:99], v[208:223]
    ds_read_b64_tr_b16 v[52:53], v5 offset:4096
    ds_read_b64_tr_b16 v[54:55], v5 offset:5120
    ds_read_b64_tr_b16 v[56:57], v8 offset:4096
    s_waitcnt lgkmcnt(7)
    v_mfma_f32_32x32x16_bf16 v[224:239], v[40:43], v[96:99], v[224:239]
    ds_read_b64_tr_b16 v[58:59], v8 offset:5120
    ds_read_b64_tr_b16 v[60:61], v9 offset:4096
    s_waitcnt lgkmcnt(7)
    v_mfma_f32_32x32x16_bf16 v[240:255], v[44:47], v[96:99], v[240:255]
    ds_read_b64_tr_b16 v[62:63], v9 offset:5120
    s_add_u32 s47, s46, 39936
    buffer_load_dwordx4 v[124:127], v1, s[8:11], s47 offen
    s_waitcnt vmcnt(12)
    s_waitcnt lgkmcnt(6)
    v_mfma_f32_32x32x16_bf16 v[192:207], v[48:51], v[100:103], v[192:207]
    ds_read_b64_tr_b16 v[32:33], v4 offset:8192
    ds_read_b64_tr_b16 v[34:35], v4 offset:9216
    s_waitcnt lgkmcnt(6)
    v_mfma_f32_32x32x16_bf16 v[208:223], v[52:55], v[100:103], v[208:223]
    ds_read_b64_tr_b16 v[36:37], v5 offset:8192
    ds_read_b64_tr_b16 v[38:39], v5 offset:9216
    s_waitcnt lgkmcnt(6)
    v_mfma_f32_32x32x16_bf16 v[224:239], v[56:59], v[100:103], v[224:239]
    ds_read_b64_tr_b16 v[40:41], v8 offset:8192
    ds_read_b64_tr_b16 v[42:43], v8 offset:9216
    s_waitcnt lgkmcnt(6)
    v_mfma_f32_32x32x16_bf16 v[240:255], v[60:63], v[100:103], v[240:255]
    ds_read_b64_tr_b16 v[44:45], v9 offset:8192
    ds_read_b64_tr_b16 v[46:47], v9 offset:9216
    s_waitcnt vmcnt(11)
    s_waitcnt lgkmcnt(6)
    v_mfma_f32_32x32x16_bf16 v[192:207], v[32:35], v[104:107], v[192:207]
    ds_read_b64_tr_b16 v[48:49], v4 offset:12288
    ds_read_b64_tr_b16 v[50:51], v4 offset:13312
    s_waitcnt lgkmcnt(6)
    v_mfma_f32_32x32x16_bf16 v[208:223], v[36:39], v[104:107], v[208:223]
    ds_read_b64_tr_b16 v[52:53], v5 offset:12288
    ds_read_b64_tr_b16 v[54:55], v5 offset:13312
    s_waitcnt lgkmcnt(6)
    v_mfma_f32_32x32x16_bf16 v[224:239], v[40:43], v[104:107], v[224:239]
    ds_read_b64_tr_b16 v[56:57], v8 offset:12288
    ds_read_b64_tr_b16 v[58:59], v8 offset:13312
    s_waitcnt lgkmcnt(6)
    v_mfma_f32_32x32x16_bf16 v[240:255], v[44:47], v[104:107], v[240:255]
    ds_read_b64_tr_b16 v[60:61], v9 offset:12288
    ds_read_b64_tr_b16 v[62:63], v9 offset:13312
    s_waitcnt vmcnt(10)
    s_waitcnt lgkmcnt(6)
    v_mfma_f32_32x32x16_bf16 v[192:207], v[48:51], v[108:111], v[192:207]
    ds_read_b64_tr_b16 v[32:33], v4 offset:16384
    ds_read_b64_tr_b16 v[34:35], v4 offset:17408
    s_waitcnt lgkmcnt(6)
    v_mfma_f32_32x32x16_bf16 v[208:223], v[52:55], v[108:111], v[208:223]
    ds_read_b64_tr_b16 v[36:37], v5 offset:16384
    ds_read_b64_tr_b16 v[38:39], v5 offset:17408
    s_waitcnt lgkmcnt(6)
    v_mfma_f32_32x32x16_bf16 v[224:239], v[56:59], v[108:111], v[224:239]
    ds_read_b64_tr_b16 v[40:41], v8 offset:16384
    ds_read_b64_tr_b16 v[42:43], v8 offset:17408
    s_waitcnt lgkmcnt(6)
    v_mfma_f32_32x32x16_bf16 v[240:255], v[60:63], v[108:111], v[240:255]
    ds_read_b64_tr_b16 v[44:45], v9 offset:16384
    ds_read_b64_tr_b16 v[46:47], v9 offset:17408
    s_waitcnt vmcnt(3)
    s_waitcnt lgkmcnt(6)
    v_mfma_f32_32x32x16_bf16 v[192:207], v[32:35], v[112:115], v[192:207]
    ds_read_b64_tr_b16 v[48:49], v4 offset:20480
    ds_read_b64_tr_b16 v[50:51], v4 offset:21504
    s_waitcnt lgkmcnt(6)
    v_mfma_f32_32x32x16_bf16 v[208:223], v[36:39], v[112:115], v[208:223]
    ds_read_b64_tr_b16 v[52:53], v5 offset:20480
    ds_read_b64_tr_b16 v[54:55], v5 offset:21504
    s_waitcnt lgkmcnt(6)
    v_mfma_f32_32x32x16_bf16 v[224:239], v[40:43], v[112:115], v[224:239]
    ds_read_b64_tr_b16 v[56:57], v8 offset:20480
    ds_read_b64_tr_b16 v[58:59], v8 offset:21504
    s_waitcnt lgkmcnt(6)
    v_mfma_f32_32x32x16_bf16 v[240:255], v[44:47], v[112:115], v[240:255]
    ds_read_b64_tr_b16 v[60:61], v9 offset:20480
    ds_read_b64_tr_b16 v[62:63], v9 offset:21504
    s_waitcnt vmcnt(2)
    s_waitcnt lgkmcnt(6)
    v_mfma_f32_32x32x16_bf16 v[192:207], v[48:51], v[116:119], v[192:207]
    ds_read_b64_tr_b16 v[32:33], v4 offset:24576
    ds_read_b64_tr_b16 v[34:35], v4 offset:25600
    s_waitcnt lgkmcnt(6)
    v_mfma_f32_32x32x16_bf16 v[208:223], v[52:55], v[116:119], v[208:223]
    ds_read_b64_tr_b16 v[36:37], v5 offset:24576
    ds_read_b64_tr_b16 v[38:39], v5 offset:25600
    s_waitcnt lgkmcnt(6)
    v_mfma_f32_32x32x16_bf16 v[224:239], v[56:59], v[116:119], v[224:239]
    ds_read_b64_tr_b16 v[40:41], v8 offset:24576
    ds_read_b64_tr_b16 v[42:43], v8 offset:25600
    s_waitcnt lgkmcnt(6)
    v_mfma_f32_32x32x16_bf16 v[240:255], v[60:63], v[116:119], v[240:255]
    ds_read_b64_tr_b16 v[44:45], v9 offset:24576
    ds_read_b64_tr_b16 v[46:47], v9 offset:25600
    s_waitcnt vmcnt(1)
    s_waitcnt lgkmcnt(6)
    v_mfma_f32_32x32x16_bf16 v[192:207], v[32:35], v[120:123], v[192:207]
    ds_read_b64_tr_b16 v[48:49], v4 offset:28672
    ds_read_b64_tr_b16 v[50:51], v4 offset:29696
    s_waitcnt lgkmcnt(6)
    v_mfma_f32_32x32x16_bf16 v[208:223], v[36:39], v[120:123], v[208:223]
    ds_read_b64_tr_b16 v[52:53], v5 offset:28672
    ds_read_b64_tr_b16 v[54:55], v5 offset:29696
    s_waitcnt lgkmcnt(6)
    v_mfma_f32_32x32x16_bf16 v[224:239], v[40:43], v[120:123], v[224:239]
    ds_read_b64_tr_b16 v[56:57], v8 offset:28672
    ds_read_b64_tr_b16 v[58:59], v8 offset:29696
    s_waitcnt lgkmcnt(6)
    v_mfma_f32_32x32x16_bf16 v[240:255], v[44:47], v[120:123], v[240:255]
    ds_read_b64_tr_b16 v[60:61], v9 offset:28672
    ds_read_b64_tr_b16 v[62:63], v9 offset:29696
    s_waitcnt vmcnt(0)
    s_waitcnt lgkmcnt(6)
    v_mfma_f32_32x32x16_bf16 v[192:207], v[48:51], v[124:127], v[192:207]
    s_waitcnt lgkmcnt(4)
    v_mfma_f32_32x32x16_bf16 v[208:223], v[52:55], v[124:127], v[208:223]
    s_waitcnt lgkmcnt(2)
    v_mfma_f32_32x32x16_bf16 v[224:239], v[56:59], v[124:127], v[224:239]
    s_waitcnt lgkmcnt(0)
    v_mfma_f32_32x32x16_bf16 v[240:255], v[60:63], v[124:127], v[240:255]
    s_nop 5
    v_mul_f32 v192, s36, v192
    v_mul_f32 v193, s36, v193
    v_mul_f32 v194, s36, v194
    v_mul_f32 v195, s36, v195
    v_mul_f32 v196, s36, v196
    v_mul_f32 v197, s36, v197
    v_mul_f32 v198, s36, v198
    v_mul_f32 v199, s36, v199
    v_mul_f32 v200, s36, v200
    v_mul_f32 v201, s36, v201
    v_mul_f32 v202, s36, v202
    v_mul_f32 v203, s36, v203
    v_mul_f32 v204, s36, v204
    v_mul_f32 v205, s36, v205
    v_mul_f32 v206, s36, v206
    v_mul_f32 v207, s36, v207
    v_mul_f32 v208, s36, v208
    v_mul_f32 v209, s36, v209
    v_mul_f32 v210, s36, v210
    v_mul_f32 v211, s36, v211
    v_mul_f32 v212, s36, v212
    v_mul_f32 v213, s36, v213
    v_mul_f32 v214, s36, v214
    v_mul_f32 v215, s36, v215
    v_mul_f32 v216, s36, v216
    v_mul_f32 v217, s36, v217
    v_mul_f32 v218, s36, v218
    v_mul_f32 v219, s36, v219
    v_mul_f32 v220, s36, v220
    v_mul_f32 v221, s36, v221
    v_mul_f32 v222, s36, v222
    v_mul_f32 v223, s36, v223
    v_mul_f32 v224, s36, v224
    v_mul_f32 v225, s36, v225
    v_mul_f32 v226, s36, v226
    v_mul_f32 v227, s36, v227
    v_mul_f32 v228, s36, v228
    v_mul_f32 v229, s36, v229
    v_mul_f32 v230, s36, v230
    v_mul_f32 v231, s36, v231
    v_mul_f32 v232, s36, v232
    v_mul_f32 v233, s36, v233
    v_mul_f32 v234, s36, v234
    v_mul_f32 v235, s36, v235
    v_mul_f32 v236, s36, v236
    v_mul_f32 v237, s36, v237
    v_mul_f32 v238, s36, v238
    v_mul_f32 v239, s36, v239
    v_mul_f32 v240, s36, v240
    v_mul_f32 v241, s36, v241
    v_mul_f32 v242, s36, v242
    v_mul_f32 v243, s36, v243
    v_mul_f32 v244, s36, v244
    v_mul_f32 v245, s36, v245
    v_mul_f32 v246, s36, v246
    v_mul_f32 v247, s36, v247
    v_mul_f32 v248, s36, v248
    v_mul_f32 v249, s36, v249
    v_mul_f32 v250, s36, v250
    v_mul_f32 v251, s36, v251
    v_mul_f32 v252, s36, v252
    v_mul_f32 v253, s36, v253
    v_mul_f32 v254, s36, v254
    v_mul_f32 v255, s36, v255
    v_cvt_pk_bf16_f32 v160, v192, v193
    v_cvt_pk_bf16_f32 v161, v194, v195
    v_cvt_pk_bf16_f32 v162, v196, v197
    v_cvt_pk_bf16_f32 v163, v198, v199
    v_cvt_pk_bf16_f32 v164, v200, v201
    v_cvt_pk_bf16_f32 v165, v202, v203
    v_cvt_pk_bf16_f32 v166, v204, v205
    v_cvt_pk_bf16_f32 v167, v206, v207
    v_cvt_pk_bf16_f32 v168, v208, v209
    v_cvt_pk_bf16_f32 v169, v210, v211
    v_cvt_pk_bf16_f32 v170, v212, v213
    v_cvt_pk_bf16_f32 v171, v214, v215
    v_cvt_pk_bf16_f32 v172, v216, v217
    v_cvt_pk_bf16_f32 v173, v218, v219
    v_cvt_pk_bf16_f32 v174, v220, v221
    v_cvt_pk_bf16_f32 v175, v222, v223
    v_cvt_pk_bf16_f32 v176, v224, v225
    v_cvt_pk_bf16_f32 v177, v226, v227
    v_cvt_pk_bf16_f32 v178, v228, v229
    v_cvt_pk_bf16_f32 v179, v230, v231
    v_cvt_pk_bf16_f32 v180, v232, v233
    v_cvt_pk_bf16_f32 v181, v234, v235
    v_cvt_pk_bf16_f32 v182, v236, v237
    v_cvt_pk_bf16_f32 v183, v238, v239
    v_cvt_pk_bf16_f32 v184, v240, v241
    v_cvt_pk_bf16_f32 v185, v242, v243
    v_cvt_pk_bf16_f32 v186, v244, v245
    v_cvt_pk_bf16_f32 v187, v246, v247
    v_cvt_pk_bf16_f32 v188, v248, v249
    v_cvt_pk_bf16_f32 v189, v250, v251
    v_cvt_pk_bf16_f32 v190, v252, v253
    v_cvt_pk_bf16_f32 v191, v254, v255
    s_lshl_b32 s46, s3, 13
    s_add_u32 s46, s46, 32768
    s_cmp_ge_u32 s3, 2
    s_cselect_b32 s60, 16384, 0
    s_add_u32 s46, s46, s60
    s_cmp_ge_u32 s3, 6
    s_cselect_b32 s60, 32768, 0
    s_add_u32 s46, s46, s60
    v_add_u32 v11, s46, v1
    ds_write_b128 v11, v[160:163] offset:0
    ds_write_b128 v11, v[164:167] offset:1024
    ds_write_b128 v11, v[168:171] offset:2048
    ds_write_b128 v11, v[172:175] offset:3072
    ds_write_b128 v11, v[176:179] offset:4096
    ds_write_b128 v11, v[180:183] offset:5120
    ds_write_b128 v11, v[184:187] offset:6144
    ds_write_b128 v11, v[188:191] offset:7168
    s_waitcnt lgkmcnt(0)
    s_barrier
    s_lshl_b32 s46, s5, 13
    s_add_u32 s46, s46, 32768
    s_cmp_ge_u32 s5, 2
    s_cselect_b32 s60, 16384, 0
    s_add_u32 s46, s46, s60
    s_cmp_ge_u32 s5, 6
    s_cselect_b32 s60, 32768, 0
    s_add_u32 s46, s46, s60
    v_add_u32 v11, s46, v1
    s_add_u32 s47, s5, 4
    s_lshl_b32 s46, s47, 13
    s_add_u32 s46, s46, 32768
    s_cmp_ge_u32 s47, 2
    s_cselect_b32 s60, 16384, 0
    s_add_u32 s46, s46, s60
    s_cmp_ge_u32 s47, 6
    s_cselect_b32 s60, 32768, 0
    s_add_u32 s46, s46, s60
    v_add_u32 v12, s46, v1
    ds_read_b128 v[160:163], v11 offset:0
    ds_read_b128 v[128:131], v12 offset:0
    ds_read_b128 v[164:167], v11 offset:1024
    ds_read_b128 v[132:135], v12 offset:1024
    ds_read_b128 v[168:171], v11 offset:2048
    ds_read_b128 v[136:139], v12 offset:2048
    ds_read_b128 v[172:175], v11 offset:3072
    ds_read_b128 v[140:143], v12 offset:3072
    ds_read_b128 v[176:179], v11 offset:4096
    ds_read_b128 v[144:147], v12 offset:4096
    ds_read_b128 v[180:183], v11 offset:5120
    ds_read_b128 v[148:151], v12 offset:5120
    ds_read_b128 v[184:187], v11 offset:6144
    ds_read_b128 v[152:155], v12 offset:6144
    ds_read_b128 v[188:191], v11 offset:7168
    ds_read_b128 v[156:159], v12 offset:7168
    v_mov_b32 v10, v15
    v_lshrrev_b32 v13, 5, v0
    v_and_b32 v12, 31, v0
    v_lshlrev_b32 v13, 3, v13
    v_sub_u32 v12, v12, v13
    s_sub_u32 s46, s5, s4
    s_lshl_b32 s46, s46, 5
    v_add_u32 v15, s46, v12
    s_lshl_b32 s41, s4, 13
    v_add_u32 v14, s41, v1
    s_add_u32 s86, s4, 2
    s_cmp_lt_u32 s5, s86
    s_cselect_b32 s86, 1, 0
    s_mov_b32 s39, 0
    s_sub_u32 s38, 15, s7
    s_mov_b32 s30, 0
    s_mov_b32 s31, 49152
    v_mov_b32 v13, 0xff800000
    v_mov_b32 v12, s37
    s_waitcnt vmcnt(0) lgkmcnt(0)
    s_barrier
K2_BLOCK:
    s_lshl_b32 s28, s38, 1
    s_add_u32 s28, s28, 2
    s_lshl_b32 s63, s28, 14
    s_add_u32 s63, s63, s48
    s_lshl_b32 s46, s38, 7
    v_add_u32 v8, s46, v15
    v_mov_b32 v192, 0
    v_mov_b32 v193, 0
    v_mov_b32 v194, 0
    v_mov_b32 v195, 0
    v_mov_b32 v196, 0
    v_mov_b32 v197, 0
    v_mov_b32 v198, 0
    v_mov_b32 v199, 0
    v_mov_b32 v200, 0
    v_mov_b32 v201, 0
    v_mov_b32 v202, 0
    v_mov_b32 v203, 0
    v_mov_b32 v204, 0
    v_mov_b32 v205, 0
    v_mov_b32 v206, 0
    v_mov_b32 v207, 0
    v_mov_b32 v208, 0
    v_mov_b32 v209, 0
    v_mov_b32 v210, 0
    v_mov_b32 v211, 0
    v_mov_b32 v212, 0
    v_mov_b32 v213, 0
    v_mov_b32 v214, 0
    v_mov_b32 v215, 0
    v_mov_b32 v216, 0
    v_mov_b32 v217, 0
    v_mov_b32 v218, 0
    v_mov_b32 v219, 0
    v_mov_b32 v220, 0
    v_mov_b32 v221, 0
    v_mov_b32 v222, 0
    v_mov_b32 v223, 0
    v_mov_b32 v224, 0
    v_mov_b32 v225, 0
    v_mov_b32 v226, 0
    v_mov_b32 v227, 0
    v_mov_b32 v228, 0
    v_mov_b32 v229, 0
    v_mov_b32 v230, 0
    v_mov_b32 v231, 0
    v_mov_b32 v232, 0
    v_mov_b32 v233, 0
    v_mov_b32 v234, 0
    v_mov_b32 v235, 0
    v_mov_b32 v236, 0
    v_mov_b32 v237, 0
    v_mov_b32 v238, 0
    v_mov_b32 v239, 0
    v_mov_b32 v240, 0
    v_mov_b32 v241, 0
    v_mov_b32 v242, 0
    v_mov_b32 v243, 0
    v_mov_b32 v244, 0
    v_mov_b32 v245, 0
    v_mov_b32 v246, 0
    v_mov_b32 v247, 0
    v_mov_b32 v248, 0
    v_mov_b32 v249, 0
    v_mov_b32 v250, 0
    v_mov_b32 v251, 0
    v_mov_b32 v252, 0
    v_mov_b32 v253, 0
    v_mov_b32 v254, 0
    v_mov_b32 v255, 0
    v_mov_b32 v16, 0
    v_mov_b32 v17, 0
    v_mov_b32 v18, 0
    v_mov_b32 v19, 0
    v_mov_b32 v20, 0
    v_mov_b32 v21, 0
    v_mov_b32 v22, 0
    v_mov_b32 v23, 0
    v_mov_b32 v24, 0
    v_mov_b32 v25, 0
    v_mov_b32 v26, 0
    v_mov_b32 v27, 0
    v_mov_b32 v28, 0
    v_mov_b32 v29, 0
    v_mov_b32 v30, 0
    v_mov_b32 v31, 0
    v_mov_b32 v6, 0
    v_mov_b32 v7, 0
    s_mov_b32 s29, 0
    s_barrier
    v_add_u32 v2, s30, v14
    s_add_u32 s30, s30, 16384
    s_cmp_eq_u32 s30, 49152
    s_cselect_b32 s30, 0, s30
    ds_read_b128 v[48:51], v2 offset:0
    ds_read_b128 v[52:55], v2 offset:1024
    ds_read_b128 v[56:59], v2 offset:2048
    ds_read_b128 v[60:63], v2 offset:3072
    s_waitcnt lgkmcnt(3)
    v_mfma_f32_32x32x16_bf16 v[96:111], v[48:51], v[160:163], v[16:31]
    ds_read_b128 v[64:67], v2 offset:4096
    s_add_u32 m0, s32, s40
    s_add_u32 s32, s32, 16384
    buffer_load_dwordx4 v10, s[16:19], s34 offen lds
    s_waitcnt lgkmcnt(3)
    v_mfma_f32_32x32x16_bf16 v[96:111], v[52:55], v[164:167], v[96:111]
    ds_read_b128 v[68:71], v2 offset:5120
    buffer_load_dwordx4 v10, s[16:19], s34 offen offset:1024 lds
    s_add_u32 s34, s34, 16384
    s_waitcnt lgkmcnt(3)
    v_mfma_f32_32x32x16_bf16 v[96:111], v[56:59], v[168:171], v[96:111]
    ds_read_b128 v[72:75], v2 offset:6144
    s_cmp_eq_u32 s32, 49152
    s_cselect_b32 s32, 0, s32
    s_waitcnt lgkmcnt(3)
    v_mfma_f32_32x32x16_bf16 v[96:111], v[60:63], v[172:175], v[96:111]
    ds_read_b128 v[76:79], v2 offset:7168
    s_cmp_eq_u32 s34, s63
    s_cselect_b32 s34, s48, s34
    s_waitcnt lgkmcnt(3)
    v_mfma_f32_32x32x16_bf16 v[96:111], v[64:67], v[176:179], v[96:111]
    s_add_u32 m0, s33, s40
    s_add_u32 s33, s33, 16384
    buffer_load_dwordx4 v10, s[20:23], s35 offen lds
    s_waitcnt lgkmcnt(2)
    v_mfma_f32_32x32x16_bf16 v[96:111], v[68:71], v[180:183], v[96:111]
    buffer_load_dwordx4 v10, s[20:23], s35 offen offset:1024 lds
    s_add_u32 s35, s35, 16384
    s_waitcnt lgkmcnt(1)
    v_mfma_f32_32x32x16_bf16 v[96:111], v[72:75], v[184:187], v[96:111]
    s_cmp_eq_u32 s33, 114688
    s_cselect_b32 s33, 49152, s33
    s_waitcnt lgkmcnt(0)
    v_mfma_f32_32x32x16_bf16 v[96:111], v[76:79], v[188:191], v[96:111]
    s_cmp_eq_u32 s35, s63
    s_cselect_b32 s35, s48, s35
    s_barrier
    v_add_u32 v2, s30, v14
    s_add_u32 s30, s30, 16384
    s_cmp_eq_u32 s30, 49152
    s_cselect_b32 s30, 0, s30
    ds_read_b128 v[48:51], v2 offset:0
    ds_read_b128 v[52:55], v2 offset:1024
    ds_read_b128 v[56:59], v2 offset:2048
    ds_read_b128 v[60:63], v2 offset:3072
    s_waitcnt lgkmcnt(3)
    v_mfma_f32_32x32x16_bf16 v[112:127], v[48:51], v[160:163], v[16:31]
    ds_read_b128 v[64:67], v2 offset:4096
    s_add_u32 m0, s32, s40
    s_add_u32 s32, s32, 16384
    buffer_load_dwordx4 v10, s[16:19], s34 offen lds
    v_subrev_u32 v9, s29, v8
    v_cmp_le_i32 vcc, 0, v9
    s_nop 1
    v_cndmask_b32 v96, v13, v96, vcc
    v_cmp_le_i32 vcc, 1, v9
    s_waitcnt lgkmcnt(3)
    v_mfma_f32_32x32x16_bf16 v[112:127], v[52:55], v[164:167], v[112:127]
    ds_read_b128 v[68:71], v2 offset:5120
    buffer_load_dwordx4 v10, s[16:19], s34 offen offset:1024 lds
    s_add_u32 s34, s34, 16384
    v_cndmask_b32 v97, v13, v97, vcc
    v_cmp_le_i32 vcc, 2, v9
    s_nop 1
    v_cndmask_b32 v98, v13, v98, vcc
    v_cmp_le_i32 vcc, 3, v9
    s_waitcnt lgkmcnt(3)
    v_mfma_f32_32x32x16_bf16 v[112:127], v[56:59], v[168:171], v[112:127]
    ds_read_b128 v[72:75], v2 offset:6144
    s_cmp_eq_u32 s32, 49152
    s_cselect_b32 s32, 0, s32
    v_cndmask_b32 v99, v13, v99, vcc
    v_cmp_le_i32 vcc, 4, v9
    s_nop 1
    v_cndmask_b32 v100, v13, v100, vcc
    v_cmp_le_i32 vcc, 5, v9
    s_waitcnt lgkmcnt(3)
    v_mfma_f32_32x32x16_bf16 v[112:127], v[60:63], v[172:175], v[112:127]
    ds_read_b128 v[76:79], v2 offset:7168
    s_cmp_eq_u32 s34, s63
    s_cselect_b32 s34, s48, s34
    v_cndmask_b32 v101, v13, v101, vcc
    v_cmp_le_i32 vcc, 6, v9
    s_nop 1
    v_cndmask_b32 v102, v13, v102, vcc
    v_cmp_le_i32 vcc, 7, v9
    s_waitcnt lgkmcnt(3)
    v_mfma_f32_32x32x16_bf16 v[112:127], v[64:67], v[176:179], v[112:127]
    v_add_u32 v3, s31, v14
    s_add_u32 s31, s31, 16384
    s_cmp_eq_u32 s31, 114688
    s_cselect_b32 s31, 49152, s31
    ds_read_b128 v[48:51], v3 offset:0
    s_add_u32 m0, s33, s40
    s_add_u32 s33, s33, 16384
    buffer_load_dwordx4 v10, s[20:23], s35 offen lds
    v_cndmask_b32 v103, v13, v103, vcc
    v_cmp_le_i32 vcc, 16, v9
    s_nop 1
    v_cndmask_b32 v104, v13, v104, vcc
    v_cmp_le_i32 vcc, 17, v9
    s_waitcnt lgkmcnt(3)
    v_mfma_f32_32x32x16_bf16 v[112:127], v[68:71], v[180:183], v[112:127]
    ds_read_b128 v[52:55], v3 offset:2048
    buffer_load_dwordx4 v10, s[20:23], s35 offen offset:1024 lds
    s_add_u32 s35, s35, 16384
    v_cndmask_b32 v105, v13, v105, vcc
    v_cmp_le_i32 vcc, 18, v9
    s_nop 1
    v_cndmask_b32 v106, v13, v106, vcc
    v_cmp_le_i32 vcc, 19, v9
    s_waitcnt lgkmcnt(3)
    v_mfma_f32_32x32x16_bf16 v[112:127], v[72:75], v[184:187], v[112:127]
    ds_read_b128 v[56:59], v3 offset:4096
    s_cmp_eq_u32 s33, 114688
    s_cselect_b32 s33, 49152, s33
    v_cndmask_b32 v107, v13, v107, vcc
    v_cmp_le_i32 vcc, 20, v9
    s_nop 1
    v_cndmask_b32 v108, v13, v108, vcc
    v_cmp_le_i32 vcc, 21, v9
    s_waitcnt lgkmcnt(3)
    v_mfma_f32_32x32x16_bf16 v[112:127], v[76:79], v[188:191], v[112:127]
    ds_read_b128 v[60:63], v3 offset:6144
    s_cmp_eq_u32 s35, s63
    s_cselect_b32 s35, s48, s35
    v_cndmask_b32 v109, v13, v109, vcc
    v_cmp_le_i32 vcc, 22, v9
    s_nop 1
    v_cndmask_b32 v110, v13, v110, vcc
    v_cmp_le_i32 vcc, 23, v9
    s_nop 1
    v_cndmask_b32 v111, v13, v111, vcc
    s_add_u32 s29, s29, 64
    s_branch K2_SLOW_1
K2_RET_2:
    s_waitcnt vmcnt(4)
    s_cmp_eq_u32 s28, 2
    s_cbranch_scc0 K2_NOT2
    s_cmp_lg_u32 s86, 0
    s_cbranch_scc1 K2_ES
    s_branch K2_E
K2_NOT2:
    s_sub_u32 s49, s28, 4
    s_lshr_b32 s49, s49, 1
    s_cmp_eq_u32 s49, 0
    s_cbranch_scc1 K2_C3
K2_LOOP:
    s_waitcnt vmcnt(4)
    s_barrier
    v_add_u32 v2, s30, v14
    s_add_u32 s30, s30, 16384
    s_cmp_eq_u32 s30, 49152
    s_cselect_b32 s30, 0, s30
    s_waitcnt lgkmcnt(3)
    v_mfma_f32_32x32x16_bf16 v[192:207], v[48:51], v[80:83], v[192:207]
    ds_read_b128 v[64:67], v3 offset:1024
    s_add_u32 m0, s32, s40
    s_add_u32 s32, s32, 16384
    buffer_load_dwordx4 v10, s[16:19], s34 offen lds
    v_exp_f32 v32, v112
    v_exp_f32 v33, v113
    s_waitcnt lgkmcnt(3)
    v_mfma_f32_32x32x16_bf16 v[208:223], v[52:55], v[80:83], v[208:223]
    ds_read_b128 v[68:71], v3 offset:3072
    buffer_load_dwordx4 v10, s[16:19], s34 offen offset:1024 lds
    s_add_u32 s34, s34, 16384
    v_exp_f32 v34, v114
    v_add_f32 v7, v6, v32
    v_exp_f32 v35, v115
    s_waitcnt lgkmcnt(3)
    v_mfma_f32_32x32x16_bf16 v[224:239], v[56:59], v[80:83], v[224:239]
    ds_read_b128 v[72:75], v3 offset:5120
    s_cmp_eq_u32 s32, 49152
    s_cselect_b32 s32, 0, s32
    v_add_f32 v7, v7, v33
    v_cvt_pk_bf16_f32 v88, v32, v33
    s_waitcnt lgkmcnt(3)
    v_mfma_f32_32x32x16_bf16 v[240:255], v[60:63], v[80:83], v[240:255]
    ds_read_b128 v[76:79], v3 offset:7168
    s_cmp_eq_u32 s34, s63
    s_cselect_b32 s34, s48, s34
    v_exp_f32 v36, v116
    v_add_f32 v7, v7, v34
    v_exp_f32 v37, v117
    s_waitcnt lgkmcnt(3)
    v_mfma_f32_32x32x16_bf16 v[192:207], v[64:67], v[84:87], v[192:207]
    ds_read_b128 v[48:51], v2 offset:0
    s_add_u32 m0, s33, s40
    s_add_u32 s33, s33, 16384
    buffer_load_dwordx4 v10, s[20:23], s35 offen lds
    v_add_f32 v7, v7, v35
    v_cvt_pk_bf16_f32 v89, v34, v35
    s_waitcnt lgkmcnt(3)
    v_mfma_f32_32x32x16_bf16 v[208:223], v[68:71], v[84:87], v[208:223]
    ds_read_b128 v[52:55], v2 offset:1024
    buffer_load_dwordx4 v10, s[20:23], s35 offen offset:1024 lds
    s_add_u32 s35, s35, 16384
    v_exp_f32 v38, v118
    v_add_f32 v7, v7, v36
    v_exp_f32 v39, v119
    s_waitcnt lgkmcnt(3)
    v_mfma_f32_32x32x16_bf16 v[224:239], v[72:75], v[84:87], v[224:239]
    ds_read_b128 v[56:59], v2 offset:2048
    s_cmp_eq_u32 s33, 114688
    s_cselect_b32 s33, 49152, s33
    v_add_f32 v7, v7, v37
    v_cvt_pk_bf16_f32 v90, v36, v37
    s_waitcnt lgkmcnt(3)
    v_mfma_f32_32x32x16_bf16 v[240:255], v[76:79], v[84:87], v[240:255]
    ds_read_b128 v[60:63], v2 offset:3072
    s_cmp_eq_u32 s35, s63
    s_cselect_b32 s35, s48, s35
    v_exp_f32 v40, v120
    v_add_f32 v7, v7, v38
    v_exp_f32 v41, v121
    s_waitcnt lgkmcnt(3)
    v_mfma_f32_32x32x16_bf16 v[96:111], v[48:51], v[160:163], v[16:31]
    ds_read_b128 v[64:67], v2 offset:4096
    v_add_f32 v7, v7, v39
    v_cvt_pk_bf16_f32 v91, v38, v39
    s_waitcnt lgkmcnt(3)
    v_mfma_f32_32x32x16_bf16 v[96:111], v[52:55], v[164:167], v[96:111]
    ds_read_b128 v[68:71], v2 offset:5120
    v_exp_f32 v42, v122
    v_add_f32 v7, v7, v40
    v_exp_f32 v43, v123
    s_waitcnt lgkmcnt(3)
    v_mfma_f32_32x32x16_bf16 v[96:111], v[56:59], v[168:171], v[96:111]
    ds_read_b128 v[72:75], v2 offset:6144
    v_add_f32 v7, v7, v41
    v_cvt_pk_bf16_f32 v92, v40, v41
    s_waitcnt lgkmcnt(3)
    v_mfma_f32_32x32x16_bf16 v[96:111], v[60:63], v[172:175], v[96:111]
    ds_read_b128 v[76:79], v2 offset:7168
    v_exp_f32 v44, v124
    v_add_f32 v7, v7, v42
    v_exp_f32 v45, v125
    s_waitcnt lgkmcnt(3)
    v_mfma_f32_32x32x16_bf16 v[96:111], v[64:67], v[176:179], v[96:111]
    v_add_u32 v3, s31, v14
    s_add_u32 s31, s31, 16384
    s_cmp_eq_u32 s31, 114688
    s_cselect_b32 s31, 49152, s31
    ds_read_b128 v[48:51], v3 offset:0
    v_add_f32 v7, v7, v43
    v_cvt_pk_bf16_f32 v93, v42, v43
    s_waitcnt lgkmcnt(3)
    v_mfma_f32_32x32x16_bf16 v[96:111], v[68:71], v[180:183], v[96:111]
    ds_read_b128 v[52:55], v3 offset:2048
    v_exp_f32 v46, v126
    v_add_f32 v7, v7, v44
    v_exp_f32 v47, v127
    s_waitcnt lgkmcnt(3)
    v_mfma_f32_32x32x16_bf16 v[96:111], v[72:75], v[184:187], v[96:111]
    ds_read_b128 v[56:59], v3 offset:4096
    v_add_f32 v7, v7, v45
    v_cvt_pk_bf16_f32 v94, v44, v45
    s_waitcnt lgkmcnt(3)
    v_mfma_f32_32x32x16_bf16 v[96:111], v[76:79], v[188:191], v[96:111]
    ds_read_b128 v[60:63], v3 offset:6144
    v_add_f32 v7, v7, v46
    v_add_f32 v7, v7, v47
    v_cvt_pk_bf16_f32 v95, v46, v47
    s_add_u32 s29, s29, 64
    v_cmp_nle_f32 vcc, v7, v12
    s_cbranch_vccnz K2_SLOW_3
K2_RET_4:
    s_waitcnt vmcnt(4)
    s_barrier
    v_add_u32 v2, s30, v14
    s_add_u32 s30, s30, 16384
    s_cmp_eq_u32 s30, 49152
    s_cselect_b32 s30, 0, s30
    s_waitcnt lgkmcnt(3)
    v_mfma_f32_32x32x16_bf16 v[192:207], v[48:51], v[88:91], v[192:207]
    ds_read_b128 v[64:67], v3 offset:1024
    s_add_u32 m0, s32, s40
    s_add_u32 s32, s32, 16384
    buffer_load_dwordx4 v10, s[16:19], s34 offen lds
    v_exp_f32 v32, v96
    v_exp_f32 v33, v97
    s_waitcnt lgkmcnt(3)
    v_mfma_f32_32x32x16_bf16 v[208:223], v[52:55], v[88:91], v[208:223]
    ds_read_b128 v[68:71], v3 offset:3072
    buffer_load_dwordx4 v10, s[16:19], s34 offen offset:1024 lds
    s_add_u32 s34, s34, 16384
    v_exp_f32 v34, v98
    v_add_f32 v6, v7, v32
    v_exp_f32 v35, v99
    s_waitcnt lgkmcnt(3)
    v_mfma_f32_32x32x16_bf16 v[224:239], v[56:59], v[88:91], v[224:239]
    ds_read_b128 v[72:75], v3 offset:5120
    s_cmp_eq_u32 s32, 49152
    s_cselect_b32 s32, 0, s32
    v_add_f32 v6, v6, v33
    v_cvt_pk_bf16_f32 v80, v32, v33
    s_waitcnt lgkmcnt(3)
    v_mfma_f32_32x32x16_bf16 v[240:255], v[60:63], v[88:91], v[240:255]
    ds_read_b128 v[76:79], v3 offset:7168
    s_cmp_eq_u32 s34, s63
    s_cselect_b32 s34, s48, s34
    v_exp_f32 v36, v100
    v_add_f32 v6, v6, v34
    v_exp_f32 v37, v101
    s_waitcnt lgkmcnt(3)
    v_mfma_f32_32x32x16_bf16 v[192:207], v[64:67], v[92:95], v[192:207]
    ds_read_b128 v[48:51], v2 offset:0
    s_add_u32 m0, s33, s40
    s_add_u32 s33, s33, 16384
    buffer_load_dwordx4 v10, s[20:23], s35 offen lds
    v_add_f32 v6, v6, v35
    v_cvt_pk_bf16_f32 v81, v34, v35
    s_waitcnt lgkmcnt(3)
    v_mfma_f32_32x32x16_bf16 v[208:223], v[68:71], v[92:95], v[208:223]
    ds_read_b128 v[52:55], v2 offset:1024
    buffer_load_dwordx4 v10, s[20:23], s35 offen offset:1024 lds
    s_add_u32 s35, s35, 16384
    v_exp_f32 v38, v102
    v_add_f32 v6, v6, v36
    v_exp_f32 v39, v103
    s_waitcnt lgkmcnt(3)
    v_mfma_f32_32x32x16_bf16 v[224:239], v[72:75], v[92:95], v[224:239]
    ds_read_b128 v[56:59], v2 offset:2048
    s_cmp_eq_u32 s33, 114688
    s_cselect_b32 s33, 49152, s33
    v_add_f32 v6, v6, v37
    v_cvt_pk_bf16_f32 v82, v36, v37
    s_waitcnt lgkmcnt(3)
    v_mfma_f32_32x32x16_bf16 v[240:255], v[76:79], v[92:95], v[240:255]
    ds_read_b128 v[60:63], v2 offset:3072
    s_cmp_eq_u32 s35, s63
    s_cselect_b32 s35, s48, s35
    v_exp_f32 v40, v104
    v_add_f32 v6, v6, v38
    v_exp_f32 v41, v105
    s_waitcnt lgkmcnt(3)
    v_mfma_f32_32x32x16_bf16 v[112:127], v[48:51], v[160:163], v[16:31]
    ds_read_b128 v[64:67], v2 offset:4096
    v_add_f32 v6, v6, v39
    v_cvt_pk_bf16_f32 v83, v38, v39
    s_waitcnt lgkmcnt(3)
    v_mfma_f32_32x32x16_bf16 v[112:127], v[52:55], v[164:167], v[112:127]
    ds_read_b128 v[68:71], v2 offset:5120
    v_exp_f32 v42, v106
    v_add_f32 v6, v6, v40
    v_exp_f32 v43, v107
    s_waitcnt lgkmcnt(3)
    v_mfma_f32_32x32x16_bf16 v[112:127], v[56:59], v[168:171], v[112:127]
    ds_read_b128 v[72:75], v2 offset:6144
    v_add_f32 v6, v6, v41
    v_cvt_pk_bf16_f32 v84, v40, v41
    s_waitcnt lgkmcnt(3)
    v_mfma_f32_32x32x16_bf16 v[112:127], v[60:63], v[172:175], v[112:127]
    ds_read_b128 v[76:79], v2 offset:7168
    v_exp_f32 v44, v108
    v_add_f32 v6, v6, v42
    v_exp_f32 v45, v109
    s_waitcnt lgkmcnt(3)
    v_mfma_f32_32x32x16_bf16 v[112:127], v[64:67], v[176:179], v[112:127]
    v_add_u32 v3, s31, v14
    s_add_u32 s31, s31, 16384
    s_cmp_eq_u32 s31, 114688
    s_cselect_b32 s31, 49152, s31
    ds_read_b128 v[48:51], v3 offset:0
    v_add_f32 v6, v6, v43
    v_cvt_pk_bf16_f32 v85, v42, v43
    s_waitcnt lgkmcnt(3)
    v_mfma_f32_32x32x16_bf16 v[112:127], v[68:71], v[180:183], v[112:127]
    ds_read_b128 v[52:55], v3 offset:2048
    v_exp_f32 v46, v110
    v_add_f32 v6, v6, v44
    v_exp_f32 v47, v111
    s_waitcnt lgkmcnt(3)
    v_mfma_f32_32x32x16_bf16 v[112:127], v[72:75], v[184:187], v[112:127]
    ds_read_b128 v[56:59], v3 offset:4096
    v_add_f32 v6, v6, v45
    v_cvt_pk_bf16_f32 v86, v44, v45
    s_waitcnt lgkmcnt(3)
    v_mfma_f32_32x32x16_bf16 v[112:127], v[76:79], v[188:191], v[112:127]
    ds_read_b128 v[60:63], v3 offset:6144
    v_add_f32 v6, v6, v46
    v_add_f32 v6, v6, v47
    v_cvt_pk_bf16_f32 v87, v46, v47
    s_add_u32 s29, s29, 64
    v_cmp_nle_f32 vcc, v6, v12
    s_cbranch_vccnz K2_SLOW_5
K2_RET_6:
    s_sub_u32 s49, s49, 1
    s_cmp_lg_u32 s49, 0
    s_cbranch_scc1 K2_LOOP
K2_C3:
    s_waitcnt vmcnt(4)
    s_barrier
    v_add_u32 v2, s30, v14
    s_add_u32 s30, s30, 16384
    s_cmp_eq_u32 s30, 49152
    s_cselect_b32 s30, 0, s30
    s_waitcnt lgkmcnt(3)
    v_mfma_f32_32x32x16_bf16 v[192:207], v[48:51], v[80:83], v[192:207]
    ds_read_b128 v[64:67], v3 offset:1024
    s_add_u32 m0, s32, s40
    s_add_u32 s32, s32, 16384
    buffer_load_dwordx4 v10, s[16:19], s34 offen lds
    v_exp_f32 v32, v112
    v_exp_f32 v33, v113
    s_waitcnt lgkmcnt(3)
    v_mfma_f32_32x32x16_bf16 v[208:223], v[52:55], v[80:83], v[208:223]
    ds_read_b128 v[68:71], v3 offset:3072
    buffer_load_dwordx4 v10, s[16:19], s34 offen offset:1024 lds
    s_add_u32 s34, s34, 16384
    v_exp_f32 v34, v114
    v_add_f32 v7, v6, v32
    v_exp_f32 v35, v115
    s_waitcnt lgkmcnt(3)
    v_mfma_f32_32x32x16_bf16 v[224:239], v[56:59], v[80:83], v[224:239]
    ds_read_b128 v[72:75], v3 offset:5120
    s_cmp_eq_u32 s32, 49152
    s_cselect_b32 s32, 0, s32
    v_add_f32 v7, v7, v33
    v_cvt_pk_bf16_f32 v88, v32, v33
    s_waitcnt lgkmcnt(3)
    v_mfma_f32_32x32x16_bf16 v[240:255], v[60:63], v[80:83], v[240:255]
    ds_read_b128 v[76:79], v3 offset:7168
    s_cmp_eq_u32 s34, s63
    s_cselect_b32 s34, s48, s34
    v_exp_f32 v36, v116
    v_add_f32 v7, v7, v34
    v_exp_f32 v37, v117
    s_waitcnt lgkmcnt(3)
    v_mfma_f32_32x32x16_bf16 v[192:207], v[64:67], v[84:87], v[192:207]
    ds_read_b128 v[48:51], v2 offset:0
    s_add_u32 m0, s33, s40
    s_add_u32 s33, s33, 16384
    buffer_load_dwordx4 v10, s[20:23], s35 offen lds
    v_add_f32 v7, v7, v35
    v_cvt_pk_bf16_f32 v89, v34, v35
    s_waitcnt lgkmcnt(3)
    v_mfma_f32_32x32x16_bf16 v[208:223], v[68:71], v[84:87], v[208:223]
    ds_read_b128 v[52:55], v2 offset:1024
    buffer_load_dwordx4 v10, s[20:23], s35 offen offset:1024 lds
    s_add_u32 s35, s35, 16384
    v_exp_f32 v38, v118
    v_add_f32 v7, v7, v36
    v_exp_f32 v39, v119
    s_waitcnt lgkmcnt(3)
    v_mfma_f32_32x32x16_bf16 v[224:239], v[72:75], v[84:87], v[224:239]
    ds_read_b128 v[56:59], v2 offset:2048
    s_cmp_eq_u32 s33, 114688
    s_cselect_b32 s33, 49152, s33
    v_add_f32 v7, v7, v37
    v_cvt_pk_bf16_f32 v90, v36, v37
    s_waitcnt lgkmcnt(3)
    v_mfma_f32_32x32x16_bf16 v[240:255], v[76:79], v[84:87], v[240:255]
    ds_read_b128 v[60:63], v2 offset:3072
    s_cmp_eq_u32 s35, s63
    s_cselect_b32 s35, s48, s35
    v_exp_f32 v40, v120
    v_add_f32 v7, v7, v38
    v_exp_f32 v41, v121
    s_waitcnt lgkmcnt(3)
    v_mfma_f32_32x32x16_bf16 v[96:111], v[48:51], v[160:163], v[16:31]
    ds_read_b128 v[64:67], v2 offset:4096
    v_add_f32 v7, v7, v39
    v_cvt_pk_bf16_f32 v91, v38, v39
    s_waitcnt lgkmcnt(3)
    v_mfma_f32_32x32x16_bf16 v[96:111], v[52:55], v[164:167], v[96:111]
    ds_read_b128 v[68:71], v2 offset:5120
    v_exp_f32 v42, v122
    v_add_f32 v7, v7, v40
    v_exp_f32 v43, v123
    s_waitcnt lgkmcnt(3)
    v_mfma_f32_32x32x16_bf16 v[96:111], v[56:59], v[168:171], v[96:111]
    ds_read_b128 v[72:75], v2 offset:6144
    v_add_f32 v7, v7, v41
    v_cvt_pk_bf16_f32 v92, v40, v41
    s_waitcnt lgkmcnt(3)
    v_mfma_f32_32x32x16_bf16 v[96:111], v[60:63], v[172:175], v[96:111]
    ds_read_b128 v[76:79], v2 offset:7168
    v_exp_f32 v44, v124
    v_add_f32 v7, v7, v42
    v_exp_f32 v45, v125
    s_waitcnt lgkmcnt(3)
    v_mfma_f32_32x32x16_bf16 v[96:111], v[64:67], v[176:179], v[96:111]
    v_add_u32 v3, s31, v14
    s_add_u32 s31, s31, 16384
    s_cmp_eq_u32 s31, 114688
    s_cselect_b32 s31, 49152, s31
    ds_read_b128 v[48:51], v3 offset:0
    v_add_f32 v7, v7, v43
    v_cvt_pk_bf16_f32 v93, v42, v43
    s_waitcnt lgkmcnt(3)
    v_mfma_f32_32x32x16_bf16 v[96:111], v[68:71], v[180:183], v[96:111]
    ds_read_b128 v[52:55], v3 offset:2048
    v_exp_f32 v46, v126
    v_add_f32 v7, v7, v44
    v_exp_f32 v47, v127
    s_waitcnt lgkmcnt(3)
    v_mfma_f32_32x32x16_bf16 v[96:111], v[72:75], v[184:187], v[96:111]
    ds_read_b128 v[56:59], v3 offset:4096
    v_add_f32 v7, v7, v45
    v_cvt_pk_bf16_f32 v94, v44, v45
    s_waitcnt lgkmcnt(3)
    v_mfma_f32_32x32x16_bf16 v[96:111], v[76:79], v[188:191], v[96:111]
    ds_read_b128 v[60:63], v3 offset:6144
    v_add_f32 v7, v7, v46
    v_add_f32 v7, v7, v47
    v_cvt_pk_bf16_f32 v95, v46, v47
    s_add_u32 s29, s29, 64
    v_cmp_nle_f32 vcc, v7, v12
    s_cbranch_vccnz K2_SLOW_7
K2_RET_8:
    s_mov_b32 s72, s80
    s_mov_b32 s73, s81
    s_mov_b32 s74, s82
    s_mov_b32 s75, s83
    s_mov_b32 s76, s84
    s_mov_b32 s77, s85
    s_cmp_ge_u32 s61, 1024
    s_cbranch_scc1 RL2_9
    s_mov_b32 s64, s72
    s_mov_b32 s65, s73
    s_mov_b32 s66, 5242880
    s_lshr_b32 s78, s61, 3
    s_and_b32 s79, s61, 7
    s_mov_b32 s72, 1280
    s_mov_b32 s73, 54525952
    s_mov_b32 s74, 128
    s_branch RLD_11
RL2_9:
    s_cmp_ge_u32 s61, 1472
    s_cbranch_scc1 RL1_10
    s_mov_b32 s64, s74
    s_mov_b32 s65, s75
    s_mov_b32 s66, 2211840
    s_sub_u32 s79, s61, 1024
    s_lshr_b32 s78, s79, 3
    s_and_b32 s79, s79, 7
    s_mov_b32 s72, 1280
    s_mov_b32 s73, 60817408
    s_mov_b32 s74, 56
    s_branch RLD_11
RL1_10:
    s_mov_b32 s64, s76
    s_mov_b32 s65, s77
    s_mov_b32 s66, 2211840
    s_sub_u32 s79, s61, 1472
    s_min_u32 s79, s79, 439
    s_mul_hi_u32 s78, s79, 0xccccccd
    s_mul_i32 s72, s78, 20
    s_sub_u32 s72, s79, s72
    s_mov_b32 s79, s78
    s_mov_b32 s78, s72
    s_mov_b32 s72, 3456
    s_mov_b32 s73, 65011712
    s_mov_b32 s74, 20
RLD_11:
    s_mov_b32 s67, 0x00020000
    s_add_u32 s68, s44, s73
    s_addc_u32 s69, s45, 0
    s_mov_b32 s70, 6291456
    s_mov_b32 s71, 0x00020000
    s_mul_i32 s75, s78, s72
    s_lshl_b32 s75, s75, 5
    s_mul_i32 s76, s79, 160
    s_add_u32 s75, s75, s76
    s_mul_i32 s76, s79, s74
    s_mul_i32 s76, s76, 5
    s_add_u32 s76, s76, s78
    s_lshl_b32 s76, s76, 10
    s_lshl_b32 s74, s74, 10
    s_mov_b32 s77, 0x1999999a
    v_add_u32 v32, 0, v0
    v_mul_hi_u32 v33, v32, s77
    v_mul_u32_u24 v34, 10, v33
    v_sub_u32 v34, v32, v34
    v_mul_lo_u32 v33, v33, s72
    v_lshl_add_u32 v33, v34, 4, v33
    s_add_u32 m0, s62, 0
    s_nop 0
    buffer_load_dwordx4 v33, s[64:67], s75 offen lds
    v_add_u32 v32, 64, v0
    v_mul_hi_u32 v33, v32, s77
    v_mul_u32_u24 v34, 10, v33
    v_sub_u32 v34, v32, v34
    v_mul_lo_u32 v33, v33, s72
    v_lshl_add_u32 v33, v34, 4, v33
    s_add_u32 m0, s62, 1024
    s_nop 0
    buffer_load_dwordx4 v33, s[64:67], s75 offen lds
    v_add_u32 v32, 128, v0
    v_mul_hi_u32 v33, v32, s77
    v_mul_u32_u24 v34, 10, v33
    v_sub_u32 v34, v32, v34
    v_mul_lo_u32 v33, v33, s72
    v_lshl_add_u32 v33, v34, 4, v33
    s_add_u32 m0, s62, 2048
    s_nop 0
    buffer_load_dwordx4 v33, s[64:67], s75 offen lds
    v_add_u32 v32, 192, v0
    v_mul_hi_u32 v33, v32, s77
    v_mul_u32_u24 v34, 10, v33
    v_sub_u32 v34, v32, v34
    v_mul_lo_u32 v33, v33, s72
    v_lshl_add_u32 v33, v34, 4, v33
    s_add_u32 m0, s62, 3072
    s_nop 0
    buffer_load_dwordx4 v33, s[64:67], s75 offen lds
    v_add_u32 v32, 256, v0
    v_mul_hi_u32 v33, v32, s77
    v_mul_u32_u24 v34, 10, v33
    v_sub_u32 v34, v32, v34
    v_mul_lo_u32 v33, v33, s72
    v_lshl_add_u32 v33, v34, 4, v33
    s_add_u32 m0, s62, 4096
    s_nop 0
    buffer_load_dwordx4 v33, s[64:67], s75 offen lds
    s_cmp_lg_u32 s86, 0
    s_cbranch_scc1 K2_DS
    s_waitcnt vmcnt(9)
    s_barrier
    v_add_u32 v2, s30, v14
    s_add_u32 s30, s30, 16384
    s_cmp_eq_u32 s30, 49152
    s_cselect_b32 s30, 0, s30
    s_waitcnt lgkmcnt(3)
    v_mfma_f32_32x32x16_bf16 v[192:207], v[48:51], v[88:91], v[192:207]
    ds_read_b128 v[64:67], v3 offset:1024
    s_add_u32 m0, s32, s40
    s_add_u32 s32, s32, 16384
    buffer_load_dwordx4 v10, s[16:19], s34 offen lds
    v_subrev_u32 v9, s29, v8
    v_cmp_le_i32 vcc, 0, v9
    s_nop 1
    v_cndmask_b32 v96, v13, v96, vcc
    v_cmp_le_i32 vcc, 1, v9
    s_waitcnt lgkmcnt(3)
    v_mfma_f32_32x32x16_bf16 v[208:223], v[52:55], v[88:91], v[208:223]
    ds_read_b128 v[68:71], v3 offset:3072
    buffer_load_dwordx4 v10, s[16:19], s34 offen offset:1024 lds
    s_add_u32 s34, s34, 16384
    v_cndmask_b32 v97, v13, v97, vcc
    v_cmp_le_i32 vcc, 2, v9
    s_nop 1
    v_cndmask_b32 v98, v13, v98, vcc
    v_cmp_le_i32 vcc, 3, v9
    s_nop 1
    v_cndmask_b32 v99, v13, v99, vcc
    s_waitcnt lgkmcnt(3)
    v_mfma_f32_32x32x16_bf16 v[224:239], v[56:59], v[88:91], v[224:239]
    ds_read_b128 v[72:75], v3 offset:5120
    s_cmp_eq_u32 s32, 49152
    s_cselect_b32 s32, 0, s32
    v_cmp_le_i32 vcc, 4, v9
    s_nop 1
    v_cndmask_b32 v100, v13, v100, vcc
    v_cmp_le_i32 vcc, 5, v9
    s_nop 1
    v_cndmask_b32 v101, v13, v101, vcc
    s_waitcnt lgkmcnt(3)
    v_mfma_f32_32x32x16_bf16 v[240:255], v[60:63], v[88:91], v[240:255]
    ds_read_b128 v[76:79], v3 offset:7168
    s_cmp_eq_u32 s34, s63
    s_cselect_b32 s34, s48, s34
    v_cmp_le_i32 vcc, 6, v9
    s_nop 1
    v_cndmask_b32 v102, v13, v102, vcc
    v_cmp_le_i32 vcc, 7, v9
    s_nop 1
    v_cndmask_b32 v103, v13, v103, vcc
    v_cmp_le_i32 vcc, 16, v9
    s_waitcnt lgkmcnt(3)
    v_mfma_f32_32x32x16_bf16 v[192:207], v[64:67], v[92:95], v[192:207]
    ds_read_b128 v[48:51], v2 offset:0
    s_add_u32 m0, s33, s40
    s_add_u32 s33, s33, 16384
    buffer_load_dwordx4 v10, s[20:23], s35 offen lds
    v_cndmask_b32 v104, v13, v104, vcc
    v_cmp_le_i32 vcc, 17, v9
    s_nop 1
    v_cndmask_b32 v105, v13, v105, vcc
    v_cmp_le_i32 vcc, 18, v9
    s_waitcnt lgkmcnt(3)
    v_mfma_f32_32x32x16_bf16 v[208:223], v[68:71], v[92:95], v[208:223]
    ds_read_b128 v[52:55], v2 offset:1024
    buffer_load_dwordx4 v10, s[20:23], s35 offen offset:1024 lds
    s_add_u32 s35, s35, 16384
    v_cndmask_b32 v106, v13, v106, vcc
    v_cmp_le_i32 vcc, 19, v9
    s_nop 1
    v_cndmask_b32 v107, v13, v107, vcc
    v_cmp_le_i32 vcc, 20, v9
    s_nop 1
    v_cndmask_b32 v108, v13, v108, vcc
    s_waitcnt lgkmcnt(3)
    v_mfma_f32_32x32x16_bf16 v[224:239], v[72:75], v[92:95], v[224:239]
    ds_read_b128 v[56:59], v2 offset:2048
    s_cmp_eq_u32 s33, 114688
    s_cselect_b32 s33, 49152, s33
    v_cmp_le_i32 vcc, 21, v9
    s_nop 1
    v_cndmask_b32 v109, v13, v109, vcc
    v_cmp_le_i32 vcc, 22, v9
    s_nop 1
    v_cndmask_b32 v110, v13, v110, vcc
    s_waitcnt lgkmcnt(3)
    v_mfma_f32_32x32x16_bf16 v[240:255], v[76:79], v[92:95], v[240:255]
    ds_read_b128 v[60:63], v2 offset:3072
    s_cmp_eq_u32 s35, s63
    s_cselect_b32 s35, s48, s35
    v_cmp_le_i32 vcc, 23, v9
    s_nop 1
    v_cndmask_b32 v111, v13, v111, vcc
    v_exp_f32 v32, v96
    v_exp_f32 v33, v97
    v_exp_f32 v34, v98
    s_waitcnt lgkmcnt(3)
    v_mfma_f32_32x32x16_bf16 v[112:127], v[48:51], v[160:163], v[16:31]
    ds_read_b128 v[64:67], v2 offset:4096
    v_add_f32 v6, v7, v32
    v_exp_f32 v35, v99
    v_add_f32 v6, v6, v33
    v_cvt_pk_bf16_f32 v80, v32, v33
    v_exp_f32 v36, v100
    s_waitcnt lgkmcnt(3)
    v_mfma_f32_32x32x16_bf16 v[112:127], v[52:55], v[164:167], v[112:127]
    ds_read_b128 v[68:71], v2 offset:5120
    v_add_f32 v6, v6, v34
    v_exp_f32 v37, v101
    v_add_f32 v6, v6, v35
    v_cvt_pk_bf16_f32 v81, v34, v35
    s_waitcnt lgkmcnt(3)
    v_mfma_f32_32x32x16_bf16 v[112:127], v[56:59], v[168:171], v[112:127]
    ds_read_b128 v[72:75], v2 offset:6144
    v_exp_f32 v38, v102
    v_add_f32 v6, v6, v36
    v_exp_f32 v39, v103
    v_add_f32 v6, v6, v37
    v_cvt_pk_bf16_f32 v82, v36, v37
    s_waitcnt lgkmcnt(3)
    v_mfma_f32_32x32x16_bf16 v[112:127], v[60:63], v[172:175], v[112:127]
    ds_read_b128 v[76:79], v2 offset:7168
    v_exp_f32 v40, v104
    v_add_f32 v6, v6, v38
    v_exp_f32 v41, v105
    v_add_f32 v6, v6, v39
    s_waitcnt lgkmcnt(3)
    v_mfma_f32_32x32x16_bf16 v[112:127], v[64:67], v[176:179], v[112:127]
    v_add_u32 v3, s31, v14
    s_add_u32 s31, s31, 16384
    s_cmp_eq_u32 s31, 114688
    s_cselect_b32 s31, 49152, s31
    ds_read_b128 v[48:51], v3 offset:0
    v_cvt_pk_bf16_f32 v83, v38, v39
    v_exp_f32 v42, v106
    v_add_f32 v6, v6, v40
    v_exp_f32 v43, v107
    v_add_f32 v6, v6, v41
    s_waitcnt lgkmcnt(3)
    v_mfma_f32_32x32x16_bf16 v[112:127], v[68:71], v[180:183], v[112:127]
    ds_read_b128 v[52:55], v3 offset:2048
    v_cvt_pk_bf16_f32 v84, v40, v41
    v_exp_f32 v44, v108
    v_add_f32 v6, v6, v42
    v_exp_f32 v45, v109
    s_waitcnt lgkmcnt(3)
    v_mfma_f32_32x32x16_bf16 v[112:127], v[72:75], v[184:187], v[112:127]
    ds_read_b128 v[56:59], v3 offset:4096
    v_add_f32 v6, v6, v43
    v_cvt_pk_bf16_f32 v85, v42, v43
    v_exp_f32 v46, v110
    v_add_f32 v6, v6, v44
    v_exp_f32 v47, v111
    s_waitcnt lgkmcnt(3)
    v_mfma_f32_32x32x16_bf16 v[112:127], v[76:79], v[188:191], v[112:127]
    ds_read_b128 v[60:63], v3 offset:6144
    v_add_f32 v6, v6, v45
    v_cvt_pk_bf16_f32 v86, v44, v45
    v_add_f32 v6, v6, v46
    v_add_f32 v6, v6, v47
    v_cvt_pk_bf16_f32 v87, v46, v47
    s_add_u32 s29, s29, 64
    v_cmp_nle_f32 vcc, v6, v12
    s_cbranch_vccnz K2_SLOW_12
K2_RET_13:
K2_E:
    s_waitcnt vmcnt(9)
    s_barrier
    s_waitcnt lgkmcnt(3)
    v_mfma_f32_32x32x16_bf16 v[192:207], v[48:51], v[80:83], v[192:207]
    ds_read_b128 v[64:67], v3 offset:1024
    v_subrev_u32 v9, s29, v8
    v_cmp_le_i32 vcc, 0, v9
    s_nop 1
    v_cndmask_b32 v112, v13, v112, vcc
    v_cmp_le_i32 vcc, 1, v9
    s_nop 1
    v_cndmask_b32 v113, v13, v113, vcc
    v_cmp_le_i32 vcc, 2, v9
    s_nop 1
    v_cndmask_b32 v114, v13, v114, vcc
    v_cmp_le_i32 vcc, 3, v9
    s_nop 1
    v_cndmask_b32 v115, v13, v115, vcc
    s_waitcnt lgkmcnt(3)
    v_mfma_f32_32x32x16_bf16 v[208:223], v[52:55], v[80:83], v[208:223]
    ds_read_b128 v[68:71], v3 offset:3072
    v_cmp_le_i32 vcc, 4, v9
    s_nop 1
    v_cndmask_b32 v116, v13, v116, vcc
    v_cmp_le_i32 vcc, 5, v9
    s_nop 1
    v_cndmask_b32 v117, v13, v117, vcc
    v_cmp_le_i32 vcc, 6, v9
    s_nop 1
    v_cndmask_b32 v118, v13, v118, vcc
    v_cmp_le_i32 vcc, 7, v9
    s_nop 1
    v_cndmask_b32 v119, v13, v119, vcc
    v_cmp_le_i32 vcc, 16, v9
    s_waitcnt lgkmcnt(3)
    v_mfma_f32_32x32x16_bf16 v[224:239], v[56:59], v[80:83], v[224:239]
    ds_read_b128 v[72:75], v3 offset:5120
    v_cndmask_b32 v120, v13, v120, vcc
    v_cmp_le_i32 vcc, 17, v9
    s_nop 1
    v_cndmask_b32 v121, v13, v121, vcc
    v_cmp_le_i32 vcc, 18, v9
    s_nop 1
    v_cndmask_b32 v122, v13, v122, vcc
    v_cmp_le_i32 vcc, 19, v9
    s_nop 1
    v_cndmask_b32 v123, v13, v123, vcc
    v_cmp_le_i32 vcc, 20, v9
    s_nop 1
    v_cndmask_b32 v124, v13, v124, vcc
    s_waitcnt lgkmcnt(3)
    v_mfma_f32_32x32x16_bf16 v[240:255], v[60:63], v[80:83], v[240:255]
    ds_read_b128 v[76:79], v3 offset:7168
    v_cmp_le_i32 vcc, 21, v9
    s_nop 1
    v_cndmask_b32 v125, v13, v125, vcc
    v_cmp_le_i32 vcc, 22, v9
    s_nop 1
    v_cndmask_b32 v126, v13, v126, vcc
    v_cmp_le_i32 vcc, 23, v9
    s_nop 1
    v_cndmask_b32 v127, v13, v127, vcc
    v_exp_f32 v32, v112
    v_exp_f32 v33, v113
    v_exp_f32 v34, v114
    s_waitcnt lgkmcnt(3)
    v_mfma_f32_32x32x16_bf16 v[192:207], v[64:67], v[84:87], v[192:207]
    v_add_u32 v3, s31, v14
    s_add_u32 s31, s31, 16384
    s_cmp_eq_u32 s31, 114688
    s_cselect_b32 s31, 49152, s31
    ds_read_b128 v[48:51], v3 offset:0
    v_add_f32 v7, v6, v32
    v_exp_f32 v35, v115
    v_add_f32 v7, v7, v33
    v_cvt_pk_bf16_f32 v88, v32, v33
    v_exp_f32 v36, v116
    v_add_f32 v7, v7, v34
    v_exp_f32 v37, v117
    v_add_f32 v7, v7, v35
    v_cvt_pk_bf16_f32 v89, v34, v35
    s_waitcnt lgkmcnt(3)
    v_mfma_f32_32x32x16_bf16 v[208:223], v[68:71], v[84:87], v[208:223]
    ds_read_b128 v[52:55], v3 offset:2048
    v_exp_f32 v38, v118
    v_add_f32 v7, v7, v36
    v_exp_f32 v39, v119
    v_add_f32 v7, v7, v37
    v_cvt_pk_bf16_f32 v90, v36, v37
    v_exp_f32 v40, v120
    v_add_f32 v7, v7, v38
    v_exp_f32 v41, v121
    v_add_f32 v7, v7, v39
    s_waitcnt lgkmcnt(3)
    v_mfma_f32_32x32x16_bf16 v[224:239], v[72:75], v[84:87], v[224:239]
    ds_read_b128 v[56:59], v3 offset:4096
    v_cvt_pk_bf16_f32 v91, v38, v39
    v_exp_f32 v42, v122
    v_add_f32 v7, v7, v40
    v_exp_f32 v43, v123
    v_add_f32 v7, v7, v41
    v_cvt_pk_bf16_f32 v92, v40, v41
    v_exp_f32 v44, v124
    v_add_f32 v7, v7, v42
    v_exp_f32 v45, v125
    s_waitcnt lgkmcnt(3)
    v_mfma_f32_32x32x16_bf16 v[240:255], v[76:79], v[84:87], v[240:255]
    ds_read_b128 v[60:63], v3 offset:6144
    v_add_f32 v7, v7, v43
    v_cvt_pk_bf16_f32 v93, v42, v43
    v_exp_f32 v46, v126
    v_add_f32 v7, v7, v44
    v_exp_f32 v47, v127
    v_add_f32 v7, v7, v45
    v_cvt_pk_bf16_f32 v94, v44, v45
    v_add_f32 v7, v7, v46
    v_add_f32 v7, v7, v47
    v_cvt_pk_bf16_f32 v95, v46, v47
    s_add_u32 s29, s29, 64
    v_cmp_nle_f32 vcc, v7, v12
    s_cbranch_vccnz K2_SLOW_14
K2_RET_15:
    s_barrier
    s_waitcnt lgkmcnt(3)
    v_mfma_f32_32x32x16_bf16 v[192:207], v[48:51], v[88:91], v[192:207]
    ds_read_b128 v[64:67], v3 offset:1024
    s_waitcnt lgkmcnt(3)
    v_mfma_f32_32x32x16_bf16 v[208:223], v[52:55], v[88:91], v[208:223]
    ds_read_b128 v[68:71], v3 offset:3072
    s_waitcnt lgkmcnt(3)
    v_mfma_f32_32x32x16_bf16 v[224:239], v[56:59], v[88:91], v[224:239]
    ds_read_b128 v[72:75], v3 offset:5120
    s_waitcnt lgkmcnt(3)
    v_mfma_f32_32x32x16_bf16 v[240:255], v[60:63], v[88:91], v[240:255]
    ds_read_b128 v[76:79], v3 offset:7168
    s_waitcnt lgkmcnt(3)
    v_mfma_f32_32x32x16_bf16 v[192:207], v[64:67], v[92:95], v[192:207]
    s_waitcnt lgkmcnt(2)
    v_mfma_f32_32x32x16_bf16 v[208:223], v[68:71], v[92:95], v[208:223]
    s_waitcnt lgkmcnt(1)
    v_mfma_f32_32x32x16_bf16 v[224:239], v[72:75], v[92:95], v[224:239]
    s_waitcnt lgkmcnt(0)
    v_mfma_f32_32x32x16_bf16 v[240:255], v[76:79], v[92:95], v[240:255]
    s_branch K2_JOIN
K2_DS:
    s_waitcnt vmcnt(9)
    s_barrier
    s_add_u32 s30, s30, 16384
    s_cmp_eq_u32 s30, 49152
    s_cselect_b32 s30, 0, s30
    s_waitcnt lgkmcnt(3)
    v_mfma_f32_32x32x16_bf16 v[192:207], v[48:51], v[88:91], v[192:207]
    ds_read_b128 v[64:67], v3 offset:1024
    s_add_u32 m0, s32, s40
    s_add_u32 s32, s32, 16384
    buffer_load_dwordx4 v10, s[16:19], s34 offen lds
    v_subrev_u32 v9, s29, v8
    v_cmp_le_i32 vcc, 0, v9
    s_nop 1
    v_cndmask_b32 v96, v13, v96, vcc
    v_cmp_le_i32 vcc, 1, v9
    s_nop 1
    v_cndmask_b32 v97, v13, v97, vcc
    v_cmp_le_i32 vcc, 2, v9
    s_nop 1
    v_cndmask_b32 v98, v13, v98, vcc
    v_cmp_le_i32 vcc, 3, v9
    s_nop 1
    v_cndmask_b32 v99, v13, v99, vcc
    s_waitcnt lgkmcnt(3)
    v_mfma_f32_32x32x16_bf16 v[208:223], v[52:55], v[88:91], v[208:223]
    ds_read_b128 v[68:71], v3 offset:3072
    buffer_load_dwordx4 v10, s[16:19], s34 offen offset:1024 lds
    s_add_u32 s34, s34, 16384
    v_cmp_le_i32 vcc, 4, v9
    s_nop 1
    v_cndmask_b32 v100, v13, v100, vcc
    v_cmp_le_i32 vcc, 5, v9
    s_nop 1
    v_cndmask_b32 v101, v13, v101, vcc
    v_cmp_le_i32 vcc, 6, v9
    s_nop 1
    v_cndmask_b32 v102, v13, v102, vcc
    v_cmp_le_i32 vcc, 7, v9
    s_nop 1
    v_cndmask_b32 v103, v13, v103, vcc
    v_cmp_le_i32 vcc, 16, v9
    s_waitcnt lgkmcnt(3)
    v_mfma_f32_32x32x16_bf16 v[224:239], v[56:59], v[88:91], v[224:239]
    ds_read_b128 v[72:75], v3 offset:5120
    s_cmp_eq_u32 s32, 49152
    s_cselect_b32 s32, 0, s32
    v_cndmask_b32 v104, v13, v104, vcc
    v_cmp_le_i32 vcc, 17, v9
    s_nop 1
    v_cndmask_b32 v105, v13, v105, vcc
    v_cmp_le_i32 vcc, 18, v9
    s_nop 1
    v_cndmask_b32 v106, v13, v106, vcc
    v_cmp_le_i32 vcc, 19, v9
    s_nop 1
    v_cndmask_b32 v107, v13, v107, vcc
    v_cmp_le_i32 vcc, 20, v9
    s_nop 1
    v_cndmask_b32 v108, v13, v108, vcc
    s_waitcnt lgkmcnt(3)
    v_mfma_f32_32x32x16_bf16 v[240:255], v[60:63], v[88:91], v[240:255]
    ds_read_b128 v[76:79], v3 offset:7168
    s_cmp_eq_u32 s34, s63
    s_cselect_b32 s34, s48, s34
    v_cmp_le_i32 vcc, 21, v9
    s_nop 1
    v_cndmask_b32 v109, v13, v109, vcc
    v_cmp_le_i32 vcc, 22, v9
    s_nop 1
    v_cndmask_b32 v110, v13, v110, vcc
    v_cmp_le_i32 vcc, 23, v9
    s_nop 1
    v_cndmask_b32 v111, v13, v111, vcc
    v_exp_f32 v32, v96
    v_exp_f32 v33, v97
    v_exp_f32 v34, v98
    s_waitcnt lgkmcnt(3)
    v_mfma_f32_32x32x16_bf16 v[192:207], v[64:67], v[92:95], v[192:207]
    v_add_u32 v3, s31, v14
    s_add_u32 s31, s31, 16384
    s_cmp_eq_u32 s31, 114688
    s_cselect_b32 s31, 49152, s31
    ds_read_b128 v[48:51], v3 offset:0
    s_add_u32 m0, s33, s40
    s_add_u32 s33, s33, 16384
    buffer_load_dwordx4 v10, s[20:23], s35 offen lds
    v_add_f32 v6, v7, v32
    v_exp_f32 v35, v99
    v_add_f32 v6, v6, v33
    v_cvt_pk_bf16_f32 v80, v32, v33
    v_exp_f32 v36, v100
    v_add_f32 v6, v6, v34
    v_exp_f32 v37, v101
    v_add_f32 v6, v6, v35
    v_cvt_pk_bf16_f32 v81, v34, v35
    s_waitcnt lgkmcnt(3)
    v_mfma_f32_32x32x16_bf16 v[208:223], v[68:71], v[92:95], v[208:223]
    ds_read_b128 v[52:55], v3 offset:2048
    buffer_load_dwordx4 v10, s[20:23], s35 offen offset:1024 lds
    s_add_u32 s35, s35, 16384
    v_exp_f32 v38, v102
    v_add_f32 v6, v6, v36
    v_exp_f32 v39, v103
    v_add_f32 v6, v6, v37
    v_cvt_pk_bf16_f32 v82, v36, v37
    v_exp_f32 v40, v104
    v_add_f32 v6, v6, v38
    v_exp_f32 v41, v105
    v_add_f32 v6, v6, v39
    s_waitcnt lgkmcnt(3)
    v_mfma_f32_32x32x16_bf16 v[224:239], v[72:75], v[92:95], v[224:239]
    ds_read_b128 v[56:59], v3 offset:4096
    s_cmp_eq_u32 s33, 114688
    s_cselect_b32 s33, 49152, s33
    v_cvt_pk_bf16_f32 v83, v38, v39
    v_exp_f32 v42, v106
    v_add_f32 v6, v6, v40
    v_exp_f32 v43, v107
    v_add_f32 v6, v6, v41
    v_cvt_pk_bf16_f32 v84, v40, v41
    v_exp_f32 v44, v108
    v_add_f32 v6, v6, v42
    v_exp_f32 v45, v109
    s_waitcnt lgkmcnt(3)
    v_mfma_f32_32x32x16_bf16 v[240:255], v[76:79], v[92:95], v[240:255]
    ds_read_b128 v[60:63], v3 offset:6144
    s_cmp_eq_u32 s35, s63
    s_cselect_b32 s35, s48, s35
    v_add_f32 v6, v6, v43
    v_cvt_pk_bf16_f32 v85, v42, v43
    v_exp_f32 v46, v110
    v_add_f32 v6, v6, v44
    v_exp_f32 v47, v111
    v_add_f32 v6, v6, v45
    v_cvt_pk_bf16_f32 v86, v44, v45
    v_add_f32 v6, v6, v46
    v_add_f32 v6, v6, v47
    v_cvt_pk_bf16_f32 v87, v46, v47
    s_add_u32 s29, s29, 64
    v_cmp_nle_f32 vcc, v6, v12
    s_cbranch_vccnz K2_SLOW_16
K2_RET_17:
K2_ES:
    s_waitcnt vmcnt(9)
    s_barrier
    s_add_u32 s31, s31, 16384
    s_cmp_eq_u32 s31, 114688
    s_cselect_b32 s31, 49152, s31
    s_waitcnt lgkmcnt(3)
    v_mfma_f32_32x32x16_bf16 v[192:207], v[48:51], v[80:83], v[192:207]
    ds_read_b128 v[64:67], v3 offset:1024
    s_waitcnt lgkmcnt(3)
    v_mfma_f32_32x32x16_bf16 v[208:223], v[52:55], v[80:83], v[208:223]
    ds_read_b128 v[68:71], v3 offset:3072
    s_waitcnt lgkmcnt(3)
    v_mfma_f32_32x32x16_bf16 v[224:239], v[56:59], v[80:83], v[224:239]
    ds_read_b128 v[72:75], v3 offset:5120
    s_waitcnt lgkmcnt(3)
    v_mfma_f32_32x32x16_bf16 v[240:255], v[60:63], v[80:83], v[240:255]
    ds_read_b128 v[76:79], v3 offset:7168
    s_waitcnt lgkmcnt(3)
    v_mfma_f32_32x32x16_bf16 v[192:207], v[64:67], v[84:87], v[192:207]
    s_waitcnt lgkmcnt(2)
    v_mfma_f32_32x32x16_bf16 v[208:223], v[68:71], v[84:87], v[208:223]
    s_waitcnt lgkmcnt(1)
    v_mfma_f32_32x32x16_bf16 v[224:239], v[72:75], v[84:87], v[224:239]
    s_waitcnt lgkmcnt(0)
    v_mfma_f32_32x32x16_bf16 v[240:255], v[76:79], v[84:87], v[240:255]
    v_mov_b32 v7, v6
    s_barrier
K2_JOIN:
    s_waitcnt vmcnt(0) lgkmcnt(0)
    s_cmp_lg_u32 s39, 0
    s_cbranch_scc1 K2_NORL
    v_lshrrev_b32 v100, 4, v0
    v_and_b32 v101, 15, v0
    v_lshrrev_b32 v102, 2, v101
    v_lshl_add_u32 v100, v100, 3, v102
    v_mul_u32_u24 v100, 160, v100
    v_and_b32 v101, 3, v101
    v_lshl_add_u32 v100, v101, 3, v100
    v_add_u32 v100, s62, v100
    v_lshlrev_b32 v101, 4, v0
    ds_read_b64_tr_b16 v[104:105], v100 offset:0
    ds_read_b64_tr_b16 v[106:107], v100 offset:640
    ds_read_b64_tr_b16 v[108:109], v100 offset:32
    ds_read_b64_tr_b16 v[110:111], v100 offset:672
    ds_read_b64_tr_b16 v[112:113], v100 offset:64
    ds_read_b64_tr_b16 v[114:115], v100 offset:704
    ds_read_b64_tr_b16 v[116:117], v100 offset:96
    ds_read_b64_tr_b16 v[118:119], v100 offset:736
    ds_read_b64_tr_b16 v[120:121], v100 offset:128
    ds_read_b64_tr_b16 v[122:123], v100 offset:768
    s_waitcnt lgkmcnt(8)
    buffer_store_dwordx4 v[104:107], v101, s[68:71], s76 offen
    s_add_u32 s76, s76, s74
    s_waitcnt lgkmcnt(6)
    buffer_store_dwordx4 v[108:111], v101, s[68:71], s76 offen
    s_add_u32 s76, s76, s74
    s_waitcnt lgkmcnt(4)
    buffer_store_dwordx4 v[112:115], v101, s[68:71], s76 offen
    s_add_u32 s76, s76, s74
    s_waitcnt lgkmcnt(2)
    buffer_store_dwordx4 v[116:119], v101, s[68:71], s76 offen
    s_add_u32 s76, s76, s74
    s_waitcnt lgkmcnt(0)
    buffer_store_dwordx4 v[120:123], v101, s[68:71], s76 offen
    s_waitcnt lgkmcnt(0)
K2_NORL:
    s_barrier
    v_mov_b32 v11, v7
    s_nop 1
    v_permlane32_swap_b32 v7, v11
    v_add_f32 v7, v7, v11
    s_mul_i32 s46, s3, 4608
    s_add_u32 s46, s46, 114688
    v_add_u32 v11, s46, v1
    v_lshrrev_b32 v9, 2, v1
    v_add_u32 v9, s46, v9
    s_xor_b32 s46, s3, 4
    s_mul_i32 s46, s46, 4608
    s_add_u32 s46, s46, 114688
    v_add_u32 v96, s46, v1
    v_lshrrev_b32 v97, 2, v1
    v_add_u32 v97, s46, v97
    ds_write_b32 v9, v16 offset:4096
    ds_write_b32 v9, v7 offset:4352
    s_cmp_eq_u32 s4, 0
    s_cbranch_scc0 K2_MRG1
    ds_write_b128 v11, v[224:227] offset:0
    ds_write_b128 v11, v[228:231] offset:1024
    ds_write_b128 v11, v[232:235] offset:2048
    ds_write_b128 v11, v[236:239] offset:3072
    s_waitcnt lgkmcnt(0)
    s_barrier
    ds_read_b32 v64, v97 offset:4096
    ds_read_b32 v65, v97 offset:4352
    ds_read_b128 v[32:35], v96 offset:0
    ds_read_b128 v[36:39], v96 offset:1024
    ds_read_b128 v[40:43], v96 offset:2048
    ds_read_b128 v[44:47], v96 offset:3072
    s_waitcnt lgkmcnt(0)
    s_barrier
    ds_write_b128 v11, v[240:243] offset:0
    ds_write_b128 v11, v[244:247] offset:1024
    ds_write_b128 v11, v[248:251] offset:2048
    ds_write_b128 v11, v[252:255] offset:3072
    s_waitcnt lgkmcnt(0)
    s_barrier
    ds_read_b128 v[48:51], v96 offset:0
    ds_read_b128 v[52:55], v96 offset:1024
    ds_read_b128 v[56:59], v96 offset:2048
    ds_read_b128 v[60:63], v96 offset:3072
    s_waitcnt lgkmcnt(0)
    s_barrier
    v_min_f32 v66, v16, v64
    v_sub_f32 v67, v66, v16
    v_sub_f32 v68, v66, v64
    v_exp_f32 v67, v67
    v_exp_f32 v68, v68
    v_mul_f32 v7, v7, v67
    v_fmac_f32 v7, v65, v68
    v_rcp_f32 v7, v7
    s_nop 0
    v_mul_f32 v67, v67, v7
    v_mul_f32 v68, v68, v7
    s_lshl_b32 s46, s38, 2
    s_add_u32 s46, s46, s5
    s_lshl_b32 s46, s46, 18
    s_lshl_b32 s47, s6, 13
    s_add_u32 s46, s46, s47
    s_lshl_b32 s47, s4, 12
    s_add_u32 s46, s46, s47
    v_mul_f32 v192, v192, v67
    v_fmac_f32 v192, v32, v68
    v_mul_f32 v193, v193, v67
    v_fmac_f32 v193, v33, v68
    v_mul_f32 v194, v194, v67
    v_fmac_f32 v194, v34, v68
    v_mul_f32 v195, v195, v67
    v_fmac_f32 v195, v35, v68
    v_mul_f32 v196, v196, v67
    v_fmac_f32 v196, v36, v68
    v_mul_f32 v197, v197, v67
    v_fmac_f32 v197, v37, v68
    v_mul_f32 v198, v198, v67
    v_fmac_f32 v198, v38, v68
    v_mul_f32 v199, v199, v67
    v_fmac_f32 v199, v39, v68
    v_mul_f32 v200, v200, v67
    v_fmac_f32 v200, v40, v68
    v_mul_f32 v201, v201, v67
    v_fmac_f32 v201, v41, v68
    v_mul_f32 v202, v202, v67
    v_fmac_f32 v202, v42, v68
    v_mul_f32 v203, v203, v67
    v_fmac_f32 v203, v43, v68
    v_mul_f32 v204, v204, v67
    v_fmac_f32 v204, v44, v68
    v_mul_f32 v205, v205, v67
    v_fmac_f32 v205, v45, v68
    v_mul_f32 v206, v206, v67
    v_fmac_f32 v206, v46, v68
    v_mul_f32 v207, v207, v67
    v_fmac_f32 v207, v47, v68
    v_mul_f32 v208, v208, v67
    v_fmac_f32 v208, v48, v68
    v_mul_f32 v209, v209, v67
    v_fmac_f32 v209, v49, v68
    v_mul_f32 v210, v210, v67
    v_fmac_f32 v210, v50, v68
    v_mul_f32 v211, v211, v67
    v_fmac_f32 v211, v51, v68
    v_mul_f32 v212, v212, v67
    v_fmac_f32 v212, v52, v68
    v_mul_f32 v213, v213, v67
    v_fmac_f32 v213, v53, v68
    v_mul_f32 v214, v214, v67
    v_fmac_f32 v214, v54, v68
    v_mul_f32 v215, v215, v67
    v_fmac_f32 v215, v55, v68
    v_mul_f32 v216, v216, v67
    v_fmac_f32 v216, v56, v68
    v_mul_f32 v217, v217, v67
    v_fmac_f32 v217, v57, v68
    v_mul_f32 v218, v218, v67
    v_fmac_f32 v218, v58, v68
    v_mul_f32 v219, v219, v67
    v_fmac_f32 v219, v59, v68
    v_mul_f32 v220, v220, v67
    v_fmac_f32 v220, v60, v68
    v_mul_f32 v221, v221, v67
    v_fmac_f32 v221, v61, v68
    v_mul_f32 v222, v222, v67
    v_fmac_f32 v222, v62, v68
    v_mul_f32 v223, v223, v67
    v_fmac_f32 v223, v63, v68
    v_cvt_pk_bf16_f32 v100, v192, v193
    v_cvt_pk_bf16_f32 v101, v194, v195
    v_cvt_pk_bf16_f32 v102, v196, v197
    v_cvt_pk_bf16_f32 v103, v198, v199
    buffer_store_dwordx4 v[100:103], v1, s[24:27], s46 offen offset:0
    v_cvt_pk_bf16_f32 v104, v200, v201
    v_cvt_pk_bf16_f32 v105, v202, v203
    v_cvt_pk_bf16_f32 v106, v204, v205
    v_cvt_pk_bf16_f32 v107, v206, v207
    buffer_store_dwordx4 v[104:107], v1, s[24:27], s46 offen offset:1024
    v_cvt_pk_bf16_f32 v108, v208, v209
    v_cvt_pk_bf16_f32 v109, v210, v211
    v_cvt_pk_bf16_f32 v110, v212, v213
    v_cvt_pk_bf16_f32 v111, v214, v215
    buffer_store_dwordx4 v[108:111], v1, s[24:27], s46 offen offset:2048
    v_cvt_pk_bf16_f32 v112, v216, v217
    v_cvt_pk_bf16_f32 v113, v218, v219
    v_cvt_pk_bf16_f32 v114, v220, v221
    v_cvt_pk_bf16_f32 v115, v222, v223
    buffer_store_dwordx4 v[112:115], v1, s[24:27], s46 offen offset:3072
    s_branch K2_FIN
K2_MRG1:
    ds_write_b128 v11, v[192:195] offset:0
    ds_write_b128 v11, v[196:199] offset:1024
    ds_write_b128 v11, v[200:203] offset:2048
    ds_write_b128 v11, v[204:207] offset:3072
    s_waitcnt lgkmcnt(0)
    s_barrier
    ds_read_b32 v64, v97 offset:4096
    ds_read_b32 v65, v97 offset:4352
    ds_read_b128 v[32:35], v96 offset:0
    ds_read_b128 v[36:39], v96 offset:1024
    ds_read_b128 v[40:43], v96 offset:2048
    ds_read_b128 v[44:47], v96 offset:3072
    s_waitcnt lgkmcnt(0)
    s_barrier
    ds_write_b128 v11, v[208:211] offset:0
    ds_write_b128 v11, v[212:215] offset:1024
    ds_write_b128 v11, v[216:219] offset:2048
    ds_write_b128 v11, v[220:223] offset:3072
    s_waitcnt lgkmcnt(0)
    s_barrier
    ds_read_b128 v[48:51], v96 offset:0
    ds_read_b128 v[52:55], v96 offset:1024
    ds_read_b128 v[56:59], v96 offset:2048
    ds_read_b128 v[60:63], v96 offset:3072
    s_waitcnt lgkmcnt(0)
    s_barrier
    v_min_f32 v66, v16, v64
    v_sub_f32 v67, v66, v16
    v_sub_f32 v68, v66, v64
    v_exp_f32 v67, v67
    v_exp_f32 v68, v68
    v_mul_f32 v7, v7, v67
    v_fmac_f32 v7, v65, v68
    v_rcp_f32 v7, v7
    s_nop 0
    v_mul_f32 v67, v67, v7
    v_mul_f32 v68, v68, v7
    s_lshl_b32 s46, s38, 2
    s_add_u32 s46, s46, s5
    s_lshl_b32 s46, s46, 18
    s_lshl_b32 s47, s6, 13
    s_add_u32 s46, s46, s47
    s_lshl_b32 s47, s4, 12
    s_add_u32 s46, s46, s47
    v_mul_f32 v224, v224, v67
    v_fmac_f32 v224, v32, v68
    v_mul_f32 v225, v225, v67
    v_fmac_f32 v225, v33, v68
    v_mul_f32 v226, v226, v67
    v_fmac_f32 v226, v34, v68
    v_mul_f32 v227, v227, v67
    v_fmac_f32 v227, v35, v68
    v_mul_f32 v228, v228, v67
    v_fmac_f32 v228, v36, v68
    v_mul_f32 v229, v229, v67
    v_fmac_f32 v229, v37, v68
    v_mul_f32 v230, v230, v67
    v_fmac_f32 v230, v38, v68
    v_mul_f32 v231, v231, v67
    v_fmac_f32 v231, v39, v68
    v_mul_f32 v232, v232, v67
    v_fmac_f32 v232, v40, v68
    v_mul_f32 v233, v233, v67
    v_fmac_f32 v233, v41, v68
    v_mul_f32 v234, v234, v67
    v_fmac_f32 v234, v42, v68
    v_mul_f32 v235, v235, v67
    v_fmac_f32 v235, v43, v68
    v_mul_f32 v236, v236, v67
    v_fmac_f32 v236, v44, v68
    v_mul_f32 v237, v237, v67
    v_fmac_f32 v237, v45, v68
    v_mul_f32 v238, v238, v67
    v_fmac_f32 v238, v46, v68
    v_mul_f32 v239, v239, v67
    v_fmac_f32 v239, v47, v68
    v_mul_f32 v240, v240, v67
    v_fmac_f32 v240, v48, v68
    v_mul_f32 v241, v241, v67
    v_fmac_f32 v241, v49, v68
    v_mul_f32 v242, v242, v67
    v_fmac_f32 v242, v50, v68
    v_mul_f32 v243, v243, v67
    v_fmac_f32 v243, v51, v68
    v_mul_f32 v244, v244, v67
    v_fmac_f32 v244, v52, v68
    v_mul_f32 v245, v245, v67
    v_fmac_f32 v245, v53, v68
    v_mul_f32 v246, v246, v67
    v_fmac_f32 v246, v54, v68
    v_mul_f32 v247, v247, v67
    v_fmac_f32 v247, v55, v68
    v_mul_f32 v248, v248, v67
    v_fmac_f32 v248, v56, v68
    v_mul_f32 v249, v249, v67
    v_fmac_f32 v249, v57, v68
    v_mul_f32 v250, v250, v67
    v_fmac_f32 v250, v58, v68
    v_mul_f32 v251, v251, v67
    v_fmac_f32 v251, v59, v68
    v_mul_f32 v252, v252, v67
    v_fmac_f32 v252, v60, v68
    v_mul_f32 v253, v253, v67
    v_fmac_f32 v253, v61, v68
    v_mul_f32 v254, v254, v67
    v_fmac_f32 v254, v62, v68
    v_mul_f32 v255, v255, v67
    v_fmac_f32 v255, v63, v68
    v_cvt_pk_bf16_f32 v100, v224, v225
    v_cvt_pk_bf16_f32 v101, v226, v227
    v_cvt_pk_bf16_f32 v102, v228, v229
    v_cvt_pk_bf16_f32 v103, v230, v231
    buffer_store_dwordx4 v[100:103], v1, s[24:27], s46 offen offset:0
    v_cvt_pk_bf16_f32 v104, v232, v233
    v_cvt_pk_bf16_f32 v105, v234, v235
    v_cvt_pk_bf16_f32 v106, v236, v237
    v_cvt_pk_bf16_f32 v107, v238, v239
    buffer_store_dwordx4 v[104:107], v1, s[24:27], s46 offen offset:1024
    v_cvt_pk_bf16_f32 v108, v240, v241
    v_cvt_pk_bf16_f32 v109, v242, v243
    v_cvt_pk_bf16_f32 v110, v244, v245
    v_cvt_pk_bf16_f32 v111, v246, v247
    buffer_store_dwordx4 v[108:111], v1, s[24:27], s46 offen offset:2048
    v_cvt_pk_bf16_f32 v112, v248, v249
    v_cvt_pk_bf16_f32 v113, v250, v251
    v_cvt_pk_bf16_f32 v114, v252, v253
    v_cvt_pk_bf16_f32 v115, v254, v255
    buffer_store_dwordx4 v[112:115], v1, s[24:27], s46 offen offset:3072
K2_FIN:
    s_add_u32 s39, s39, 1
    s_cmp_eq_u32 s39, 2
    s_cbranch_scc1 K2_END
    v_mov_b32 v160, v128
    v_mov_b32 v161, v129
    v_mov_b32 v162, v130
    v_mov_b32 v163, v131
    v_mov_b32 v164, v132
    v_mov_b32 v165, v133
    v_mov_b32 v166, v134
    v_mov_b32 v167, v135
    v_mov_b32 v168, v136
    v_mov_b32 v169, v137
    v_mov_b32 v170, v138
    v_mov_b32 v171, v139
    v_mov_b32 v172, v140
    v_mov_b32 v173, v141
    v_mov_b32 v174, v142
    v_mov_b32 v175, v143
    v_mov_b32 v176, v144
    v_mov_b32 v177, v145
    v_mov_b32 v178, v146
    v_mov_b32 v179, v147
    v_mov_b32 v180, v148
    v_mov_b32 v181, v149
    v_mov_b32 v182, v150
    v_mov_b32 v183, v151
    v_mov_b32 v184, v152
    v_mov_b32 v185, v153
    v_mov_b32 v186, v154
    v_mov_b32 v187, v155
    v_mov_b32 v188, v156
    v_mov_b32 v189, v157
    v_mov_b32 v190, v158
    v_mov_b32 v191, v159
    s_mov_b32 s38, s7
    s_waitcnt vmcnt(4)
    s_branch K2_BLOCK
K2_END:
    s_endpgm
K2_SLOW_1:
    v_max3_f32 v11, v96, v97, v98
    v_max3_f32 v11, v11, v99, v100
    v_max3_f32 v11, v11, v101, v102
    v_max3_f32 v11, v11, v103, v104
    v_max3_f32 v11, v11, v105, v106
    v_max3_f32 v11, v11, v107, v108
    v_max3_f32 v11, v11, v109, v110
    v_mov_b32 v9, 0xf149f2ca
    v_max3_f32 v11, v11, v111, v9
    v_mov_b32 v9, v11
    s_nop 1
    v_permlane32_swap_b32 v11, v9
    v_max_f32 v11, v11, v9
    v_sub_f32 v16, v16, v11
    v_sub_f32 v17, v17, v11
    v_sub_f32 v18, v18, v11
    v_sub_f32 v19, v19, v11
    v_sub_f32 v20, v20, v11
    v_sub_f32 v21, v21, v11
    v_sub_f32 v22, v22, v11
    v_sub_f32 v23, v23, v11
    v_sub_f32 v24, v24, v11
    v_sub_f32 v25, v25, v11
    v_sub_f32 v26, v26, v11
    v_sub_f32 v27, v27, v11
    v_sub_f32 v28, v28, v11
    v_sub_f32 v29, v29, v11
    v_sub_f32 v30, v30, v11
    v_sub_f32 v31, v31, v11
    v_mov_b32 v6, 0
    v_sub_f32 v112, v112, v11
    v_sub_f32 v113, v113, v11
    v_sub_f32 v114, v114, v11
    v_sub_f32 v115, v115, v11
    v_sub_f32 v116, v116, v11
    v_sub_f32 v117, v117, v11
    v_sub_f32 v118, v118, v11
    v_sub_f32 v119, v119, v11
    v_sub_f32 v120, v120, v11
    v_sub_f32 v121, v121, v11
    v_sub_f32 v122, v122, v11
    v_sub_f32 v123, v123, v11
    v_sub_f32 v124, v124, v11
    v_sub_f32 v125, v125, v11
    v_sub_f32 v126, v126, v11
    v_sub_f32 v127, v127, v11
    v_sub_f32 v32, v96, v11
    v_sub_f32 v33, v97, v11
    v_sub_f32 v34, v98, v11
    v_sub_f32 v35, v99, v11
    v_sub_f32 v36, v100, v11
    v_sub_f32 v37, v101, v11
    v_sub_f32 v38, v102, v11
    v_sub_f32 v39, v103, v11
    v_sub_f32 v40, v104, v11
    v_sub_f32 v41, v105, v11
    v_sub_f32 v42, v106, v11
    v_sub_f32 v43, v107, v11
    v_sub_f32 v44, v108, v11
    v_sub_f32 v45, v109, v11
    v_sub_f32 v46, v110, v11
    v_sub_f32 v47, v111, v11
    v_exp_f32 v32, v32
    v_exp_f32 v33, v33
    v_exp_f32 v34, v34
    v_exp_f32 v35, v35
    v_exp_f32 v36, v36
    v_exp_f32 v37, v37
    v_exp_f32 v38, v38
    v_exp_f32 v39, v39
    v_exp_f32 v40, v40
    v_exp_f32 v41, v41
    v_exp_f32 v42, v42
    v_exp_f32 v43, v43
    v_exp_f32 v44, v44
    v_exp_f32 v45, v45
    v_exp_f32 v46, v46
    v_exp_f32 v47, v47
    v_add_f32 v6, v6, v32
    v_add_f32 v6, v6, v33
    v_add_f32 v6, v6, v34
    v_add_f32 v6, v6, v35
    v_add_f32 v6, v6, v36
    v_add_f32 v6, v6, v37
    v_add_f32 v6, v6, v38
    v_add_f32 v6, v6, v39
    v_add_f32 v6, v6, v40
    v_add_f32 v6, v6, v41
    v_add_f32 v6, v6, v42
    v_add_f32 v6, v6, v43
    v_add_f32 v6, v6, v44
    v_add_f32 v6, v6, v45
    v_add_f32 v6, v6, v46
    v_add_f32 v6, v6, v47
    v_cvt_pk_bf16_f32 v80, v32, v33
    v_cvt_pk_bf16_f32 v81, v34, v35
    v_cvt_pk_bf16_f32 v82, v36, v37
    v_cvt_pk_bf16_f32 v83, v38, v39
    v_cvt_pk_bf16_f32 v84, v40, v41
    v_cvt_pk_bf16_f32 v85, v42, v43
    v_cvt_pk_bf16_f32 v86, v44, v45
    v_cvt_pk_bf16_f32 v87, v46, v47
    s_branch K2_RET_2
K2_SLOW_3:
    v_max3_f32 v11, v112, v113, v114
    v_max3_f32 v11, v11, v115, v116
    v_max3_f32 v11, v11, v117, v118
    v_max3_f32 v11, v11, v119, v120
    v_max3_f32 v11, v11, v121, v122
    v_max3_f32 v11, v11, v123, v124
    v_max3_f32 v11, v11, v125, v126
    v_max3_f32 v11, v11, v127, 0
    v_mov_b32 v9, v11
    s_nop 1
    v_permlane32_swap_b32 v11, v9
    v_max_f32 v11, v11, v9
    v_sub_f32 v16, v16, v11
    v_sub_f32 v17, v17, v11
    v_sub_f32 v18, v18, v11
    v_sub_f32 v19, v19, v11
    v_sub_f32 v20, v20, v11
    v_sub_f32 v21, v21, v11
    v_sub_f32 v22, v22, v11
    v_sub_f32 v23, v23, v11
    v_sub_f32 v24, v24, v11
    v_sub_f32 v25, v25, v11
    v_sub_f32 v26, v26, v11
    v_sub_f32 v27, v27, v11
    v_sub_f32 v28, v28, v11
    v_sub_f32 v29, v29, v11
    v_sub_f32 v30, v30, v11
    v_sub_f32 v31, v31, v11
    v_sub_f32 v9, 0, v11
    v_exp_f32 v9, v9
    s_nop 0
    v_mul_f32 v192, v192, v9
    v_mul_f32 v193, v193, v9
    v_mul_f32 v194, v194, v9
    v_mul_f32 v195, v195, v9
    v_mul_f32 v196, v196, v9
    v_mul_f32 v197, v197, v9
    v_mul_f32 v198, v198, v9
    v_mul_f32 v199, v199, v9
    v_mul_f32 v200, v200, v9
    v_mul_f32 v201, v201, v9
    v_mul_f32 v202, v202, v9
    v_mul_f32 v203, v203, v9
    v_mul_f32 v204, v204, v9
    v_mul_f32 v205, v205, v9
    v_mul_f32 v206, v206, v9
    v_mul_f32 v207, v207, v9
    v_mul_f32 v208, v208, v9
    v_mul_f32 v209, v209, v9
    v_mul_f32 v210, v210, v9
    v_mul_f32 v211, v211, v9
    v_mul_f32 v212, v212, v9
    v_mul_f32 v213, v213, v9
    v_mul_f32 v214, v214, v9
    v_mul_f32 v215, v215, v9
    v_mul_f32 v216, v216, v9
    v_mul_f32 v217, v217, v9
    v_mul_f32 v218, v218, v9
    v_mul_f32 v219, v219, v9
    v_mul_f32 v220, v220, v9
    v_mul_f32 v221, v221, v9
    v_mul_f32 v222, v222, v9
    v_mul_f32 v223, v223, v9
    v_mul_f32 v224, v224, v9
    v_mul_f32 v225, v225, v9
    v_mul_f32 v226, v226, v9
    v_mul_f32 v227, v227, v9
    v_mul_f32 v228, v228, v9
    v_mul_f32 v229, v229, v9
    v_mul_f32 v230, v230, v9
    v_mul_f32 v231, v231, v9
    v_mul_f32 v232, v232, v9
    v_mul_f32 v233, v233, v9
    v_mul_f32 v234, v234, v9
    v_mul_f32 v235, v235, v9
    v_mul_f32 v236, v236, v9
    v_mul_f32 v237, v237, v9
    v_mul_f32 v238, v238, v9
    v_mul_f32 v239, v239, v9
    v_mul_f32 v240, v240, v9
    v_mul_f32 v241, v241, v9
    v_mul_f32 v242, v242, v9
    v_mul_f32 v243, v243, v9
    v_mul_f32 v244, v244, v9
    v_mul_f32 v245, v245, v9
    v_mul_f32 v246, v246, v9
    v_mul_f32 v247, v247, v9
    v_mul_f32 v248, v248, v9
    v_mul_f32 v249, v249, v9
    v_mul_f32 v250, v250, v9
    v_mul_f32 v251, v251, v9
    v_mul_f32 v252, v252, v9
    v_mul_f32 v253, v253, v9
    v_mul_f32 v254, v254, v9
    v_mul_f32 v255, v255, v9
    v_mul_f32 v7, v6, v9
    v_sub_f32 v96, v96, v11
    v_sub_f32 v97, v97, v11
    v_sub_f32 v98, v98, v11
    v_sub_f32 v99, v99, v11
    v_sub_f32 v100, v100, v11
    v_sub_f32 v101, v101, v11
    v_sub_f32 v102, v102, v11
    v_sub_f32 v103, v103, v11
    v_sub_f32 v104, v104, v11
    v_sub_f32 v105, v105, v11
    v_sub_f32 v106, v106, v11
    v_sub_f32 v107, v107, v11
    v_sub_f32 v108, v108, v11
    v_sub_f32 v109, v109, v11
    v_sub_f32 v110, v110, v11
    v_sub_f32 v111, v111, v11
    v_sub_f32 v32, v112, v11
    v_sub_f32 v33, v113, v11
    v_sub_f32 v34, v114, v11
    v_sub_f32 v35, v115, v11
    v_sub_f32 v36, v116, v11
    v_sub_f32 v37, v117, v11
    v_sub_f32 v38, v118, v11
    v_sub_f32 v39, v119, v11
    v_sub_f32 v40, v120, v11
    v_sub_f32 v41, v121, v11
    v_sub_f32 v42, v122, v11
    v_sub_f32 v43, v123, v11
    v_sub_f32 v44, v124, v11
    v_sub_f32 v45, v125, v11
    v_sub_f32 v46, v126, v11
    v_sub_f32 v47, v127, v11
    v_exp_f32 v32, v32
    v_exp_f32 v33, v33
    v_exp_f32 v34, v34
    v_exp_f32 v35, v35
    v_exp_f32 v36, v36
    v_exp_f32 v37, v37
    v_exp_f32 v38, v38
    v_exp_f32 v39, v39
    v_exp_f32 v40, v40
    v_exp_f32 v41, v41
    v_exp_f32 v42, v42
    v_exp_f32 v43, v43
    v_exp_f32 v44, v44
    v_exp_f32 v45, v45
    v_exp_f32 v46, v46
    v_exp_f32 v47, v47
    v_add_f32 v7, v7, v32
    v_add_f32 v7, v7, v33
    v_add_f32 v7, v7, v34
    v_add_f32 v7, v7, v35
    v_add_f32 v7, v7, v36
    v_add_f32 v7, v7, v37
    v_add_f32 v7, v7, v38
    v_add_f32 v7, v7, v39
    v_add_f32 v7, v7, v40
    v_add_f32 v7, v7, v41
    v_add_f32 v7, v7, v42
    v_add_f32 v7, v7, v43
    v_add_f32 v7, v7, v44
    v_add_f32 v7, v7, v45
    v_add_f32 v7, v7, v46
    v_add_f32 v7, v7, v47
    v_cvt_pk_bf16_f32 v88, v32, v33
    v_cvt_pk_bf16_f32 v89, v34, v35
    v_cvt_pk_bf16_f32 v90, v36, v37
    v_cvt_pk_bf16_f32 v91, v38, v39
    v_cvt_pk_bf16_f32 v92, v40, v41
    v_cvt_pk_bf16_f32 v93, v42, v43
    v_cvt_pk_bf16_f32 v94, v44, v45
    v_cvt_pk_bf16_f32 v95, v46, v47
    s_branch K2_RET_4
K2_SLOW_5:
    v_max3_f32 v11, v96, v97, v98
    v_max3_f32 v11, v11, v99, v100
    v_max3_f32 v11, v11, v101, v102
    v_max3_f32 v11, v11, v103, v104
    v_max3_f32 v11, v11, v105, v106
    v_max3_f32 v11, v11, v107, v108
    v_max3_f32 v11, v11, v109, v110
    v_max3_f32 v11, v11, v111, 0
    v_mov_b32 v9, v11
    s_nop 1
    v_permlane32_swap_b32 v11, v9
    v_max_f32 v11, v11, v9
    v_sub_f32 v16, v16, v11
    v_sub_f32 v17, v17, v11
    v_sub_f32 v18, v18, v11
    v_sub_f32 v19, v19, v11
    v_sub_f32 v20, v20, v11
    v_sub_f32 v21, v21, v11
    v_sub_f32 v22, v22, v11
    v_sub_f32 v23, v23, v11
    v_sub_f32 v24, v24, v11
    v_sub_f32 v25, v25, v11
    v_sub_f32 v26, v26, v11
    v_sub_f32 v27, v27, v11
    v_sub_f32 v28, v28, v11
    v_sub_f32 v29, v29, v11
    v_sub_f32 v30, v30, v11
    v_sub_f32 v31, v31, v11
    v_sub_f32 v9, 0, v11
    v_exp_f32 v9, v9
    s_nop 0
    v_mul_f32 v192, v192, v9
    v_mul_f32 v193, v193, v9
    v_mul_f32 v194, v194, v9
    v_mul_f32 v195, v195, v9
    v_mul_f32 v196, v196, v9
    v_mul_f32 v197, v197, v9
    v_mul_f32 v198, v198, v9
    v_mul_f32 v199, v199, v9
    v_mul_f32 v200, v200, v9
    v_mul_f32 v201, v201, v9
    v_mul_f32 v202, v202, v9
    v_mul_f32 v203, v203, v9
    v_mul_f32 v204, v204, v9
    v_mul_f32 v205, v205, v9
    v_mul_f32 v206, v206, v9
    v_mul_f32 v207, v207, v9
    v_mul_f32 v208, v208, v9
    v_mul_f32 v209, v209, v9
    v_mul_f32 v210, v210, v9
    v_mul_f32 v211, v211, v9
    v_mul_f32 v212, v212, v9
    v_mul_f32 v213, v213, v9
    v_mul_f32 v214, v214, v9
    v_mul_f32 v215, v215, v9
    v_mul_f32 v216, v216, v9
    v_mul_f32 v217, v217, v9
    v_mul_f32 v218, v218, v9
    v_mul_f32 v219, v219, v9
    v_mul_f32 v220, v220, v9
    v_mul_f32 v221, v221, v9
    v_mul_f32 v222, v222, v9
    v_mul_f32 v223, v223, v9
    v_mul_f32 v224, v224, v9
    v_mul_f32 v225, v225, v9
    v_mul_f32 v226, v226, v9
    v_mul_f32 v227, v227, v9
    v_mul_f32 v228, v228, v9
    v_mul_f32 v229, v229, v9
    v_mul_f32 v230, v230, v9
    v_mul_f32 v231, v231, v9
    v_mul_f32 v232, v232, v9
    v_mul_f32 v233, v233, v9
    v_mul_f32 v234, v234, v9
    v_mul_f32 v235, v235, v9
    v_mul_f32 v236, v236, v9
    v_mul_f32 v237, v237, v9
    v_mul_f32 v238, v238, v9
    v_mul_f32 v239, v239, v9
    v_mul_f32 v240, v240, v9
    v_mul_f32 v241, v241, v9
    v_mul_f32 v242, v242, v9
    v_mul_f32 v243, v243, v9
    v_mul_f32 v244, v244, v9
    v_mul_f32 v245, v245, v9
    v_mul_f32 v246, v246, v9
    v_mul_f32 v247, v247, v9
    v_mul_f32 v248, v248, v9
    v_mul_f32 v249, v249, v9
    v_mul_f32 v250, v250, v9
    v_mul_f32 v251, v251, v9
    v_mul_f32 v252, v252, v9
    v_mul_f32 v253, v253, v9
    v_mul_f32 v254, v254, v9
    v_mul_f32 v255, v255, v9
    v_mul_f32 v6, v7, v9
    v_sub_f32 v112, v112, v11
    v_sub_f32 v113, v113, v11
    v_sub_f32 v114, v114, v11
    v_sub_f32 v115, v115, v11
    v_sub_f32 v116, v116, v11
    v_sub_f32 v117, v117, v11
    v_sub_f32 v118, v118, v11
    v_sub_f32 v119, v119, v11
    v_sub_f32 v120, v120, v11
    v_sub_f32 v121, v121, v11
    v_sub_f32 v122, v122, v11
    v_sub_f32 v123, v123, v11
    v_sub_f32 v124, v124, v11
    v_sub_f32 v125, v125, v11
    v_sub_f32 v126, v126, v11
    v_sub_f32 v127, v127, v11
    v_sub_f32 v32, v96, v11
    v_sub_f32 v33, v97, v11
    v_sub_f32 v34, v98, v11
    v_sub_f32 v35, v99, v11
    v_sub_f32 v36, v100, v11
    v_sub_f32 v37, v101, v11
    v_sub_f32 v38, v102, v11
    v_sub_f32 v39, v103, v11
    v_sub_f32 v40, v104, v11
    v_sub_f32 v41, v105, v11
    v_sub_f32 v42, v106, v11
    v_sub_f32 v43, v107, v11
    v_sub_f32 v44, v108, v11
    v_sub_f32 v45, v109, v11
    v_sub_f32 v46, v110, v11
    v_sub_f32 v47, v111, v11
    v_exp_f32 v32, v32
    v_exp_f32 v33, v33
    v_exp_f32 v34, v34
    v_exp_f32 v35, v35
    v_exp_f32 v36, v36
    v_exp_f32 v37, v37
    v_exp_f32 v38, v38
    v_exp_f32 v39, v39
    v_exp_f32 v40, v40
    v_exp_f32 v41, v41
    v_exp_f32 v42, v42
    v_exp_f32 v43, v43
    v_exp_f32 v44, v44
    v_exp_f32 v45, v45
    v_exp_f32 v46, v46
    v_exp_f32 v47, v47
    v_add_f32 v6, v6, v32
    v_add_f32 v6, v6, v33
    v_add_f32 v6, v6, v34
    v_add_f32 v6, v6, v35
    v_add_f32 v6, v6, v36
    v_add_f32 v6, v6, v37
    v_add_f32 v6, v6, v38
    v_add_f32 v6, v6, v39
    v_add_f32 v6, v6, v40
    v_add_f32 v6, v6, v41
    v_add_f32 v6, v6, v42
    v_add_f32 v6, v6, v43
    v_add_f32 v6, v6, v44
    v_add_f32 v6, v6, v45
    v_add_f32 v6, v6, v46
    v_add_f32 v6, v6, v47
    v_cvt_pk_bf16_f32 v80, v32, v33
    v_cvt_pk_bf16_f32 v81, v34, v35
    v_cvt_pk_bf16_f32 v82, v36, v37
    v_cvt_pk_bf16_f32 v83, v38, v39
    v_cvt_pk_bf16_f32 v84, v40, v41
    v_cvt_pk_bf16_f32 v85, v42, v43
    v_cvt_pk_bf16_f32 v86, v44, v45
    v_cvt_pk_bf16_f32 v87, v46, v47
    s_branch K2_RET_6
K2_SLOW_7:
    v_max3_f32 v11, v112, v113, v114
    v_max3_f32 v11, v11, v115, v116
    v_max3_f32 v11, v11, v117, v118
    v_max3_f32 v11, v11, v119, v120
    v_max3_f32 v11, v11, v121, v122
    v_max3_f32 v11, v11, v123, v124
    v_max3_f32 v11, v11, v125, v126
    v_max3_f32 v11, v11, v127, 0
    v_mov_b32 v9, v11
    s_nop 1
    v_permlane32_swap_b32 v11, v9
    v_max_f32 v11, v11, v9
    v_sub_f32 v16, v16, v11
    v_sub_f32 v17, v17, v11
    v_sub_f32 v18, v18, v11
    v_sub_f32 v19, v19, v11
    v_sub_f32 v20, v20, v11
    v_sub_f32 v21, v21, v11
    v_sub_f32 v22, v22, v11
    v_sub_f32 v23, v23, v11
    v_sub_f32 v24, v24, v11
    v_sub_f32 v25, v25, v11
    v_sub_f32 v26, v26, v11
    v_sub_f32 v27, v27, v11
    v_sub_f32 v28, v28, v11
    v_sub_f32 v29, v29, v11
    v_sub_f32 v30, v30, v11
    v_sub_f32 v31, v31, v11
    v_sub_f32 v9, 0, v11
    v_exp_f32 v9, v9
    s_nop 0
    v_mul_f32 v192, v192, v9
    v_mul_f32 v193, v193, v9
    v_mul_f32 v194, v194, v9
    v_mul_f32 v195, v195, v9
    v_mul_f32 v196, v196, v9
    v_mul_f32 v197, v197, v9
    v_mul_f32 v198, v198, v9
    v_mul_f32 v199, v199, v9
    v_mul_f32 v200, v200, v9
    v_mul_f32 v201, v201, v9
    v_mul_f32 v202, v202, v9
    v_mul_f32 v203, v203, v9
    v_mul_f32 v204, v204, v9
    v_mul_f32 v205, v205, v9
    v_mul_f32 v206, v206, v9
    v_mul_f32 v207, v207, v9
    v_mul_f32 v208, v208, v9
    v_mul_f32 v209, v209, v9
    v_mul_f32 v210, v210, v9
    v_mul_f32 v211, v211, v9
    v_mul_f32 v212, v212, v9
    v_mul_f32 v213, v213, v9
    v_mul_f32 v214, v214, v9
    v_mul_f32 v215, v215, v9
    v_mul_f32 v216, v216, v9
    v_mul_f32 v217, v217, v9
    v_mul_f32 v218, v218, v9
    v_mul_f32 v219, v219, v9
    v_mul_f32 v220, v220, v9
    v_mul_f32 v221, v221, v9
    v_mul_f32 v222, v222, v9
    v_mul_f32 v223, v223, v9
    v_mul_f32 v224, v224, v9
    v_mul_f32 v225, v225, v9
    v_mul_f32 v226, v226, v9
    v_mul_f32 v227, v227, v9
    v_mul_f32 v228, v228, v9
    v_mul_f32 v229, v229, v9
    v_mul_f32 v230, v230, v9
    v_mul_f32 v231, v231, v9
    v_mul_f32 v232, v232, v9
    v_mul_f32 v233, v233, v9
    v_mul_f32 v234, v234, v9
    v_mul_f32 v235, v235, v9
    v_mul_f32 v236, v236, v9
    v_mul_f32 v237, v237, v9
    v_mul_f32 v238, v238, v9
    v_mul_f32 v239, v239, v9
    v_mul_f32 v240, v240, v9
    v_mul_f32 v241, v241, v9
    v_mul_f32 v242, v242, v9
    v_mul_f32 v243, v243, v9
    v_mul_f32 v244, v244, v9
    v_mul_f32 v245, v245, v9
    v_mul_f32 v246, v246, v9
    v_mul_f32 v247, v247, v9
    v_mul_f32 v248, v248, v9
    v_mul_f32 v249, v249, v9
    v_mul_f32 v250, v250, v9
    v_mul_f32 v251, v251, v9
    v_mul_f32 v252, v252, v9
    v_mul_f32 v253, v253, v9
    v_mul_f32 v254, v254, v9
    v_mul_f32 v255, v255, v9
    v_mul_f32 v7, v6, v9
    v_sub_f32 v96, v96, v11
    v_sub_f32 v97, v97, v11
    v_sub_f32 v98, v98, v11
    v_sub_f32 v99, v99, v11
    v_sub_f32 v100, v100, v11
    v_sub_f32 v101, v101, v11
    v_sub_f32 v102, v102, v11
    v_sub_f32 v103, v103, v11
    v_sub_f32 v104, v104, v11
    v_sub_f32 v105, v105, v11
    v_sub_f32 v106, v106, v11
    v_sub_f32 v107, v107, v11
    v_sub_f32 v108, v108, v11
    v_sub_f32 v109, v109, v11
    v_sub_f32 v110, v110, v11
    v_sub_f32 v111, v111, v11
    v_sub_f32 v32, v112, v11
    v_sub_f32 v33, v113, v11
    v_sub_f32 v34, v114, v11
    v_sub_f32 v35, v115, v11
    v_sub_f32 v36, v116, v11
    v_sub_f32 v37, v117, v11
    v_sub_f32 v38, v118, v11
    v_sub_f32 v39, v119, v11
    v_sub_f32 v40, v120, v11
    v_sub_f32 v41, v121, v11
    v_sub_f32 v42, v122, v11
    v_sub_f32 v43, v123, v11
    v_sub_f32 v44, v124, v11
    v_sub_f32 v45, v125, v11
    v_sub_f32 v46, v126, v11
    v_sub_f32 v47, v127, v11
    v_exp_f32 v32, v32
    v_exp_f32 v33, v33
    v_exp_f32 v34, v34
    v_exp_f32 v35, v35
    v_exp_f32 v36, v36
    v_exp_f32 v37, v37
    v_exp_f32 v38, v38
    v_exp_f32 v39, v39
    v_exp_f32 v40, v40
    v_exp_f32 v41, v41
    v_exp_f32 v42, v42
    v_exp_f32 v43, v43
    v_exp_f32 v44, v44
    v_exp_f32 v45, v45
    v_exp_f32 v46, v46
    v_exp_f32 v47, v47
    v_add_f32 v7, v7, v32
    v_add_f32 v7, v7, v33
    v_add_f32 v7, v7, v34
    v_add_f32 v7, v7, v35
    v_add_f32 v7, v7, v36
    v_add_f32 v7, v7, v37
    v_add_f32 v7, v7, v38
    v_add_f32 v7, v7, v39
    v_add_f32 v7, v7, v40
    v_add_f32 v7, v7, v41
    v_add_f32 v7, v7, v42
    v_add_f32 v7, v7, v43
    v_add_f32 v7, v7, v44
    v_add_f32 v7, v7, v45
    v_add_f32 v7, v7, v46
    v_add_f32 v7, v7, v47
    v_cvt_pk_bf16_f32 v88, v32, v33
    v_cvt_pk_bf16_f32 v89, v34, v35
    v_cvt_pk_bf16_f32 v90, v36, v37
    v_cvt_pk_bf16_f32 v91, v38, v39
    v_cvt_pk_bf16_f32 v92, v40, v41
    v_cvt_pk_bf16_f32 v93, v42, v43
    v_cvt_pk_bf16_f32 v94, v44, v45
    v_cvt_pk_bf16_f32 v95, v46, v47
    s_branch K2_RET_8
K2_SLOW_12:
    v_max3_f32 v11, v96, v97, v98
    v_max3_f32 v11, v11, v99, v100
    v_max3_f32 v11, v11, v101, v102
    v_max3_f32 v11, v11, v103, v104
    v_max3_f32 v11, v11, v105, v106
    v_max3_f32 v11, v11, v107, v108
    v_max3_f32 v11, v11, v109, v110
    v_max3_f32 v11, v11, v111, 0
    v_mov_b32 v9, v11
    s_nop 1
    v_permlane32_swap_b32 v11, v9
    v_max_f32 v11, v11, v9
    v_sub_f32 v16, v16, v11
    v_sub_f32 v17, v17, v11
    v_sub_f32 v18, v18, v11
    v_sub_f32 v19, v19, v11
    v_sub_f32 v20, v20, v11
    v_sub_f32 v21, v21, v11
    v_sub_f32 v22, v22, v11
    v_sub_f32 v23, v23, v11
    v_sub_f32 v24, v24, v11
    v_sub_f32 v25, v25, v11
    v_sub_f32 v26, v26, v11
    v_sub_f32 v27, v27, v11
    v_sub_f32 v28, v28, v11
    v_sub_f32 v29, v29, v11
    v_sub_f32 v30, v30, v11
    v_sub_f32 v31, v31, v11
    v_sub_f32 v9, 0, v11
    v_exp_f32 v9, v9
    s_nop 0
    v_mul_f32 v192, v192, v9
    v_mul_f32 v193, v193, v9
    v_mul_f32 v194, v194, v9
    v_mul_f32 v195, v195, v9
    v_mul_f32 v196, v196, v9
    v_mul_f32 v197, v197, v9
    v_mul_f32 v198, v198, v9
    v_mul_f32 v199, v199, v9
    v_mul_f32 v200, v200, v9
    v_mul_f32 v201, v201, v9
    v_mul_f32 v202, v202, v9
    v_mul_f32 v203, v203, v9
    v_mul_f32 v204, v204, v9
    v_mul_f32 v205, v205, v9
    v_mul_f32 v206, v206, v9
    v_mul_f32 v207, v207, v9
    v_mul_f32 v208, v208, v9
    v_mul_f32 v209, v209, v9
    v_mul_f32 v210, v210, v9
    v_mul_f32 v211, v211, v9
    v_mul_f32 v212, v212, v9
    v_mul_f32 v213, v213, v9
    v_mul_f32 v214, v214, v9
    v_mul_f32 v215, v215, v9
    v_mul_f32 v216, v216, v9
    v_mul_f32 v217, v217, v9
    v_mul_f32 v218, v218, v9
    v_mul_f32 v219, v219, v9
    v_mul_f32 v220, v220, v9
    v_mul_f32 v221, v221, v9
    v_mul_f32 v222, v222, v9
    v_mul_f32 v223, v223, v9
    v_mul_f32 v224, v224, v9
    v_mul_f32 v225, v225, v9
    v_mul_f32 v226, v226, v9
    v_mul_f32 v227, v227, v9
    v_mul_f32 v228, v228, v9
    v_mul_f32 v229, v229, v9
    v_mul_f32 v230, v230, v9
    v_mul_f32 v231, v231, v9
    v_mul_f32 v232, v232, v9
    v_mul_f32 v233, v233, v9
    v_mul_f32 v234, v234, v9
    v_mul_f32 v235, v235, v9
    v_mul_f32 v236, v236, v9
    v_mul_f32 v237, v237, v9
    v_mul_f32 v238, v238, v9
    v_mul_f32 v239, v239, v9
    v_mul_f32 v240, v240, v9
    v_mul_f32 v241, v241, v9
    v_mul_f32 v242, v242, v9
    v_mul_f32 v243, v243, v9
    v_mul_f32 v244, v244, v9
    v_mul_f32 v245, v245, v9
    v_mul_f32 v246, v246, v9
    v_mul_f32 v247, v247, v9
    v_mul_f32 v248, v248, v9
    v_mul_f32 v249, v249, v9
    v_mul_f32 v250, v250, v9
    v_mul_f32 v251, v251, v9
    v_mul_f32 v252, v252, v9
    v_mul_f32 v253, v253, v9
    v_mul_f32 v254, v254, v9
    v_mul_f32 v255, v255, v9
    v_mul_f32 v6, v7, v9
    v_sub_f32 v112, v112, v11
    v_sub_f32 v113, v113, v11
    v_sub_f32 v114, v114, v11
    v_sub_f32 v115, v115, v11
    v_sub_f32 v116, v116, v11
    v_sub_f32 v117, v117, v11
    v_sub_f32 v118, v118, v11
    v_sub_f32 v119, v119, v11
    v_sub_f32 v120, v120, v11
    v_sub_f32 v121, v121, v11
    v_sub_f32 v122, v122, v11
    v_sub_f32 v123, v123, v11
    v_sub_f32 v124, v124, v11
    v_sub_f32 v125, v125, v11
    v_sub_f32 v126, v126, v11
    v_sub_f32 v127, v127, v11
    v_sub_f32 v32, v96, v11
    v_sub_f32 v33, v97, v11
    v_sub_f32 v34, v98, v11
    v_sub_f32 v35, v99, v11
    v_sub_f32 v36, v100, v11
    v_sub_f32 v37, v101, v11
    v_sub_f32 v38, v102, v11
    v_sub_f32 v39, v103, v11
    v_sub_f32 v40, v104, v11
    v_sub_f32 v41, v105, v11
    v_sub_f32 v42, v106, v11
    v_sub_f32 v43, v107, v11
    v_sub_f32 v44, v108, v11
    v_sub_f32 v45, v109, v11
    v_sub_f32 v46, v110, v11
    v_sub_f32 v47, v111, v11
    v_exp_f32 v32, v32
    v_exp_f32 v33, v33
    v_exp_f32 v34, v34
    v_exp_f32 v35, v35
    v_exp_f32 v36, v36
    v_exp_f32 v37, v37
    v_exp_f32 v38, v38
    v_exp_f32 v39, v39
    v_exp_f32 v40, v40
    v_exp_f32 v41, v41
    v_exp_f32 v42, v42
    v_exp_f32 v43, v43
    v_exp_f32 v44, v44
    v_exp_f32 v45, v45
    v_exp_f32 v46, v46
    v_exp_f32 v47, v47
    v_add_f32 v6, v6, v32
    v_add_f32 v6, v6, v33
    v_add_f32 v6, v6, v34
    v_add_f32 v6, v6, v35
    v_add_f32 v6, v6, v36
    v_add_f32 v6, v6, v37
    v_add_f32 v6, v6, v38
    v_add_f32 v6, v6, v39
    v_add_f32 v6, v6, v40
    v_add_f32 v6, v6, v41
    v_add_f32 v6, v6, v42
    v_add_f32 v6, v6, v43
    v_add_f32 v6, v6, v44
    v_add_f32 v6, v6, v45
    v_add_f32 v6, v6, v46
    v_add_f32 v6, v6, v47
    v_cvt_pk_bf16_f32 v80, v32, v33
    v_cvt_pk_bf16_f32 v81, v34, v35
    v_cvt_pk_bf16_f32 v82, v36, v37
    v_cvt_pk_bf16_f32 v83, v38, v39
    v_cvt_pk_bf16_f32 v84, v40, v41
    v_cvt_pk_bf16_f32 v85, v42, v43
    v_cvt_pk_bf16_f32 v86, v44, v45
    v_cvt_pk_bf16_f32 v87, v46, v47
    s_branch K2_RET_13
K2_SLOW_14:
    v_max3_f32 v11, v112, v113, v114
    v_max3_f32 v11, v11, v115, v116
    v_max3_f32 v11, v11, v117, v118
    v_max3_f32 v11, v11, v119, v120
    v_max3_f32 v11, v11, v121, v122
    v_max3_f32 v11, v11, v123, v124
    v_max3_f32 v11, v11, v125, v126
    v_max3_f32 v11, v11, v127, 0
    v_mov_b32 v9, v11
    s_nop 1
    v_permlane32_swap_b32 v11, v9
    v_max_f32 v11, v11, v9
    v_sub_f32 v16, v16, v11
    v_sub_f32 v17, v17, v11
    v_sub_f32 v18, v18, v11
    v_sub_f32 v19, v19, v11
    v_sub_f32 v20, v20, v11
    v_sub_f32 v21, v21, v11
    v_sub_f32 v22, v22, v11
    v_sub_f32 v23, v23, v11
    v_sub_f32 v24, v24, v11
    v_sub_f32 v25, v25, v11
    v_sub_f32 v26, v26, v11
    v_sub_f32 v27, v27, v11
    v_sub_f32 v28, v28, v11
    v_sub_f32 v29, v29, v11
    v_sub_f32 v30, v30, v11
    v_sub_f32 v31, v31, v11
    v_sub_f32 v9, 0, v11
    v_exp_f32 v9, v9
    s_nop 0
    v_mul_f32 v192, v192, v9
    v_mul_f32 v193, v193, v9
    v_mul_f32 v194, v194, v9
    v_mul_f32 v195, v195, v9
    v_mul_f32 v196, v196, v9
    v_mul_f32 v197, v197, v9
    v_mul_f32 v198, v198, v9
    v_mul_f32 v199, v199, v9
    v_mul_f32 v200, v200, v9
    v_mul_f32 v201, v201, v9
    v_mul_f32 v202, v202, v9
    v_mul_f32 v203, v203, v9
    v_mul_f32 v204, v204, v9
    v_mul_f32 v205, v205, v9
    v_mul_f32 v206, v206, v9
    v_mul_f32 v207, v207, v9
    v_mul_f32 v208, v208, v9
    v_mul_f32 v209, v209, v9
    v_mul_f32 v210, v210, v9
    v_mul_f32 v211, v211, v9
    v_mul_f32 v212, v212, v9
    v_mul_f32 v213, v213, v9
    v_mul_f32 v214, v214, v9
    v_mul_f32 v215, v215, v9
    v_mul_f32 v216, v216, v9
    v_mul_f32 v217, v217, v9
    v_mul_f32 v218, v218, v9
    v_mul_f32 v219, v219, v9
    v_mul_f32 v220, v220, v9
    v_mul_f32 v221, v221, v9
    v_mul_f32 v222, v222, v9
    v_mul_f32 v223, v223, v9
    v_mul_f32 v224, v224, v9
    v_mul_f32 v225, v225, v9
    v_mul_f32 v226, v226, v9
    v_mul_f32 v227, v227, v9
    v_mul_f32 v228, v228, v9
    v_mul_f32 v229, v229, v9
    v_mul_f32 v230, v230, v9
    v_mul_f32 v231, v231, v9
    v_mul_f32 v232, v232, v9
    v_mul_f32 v233, v233, v9
    v_mul_f32 v234, v234, v9
    v_mul_f32 v235, v235, v9
    v_mul_f32 v236, v236, v9
    v_mul_f32 v237, v237, v9
    v_mul_f32 v238, v238, v9
    v_mul_f32 v239, v239, v9
    v_mul_f32 v240, v240, v9
    v_mul_f32 v241, v241, v9
    v_mul_f32 v242, v242, v9
    v_mul_f32 v243, v243, v9
    v_mul_f32 v244, v244, v9
    v_mul_f32 v245, v245, v9
    v_mul_f32 v246, v246, v9
    v_mul_f32 v247, v247, v9
    v_mul_f32 v248, v248, v9
    v_mul_f32 v249, v249, v9
    v_mul_f32 v250, v250, v9
    v_mul_f32 v251, v251, v9
    v_mul_f32 v252, v252, v9
    v_mul_f32 v253, v253, v9
    v_mul_f32 v254, v254, v9
    v_mul_f32 v255, v255, v9
    v_mul_f32 v7, v6, v9
    v_sub_f32 v32, v112, v11
    v_sub_f32 v33, v113, v11
    v_sub_f32 v34, v114, v11
    v_sub_f32 v35, v115, v11
    v_sub_f32 v36, v116, v11
    v_sub_f32 v37, v117, v11
    v_sub_f32 v38, v118, v11
    v_sub_f32 v39, v119, v11
    v_sub_f32 v40, v120, v11
    v_sub_f32 v41, v121, v11
    v_sub_f32 v42, v122, v11
    v_sub_f32 v43, v123, v11
    v_sub_f32 v44, v124, v11
    v_sub_f32 v45, v125, v11
    v_sub_f32 v46, v126, v11
    v_sub_f32 v47, v127, v11
    v_exp_f32 v32, v32
    v_exp_f32 v33, v33
    v_exp_f32 v34, v34
    v_exp_f32 v35, v35
    v_exp_f32 v36, v36
    v_exp_f32 v37, v37
    v_exp_f32 v38, v38
    v_exp_f32 v39, v39
    v_exp_f32 v40, v40
    v_exp_f32 v41, v41
    v_exp_f32 v42, v42
    v_exp_f32 v43, v43
    v_exp_f32 v44, v44
    v_exp_f32 v45, v45
    v_exp_f32 v46, v46
    v_exp_f32 v47, v47
    v_add_f32 v7, v7, v32
    v_add_f32 v7, v7, v33
    v_add_f32 v7, v7, v34
    v_add_f32 v7, v7, v35
    v_add_f32 v7, v7, v36
    v_add_f32 v7, v7, v37
    v_add_f32 v7, v7, v38
    v_add_f32 v7, v7, v39
    v_add_f32 v7, v7, v40
    v_add_f32 v7, v7, v41
    v_add_f32 v7, v7, v42
    v_add_f32 v7, v7, v43
    v_add_f32 v7, v7, v44
    v_add_f32 v7, v7, v45
    v_add_f32 v7, v7, v46
    v_add_f32 v7, v7, v47
    v_cvt_pk_bf16_f32 v88, v32, v33
    v_cvt_pk_bf16_f32 v89, v34, v35
    v_cvt_pk_bf16_f32 v90, v36, v37
    v_cvt_pk_bf16_f32 v91, v38, v39
    v_cvt_pk_bf16_f32 v92, v40, v41
    v_cvt_pk_bf16_f32 v93, v42, v43
    v_cvt_pk_bf16_f32 v94, v44, v45
    v_cvt_pk_bf16_f32 v95, v46, v47
    s_branch K2_RET_15
K2_SLOW_16:
    v_max3_f32 v11, v96, v97, v98
    v_max3_f32 v11, v11, v99, v100
    v_max3_f32 v11, v11, v101, v102
    v_max3_f32 v11, v11, v103, v104
    v_max3_f32 v11, v11, v105, v106
    v_max3_f32 v11, v11, v107, v108
    v_max3_f32 v11, v11, v109, v110
    v_max3_f32 v11, v11, v111, 0
    v_mov_b32 v9, v11
    s_nop 1
    v_permlane32_swap_b32 v11, v9
    v_max_f32 v11, v11, v9
    v_sub_f32 v16, v16, v11
    v_sub_f32 v17, v17, v11
    v_sub_f32 v18, v18, v11
    v_sub_f32 v19, v19, v11
    v_sub_f32 v20, v20, v11
    v_sub_f32 v21, v21, v11
    v_sub_f32 v22, v22, v11
    v_sub_f32 v23, v23, v11
    v_sub_f32 v24, v24, v11
    v_sub_f32 v25, v25, v11
    v_sub_f32 v26, v26, v11
    v_sub_f32 v27, v27, v11
    v_sub_f32 v28, v28, v11
    v_sub_f32 v29, v29, v11
    v_sub_f32 v30, v30, v11
    v_sub_f32 v31, v31, v11
    v_sub_f32 v9, 0, v11
    v_exp_f32 v9, v9
    s_nop 0
    v_mul_f32 v192, v192, v9
    v_mul_f32 v193, v193, v9
    v_mul_f32 v194, v194, v9
    v_mul_f32 v195, v195, v9
    v_mul_f32 v196, v196, v9
    v_mul_f32 v197, v197, v9
    v_mul_f32 v198, v198, v9
    v_mul_f32 v199, v199, v9
    v_mul_f32 v200, v200, v9
    v_mul_f32 v201, v201, v9
    v_mul_f32 v202, v202, v9
    v_mul_f32 v203, v203, v9
    v_mul_f32 v204, v204, v9
    v_mul_f32 v205, v205, v9
    v_mul_f32 v206, v206, v9
    v_mul_f32 v207, v207, v9
    v_mul_f32 v208, v208, v9
    v_mul_f32 v209, v209, v9
    v_mul_f32 v210, v210, v9
    v_mul_f32 v211, v211, v9
    v_mul_f32 v212, v212, v9
    v_mul_f32 v213, v213, v9
    v_mul_f32 v214, v214, v9
    v_mul_f32 v215, v215, v9
    v_mul_f32 v216, v216, v9
    v_mul_f32 v217, v217, v9
    v_mul_f32 v218, v218, v9
    v_mul_f32 v219, v219, v9
    v_mul_f32 v220, v220, v9
    v_mul_f32 v221, v221, v9
    v_mul_f32 v222, v222, v9
    v_mul_f32 v223, v223, v9
    v_mul_f32 v224, v224, v9
    v_mul_f32 v225, v225, v9
    v_mul_f32 v226, v226, v9
    v_mul_f32 v227, v227, v9
    v_mul_f32 v228, v228, v9
    v_mul_f32 v229, v229, v9
    v_mul_f32 v230, v230, v9
    v_mul_f32 v231, v231, v9
    v_mul_f32 v232, v232, v9
    v_mul_f32 v233, v233, v9
    v_mul_f32 v234, v234, v9
    v_mul_f32 v235, v235, v9
    v_mul_f32 v236, v236, v9
    v_mul_f32 v237, v237, v9
    v_mul_f32 v238, v238, v9
    v_mul_f32 v239, v239, v9
    v_mul_f32 v240, v240, v9
    v_mul_f32 v241, v241, v9
    v_mul_f32 v242, v242, v9
    v_mul_f32 v243, v243, v9
    v_mul_f32 v244, v244, v9
    v_mul_f32 v245, v245, v9
    v_mul_f32 v246, v246, v9
    v_mul_f32 v247, v247, v9
    v_mul_f32 v248, v248, v9
    v_mul_f32 v249, v249, v9
    v_mul_f32 v250, v250, v9
    v_mul_f32 v251, v251, v9
    v_mul_f32 v252, v252, v9
    v_mul_f32 v253, v253, v9
    v_mul_f32 v254, v254, v9
    v_mul_f32 v255, v255, v9
    v_mul_f32 v6, v7, v9
    v_sub_f32 v32, v96, v11
    v_sub_f32 v33, v97, v11
    v_sub_f32 v34, v98, v11
    v_sub_f32 v35, v99, v11
    v_sub_f32 v36, v100, v11
    v_sub_f32 v37, v101, v11
    v_sub_f32 v38, v102, v11
    v_sub_f32 v39, v103, v11
    v_sub_f32 v40, v104, v11
    v_sub_f32 v41, v105, v11
    v_sub_f32 v42, v106, v11
    v_sub_f32 v43, v107, v11
    v_sub_f32 v44, v108, v11
    v_sub_f32 v45, v109, v11
    v_sub_f32 v46, v110, v11
    v_sub_f32 v47, v111, v11
    v_exp_f32 v32, v32
    v_exp_f32 v33, v33
    v_exp_f32 v34, v34
    v_exp_f32 v35, v35
    v_exp_f32 v36, v36
    v_exp_f32 v37, v37
    v_exp_f32 v38, v38
    v_exp_f32 v39, v39
    v_exp_f32 v40, v40
    v_exp_f32 v41, v41
    v_exp_f32 v42, v42
    v_exp_f32 v43, v43
    v_exp_f32 v44, v44
    v_exp_f32 v45, v45
    v_exp_f32 v46, v46
    v_exp_f32 v47, v47
    v_add_f32 v6, v6, v32
    v_add_f32 v6, v6, v33
    v_add_f32 v6, v6, v34
    v_add_f32 v6, v6, v35
    v_add_f32 v6, v6, v36
    v_add_f32 v6, v6, v37
    v_add_f32 v6, v6, v38
    v_add_f32 v6, v6, v39
    v_add_f32 v6, v6, v40
    v_add_f32 v6, v6, v41
    v_add_f32 v6, v6, v42
    v_add_f32 v6, v6, v43
    v_add_f32 v6, v6, v44
    v_add_f32 v6, v6, v45
    v_add_f32 v6, v6, v46
    v_add_f32 v6, v6, v47
    v_cvt_pk_bf16_f32 v80, v32, v33
    v_cvt_pk_bf16_f32 v81, v34, v35
    v_cvt_pk_bf16_f32 v82, v36, v37
    v_cvt_pk_bf16_f32 v83, v38, v39
    v_cvt_pk_bf16_f32 v84, v40, v41
    v_cvt_pk_bf16_f32 v85, v42, v43
    v_cvt_pk_bf16_f32 v86, v44, v45
    v_cvt_pk_bf16_f32 v87, v46, v47
    s_branch K2_RET_17
.globl k3_kernel
.p2align 8
.type k3_kernel,@function
k3_kernel:
    s_cmp_ge_u32 s2, 256
    s_cbranch_scc1 K3_KERNEL_END
    s_load_dwordx2 s[6:7], s[0:1], 104
    s_load_dwordx2 s[24:25], s[0:1], 0
    v_lshrrev_b32 v1, 6, v0
    v_mov_b32 v9, v0
    v_and_b32 v0, 63, v0
    v_readfirstlane_b32 s3, v1
    s_and_b32 s30, s2, 7
    s_lshl_b32 s30, s30, 2
    s_lshr_b32 s31, s2, 3
    s_and_b32 s33, s31, 3
    s_add_u32 s30, s30, s33
    s_lshr_b32 s31, s2, 5
    s_mov_b32 s32, s3
    s_mov_b32 s33, 0
    v_lshrrev_b32 v2, 5, v0
    v_lshlrev_b32 v2, 10, v2
    v_lshrrev_b32 v3, 4, v0
    v_and_b32 v3, 1, v3
    v_lshl_add_u32 v2, v3, 9, v2
    v_and_b32 v3, 15, v0
    v_lshl_add_u32 v1, v3, 4, v2
    v_lshlrev_b32 v2, 4, v0
    s_mul_i32 s36, s30, 524288
    s_mul_i32 s37, s32, 65536
    s_add_u32 s36, s36, s37
    s_add_u32 s35, s36, 262144
    s_mul_i32 s37, s31, 655360
    s_mul_i32 s38, s33, 655360
    s_add_u32 s37, s37, s38
    s_mul_i32 s38, s32, 32768
    s_add_u32 s37, s37, s38
    s_waitcnt lgkmcnt(0)
    s_add_u32 s8, s6, 37748736
    s_addc_u32 s9, s7, 0
    s_mov_b32 s10, 16777216
    s_mov_b32 s11, 0x00020000
    s_add_u32 s12, s6, 54525952
    s_addc_u32 s13, s7, 0
    s_mov_b32 s14, 5242880
    s_mov_b32 s15, 0x00020000
    s_add_u32 s45, s37, 0
    buffer_load_dwordx4 v[28:31], v2, s[12:15], s45 offen
    s_add_u32 s45, s37, 131072
    buffer_load_dwordx4 v[32:35], v2, s[12:15], s45 offen
    s_add_u32 s45, s37, 262144
    buffer_load_dwordx4 v[36:39], v2, s[12:15], s45 offen
    s_add_u32 s45, s37, 393216
    buffer_load_dwordx4 v[40:43], v2, s[12:15], s45 offen
    s_add_u32 s45, s37, 524288
    buffer_load_dwordx4 v[44:47], v2, s[12:15], s45 offen
    s_add_u32 s43, s36, 0
    s_add_u32 s44, s35, 0
    buffer_load_dwordx4 v[12:15], v1, s[8:11], s43 offen
    buffer_load_dwordx4 v[16:19], v1, s[8:11], s43 offen offset:256
    buffer_load_dwordx4 v[20:23], v1, s[8:11], s44 offen
    buffer_load_dwordx4 v[24:27], v1, s[8:11], s44 offen offset:256
    s_add_u32 s45, s37, 1024
    buffer_load_dwordx4 v[64:67], v2, s[12:15], s45 offen
    s_add_u32 s45, s37, 132096
    buffer_load_dwordx4 v[68:71], v2, s[12:15], s45 offen
    s_add_u32 s45, s37, 263168
    buffer_load_dwordx4 v[72:75], v2, s[12:15], s45 offen
    s_add_u32 s45, s37, 394240
    buffer_load_dwordx4 v[76:79], v2, s[12:15], s45 offen
    s_add_u32 s45, s37, 525312
    buffer_load_dwordx4 v[80:83], v2, s[12:15], s45 offen
    s_add_u32 s43, s36, 2048
    s_add_u32 s44, s35, 2048
    buffer_load_dwordx4 v[48:51], v1, s[8:11], s43 offen
    buffer_load_dwordx4 v[52:55], v1, s[8:11], s43 offen offset:256
    buffer_load_dwordx4 v[56:59], v1, s[8:11], s44 offen
    buffer_load_dwordx4 v[60:63], v1, s[8:11], s44 offen offset:256
    s_add_u32 s45, s37, 2048
    buffer_load_dwordx4 v[100:103], v2, s[12:15], s45 offen
    s_add_u32 s45, s37, 133120
    buffer_load_dwordx4 v[104:107], v2, s[12:15], s45 offen
    s_add_u32 s45, s37, 264192
    buffer_load_dwordx4 v[108:111], v2, s[12:15], s45 offen
    s_add_u32 s45, s37, 395264
    buffer_load_dwordx4 v[112:115], v2, s[12:15], s45 offen
    s_add_u32 s45, s37, 526336
    buffer_load_dwordx4 v[116:119], v2, s[12:15], s45 offen
    s_add_u32 s43, s36, 4096
    s_add_u32 s44, s35, 4096
    buffer_load_dwordx4 v[84:87], v1, s[8:11], s43 offen
    buffer_load_dwordx4 v[88:91], v1, s[8:11], s43 offen offset:256
    buffer_load_dwordx4 v[92:95], v1, s[8:11], s44 offen
    buffer_load_dwordx4 v[96:99], v1, s[8:11], s44 offen offset:256
    s_add_u32 s45, s37, 3072
    buffer_load_dwordx4 v[136:139], v2, s[12:15], s45 offen
    s_add_u32 s45, s37, 134144
    buffer_load_dwordx4 v[140:143], v2, s[12:15], s45 offen
    s_add_u32 s45, s37, 265216
    buffer_load_dwordx4 v[144:147], v2, s[12:15], s45 offen
    s_add_u32 s45, s37, 396288
    buffer_load_dwordx4 v[148:151], v2, s[12:15], s45 offen
    s_add_u32 s45, s37, 527360
    buffer_load_dwordx4 v[152:155], v2, s[12:15], s45 offen
    s_add_u32 s43, s36, 6144
    s_add_u32 s44, s35, 6144
    buffer_load_dwordx4 v[120:123], v1, s[8:11], s43 offen
    buffer_load_dwordx4 v[124:127], v1, s[8:11], s43 offen offset:256
    buffer_load_dwordx4 v[128:131], v1, s[8:11], s44 offen
    buffer_load_dwordx4 v[132:135], v1, s[8:11], s44 offen offset:256
    v_mov_b32 v176, 0
    v_mov_b32 v177, 0
    v_mov_b32 v178, 0
    v_mov_b32 v179, 0
    v_mov_b32 v180, 0
    v_mov_b32 v181, 0
    v_mov_b32 v182, 0
    v_mov_b32 v183, 0
    v_mov_b32 v184, 0
    v_mov_b32 v185, 0
    v_mov_b32 v186, 0
    v_mov_b32 v187, 0
    v_mov_b32 v188, 0
    v_mov_b32 v189, 0
    v_mov_b32 v190, 0
    v_mov_b32 v191, 0
    v_mov_b32 v192, 0
    v_mov_b32 v193, 0
    v_mov_b32 v194, 0
    v_mov_b32 v195, 0
    v_mov_b32 v196, 0
    v_mov_b32 v197, 0
    v_mov_b32 v198, 0
    v_mov_b32 v199, 0
    v_mov_b32 v200, 0
    v_mov_b32 v201, 0
    v_mov_b32 v202, 0
    v_mov_b32 v203, 0
    v_mov_b32 v204, 0
    v_mov_b32 v205, 0
    v_mov_b32 v206, 0
    v_mov_b32 v207, 0
    v_mov_b32 v208, 0
    v_mov_b32 v209, 0
    v_mov_b32 v210, 0
    v_mov_b32 v211, 0
    v_mov_b32 v212, 0
    v_mov_b32 v213, 0
    v_mov_b32 v214, 0
    v_mov_b32 v215, 0
    v_mov_b32 v216, 0
    v_mov_b32 v217, 0
    v_mov_b32 v218, 0
    v_mov_b32 v219, 0
    v_mov_b32 v220, 0
    v_mov_b32 v221, 0
    v_mov_b32 v222, 0
    v_mov_b32 v223, 0
    v_mov_b32 v224, 0
    v_mov_b32 v225, 0
    v_mov_b32 v226, 0
    v_mov_b32 v227, 0
    v_mov_b32 v228, 0
    v_mov_b32 v229, 0
    v_mov_b32 v230, 0
    v_mov_b32 v231, 0
    v_mov_b32 v232, 0
    v_mov_b32 v233, 0
    v_mov_b32 v234, 0
    v_mov_b32 v235, 0
    v_mov_b32 v236, 0
    v_mov_b32 v237, 0
    v_mov_b32 v238, 0
    v_mov_b32 v239, 0
    v_mov_b32 v240, 0
    v_mov_b32 v241, 0
    v_mov_b32 v242, 0
    v_mov_b32 v243, 0
    v_mov_b32 v244, 0
    v_mov_b32 v245, 0
    v_mov_b32 v246, 0
    v_mov_b32 v247, 0
    v_mov_b32 v248, 0
    v_mov_b32 v249, 0
    v_mov_b32 v250, 0
    v_mov_b32 v251, 0
    v_mov_b32 v252, 0
    v_mov_b32 v253, 0
    v_mov_b32 v254, 0
    v_mov_b32 v255, 0
    s_waitcnt vmcnt(27)
    v_mfma_f32_16x16x32_bf16 v[176:179], v[28:31], v[12:15], v[176:179]
    v_mfma_f32_16x16x32_bf16 v[196:199], v[28:31], v[16:19], v[196:199]
    v_mfma_f32_16x16x32_bf16 v[216:219], v[28:31], v[20:23], v[216:219]
    v_mfma_f32_16x16x32_bf16 v[236:239], v[28:31], v[24:27], v[236:239]
    s_add_u32 s45, s37, 4096
    buffer_load_dwordx4 v[28:31], v2, s[12:15], s45 offen
    v_mfma_f32_16x16x32_bf16 v[180:183], v[32:35], v[12:15], v[180:183]
    v_mfma_f32_16x16x32_bf16 v[200:203], v[32:35], v[16:19], v[200:203]
    v_mfma_f32_16x16x32_bf16 v[220:223], v[32:35], v[20:23], v[220:223]
    v_mfma_f32_16x16x32_bf16 v[240:243], v[32:35], v[24:27], v[240:243]
    s_add_u32 s45, s37, 135168
    buffer_load_dwordx4 v[32:35], v2, s[12:15], s45 offen
    v_mfma_f32_16x16x32_bf16 v[184:187], v[36:39], v[12:15], v[184:187]
    v_mfma_f32_16x16x32_bf16 v[204:207], v[36:39], v[16:19], v[204:207]
    v_mfma_f32_16x16x32_bf16 v[224:227], v[36:39], v[20:23], v[224:227]
    v_mfma_f32_16x16x32_bf16 v[244:247], v[36:39], v[24:27], v[244:247]
    s_add_u32 s45, s37, 266240
    buffer_load_dwordx4 v[36:39], v2, s[12:15], s45 offen
    v_mfma_f32_16x16x32_bf16 v[188:191], v[40:43], v[12:15], v[188:191]
    v_mfma_f32_16x16x32_bf16 v[208:211], v[40:43], v[16:19], v[208:211]
    v_mfma_f32_16x16x32_bf16 v[228:231], v[40:43], v[20:23], v[228:231]
    v_mfma_f32_16x16x32_bf16 v[248:251], v[40:43], v[24:27], v[248:251]
    s_add_u32 s45, s37, 397312
    buffer_load_dwordx4 v[40:43], v2, s[12:15], s45 offen
    v_mfma_f32_16x16x32_bf16 v[192:195], v[44:47], v[12:15], v[192:195]
    v_mfma_f32_16x16x32_bf16 v[212:215], v[44:47], v[16:19], v[212:215]
    v_mfma_f32_16x16x32_bf16 v[232:235], v[44:47], v[20:23], v[232:235]
    v_mfma_f32_16x16x32_bf16 v[252:255], v[44:47], v[24:27], v[252:255]
    s_add_u32 s45, s37, 528384
    buffer_load_dwordx4 v[44:47], v2, s[12:15], s45 offen
    s_add_u32 s43, s36, 8192
    s_add_u32 s44, s35, 8192
    buffer_load_dwordx4 v[12:15], v1, s[8:11], s43 offen
    buffer_load_dwordx4 v[16:19], v1, s[8:11], s43 offen offset:256
    buffer_load_dwordx4 v[20:23], v1, s[8:11], s44 offen
    buffer_load_dwordx4 v[24:27], v1, s[8:11], s44 offen offset:256
    s_waitcnt vmcnt(27)
    v_mfma_f32_16x16x32_bf16 v[176:179], v[64:67], v[48:51], v[176:179]
    v_mfma_f32_16x16x32_bf16 v[196:199], v[64:67], v[52:55], v[196:199]
    v_mfma_f32_16x16x32_bf16 v[216:219], v[64:67], v[56:59], v[216:219]
    v_mfma_f32_16x16x32_bf16 v[236:239], v[64:67], v[60:63], v[236:239]
    s_add_u32 s45, s37, 5120
    buffer_load_dwordx4 v[64:67], v2, s[12:15], s45 offen
    v_mfma_f32_16x16x32_bf16 v[180:183], v[68:71], v[48:51], v[180:183]
    v_mfma_f32_16x16x32_bf16 v[200:203], v[68:71], v[52:55], v[200:203]
    v_mfma_f32_16x16x32_bf16 v[220:223], v[68:71], v[56:59], v[220:223]
    v_mfma_f32_16x16x32_bf16 v[240:243], v[68:71], v[60:63], v[240:243]
    s_add_u32 s45, s37, 136192
    buffer_load_dwordx4 v[68:71], v2, s[12:15], s45 offen
    v_mfma_f32_16x16x32_bf16 v[184:187], v[72:75], v[48:51], v[184:187]
    v_mfma_f32_16x16x32_bf16 v[204:207], v[72:75], v[52:55], v[204:207]
    v_mfma_f32_16x16x32_bf16 v[224:227], v[72:75], v[56:59], v[224:227]
    v_mfma_f32_16x16x32_bf16 v[244:247], v[72:75], v[60:63], v[244:247]
    s_add_u32 s45, s37, 267264
    buffer_load_dwordx4 v[72:75], v2, s[12:15], s45 offen
    v_mfma_f32_16x16x32_bf16 v[188:191], v[76:79], v[48:51], v[188:191]
    v_mfma_f32_16x16x32_bf16 v[208:211], v[76:79], v[52:55], v[208:211]
    v_mfma_f32_16x16x32_bf16 v[228:231], v[76:79], v[56:59], v[228:231]
    v_mfma_f32_16x16x32_bf16 v[248:251], v[76:79], v[60:63], v[248:251]
    s_add_u32 s45, s37, 398336
    buffer_load_dwordx4 v[76:79], v2, s[12:15], s45 offen
    v_mfma_f32_16x16x32_bf16 v[192:195], v[80:83], v[48:51], v[192:195]
    v_mfma_f32_16x16x32_bf16 v[212:215], v[80:83], v[52:55], v[212:215]
    v_mfma_f32_16x16x32_bf16 v[232:235], v[80:83], v[56:59], v[232:235]
    v_mfma_f32_16x16x32_bf16 v[252:255], v[80:83], v[60:63], v[252:255]
    s_add_u32 s45, s37, 529408
    buffer_load_dwordx4 v[80:83], v2, s[12:15], s45 offen
    s_add_u32 s43, s36, 10240
    s_add_u32 s44, s35, 10240
    buffer_load_dwordx4 v[48:51], v1, s[8:11], s43 offen
    buffer_load_dwordx4 v[52:55], v1, s[8:11], s43 offen offset:256
    buffer_load_dwordx4 v[56:59], v1, s[8:11], s44 offen
    buffer_load_dwordx4 v[60:63], v1, s[8:11], s44 offen offset:256
    s_waitcnt vmcnt(27)
    v_mfma_f32_16x16x32_bf16 v[176:179], v[100:103], v[84:87], v[176:179]
    v_mfma_f32_16x16x32_bf16 v[196:199], v[100:103], v[88:91], v[196:199]
    v_mfma_f32_16x16x32_bf16 v[216:219], v[100:103], v[92:95], v[216:219]
    v_mfma_f32_16x16x32_bf16 v[236:239], v[100:103], v[96:99], v[236:239]
    s_add_u32 s45, s37, 6144
    buffer_load_dwordx4 v[100:103], v2, s[12:15], s45 offen
    v_mfma_f32_16x16x32_bf16 v[180:183], v[104:107], v[84:87], v[180:183]
    v_mfma_f32_16x16x32_bf16 v[200:203], v[104:107], v[88:91], v[200:203]
    v_mfma_f32_16x16x32_bf16 v[220:223], v[104:107], v[92:95], v[220:223]
    v_mfma_f32_16x16x32_bf16 v[240:243], v[104:107], v[96:99], v[240:243]
    s_add_u32 s45, s37, 137216
    buffer_load_dwordx4 v[104:107], v2, s[12:15], s45 offen
    v_mfma_f32_16x16x32_bf16 v[184:187], v[108:111], v[84:87], v[184:187]
    v_mfma_f32_16x16x32_bf16 v[204:207], v[108:111], v[88:91], v[204:207]
    v_mfma_f32_16x16x32_bf16 v[224:227], v[108:111], v[92:95], v[224:227]
    v_mfma_f32_16x16x32_bf16 v[244:247], v[108:111], v[96:99], v[244:247]
    s_add_u32 s45, s37, 268288
    buffer_load_dwordx4 v[108:111], v2, s[12:15], s45 offen
    v_mfma_f32_16x16x32_bf16 v[188:191], v[112:115], v[84:87], v[188:191]
    v_mfma_f32_16x16x32_bf16 v[208:211], v[112:115], v[88:91], v[208:211]
    v_mfma_f32_16x16x32_bf16 v[228:231], v[112:115], v[92:95], v[228:231]
    v_mfma_f32_16x16x32_bf16 v[248:251], v[112:115], v[96:99], v[248:251]
    s_add_u32 s45, s37, 399360
    buffer_load_dwordx4 v[112:115], v2, s[12:15], s45 offen
    v_mfma_f32_16x16x32_bf16 v[192:195], v[116:119], v[84:87], v[192:195]
    v_mfma_f32_16x16x32_bf16 v[212:215], v[116:119], v[88:91], v[212:215]
    v_mfma_f32_16x16x32_bf16 v[232:235], v[116:119], v[92:95], v[232:235]
    v_mfma_f32_16x16x32_bf16 v[252:255], v[116:119], v[96:99], v[252:255]
    s_add_u32 s45, s37, 530432
    buffer_load_dwordx4 v[116:119], v2, s[12:15], s45 offen
    s_add_u32 s43, s36, 12288
    s_add_u32 s44, s35, 12288
    buffer_load_dwordx4 v[84:87], v1, s[8:11], s43 offen
    buffer_load_dwordx4 v[88:91], v1, s[8:11], s43 offen offset:256
    buffer_load_dwordx4 v[92:95], v1, s[8:11], s44 offen
    buffer_load_dwordx4 v[96:99], v1, s[8:11], s44 offen offset:256
    s_waitcnt vmcnt(27)
    v_mfma_f32_16x16x32_bf16 v[176:179], v[136:139], v[120:123], v[176:179]
    v_mfma_f32_16x16x32_bf16 v[196:199], v[136:139], v[124:127], v[196:199]
    v_mfma_f32_16x16x32_bf16 v[216:219], v[136:139], v[128:131], v[216:219]
    v_mfma_f32_16x16x32_bf16 v[236:239], v[136:139], v[132:135], v[236:239]
    s_add_u32 s45, s37, 7168
    buffer_load_dwordx4 v[136:139], v2, s[12:15], s45 offen
    v_mfma_f32_16x16x32_bf16 v[180:183], v[140:143], v[120:123], v[180:183]
    v_mfma_f32_16x16x32_bf16 v[200:203], v[140:143], v[124:127], v[200:203]
    v_mfma_f32_16x16x32_bf16 v[220:223], v[140:143], v[128:131], v[220:223]
    v_mfma_f32_16x16x32_bf16 v[240:243], v[140:143], v[132:135], v[240:243]
    s_add_u32 s45, s37, 138240
    buffer_load_dwordx4 v[140:143], v2, s[12:15], s45 offen
    v_mfma_f32_16x16x32_bf16 v[184:187], v[144:147], v[120:123], v[184:187]
    v_mfma_f32_16x16x32_bf16 v[204:207], v[144:147], v[124:127], v[204:207]
    v_mfma_f32_16x16x32_bf16 v[224:227], v[144:147], v[128:131], v[224:227]
    v_mfma_f32_16x16x32_bf16 v[244:247], v[144:147], v[132:135], v[244:247]
    s_add_u32 s45, s37, 269312
    buffer_load_dwordx4 v[144:147], v2, s[12:15], s45 offen
    v_mfma_f32_16x16x32_bf16 v[188:191], v[148:151], v[120:123], v[188:191]
    v_mfma_f32_16x16x32_bf16 v[208:211], v[148:151], v[124:127], v[208:211]
    v_mfma_f32_16x16x32_bf16 v[228:231], v[148:151], v[128:131], v[228:231]
    v_mfma_f32_16x16x32_bf16 v[248:251], v[148:151], v[132:135], v[248:251]
    s_add_u32 s45, s37, 400384
    buffer_load_dwordx4 v[148:151], v2, s[12:15], s45 offen
    v_mfma_f32_16x16x32_bf16 v[192:195], v[152:155], v[120:123], v[192:195]
    v_mfma_f32_16x16x32_bf16 v[212:215], v[152:155], v[124:127], v[212:215]
    v_mfma_f32_16x16x32_bf16 v[232:235], v[152:155], v[128:131], v[232:235]
    v_mfma_f32_16x16x32_bf16 v[252:255], v[152:155], v[132:135], v[252:255]
    s_add_u32 s45, s37, 531456
    buffer_load_dwordx4 v[152:155], v2, s[12:15], s45 offen
    s_add_u32 s43, s36, 14336
    s_add_u32 s44, s35, 14336
    buffer_load_dwordx4 v[120:123], v1, s[8:11], s43 offen
    buffer_load_dwordx4 v[124:127], v1, s[8:11], s43 offen offset:256
    buffer_load_dwordx4 v[128:131], v1, s[8:11], s44 offen
    buffer_load_dwordx4 v[132:135], v1, s[8:11], s44 offen offset:256
    s_waitcnt vmcnt(27)
    v_mfma_f32_16x16x32_bf16 v[176:179], v[28:31], v[12:15], v[176:179]
    v_mfma_f32_16x16x32_bf16 v[196:199], v[28:31], v[16:19], v[196:199]
    v_mfma_f32_16x16x32_bf16 v[216:219], v[28:31], v[20:23], v[216:219]
    v_mfma_f32_16x16x32_bf16 v[236:239], v[28:31], v[24:27], v[236:239]
    s_add_u32 s45, s37, 8192
    buffer_load_dwordx4 v[28:31], v2, s[12:15], s45 offen
    v_mfma_f32_16x16x32_bf16 v[180:183], v[32:35], v[12:15], v[180:183]
    v_mfma_f32_16x16x32_bf16 v[200:203], v[32:35], v[16:19], v[200:203]
    v_mfma_f32_16x16x32_bf16 v[220:223], v[32:35], v[20:23], v[220:223]
    v_mfma_f32_16x16x32_bf16 v[240:243], v[32:35], v[24:27], v[240:243]
    s_add_u32 s45, s37, 139264
    buffer_load_dwordx4 v[32:35], v2, s[12:15], s45 offen
    v_mfma_f32_16x16x32_bf16 v[184:187], v[36:39], v[12:15], v[184:187]
    v_mfma_f32_16x16x32_bf16 v[204:207], v[36:39], v[16:19], v[204:207]
    v_mfma_f32_16x16x32_bf16 v[224:227], v[36:39], v[20:23], v[224:227]
    v_mfma_f32_16x16x32_bf16 v[244:247], v[36:39], v[24:27], v[244:247]
    s_add_u32 s45, s37, 270336
    buffer_load_dwordx4 v[36:39], v2, s[12:15], s45 offen
    v_mfma_f32_16x16x32_bf16 v[188:191], v[40:43], v[12:15], v[188:191]
    v_mfma_f32_16x16x32_bf16 v[208:211], v[40:43], v[16:19], v[208:211]
    v_mfma_f32_16x16x32_bf16 v[228:231], v[40:43], v[20:23], v[228:231]
    v_mfma_f32_16x16x32_bf16 v[248:251], v[40:43], v[24:27], v[248:251]
    s_add_u32 s45, s37, 401408
    buffer_load_dwordx4 v[40:43], v2, s[12:15], s45 offen
    v_mfma_f32_16x16x32_bf16 v[192:195], v[44:47], v[12:15], v[192:195]
    v_mfma_f32_16x16x32_bf16 v[212:215], v[44:47], v[16:19], v[212:215]
    v_mfma_f32_16x16x32_bf16 v[232:235], v[44:47], v[20:23], v[232:235]
    v_mfma_f32_16x16x32_bf16 v[252:255], v[44:47], v[24:27], v[252:255]
    s_add_u32 s45, s37, 532480
    buffer_load_dwordx4 v[44:47], v2, s[12:15], s45 offen
    s_add_u32 s43, s36, 16384
    s_add_u32 s44, s35, 16384
    buffer_load_dwordx4 v[12:15], v1, s[8:11], s43 offen
    buffer_load_dwordx4 v[16:19], v1, s[8:11], s43 offen offset:256
    buffer_load_dwordx4 v[20:23], v1, s[8:11], s44 offen
    buffer_load_dwordx4 v[24:27], v1, s[8:11], s44 offen offset:256
    s_waitcnt vmcnt(27)
    v_mfma_f32_16x16x32_bf16 v[176:179], v[64:67], v[48:51], v[176:179]
    v_mfma_f32_16x16x32_bf16 v[196:199], v[64:67], v[52:55], v[196:199]
    v_mfma_f32_16x16x32_bf16 v[216:219], v[64:67], v[56:59], v[216:219]
    v_mfma_f32_16x16x32_bf16 v[236:239], v[64:67], v[60:63], v[236:239]
    s_add_u32 s45, s37, 9216
    buffer_load_dwordx4 v[64:67], v2, s[12:15], s45 offen
    v_mfma_f32_16x16x32_bf16 v[180:183], v[68:71], v[48:51], v[180:183]
    v_mfma_f32_16x16x32_bf16 v[200:203], v[68:71], v[52:55], v[200:203]
    v_mfma_f32_16x16x32_bf16 v[220:223], v[68:71], v[56:59], v[220:223]
    v_mfma_f32_16x16x32_bf16 v[240:243], v[68:71], v[60:63], v[240:243]
    s_add_u32 s45, s37, 140288
    buffer_load_dwordx4 v[68:71], v2, s[12:15], s45 offen
    v_mfma_f32_16x16x32_bf16 v[184:187], v[72:75], v[48:51], v[184:187]
    v_mfma_f32_16x16x32_bf16 v[204:207], v[72:75], v[52:55], v[204:207]
    v_mfma_f32_16x16x32_bf16 v[224:227], v[72:75], v[56:59], v[224:227]
    v_mfma_f32_16x16x32_bf16 v[244:247], v[72:75], v[60:63], v[244:247]
    s_add_u32 s45, s37, 271360
    buffer_load_dwordx4 v[72:75], v2, s[12:15], s45 offen
    v_mfma_f32_16x16x32_bf16 v[188:191], v[76:79], v[48:51], v[188:191]
    v_mfma_f32_16x16x32_bf16 v[208:211], v[76:79], v[52:55], v[208:211]
    v_mfma_f32_16x16x32_bf16 v[228:231], v[76:79], v[56:59], v[228:231]
    v_mfma_f32_16x16x32_bf16 v[248:251], v[76:79], v[60:63], v[248:251]
    s_add_u32 s45, s37, 402432
    buffer_load_dwordx4 v[76:79], v2, s[12:15], s45 offen
    v_mfma_f32_16x16x32_bf16 v[192:195], v[80:83], v[48:51], v[192:195]
    v_mfma_f32_16x16x32_bf16 v[212:215], v[80:83], v[52:55], v[212:215]
    v_mfma_f32_16x16x32_bf16 v[232:235], v[80:83], v[56:59], v[232:235]
    v_mfma_f32_16x16x32_bf16 v[252:255], v[80:83], v[60:63], v[252:255]
    s_add_u32 s45, s37, 533504
    buffer_load_dwordx4 v[80:83], v2, s[12:15], s45 offen
    s_add_u32 s43, s36, 18432
    s_add_u32 s44, s35, 18432
    buffer_load_dwordx4 v[48:51], v1, s[8:11], s43 offen
    buffer_load_dwordx4 v[52:55], v1, s[8:11], s43 offen offset:256
    buffer_load_dwordx4 v[56:59], v1, s[8:11], s44 offen
    buffer_load_dwordx4 v[60:63], v1, s[8:11], s44 offen offset:256
    s_waitcnt vmcnt(27)
    v_mfma_f32_16x16x32_bf16 v[176:179], v[100:103], v[84:87], v[176:179]
    v_mfma_f32_16x16x32_bf16 v[196:199], v[100:103], v[88:91], v[196:199]
    v_mfma_f32_16x16x32_bf16 v[216:219], v[100:103], v[92:95], v[216:219]
    v_mfma_f32_16x16x32_bf16 v[236:239], v[100:103], v[96:99], v[236:239]
    s_add_u32 s45, s37, 10240
    buffer_load_dwordx4 v[100:103], v2, s[12:15], s45 offen
    v_mfma_f32_16x16x32_bf16 v[180:183], v[104:107], v[84:87], v[180:183]
    v_mfma_f32_16x16x32_bf16 v[200:203], v[104:107], v[88:91], v[200:203]
    v_mfma_f32_16x16x32_bf16 v[220:223], v[104:107], v[92:95], v[220:223]
    v_mfma_f32_16x16x32_bf16 v[240:243], v[104:107], v[96:99], v[240:243]
    s_add_u32 s45, s37, 141312
    buffer_load_dwordx4 v[104:107], v2, s[12:15], s45 offen
    v_mfma_f32_16x16x32_bf16 v[184:187], v[108:111], v[84:87], v[184:187]
    v_mfma_f32_16x16x32_bf16 v[204:207], v[108:111], v[88:91], v[204:207]
    v_mfma_f32_16x16x32_bf16 v[224:227], v[108:111], v[92:95], v[224:227]
    v_mfma_f32_16x16x32_bf16 v[244:247], v[108:111], v[96:99], v[244:247]
    s_add_u32 s45, s37, 272384
    buffer_load_dwordx4 v[108:111], v2, s[12:15], s45 offen
    v_mfma_f32_16x16x32_bf16 v[188:191], v[112:115], v[84:87], v[188:191]
    v_mfma_f32_16x16x32_bf16 v[208:211], v[112:115], v[88:91], v[208:211]
    v_mfma_f32_16x16x32_bf16 v[228:231], v[112:115], v[92:95], v[228:231]
    v_mfma_f32_16x16x32_bf16 v[248:251], v[112:115], v[96:99], v[248:251]
    s_add_u32 s45, s37, 403456
    buffer_load_dwordx4 v[112:115], v2, s[12:15], s45 offen
    v_mfma_f32_16x16x32_bf16 v[192:195], v[116:119], v[84:87], v[192:195]
    v_mfma_f32_16x16x32_bf16 v[212:215], v[116:119], v[88:91], v[212:215]
    v_mfma_f32_16x16x32_bf16 v[232:235], v[116:119], v[92:95], v[232:235]
    v_mfma_f32_16x16x32_bf16 v[252:255], v[116:119], v[96:99], v[252:255]
    s_add_u32 s45, s37, 534528
    buffer_load_dwordx4 v[116:119], v2, s[12:15], s45 offen
    s_add_u32 s43, s36, 20480
    s_add_u32 s44, s35, 20480
    buffer_load_dwordx4 v[84:87], v1, s[8:11], s43 offen
    buffer_load_dwordx4 v[88:91], v1, s[8:11], s43 offen offset:256
    buffer_load_dwordx4 v[92:95], v1, s[8:11], s44 offen
    buffer_load_dwordx4 v[96:99], v1, s[8:11], s44 offen offset:256
    s_waitcnt vmcnt(27)
    v_mfma_f32_16x16x32_bf16 v[176:179], v[136:139], v[120:123], v[176:179]
    v_mfma_f32_16x16x32_bf16 v[196:199], v[136:139], v[124:127], v[196:199]
    v_mfma_f32_16x16x32_bf16 v[216:219], v[136:139], v[128:131], v[216:219]
    v_mfma_f32_16x16x32_bf16 v[236:239], v[136:139], v[132:135], v[236:239]
    s_add_u32 s45, s37, 11264
    buffer_load_dwordx4 v[136:139], v2, s[12:15], s45 offen
    v_mfma_f32_16x16x32_bf16 v[180:183], v[140:143], v[120:123], v[180:183]
    v_mfma_f32_16x16x32_bf16 v[200:203], v[140:143], v[124:127], v[200:203]
    v_mfma_f32_16x16x32_bf16 v[220:223], v[140:143], v[128:131], v[220:223]
    v_mfma_f32_16x16x32_bf16 v[240:243], v[140:143], v[132:135], v[240:243]
    s_add_u32 s45, s37, 142336
    buffer_load_dwordx4 v[140:143], v2, s[12:15], s45 offen
    v_mfma_f32_16x16x32_bf16 v[184:187], v[144:147], v[120:123], v[184:187]
    v_mfma_f32_16x16x32_bf16 v[204:207], v[144:147], v[124:127], v[204:207]
    v_mfma_f32_16x16x32_bf16 v[224:227], v[144:147], v[128:131], v[224:227]
    v_mfma_f32_16x16x32_bf16 v[244:247], v[144:147], v[132:135], v[244:247]
    s_add_u32 s45, s37, 273408
    buffer_load_dwordx4 v[144:147], v2, s[12:15], s45 offen
    v_mfma_f32_16x16x32_bf16 v[188:191], v[148:151], v[120:123], v[188:191]
    v_mfma_f32_16x16x32_bf16 v[208:211], v[148:151], v[124:127], v[208:211]
    v_mfma_f32_16x16x32_bf16 v[228:231], v[148:151], v[128:131], v[228:231]
    v_mfma_f32_16x16x32_bf16 v[248:251], v[148:151], v[132:135], v[248:251]
    s_add_u32 s45, s37, 404480
    buffer_load_dwordx4 v[148:151], v2, s[12:15], s45 offen
    v_mfma_f32_16x16x32_bf16 v[192:195], v[152:155], v[120:123], v[192:195]
    v_mfma_f32_16x16x32_bf16 v[212:215], v[152:155], v[124:127], v[212:215]
    v_mfma_f32_16x16x32_bf16 v[232:235], v[152:155], v[128:131], v[232:235]
    v_mfma_f32_16x16x32_bf16 v[252:255], v[152:155], v[132:135], v[252:255]
    s_add_u32 s45, s37, 535552
    buffer_load_dwordx4 v[152:155], v2, s[12:15], s45 offen
    s_add_u32 s43, s36, 22528
    s_add_u32 s44, s35, 22528
    buffer_load_dwordx4 v[120:123], v1, s[8:11], s43 offen
    buffer_load_dwordx4 v[124:127], v1, s[8:11], s43 offen offset:256
    buffer_load_dwordx4 v[128:131], v1, s[8:11], s44 offen
    buffer_load_dwordx4 v[132:135], v1, s[8:11], s44 offen offset:256
    s_waitcnt vmcnt(27)
    v_mfma_f32_16x16x32_bf16 v[176:179], v[28:31], v[12:15], v[176:179]
    v_mfma_f32_16x16x32_bf16 v[196:199], v[28:31], v[16:19], v[196:199]
    v_mfma_f32_16x16x32_bf16 v[216:219], v[28:31], v[20:23], v[216:219]
    v_mfma_f32_16x16x32_bf16 v[236:239], v[28:31], v[24:27], v[236:239]
    s_add_u32 s45, s37, 12288
    buffer_load_dwordx4 v[28:31], v2, s[12:15], s45 offen
    v_mfma_f32_16x16x32_bf16 v[180:183], v[32:35], v[12:15], v[180:183]
    v_mfma_f32_16x16x32_bf16 v[200:203], v[32:35], v[16:19], v[200:203]
    v_mfma_f32_16x16x32_bf16 v[220:223], v[32:35], v[20:23], v[220:223]
    v_mfma_f32_16x16x32_bf16 v[240:243], v[32:35], v[24:27], v[240:243]
    s_add_u32 s45, s37, 143360
    buffer_load_dwordx4 v[32:35], v2, s[12:15], s45 offen
    v_mfma_f32_16x16x32_bf16 v[184:187], v[36:39], v[12:15], v[184:187]
    v_mfma_f32_16x16x32_bf16 v[204:207], v[36:39], v[16:19], v[204:207]
    v_mfma_f32_16x16x32_bf16 v[224:227], v[36:39], v[20:23], v[224:227]
    v_mfma_f32_16x16x32_bf16 v[244:247], v[36:39], v[24:27], v[244:247]
    s_add_u32 s45, s37, 274432
    buffer_load_dwordx4 v[36:39], v2, s[12:15], s45 offen
    v_mfma_f32_16x16x32_bf16 v[188:191], v[40:43], v[12:15], v[188:191]
    v_mfma_f32_16x16x32_bf16 v[208:211], v[40:43], v[16:19], v[208:211]
    v_mfma_f32_16x16x32_bf16 v[228:231], v[40:43], v[20:23], v[228:231]
    v_mfma_f32_16x16x32_bf16 v[248:251], v[40:43], v[24:27], v[248:251]
    s_add_u32 s45, s37, 405504
    buffer_load_dwordx4 v[40:43], v2, s[12:15], s45 offen
    v_mfma_f32_16x16x32_bf16 v[192:195], v[44:47], v[12:15], v[192:195]
    v_mfma_f32_16x16x32_bf16 v[212:215], v[44:47], v[16:19], v[212:215]
    v_mfma_f32_16x16x32_bf16 v[232:235], v[44:47], v[20:23], v[232:235]
    v_mfma_f32_16x16x32_bf16 v[252:255], v[44:47], v[24:27], v[252:255]
    s_add_u32 s45, s37, 536576
    buffer_load_dwordx4 v[44:47], v2, s[12:15], s45 offen
    s_add_u32 s43, s36, 24576
    s_add_u32 s44, s35, 24576
    buffer_load_dwordx4 v[12:15], v1, s[8:11], s43 offen
    buffer_load_dwordx4 v[16:19], v1, s[8:11], s43 offen offset:256
    buffer_load_dwordx4 v[20:23], v1, s[8:11], s44 offen
    buffer_load_dwordx4 v[24:27], v1, s[8:11], s44 offen offset:256
    s_waitcnt vmcnt(27)
    v_mfma_f32_16x16x32_bf16 v[176:179], v[64:67], v[48:51], v[176:179]
    v_mfma_f32_16x16x32_bf16 v[196:199], v[64:67], v[52:55], v[196:199]
    v_mfma_f32_16x16x32_bf16 v[216:219], v[64:67], v[56:59], v[216:219]
    v_mfma_f32_16x16x32_bf16 v[236:239], v[64:67], v[60:63], v[236:239]
    s_add_u32 s45, s37, 13312
    buffer_load_dwordx4 v[64:67], v2, s[12:15], s45 offen
    v_mfma_f32_16x16x32_bf16 v[180:183], v[68:71], v[48:51], v[180:183]
    v_mfma_f32_16x16x32_bf16 v[200:203], v[68:71], v[52:55], v[200:203]
    v_mfma_f32_16x16x32_bf16 v[220:223], v[68:71], v[56:59], v[220:223]
    v_mfma_f32_16x16x32_bf16 v[240:243], v[68:71], v[60:63], v[240:243]
    s_add_u32 s45, s37, 144384
    buffer_load_dwordx4 v[68:71], v2, s[12:15], s45 offen
    v_mfma_f32_16x16x32_bf16 v[184:187], v[72:75], v[48:51], v[184:187]
    v_mfma_f32_16x16x32_bf16 v[204:207], v[72:75], v[52:55], v[204:207]
    v_mfma_f32_16x16x32_bf16 v[224:227], v[72:75], v[56:59], v[224:227]
    v_mfma_f32_16x16x32_bf16 v[244:247], v[72:75], v[60:63], v[244:247]
    s_add_u32 s45, s37, 275456
    buffer_load_dwordx4 v[72:75], v2, s[12:15], s45 offen
    v_mfma_f32_16x16x32_bf16 v[188:191], v[76:79], v[48:51], v[188:191]
    v_mfma_f32_16x16x32_bf16 v[208:211], v[76:79], v[52:55], v[208:211]
    v_mfma_f32_16x16x32_bf16 v[228:231], v[76:79], v[56:59], v[228:231]
    v_mfma_f32_16x16x32_bf16 v[248:251], v[76:79], v[60:63], v[248:251]
    s_add_u32 s45, s37, 406528
    buffer_load_dwordx4 v[76:79], v2, s[12:15], s45 offen
    v_mfma_f32_16x16x32_bf16 v[192:195], v[80:83], v[48:51], v[192:195]
    v_mfma_f32_16x16x32_bf16 v[212:215], v[80:83], v[52:55], v[212:215]
    v_mfma_f32_16x16x32_bf16 v[232:235], v[80:83], v[56:59], v[232:235]
    v_mfma_f32_16x16x32_bf16 v[252:255], v[80:83], v[60:63], v[252:255]
    s_add_u32 s45, s37, 537600
    buffer_load_dwordx4 v[80:83], v2, s[12:15], s45 offen
    s_add_u32 s43, s36, 26624
    s_add_u32 s44, s35, 26624
    buffer_load_dwordx4 v[48:51], v1, s[8:11], s43 offen
    buffer_load_dwordx4 v[52:55], v1, s[8:11], s43 offen offset:256
    buffer_load_dwordx4 v[56:59], v1, s[8:11], s44 offen
    buffer_load_dwordx4 v[60:63], v1, s[8:11], s44 offen offset:256
    s_waitcnt vmcnt(27)
    v_mfma_f32_16x16x32_bf16 v[176:179], v[100:103], v[84:87], v[176:179]
    v_mfma_f32_16x16x32_bf16 v[196:199], v[100:103], v[88:91], v[196:199]
    v_mfma_f32_16x16x32_bf16 v[216:219], v[100:103], v[92:95], v[216:219]
    v_mfma_f32_16x16x32_bf16 v[236:239], v[100:103], v[96:99], v[236:239]
    s_add_u32 s45, s37, 14336
    buffer_load_dwordx4 v[100:103], v2, s[12:15], s45 offen
    v_mfma_f32_16x16x32_bf16 v[180:183], v[104:107], v[84:87], v[180:183]
    v_mfma_f32_16x16x32_bf16 v[200:203], v[104:107], v[88:91], v[200:203]
    v_mfma_f32_16x16x32_bf16 v[220:223], v[104:107], v[92:95], v[220:223]
    v_mfma_f32_16x16x32_bf16 v[240:243], v[104:107], v[96:99], v[240:243]
    s_add_u32 s45, s37, 145408
    buffer_load_dwordx4 v[104:107], v2, s[12:15], s45 offen
    v_mfma_f32_16x16x32_bf16 v[184:187], v[108:111], v[84:87], v[184:187]
    v_mfma_f32_16x16x32_bf16 v[204:207], v[108:111], v[88:91], v[204:207]
    v_mfma_f32_16x16x32_bf16 v[224:227], v[108:111], v[92:95], v[224:227]
    v_mfma_f32_16x16x32_bf16 v[244:247], v[108:111], v[96:99], v[244:247]
    s_add_u32 s45, s37, 276480
    buffer_load_dwordx4 v[108:111], v2, s[12:15], s45 offen
    v_mfma_f32_16x16x32_bf16 v[188:191], v[112:115], v[84:87], v[188:191]
    v_mfma_f32_16x16x32_bf16 v[208:211], v[112:115], v[88:91], v[208:211]
    v_mfma_f32_16x16x32_bf16 v[228:231], v[112:115], v[92:95], v[228:231]
    v_mfma_f32_16x16x32_bf16 v[248:251], v[112:115], v[96:99], v[248:251]
    s_add_u32 s45, s37, 407552
    buffer_load_dwordx4 v[112:115], v2, s[12:15], s45 offen
    v_mfma_f32_16x16x32_bf16 v[192:195], v[116:119], v[84:87], v[192:195]
    v_mfma_f32_16x16x32_bf16 v[212:215], v[116:119], v[88:91], v[212:215]
    v_mfma_f32_16x16x32_bf16 v[232:235], v[116:119], v[92:95], v[232:235]
    v_mfma_f32_16x16x32_bf16 v[252:255], v[116:119], v[96:99], v[252:255]
    s_add_u32 s45, s37, 538624
    buffer_load_dwordx4 v[116:119], v2, s[12:15], s45 offen
    s_add_u32 s43, s36, 28672
    s_add_u32 s44, s35, 28672
    buffer_load_dwordx4 v[84:87], v1, s[8:11], s43 offen
    buffer_load_dwordx4 v[88:91], v1, s[8:11], s43 offen offset:256
    buffer_load_dwordx4 v[92:95], v1, s[8:11], s44 offen
    buffer_load_dwordx4 v[96:99], v1, s[8:11], s44 offen offset:256
    s_waitcnt vmcnt(27)
    v_mfma_f32_16x16x32_bf16 v[176:179], v[136:139], v[120:123], v[176:179]
    v_mfma_f32_16x16x32_bf16 v[196:199], v[136:139], v[124:127], v[196:199]
    v_mfma_f32_16x16x32_bf16 v[216:219], v[136:139], v[128:131], v[216:219]
    v_mfma_f32_16x16x32_bf16 v[236:239], v[136:139], v[132:135], v[236:239]
    s_add_u32 s45, s37, 15360
    buffer_load_dwordx4 v[136:139], v2, s[12:15], s45 offen
    v_mfma_f32_16x16x32_bf16 v[180:183], v[140:143], v[120:123], v[180:183]
    v_mfma_f32_16x16x32_bf16 v[200:203], v[140:143], v[124:127], v[200:203]
    v_mfma_f32_16x16x32_bf16 v[220:223], v[140:143], v[128:131], v[220:223]
    v_mfma_f32_16x16x32_bf16 v[240:243], v[140:143], v[132:135], v[240:243]
    s_add_u32 s45, s37, 146432
    buffer_load_dwordx4 v[140:143], v2, s[12:15], s45 offen
    v_mfma_f32_16x16x32_bf16 v[184:187], v[144:147], v[120:123], v[184:187]
    v_mfma_f32_16x16x32_bf16 v[204:207], v[144:147], v[124:127], v[204:207]
    v_mfma_f32_16x16x32_bf16 v[224:227], v[144:147], v[128:131], v[224:227]
    v_mfma_f32_16x16x32_bf16 v[244:247], v[144:147], v[132:135], v[244:247]
    s_add_u32 s45, s37, 277504
    buffer_load_dwordx4 v[144:147], v2, s[12:15], s45 offen
    v_mfma_f32_16x16x32_bf16 v[188:191], v[148:151], v[120:123], v[188:191]
    v_mfma_f32_16x16x32_bf16 v[208:211], v[148:151], v[124:127], v[208:211]
    v_mfma_f32_16x16x32_bf16 v[228:231], v[148:151], v[128:131], v[228:231]
    v_mfma_f32_16x16x32_bf16 v[248:251], v[148:151], v[132:135], v[248:251]
    s_add_u32 s45, s37, 408576
    buffer_load_dwordx4 v[148:151], v2, s[12:15], s45 offen
    v_mfma_f32_16x16x32_bf16 v[192:195], v[152:155], v[120:123], v[192:195]
    v_mfma_f32_16x16x32_bf16 v[212:215], v[152:155], v[124:127], v[212:215]
    v_mfma_f32_16x16x32_bf16 v[232:235], v[152:155], v[128:131], v[232:235]
    v_mfma_f32_16x16x32_bf16 v[252:255], v[152:155], v[132:135], v[252:255]
    s_add_u32 s45, s37, 539648
    buffer_load_dwordx4 v[152:155], v2, s[12:15], s45 offen
    s_add_u32 s43, s36, 30720
    s_add_u32 s44, s35, 30720
    buffer_load_dwordx4 v[120:123], v1, s[8:11], s43 offen
    buffer_load_dwordx4 v[124:127], v1, s[8:11], s43 offen offset:256
    buffer_load_dwordx4 v[128:131], v1, s[8:11], s44 offen
    buffer_load_dwordx4 v[132:135], v1, s[8:11], s44 offen offset:256
    s_waitcnt vmcnt(27)
    v_mfma_f32_16x16x32_bf16 v[176:179], v[28:31], v[12:15], v[176:179]
    v_mfma_f32_16x16x32_bf16 v[196:199], v[28:31], v[16:19], v[196:199]
    v_mfma_f32_16x16x32_bf16 v[216:219], v[28:31], v[20:23], v[216:219]
    v_mfma_f32_16x16x32_bf16 v[236:239], v[28:31], v[24:27], v[236:239]
    s_add_u32 s45, s37, 16384
    buffer_load_dwordx4 v[28:31], v2, s[12:15], s45 offen
    v_mfma_f32_16x16x32_bf16 v[180:183], v[32:35], v[12:15], v[180:183]
    v_mfma_f32_16x16x32_bf16 v[200:203], v[32:35], v[16:19], v[200:203]
    v_mfma_f32_16x16x32_bf16 v[220:223], v[32:35], v[20:23], v[220:223]
    v_mfma_f32_16x16x32_bf16 v[240:243], v[32:35], v[24:27], v[240:243]
    s_add_u32 s45, s37, 147456
    buffer_load_dwordx4 v[32:35], v2, s[12:15], s45 offen
    v_mfma_f32_16x16x32_bf16 v[184:187], v[36:39], v[12:15], v[184:187]
    v_mfma_f32_16x16x32_bf16 v[204:207], v[36:39], v[16:19], v[204:207]
    v_mfma_f32_16x16x32_bf16 v[224:227], v[36:39], v[20:23], v[224:227]
    v_mfma_f32_16x16x32_bf16 v[244:247], v[36:39], v[24:27], v[244:247]
    s_add_u32 s45, s37, 278528
    buffer_load_dwordx4 v[36:39], v2, s[12:15], s45 offen
    v_mfma_f32_16x16x32_bf16 v[188:191], v[40:43], v[12:15], v[188:191]
    v_mfma_f32_16x16x32_bf16 v[208:211], v[40:43], v[16:19], v[208:211]
    v_mfma_f32_16x16x32_bf16 v[228:231], v[40:43], v[20:23], v[228:231]
    v_mfma_f32_16x16x32_bf16 v[248:251], v[40:43], v[24:27], v[248:251]
    s_add_u32 s45, s37, 409600
    buffer_load_dwordx4 v[40:43], v2, s[12:15], s45 offen
    v_mfma_f32_16x16x32_bf16 v[192:195], v[44:47], v[12:15], v[192:195]
    v_mfma_f32_16x16x32_bf16 v[212:215], v[44:47], v[16:19], v[212:215]
    v_mfma_f32_16x16x32_bf16 v[232:235], v[44:47], v[20:23], v[232:235]
    v_mfma_f32_16x16x32_bf16 v[252:255], v[44:47], v[24:27], v[252:255]
    s_add_u32 s45, s37, 540672
    buffer_load_dwordx4 v[44:47], v2, s[12:15], s45 offen
    s_add_u32 s43, s36, 32768
    s_add_u32 s44, s35, 32768
    buffer_load_dwordx4 v[12:15], v1, s[8:11], s43 offen
    buffer_load_dwordx4 v[16:19], v1, s[8:11], s43 offen offset:256
    buffer_load_dwordx4 v[20:23], v1, s[8:11], s44 offen
    buffer_load_dwordx4 v[24:27], v1, s[8:11], s44 offen offset:256
    s_waitcnt vmcnt(27)
    v_mfma_f32_16x16x32_bf16 v[176:179], v[64:67], v[48:51], v[176:179]
    v_mfma_f32_16x16x32_bf16 v[196:199], v[64:67], v[52:55], v[196:199]
    v_mfma_f32_16x16x32_bf16 v[216:219], v[64:67], v[56:59], v[216:219]
    v_mfma_f32_16x16x32_bf16 v[236:239], v[64:67], v[60:63], v[236:239]
    s_add_u32 s45, s37, 17408
    buffer_load_dwordx4 v[64:67], v2, s[12:15], s45 offen
    v_mfma_f32_16x16x32_bf16 v[180:183], v[68:71], v[48:51], v[180:183]
    v_mfma_f32_16x16x32_bf16 v[200:203], v[68:71], v[52:55], v[200:203]
    v_mfma_f32_16x16x32_bf16 v[220:223], v[68:71], v[56:59], v[220:223]
    v_mfma_f32_16x16x32_bf16 v[240:243], v[68:71], v[60:63], v[240:243]
    s_add_u32 s45, s37, 148480
    buffer_load_dwordx4 v[68:71], v2, s[12:15], s45 offen
    v_mfma_f32_16x16x32_bf16 v[184:187], v[72:75], v[48:51], v[184:187]
    v_mfma_f32_16x16x32_bf16 v[204:207], v[72:75], v[52:55], v[204:207]
    v_mfma_f32_16x16x32_bf16 v[224:227], v[72:75], v[56:59], v[224:227]
    v_mfma_f32_16x16x32_bf16 v[244:247], v[72:75], v[60:63], v[244:247]
    s_add_u32 s45, s37, 279552
    buffer_load_dwordx4 v[72:75], v2, s[12:15], s45 offen
    v_mfma_f32_16x16x32_bf16 v[188:191], v[76:79], v[48:51], v[188:191]
    v_mfma_f32_16x16x32_bf16 v[208:211], v[76:79], v[52:55], v[208:211]
    v_mfma_f32_16x16x32_bf16 v[228:231], v[76:79], v[56:59], v[228:231]
    v_mfma_f32_16x16x32_bf16 v[248:251], v[76:79], v[60:63], v[248:251]
    s_add_u32 s45, s37, 410624
    buffer_load_dwordx4 v[76:79], v2, s[12:15], s45 offen
    v_mfma_f32_16x16x32_bf16 v[192:195], v[80:83], v[48:51], v[192:195]
    v_mfma_f32_16x16x32_bf16 v[212:215], v[80:83], v[52:55], v[212:215]
    v_mfma_f32_16x16x32_bf16 v[232:235], v[80:83], v[56:59], v[232:235]
    v_mfma_f32_16x16x32_bf16 v[252:255], v[80:83], v[60:63], v[252:255]
    s_add_u32 s45, s37, 541696
    buffer_load_dwordx4 v[80:83], v2, s[12:15], s45 offen
    s_add_u32 s43, s36, 34816
    s_add_u32 s44, s35, 34816
    buffer_load_dwordx4 v[48:51], v1, s[8:11], s43 offen
    buffer_load_dwordx4 v[52:55], v1, s[8:11], s43 offen offset:256
    buffer_load_dwordx4 v[56:59], v1, s[8:11], s44 offen
    buffer_load_dwordx4 v[60:63], v1, s[8:11], s44 offen offset:256
    s_waitcnt vmcnt(27)
    v_mfma_f32_16x16x32_bf16 v[176:179], v[100:103], v[84:87], v[176:179]
    v_mfma_f32_16x16x32_bf16 v[196:199], v[100:103], v[88:91], v[196:199]
    v_mfma_f32_16x16x32_bf16 v[216:219], v[100:103], v[92:95], v[216:219]
    v_mfma_f32_16x16x32_bf16 v[236:239], v[100:103], v[96:99], v[236:239]
    s_add_u32 s45, s37, 18432
    buffer_load_dwordx4 v[100:103], v2, s[12:15], s45 offen
    v_mfma_f32_16x16x32_bf16 v[180:183], v[104:107], v[84:87], v[180:183]
    v_mfma_f32_16x16x32_bf16 v[200:203], v[104:107], v[88:91], v[200:203]
    v_mfma_f32_16x16x32_bf16 v[220:223], v[104:107], v[92:95], v[220:223]
    v_mfma_f32_16x16x32_bf16 v[240:243], v[104:107], v[96:99], v[240:243]
    s_add_u32 s45, s37, 149504
    buffer_load_dwordx4 v[104:107], v2, s[12:15], s45 offen
    v_mfma_f32_16x16x32_bf16 v[184:187], v[108:111], v[84:87], v[184:187]
    v_mfma_f32_16x16x32_bf16 v[204:207], v[108:111], v[88:91], v[204:207]
    v_mfma_f32_16x16x32_bf16 v[224:227], v[108:111], v[92:95], v[224:227]
    v_mfma_f32_16x16x32_bf16 v[244:247], v[108:111], v[96:99], v[244:247]
    s_add_u32 s45, s37, 280576
    buffer_load_dwordx4 v[108:111], v2, s[12:15], s45 offen
    v_mfma_f32_16x16x32_bf16 v[188:191], v[112:115], v[84:87], v[188:191]
    v_mfma_f32_16x16x32_bf16 v[208:211], v[112:115], v[88:91], v[208:211]
    v_mfma_f32_16x16x32_bf16 v[228:231], v[112:115], v[92:95], v[228:231]
    v_mfma_f32_16x16x32_bf16 v[248:251], v[112:115], v[96:99], v[248:251]
    s_add_u32 s45, s37, 411648
    buffer_load_dwordx4 v[112:115], v2, s[12:15], s45 offen
    v_mfma_f32_16x16x32_bf16 v[192:195], v[116:119], v[84:87], v[192:195]
    v_mfma_f32_16x16x32_bf16 v[212:215], v[116:119], v[88:91], v[212:215]
    v_mfma_f32_16x16x32_bf16 v[232:235], v[116:119], v[92:95], v[232:235]
    v_mfma_f32_16x16x32_bf16 v[252:255], v[116:119], v[96:99], v[252:255]
    s_add_u32 s45, s37, 542720
    buffer_load_dwordx4 v[116:119], v2, s[12:15], s45 offen
    s_add_u32 s43, s36, 36864
    s_add_u32 s44, s35, 36864
    buffer_load_dwordx4 v[84:87], v1, s[8:11], s43 offen
    buffer_load_dwordx4 v[88:91], v1, s[8:11], s43 offen offset:256
    buffer_load_dwordx4 v[92:95], v1, s[8:11], s44 offen
    buffer_load_dwordx4 v[96:99], v1, s[8:11], s44 offen offset:256
    s_waitcnt vmcnt(27)
    v_mfma_f32_16x16x32_bf16 v[176:179], v[136:139], v[120:123], v[176:179]
    v_mfma_f32_16x16x32_bf16 v[196:199], v[136:139], v[124:127], v[196:199]
    v_mfma_f32_16x16x32_bf16 v[216:219], v[136:139], v[128:131], v[216:219]
    v_mfma_f32_16x16x32_bf16 v[236:239], v[136:139], v[132:135], v[236:239]
    s_add_u32 s45, s37, 19456
    buffer_load_dwordx4 v[136:139], v2, s[12:15], s45 offen
    v_mfma_f32_16x16x32_bf16 v[180:183], v[140:143], v[120:123], v[180:183]
    v_mfma_f32_16x16x32_bf16 v[200:203], v[140:143], v[124:127], v[200:203]
    v_mfma_f32_16x16x32_bf16 v[220:223], v[140:143], v[128:131], v[220:223]
    v_mfma_f32_16x16x32_bf16 v[240:243], v[140:143], v[132:135], v[240:243]
    s_add_u32 s45, s37, 150528
    buffer_load_dwordx4 v[140:143], v2, s[12:15], s45 offen
    v_mfma_f32_16x16x32_bf16 v[184:187], v[144:147], v[120:123], v[184:187]
    v_mfma_f32_16x16x32_bf16 v[204:207], v[144:147], v[124:127], v[204:207]
    v_mfma_f32_16x16x32_bf16 v[224:227], v[144:147], v[128:131], v[224:227]
    v_mfma_f32_16x16x32_bf16 v[244:247], v[144:147], v[132:135], v[244:247]
    s_add_u32 s45, s37, 281600
    buffer_load_dwordx4 v[144:147], v2, s[12:15], s45 offen
    v_mfma_f32_16x16x32_bf16 v[188:191], v[148:151], v[120:123], v[188:191]
    v_mfma_f32_16x16x32_bf16 v[208:211], v[148:151], v[124:127], v[208:211]
    v_mfma_f32_16x16x32_bf16 v[228:231], v[148:151], v[128:131], v[228:231]
    v_mfma_f32_16x16x32_bf16 v[248:251], v[148:151], v[132:135], v[248:251]
    s_add_u32 s45, s37, 412672
    buffer_load_dwordx4 v[148:151], v2, s[12:15], s45 offen
    v_mfma_f32_16x16x32_bf16 v[192:195], v[152:155], v[120:123], v[192:195]
    v_mfma_f32_16x16x32_bf16 v[212:215], v[152:155], v[124:127], v[212:215]
    v_mfma_f32_16x16x32_bf16 v[232:235], v[152:155], v[128:131], v[232:235]
    v_mfma_f32_16x16x32_bf16 v[252:255], v[152:155], v[132:135], v[252:255]
    s_add_u32 s45, s37, 543744
    buffer_load_dwordx4 v[152:155], v2, s[12:15], s45 offen
    s_add_u32 s43, s36, 38912
    s_add_u32 s44, s35, 38912
    buffer_load_dwordx4 v[120:123], v1, s[8:11], s43 offen
    buffer_load_dwordx4 v[124:127], v1, s[8:11], s43 offen offset:256
    buffer_load_dwordx4 v[128:131], v1, s[8:11], s44 offen
    buffer_load_dwordx4 v[132:135], v1, s[8:11], s44 offen offset:256
    s_waitcnt vmcnt(27)
    v_mfma_f32_16x16x32_bf16 v[176:179], v[28:31], v[12:15], v[176:179]
    v_mfma_f32_16x16x32_bf16 v[196:199], v[28:31], v[16:19], v[196:199]
    v_mfma_f32_16x16x32_bf16 v[216:219], v[28:31], v[20:23], v[216:219]
    v_mfma_f32_16x16x32_bf16 v[236:239], v[28:31], v[24:27], v[236:239]
    s_add_u32 s45, s37, 20480
    buffer_load_dwordx4 v[28:31], v2, s[12:15], s45 offen
    v_mfma_f32_16x16x32_bf16 v[180:183], v[32:35], v[12:15], v[180:183]
    v_mfma_f32_16x16x32_bf16 v[200:203], v[32:35], v[16:19], v[200:203]
    v_mfma_f32_16x16x32_bf16 v[220:223], v[32:35], v[20:23], v[220:223]
    v_mfma_f32_16x16x32_bf16 v[240:243], v[32:35], v[24:27], v[240:243]
    s_add_u32 s45, s37, 151552
    buffer_load_dwordx4 v[32:35], v2, s[12:15], s45 offen
    v_mfma_f32_16x16x32_bf16 v[184:187], v[36:39], v[12:15], v[184:187]
    v_mfma_f32_16x16x32_bf16 v[204:207], v[36:39], v[16:19], v[204:207]
    v_mfma_f32_16x16x32_bf16 v[224:227], v[36:39], v[20:23], v[224:227]
    v_mfma_f32_16x16x32_bf16 v[244:247], v[36:39], v[24:27], v[244:247]
    s_add_u32 s45, s37, 282624
    buffer_load_dwordx4 v[36:39], v2, s[12:15], s45 offen
    v_mfma_f32_16x16x32_bf16 v[188:191], v[40:43], v[12:15], v[188:191]
    v_mfma_f32_16x16x32_bf16 v[208:211], v[40:43], v[16:19], v[208:211]
    v_mfma_f32_16x16x32_bf16 v[228:231], v[40:43], v[20:23], v[228:231]
    v_mfma_f32_16x16x32_bf16 v[248:251], v[40:43], v[24:27], v[248:251]
    s_add_u32 s45, s37, 413696
    buffer_load_dwordx4 v[40:43], v2, s[12:15], s45 offen
    v_mfma_f32_16x16x32_bf16 v[192:195], v[44:47], v[12:15], v[192:195]
    v_mfma_f32_16x16x32_bf16 v[212:215], v[44:47], v[16:19], v[212:215]
    v_mfma_f32_16x16x32_bf16 v[232:235], v[44:47], v[20:23], v[232:235]
    v_mfma_f32_16x16x32_bf16 v[252:255], v[44:47], v[24:27], v[252:255]
    s_add_u32 s45, s37, 544768
    buffer_load_dwordx4 v[44:47], v2, s[12:15], s45 offen
    s_add_u32 s43, s36, 40960
    s_add_u32 s44, s35, 40960
    buffer_load_dwordx4 v[12:15], v1, s[8:11], s43 offen
    buffer_load_dwordx4 v[16:19], v1, s[8:11], s43 offen offset:256
    buffer_load_dwordx4 v[20:23], v1, s[8:11], s44 offen
    buffer_load_dwordx4 v[24:27], v1, s[8:11], s44 offen offset:256
    s_waitcnt vmcnt(27)
    v_mfma_f32_16x16x32_bf16 v[176:179], v[64:67], v[48:51], v[176:179]
    v_mfma_f32_16x16x32_bf16 v[196:199], v[64:67], v[52:55], v[196:199]
    v_mfma_f32_16x16x32_bf16 v[216:219], v[64:67], v[56:59], v[216:219]
    v_mfma_f32_16x16x32_bf16 v[236:239], v[64:67], v[60:63], v[236:239]
    s_add_u32 s45, s37, 21504
    buffer_load_dwordx4 v[64:67], v2, s[12:15], s45 offen
    v_mfma_f32_16x16x32_bf16 v[180:183], v[68:71], v[48:51], v[180:183]
    v_mfma_f32_16x16x32_bf16 v[200:203], v[68:71], v[52:55], v[200:203]
    v_mfma_f32_16x16x32_bf16 v[220:223], v[68:71], v[56:59], v[220:223]
    v_mfma_f32_16x16x32_bf16 v[240:243], v[68:71], v[60:63], v[240:243]
    s_add_u32 s45, s37, 152576
    buffer_load_dwordx4 v[68:71], v2, s[12:15], s45 offen
    v_mfma_f32_16x16x32_bf16 v[184:187], v[72:75], v[48:51], v[184:187]
    v_mfma_f32_16x16x32_bf16 v[204:207], v[72:75], v[52:55], v[204:207]
    v_mfma_f32_16x16x32_bf16 v[224:227], v[72:75], v[56:59], v[224:227]
    v_mfma_f32_16x16x32_bf16 v[244:247], v[72:75], v[60:63], v[244:247]
    s_add_u32 s45, s37, 283648
    buffer_load_dwordx4 v[72:75], v2, s[12:15], s45 offen
    v_mfma_f32_16x16x32_bf16 v[188:191], v[76:79], v[48:51], v[188:191]
    v_mfma_f32_16x16x32_bf16 v[208:211], v[76:79], v[52:55], v[208:211]
    v_mfma_f32_16x16x32_bf16 v[228:231], v[76:79], v[56:59], v[228:231]
    v_mfma_f32_16x16x32_bf16 v[248:251], v[76:79], v[60:63], v[248:251]
    s_add_u32 s45, s37, 414720
    buffer_load_dwordx4 v[76:79], v2, s[12:15], s45 offen
    v_mfma_f32_16x16x32_bf16 v[192:195], v[80:83], v[48:51], v[192:195]
    v_mfma_f32_16x16x32_bf16 v[212:215], v[80:83], v[52:55], v[212:215]
    v_mfma_f32_16x16x32_bf16 v[232:235], v[80:83], v[56:59], v[232:235]
    v_mfma_f32_16x16x32_bf16 v[252:255], v[80:83], v[60:63], v[252:255]
    s_add_u32 s45, s37, 545792
    buffer_load_dwordx4 v[80:83], v2, s[12:15], s45 offen
    s_add_u32 s43, s36, 43008
    s_add_u32 s44, s35, 43008
    buffer_load_dwordx4 v[48:51], v1, s[8:11], s43 offen
    buffer_load_dwordx4 v[52:55], v1, s[8:11], s43 offen offset:256
    buffer_load_dwordx4 v[56:59], v1, s[8:11], s44 offen
    buffer_load_dwordx4 v[60:63], v1, s[8:11], s44 offen offset:256
    s_waitcnt vmcnt(27)
    v_mfma_f32_16x16x32_bf16 v[176:179], v[100:103], v[84:87], v[176:179]
    v_mfma_f32_16x16x32_bf16 v[196:199], v[100:103], v[88:91], v[196:199]
    v_mfma_f32_16x16x32_bf16 v[216:219], v[100:103], v[92:95], v[216:219]
    v_mfma_f32_16x16x32_bf16 v[236:239], v[100:103], v[96:99], v[236:239]
    s_add_u32 s45, s37, 22528
    buffer_load_dwordx4 v[100:103], v2, s[12:15], s45 offen
    v_mfma_f32_16x16x32_bf16 v[180:183], v[104:107], v[84:87], v[180:183]
    v_mfma_f32_16x16x32_bf16 v[200:203], v[104:107], v[88:91], v[200:203]
    v_mfma_f32_16x16x32_bf16 v[220:223], v[104:107], v[92:95], v[220:223]
    v_mfma_f32_16x16x32_bf16 v[240:243], v[104:107], v[96:99], v[240:243]
    s_add_u32 s45, s37, 153600
    buffer_load_dwordx4 v[104:107], v2, s[12:15], s45 offen
    v_mfma_f32_16x16x32_bf16 v[184:187], v[108:111], v[84:87], v[184:187]
    v_mfma_f32_16x16x32_bf16 v[204:207], v[108:111], v[88:91], v[204:207]
    v_mfma_f32_16x16x32_bf16 v[224:227], v[108:111], v[92:95], v[224:227]
    v_mfma_f32_16x16x32_bf16 v[244:247], v[108:111], v[96:99], v[244:247]
    s_add_u32 s45, s37, 284672
    buffer_load_dwordx4 v[108:111], v2, s[12:15], s45 offen
    v_mfma_f32_16x16x32_bf16 v[188:191], v[112:115], v[84:87], v[188:191]
    v_mfma_f32_16x16x32_bf16 v[208:211], v[112:115], v[88:91], v[208:211]
    v_mfma_f32_16x16x32_bf16 v[228:231], v[112:115], v[92:95], v[228:231]
    v_mfma_f32_16x16x32_bf16 v[248:251], v[112:115], v[96:99], v[248:251]
    s_add_u32 s45, s37, 415744
    buffer_load_dwordx4 v[112:115], v2, s[12:15], s45 offen
    v_mfma_f32_16x16x32_bf16 v[192:195], v[116:119], v[84:87], v[192:195]
    v_mfma_f32_16x16x32_bf16 v[212:215], v[116:119], v[88:91], v[212:215]
    v_mfma_f32_16x16x32_bf16 v[232:235], v[116:119], v[92:95], v[232:235]
    v_mfma_f32_16x16x32_bf16 v[252:255], v[116:119], v[96:99], v[252:255]
    s_add_u32 s45, s37, 546816
    buffer_load_dwordx4 v[116:119], v2, s[12:15], s45 offen
    s_add_u32 s43, s36, 45056
    s_add_u32 s44, s35, 45056
    buffer_load_dwordx4 v[84:87], v1, s[8:11], s43 offen
    buffer_load_dwordx4 v[88:91], v1, s[8:11], s43 offen offset:256
    buffer_load_dwordx4 v[92:95], v1, s[8:11], s44 offen
    buffer_load_dwordx4 v[96:99], v1, s[8:11], s44 offen offset:256
    s_waitcnt vmcnt(27)
    v_mfma_f32_16x16x32_bf16 v[176:179], v[136:139], v[120:123], v[176:179]
    v_mfma_f32_16x16x32_bf16 v[196:199], v[136:139], v[124:127], v[196:199]
    v_mfma_f32_16x16x32_bf16 v[216:219], v[136:139], v[128:131], v[216:219]
    v_mfma_f32_16x16x32_bf16 v[236:239], v[136:139], v[132:135], v[236:239]
    s_add_u32 s45, s37, 23552
    buffer_load_dwordx4 v[136:139], v2, s[12:15], s45 offen
    v_mfma_f32_16x16x32_bf16 v[180:183], v[140:143], v[120:123], v[180:183]
    v_mfma_f32_16x16x32_bf16 v[200:203], v[140:143], v[124:127], v[200:203]
    v_mfma_f32_16x16x32_bf16 v[220:223], v[140:143], v[128:131], v[220:223]
    v_mfma_f32_16x16x32_bf16 v[240:243], v[140:143], v[132:135], v[240:243]
    s_add_u32 s45, s37, 154624
    buffer_load_dwordx4 v[140:143], v2, s[12:15], s45 offen
    v_mfma_f32_16x16x32_bf16 v[184:187], v[144:147], v[120:123], v[184:187]
    v_mfma_f32_16x16x32_bf16 v[204:207], v[144:147], v[124:127], v[204:207]
    v_mfma_f32_16x16x32_bf16 v[224:227], v[144:147], v[128:131], v[224:227]
    v_mfma_f32_16x16x32_bf16 v[244:247], v[144:147], v[132:135], v[244:247]
    s_add_u32 s45, s37, 285696
    buffer_load_dwordx4 v[144:147], v2, s[12:15], s45 offen
    v_mfma_f32_16x16x32_bf16 v[188:191], v[148:151], v[120:123], v[188:191]
    v_mfma_f32_16x16x32_bf16 v[208:211], v[148:151], v[124:127], v[208:211]
    v_mfma_f32_16x16x32_bf16 v[228:231], v[148:151], v[128:131], v[228:231]
    v_mfma_f32_16x16x32_bf16 v[248:251], v[148:151], v[132:135], v[248:251]
    s_add_u32 s45, s37, 416768
    buffer_load_dwordx4 v[148:151], v2, s[12:15], s45 offen
    v_mfma_f32_16x16x32_bf16 v[192:195], v[152:155], v[120:123], v[192:195]
    v_mfma_f32_16x16x32_bf16 v[212:215], v[152:155], v[124:127], v[212:215]
    v_mfma_f32_16x16x32_bf16 v[232:235], v[152:155], v[128:131], v[232:235]
    v_mfma_f32_16x16x32_bf16 v[252:255], v[152:155], v[132:135], v[252:255]
    s_add_u32 s45, s37, 547840
    buffer_load_dwordx4 v[152:155], v2, s[12:15], s45 offen
    s_add_u32 s43, s36, 47104
    s_add_u32 s44, s35, 47104
    buffer_load_dwordx4 v[120:123], v1, s[8:11], s43 offen
    buffer_load_dwordx4 v[124:127], v1, s[8:11], s43 offen offset:256
    buffer_load_dwordx4 v[128:131], v1, s[8:11], s44 offen
    buffer_load_dwordx4 v[132:135], v1, s[8:11], s44 offen offset:256
    s_waitcnt vmcnt(27)
    v_mfma_f32_16x16x32_bf16 v[176:179], v[28:31], v[12:15], v[176:179]
    v_mfma_f32_16x16x32_bf16 v[196:199], v[28:31], v[16:19], v[196:199]
    v_mfma_f32_16x16x32_bf16 v[216:219], v[28:31], v[20:23], v[216:219]
    v_mfma_f32_16x16x32_bf16 v[236:239], v[28:31], v[24:27], v[236:239]
    s_add_u32 s45, s37, 24576
    buffer_load_dwordx4 v[28:31], v2, s[12:15], s45 offen
    v_mfma_f32_16x16x32_bf16 v[180:183], v[32:35], v[12:15], v[180:183]
    v_mfma_f32_16x16x32_bf16 v[200:203], v[32:35], v[16:19], v[200:203]
    v_mfma_f32_16x16x32_bf16 v[220:223], v[32:35], v[20:23], v[220:223]
    v_mfma_f32_16x16x32_bf16 v[240:243], v[32:35], v[24:27], v[240:243]
    s_add_u32 s45, s37, 155648
    buffer_load_dwordx4 v[32:35], v2, s[12:15], s45 offen
    v_mfma_f32_16x16x32_bf16 v[184:187], v[36:39], v[12:15], v[184:187]
    v_mfma_f32_16x16x32_bf16 v[204:207], v[36:39], v[16:19], v[204:207]
    v_mfma_f32_16x16x32_bf16 v[224:227], v[36:39], v[20:23], v[224:227]
    v_mfma_f32_16x16x32_bf16 v[244:247], v[36:39], v[24:27], v[244:247]
    s_add_u32 s45, s37, 286720
    buffer_load_dwordx4 v[36:39], v2, s[12:15], s45 offen
    v_mfma_f32_16x16x32_bf16 v[188:191], v[40:43], v[12:15], v[188:191]
    v_mfma_f32_16x16x32_bf16 v[208:211], v[40:43], v[16:19], v[208:211]
    v_mfma_f32_16x16x32_bf16 v[228:231], v[40:43], v[20:23], v[228:231]
    v_mfma_f32_16x16x32_bf16 v[248:251], v[40:43], v[24:27], v[248:251]
    s_add_u32 s45, s37, 417792
    buffer_load_dwordx4 v[40:43], v2, s[12:15], s45 offen
    v_mfma_f32_16x16x32_bf16 v[192:195], v[44:47], v[12:15], v[192:195]
    v_mfma_f32_16x16x32_bf16 v[212:215], v[44:47], v[16:19], v[212:215]
    v_mfma_f32_16x16x32_bf16 v[232:235], v[44:47], v[20:23], v[232:235]
    v_mfma_f32_16x16x32_bf16 v[252:255], v[44:47], v[24:27], v[252:255]
    s_add_u32 s45, s37, 548864
    buffer_load_dwordx4 v[44:47], v2, s[12:15], s45 offen
    s_add_u32 s43, s36, 49152
    s_add_u32 s44, s35, 49152
    buffer_load_dwordx4 v[12:15], v1, s[8:11], s43 offen
    buffer_load_dwordx4 v[16:19], v1, s[8:11], s43 offen offset:256
    buffer_load_dwordx4 v[20:23], v1, s[8:11], s44 offen
    buffer_load_dwordx4 v[24:27], v1, s[8:11], s44 offen offset:256
    s_waitcnt vmcnt(27)
    v_mfma_f32_16x16x32_bf16 v[176:179], v[64:67], v[48:51], v[176:179]
    v_mfma_f32_16x16x32_bf16 v[196:199], v[64:67], v[52:55], v[196:199]
    v_mfma_f32_16x16x32_bf16 v[216:219], v[64:67], v[56:59], v[216:219]
    v_mfma_f32_16x16x32_bf16 v[236:239], v[64:67], v[60:63], v[236:239]
    s_add_u32 s45, s37, 25600
    buffer_load_dwordx4 v[64:67], v2, s[12:15], s45 offen
    v_mfma_f32_16x16x32_bf16 v[180:183], v[68:71], v[48:51], v[180:183]
    v_mfma_f32_16x16x32_bf16 v[200:203], v[68:71], v[52:55], v[200:203]
    v_mfma_f32_16x16x32_bf16 v[220:223], v[68:71], v[56:59], v[220:223]
    v_mfma_f32_16x16x32_bf16 v[240:243], v[68:71], v[60:63], v[240:243]
    s_add_u32 s45, s37, 156672
    buffer_load_dwordx4 v[68:71], v2, s[12:15], s45 offen
    v_mfma_f32_16x16x32_bf16 v[184:187], v[72:75], v[48:51], v[184:187]
    v_mfma_f32_16x16x32_bf16 v[204:207], v[72:75], v[52:55], v[204:207]
    v_mfma_f32_16x16x32_bf16 v[224:227], v[72:75], v[56:59], v[224:227]
    v_mfma_f32_16x16x32_bf16 v[244:247], v[72:75], v[60:63], v[244:247]
    s_add_u32 s45, s37, 287744
    buffer_load_dwordx4 v[72:75], v2, s[12:15], s45 offen
    v_mfma_f32_16x16x32_bf16 v[188:191], v[76:79], v[48:51], v[188:191]
    v_mfma_f32_16x16x32_bf16 v[208:211], v[76:79], v[52:55], v[208:211]
    v_mfma_f32_16x16x32_bf16 v[228:231], v[76:79], v[56:59], v[228:231]
    v_mfma_f32_16x16x32_bf16 v[248:251], v[76:79], v[60:63], v[248:251]
    s_add_u32 s45, s37, 418816
    buffer_load_dwordx4 v[76:79], v2, s[12:15], s45 offen
    v_mfma_f32_16x16x32_bf16 v[192:195], v[80:83], v[48:51], v[192:195]
    v_mfma_f32_16x16x32_bf16 v[212:215], v[80:83], v[52:55], v[212:215]
    v_mfma_f32_16x16x32_bf16 v[232:235], v[80:83], v[56:59], v[232:235]
    v_mfma_f32_16x16x32_bf16 v[252:255], v[80:83], v[60:63], v[252:255]
    s_add_u32 s45, s37, 549888
    buffer_load_dwordx4 v[80:83], v2, s[12:15], s45 offen
    s_add_u32 s43, s36, 51200
    s_add_u32 s44, s35, 51200
    buffer_load_dwordx4 v[48:51], v1, s[8:11], s43 offen
    buffer_load_dwordx4 v[52:55], v1, s[8:11], s43 offen offset:256
    buffer_load_dwordx4 v[56:59], v1, s[8:11], s44 offen
    buffer_load_dwordx4 v[60:63], v1, s[8:11], s44 offen offset:256
    s_waitcnt vmcnt(27)
    v_mfma_f32_16x16x32_bf16 v[176:179], v[100:103], v[84:87], v[176:179]
    v_mfma_f32_16x16x32_bf16 v[196:199], v[100:103], v[88:91], v[196:199]
    v_mfma_f32_16x16x32_bf16 v[216:219], v[100:103], v[92:95], v[216:219]
    v_mfma_f32_16x16x32_bf16 v[236:239], v[100:103], v[96:99], v[236:239]
    s_add_u32 s45, s37, 26624
    buffer_load_dwordx4 v[100:103], v2, s[12:15], s45 offen
    v_mfma_f32_16x16x32_bf16 v[180:183], v[104:107], v[84:87], v[180:183]
    v_mfma_f32_16x16x32_bf16 v[200:203], v[104:107], v[88:91], v[200:203]
    v_mfma_f32_16x16x32_bf16 v[220:223], v[104:107], v[92:95], v[220:223]
    v_mfma_f32_16x16x32_bf16 v[240:243], v[104:107], v[96:99], v[240:243]
    s_add_u32 s45, s37, 157696
    buffer_load_dwordx4 v[104:107], v2, s[12:15], s45 offen
    v_mfma_f32_16x16x32_bf16 v[184:187], v[108:111], v[84:87], v[184:187]
    v_mfma_f32_16x16x32_bf16 v[204:207], v[108:111], v[88:91], v[204:207]
    v_mfma_f32_16x16x32_bf16 v[224:227], v[108:111], v[92:95], v[224:227]
    v_mfma_f32_16x16x32_bf16 v[244:247], v[108:111], v[96:99], v[244:247]
    s_add_u32 s45, s37, 288768
    buffer_load_dwordx4 v[108:111], v2, s[12:15], s45 offen
    v_mfma_f32_16x16x32_bf16 v[188:191], v[112:115], v[84:87], v[188:191]
    v_mfma_f32_16x16x32_bf16 v[208:211], v[112:115], v[88:91], v[208:211]
    v_mfma_f32_16x16x32_bf16 v[228:231], v[112:115], v[92:95], v[228:231]
    v_mfma_f32_16x16x32_bf16 v[248:251], v[112:115], v[96:99], v[248:251]
    s_add_u32 s45, s37, 419840
    buffer_load_dwordx4 v[112:115], v2, s[12:15], s45 offen
    v_mfma_f32_16x16x32_bf16 v[192:195], v[116:119], v[84:87], v[192:195]
    v_mfma_f32_16x16x32_bf16 v[212:215], v[116:119], v[88:91], v[212:215]
    v_mfma_f32_16x16x32_bf16 v[232:235], v[116:119], v[92:95], v[232:235]
    v_mfma_f32_16x16x32_bf16 v[252:255], v[116:119], v[96:99], v[252:255]
    s_add_u32 s45, s37, 550912
    buffer_load_dwordx4 v[116:119], v2, s[12:15], s45 offen
    s_add_u32 s43, s36, 53248
    s_add_u32 s44, s35, 53248
    buffer_load_dwordx4 v[84:87], v1, s[8:11], s43 offen
    buffer_load_dwordx4 v[88:91], v1, s[8:11], s43 offen offset:256
    buffer_load_dwordx4 v[92:95], v1, s[8:11], s44 offen
    buffer_load_dwordx4 v[96:99], v1, s[8:11], s44 offen offset:256
    s_waitcnt vmcnt(27)
    v_mfma_f32_16x16x32_bf16 v[176:179], v[136:139], v[120:123], v[176:179]
    v_mfma_f32_16x16x32_bf16 v[196:199], v[136:139], v[124:127], v[196:199]
    v_mfma_f32_16x16x32_bf16 v[216:219], v[136:139], v[128:131], v[216:219]
    v_mfma_f32_16x16x32_bf16 v[236:239], v[136:139], v[132:135], v[236:239]
    s_add_u32 s45, s37, 27648
    buffer_load_dwordx4 v[136:139], v2, s[12:15], s45 offen
    v_mfma_f32_16x16x32_bf16 v[180:183], v[140:143], v[120:123], v[180:183]
    v_mfma_f32_16x16x32_bf16 v[200:203], v[140:143], v[124:127], v[200:203]
    v_mfma_f32_16x16x32_bf16 v[220:223], v[140:143], v[128:131], v[220:223]
    v_mfma_f32_16x16x32_bf16 v[240:243], v[140:143], v[132:135], v[240:243]
    s_add_u32 s45, s37, 158720
    buffer_load_dwordx4 v[140:143], v2, s[12:15], s45 offen
    v_mfma_f32_16x16x32_bf16 v[184:187], v[144:147], v[120:123], v[184:187]
    v_mfma_f32_16x16x32_bf16 v[204:207], v[144:147], v[124:127], v[204:207]
    v_mfma_f32_16x16x32_bf16 v[224:227], v[144:147], v[128:131], v[224:227]
    v_mfma_f32_16x16x32_bf16 v[244:247], v[144:147], v[132:135], v[244:247]
    s_add_u32 s45, s37, 289792
    buffer_load_dwordx4 v[144:147], v2, s[12:15], s45 offen
    v_mfma_f32_16x16x32_bf16 v[188:191], v[148:151], v[120:123], v[188:191]
    v_mfma_f32_16x16x32_bf16 v[208:211], v[148:151], v[124:127], v[208:211]
    v_mfma_f32_16x16x32_bf16 v[228:231], v[148:151], v[128:131], v[228:231]
    v_mfma_f32_16x16x32_bf16 v[248:251], v[148:151], v[132:135], v[248:251]
    s_add_u32 s45, s37, 420864
    buffer_load_dwordx4 v[148:151], v2, s[12:15], s45 offen
    v_mfma_f32_16x16x32_bf16 v[192:195], v[152:155], v[120:123], v[192:195]
    v_mfma_f32_16x16x32_bf16 v[212:215], v[152:155], v[124:127], v[212:215]
    v_mfma_f32_16x16x32_bf16 v[232:235], v[152:155], v[128:131], v[232:235]
    v_mfma_f32_16x16x32_bf16 v[252:255], v[152:155], v[132:135], v[252:255]
    s_add_u32 s45, s37, 551936
    buffer_load_dwordx4 v[152:155], v2, s[12:15], s45 offen
    s_add_u32 s43, s36, 55296
    s_add_u32 s44, s35, 55296
    buffer_load_dwordx4 v[120:123], v1, s[8:11], s43 offen
    buffer_load_dwordx4 v[124:127], v1, s[8:11], s43 offen offset:256
    buffer_load_dwordx4 v[128:131], v1, s[8:11], s44 offen
    buffer_load_dwordx4 v[132:135], v1, s[8:11], s44 offen offset:256
    s_waitcnt vmcnt(27)
    v_mfma_f32_16x16x32_bf16 v[176:179], v[28:31], v[12:15], v[176:179]
    v_mfma_f32_16x16x32_bf16 v[196:199], v[28:31], v[16:19], v[196:199]
    v_mfma_f32_16x16x32_bf16 v[216:219], v[28:31], v[20:23], v[216:219]
    v_mfma_f32_16x16x32_bf16 v[236:239], v[28:31], v[24:27], v[236:239]
    s_add_u32 s45, s37, 28672
    buffer_load_dwordx4 v[28:31], v2, s[12:15], s45 offen
    v_mfma_f32_16x16x32_bf16 v[180:183], v[32:35], v[12:15], v[180:183]
    v_mfma_f32_16x16x32_bf16 v[200:203], v[32:35], v[16:19], v[200:203]
    v_mfma_f32_16x16x32_bf16 v[220:223], v[32:35], v[20:23], v[220:223]
    v_mfma_f32_16x16x32_bf16 v[240:243], v[32:35], v[24:27], v[240:243]
    s_add_u32 s45, s37, 159744
    buffer_load_dwordx4 v[32:35], v2, s[12:15], s45 offen
    v_mfma_f32_16x16x32_bf16 v[184:187], v[36:39], v[12:15], v[184:187]
    v_mfma_f32_16x16x32_bf16 v[204:207], v[36:39], v[16:19], v[204:207]
    v_mfma_f32_16x16x32_bf16 v[224:227], v[36:39], v[20:23], v[224:227]
    v_mfma_f32_16x16x32_bf16 v[244:247], v[36:39], v[24:27], v[244:247]
    s_add_u32 s45, s37, 290816
    buffer_load_dwordx4 v[36:39], v2, s[12:15], s45 offen
    v_mfma_f32_16x16x32_bf16 v[188:191], v[40:43], v[12:15], v[188:191]
    v_mfma_f32_16x16x32_bf16 v[208:211], v[40:43], v[16:19], v[208:211]
    v_mfma_f32_16x16x32_bf16 v[228:231], v[40:43], v[20:23], v[228:231]
    v_mfma_f32_16x16x32_bf16 v[248:251], v[40:43], v[24:27], v[248:251]
    s_add_u32 s45, s37, 421888
    buffer_load_dwordx4 v[40:43], v2, s[12:15], s45 offen
    v_mfma_f32_16x16x32_bf16 v[192:195], v[44:47], v[12:15], v[192:195]
    v_mfma_f32_16x16x32_bf16 v[212:215], v[44:47], v[16:19], v[212:215]
    v_mfma_f32_16x16x32_bf16 v[232:235], v[44:47], v[20:23], v[232:235]
    v_mfma_f32_16x16x32_bf16 v[252:255], v[44:47], v[24:27], v[252:255]
    s_add_u32 s45, s37, 552960
    buffer_load_dwordx4 v[44:47], v2, s[12:15], s45 offen
    s_add_u32 s43, s36, 57344
    s_add_u32 s44, s35, 57344
    buffer_load_dwordx4 v[12:15], v1, s[8:11], s43 offen
    buffer_load_dwordx4 v[16:19], v1, s[8:11], s43 offen offset:256
    buffer_load_dwordx4 v[20:23], v1, s[8:11], s44 offen
    buffer_load_dwordx4 v[24:27], v1, s[8:11], s44 offen offset:256
    s_waitcnt vmcnt(27)
    v_mfma_f32_16x16x32_bf16 v[176:179], v[64:67], v[48:51], v[176:179]
    v_mfma_f32_16x16x32_bf16 v[196:199], v[64:67], v[52:55], v[196:199]
    v_mfma_f32_16x16x32_bf16 v[216:219], v[64:67], v[56:59], v[216:219]
    v_mfma_f32_16x16x32_bf16 v[236:239], v[64:67], v[60:63], v[236:239]
    s_add_u32 s45, s37, 29696
    buffer_load_dwordx4 v[64:67], v2, s[12:15], s45 offen
    v_mfma_f32_16x16x32_bf16 v[180:183], v[68:71], v[48:51], v[180:183]
    v_mfma_f32_16x16x32_bf16 v[200:203], v[68:71], v[52:55], v[200:203]
    v_mfma_f32_16x16x32_bf16 v[220:223], v[68:71], v[56:59], v[220:223]
    v_mfma_f32_16x16x32_bf16 v[240:243], v[68:71], v[60:63], v[240:243]
    s_add_u32 s45, s37, 160768
    buffer_load_dwordx4 v[68:71], v2, s[12:15], s45 offen
    v_mfma_f32_16x16x32_bf16 v[184:187], v[72:75], v[48:51], v[184:187]
    v_mfma_f32_16x16x32_bf16 v[204:207], v[72:75], v[52:55], v[204:207]
    v_mfma_f32_16x16x32_bf16 v[224:227], v[72:75], v[56:59], v[224:227]
    v_mfma_f32_16x16x32_bf16 v[244:247], v[72:75], v[60:63], v[244:247]
    s_add_u32 s45, s37, 291840
    buffer_load_dwordx4 v[72:75], v2, s[12:15], s45 offen
    v_mfma_f32_16x16x32_bf16 v[188:191], v[76:79], v[48:51], v[188:191]
    v_mfma_f32_16x16x32_bf16 v[208:211], v[76:79], v[52:55], v[208:211]
    v_mfma_f32_16x16x32_bf16 v[228:231], v[76:79], v[56:59], v[228:231]
    v_mfma_f32_16x16x32_bf16 v[248:251], v[76:79], v[60:63], v[248:251]
    s_add_u32 s45, s37, 422912
    buffer_load_dwordx4 v[76:79], v2, s[12:15], s45 offen
    v_mfma_f32_16x16x32_bf16 v[192:195], v[80:83], v[48:51], v[192:195]
    v_mfma_f32_16x16x32_bf16 v[212:215], v[80:83], v[52:55], v[212:215]
    v_mfma_f32_16x16x32_bf16 v[232:235], v[80:83], v[56:59], v[232:235]
    v_mfma_f32_16x16x32_bf16 v[252:255], v[80:83], v[60:63], v[252:255]
    s_add_u32 s45, s37, 553984
    buffer_load_dwordx4 v[80:83], v2, s[12:15], s45 offen
    s_add_u32 s43, s36, 59392
    s_add_u32 s44, s35, 59392
    buffer_load_dwordx4 v[48:51], v1, s[8:11], s43 offen
    buffer_load_dwordx4 v[52:55], v1, s[8:11], s43 offen offset:256
    buffer_load_dwordx4 v[56:59], v1, s[8:11], s44 offen
    buffer_load_dwordx4 v[60:63], v1, s[8:11], s44 offen offset:256
    s_waitcnt vmcnt(27)
    v_mfma_f32_16x16x32_bf16 v[176:179], v[100:103], v[84:87], v[176:179]
    v_mfma_f32_16x16x32_bf16 v[196:199], v[100:103], v[88:91], v[196:199]
    v_mfma_f32_16x16x32_bf16 v[216:219], v[100:103], v[92:95], v[216:219]
    v_mfma_f32_16x16x32_bf16 v[236:239], v[100:103], v[96:99], v[236:239]
    s_add_u32 s45, s37, 30720
    buffer_load_dwordx4 v[100:103], v2, s[12:15], s45 offen
    v_mfma_f32_16x16x32_bf16 v[180:183], v[104:107], v[84:87], v[180:183]
    v_mfma_f32_16x16x32_bf16 v[200:203], v[104:107], v[88:91], v[200:203]
    v_mfma_f32_16x16x32_bf16 v[220:223], v[104:107], v[92:95], v[220:223]
    v_mfma_f32_16x16x32_bf16 v[240:243], v[104:107], v[96:99], v[240:243]
    s_add_u32 s45, s37, 161792
    buffer_load_dwordx4 v[104:107], v2, s[12:15], s45 offen
    v_mfma_f32_16x16x32_bf16 v[184:187], v[108:111], v[84:87], v[184:187]
    v_mfma_f32_16x16x32_bf16 v[204:207], v[108:111], v[88:91], v[204:207]
    v_mfma_f32_16x16x32_bf16 v[224:227], v[108:111], v[92:95], v[224:227]
    v_mfma_f32_16x16x32_bf16 v[244:247], v[108:111], v[96:99], v[244:247]
    s_add_u32 s45, s37, 292864
    buffer_load_dwordx4 v[108:111], v2, s[12:15], s45 offen
    v_mfma_f32_16x16x32_bf16 v[188:191], v[112:115], v[84:87], v[188:191]
    v_mfma_f32_16x16x32_bf16 v[208:211], v[112:115], v[88:91], v[208:211]
    v_mfma_f32_16x16x32_bf16 v[228:231], v[112:115], v[92:95], v[228:231]
    v_mfma_f32_16x16x32_bf16 v[248:251], v[112:115], v[96:99], v[248:251]
    s_add_u32 s45, s37, 423936
    buffer_load_dwordx4 v[112:115], v2, s[12:15], s45 offen
    v_mfma_f32_16x16x32_bf16 v[192:195], v[116:119], v[84:87], v[192:195]
    v_mfma_f32_16x16x32_bf16 v[212:215], v[116:119], v[88:91], v[212:215]
    v_mfma_f32_16x16x32_bf16 v[232:235], v[116:119], v[92:95], v[232:235]
    v_mfma_f32_16x16x32_bf16 v[252:255], v[116:119], v[96:99], v[252:255]
    s_add_u32 s45, s37, 555008
    buffer_load_dwordx4 v[116:119], v2, s[12:15], s45 offen
    s_add_u32 s43, s36, 61440
    s_add_u32 s44, s35, 61440
    buffer_load_dwordx4 v[84:87], v1, s[8:11], s43 offen
    buffer_load_dwordx4 v[88:91], v1, s[8:11], s43 offen offset:256
    buffer_load_dwordx4 v[92:95], v1, s[8:11], s44 offen
    buffer_load_dwordx4 v[96:99], v1, s[8:11], s44 offen offset:256
    s_waitcnt vmcnt(27)
    v_mfma_f32_16x16x32_bf16 v[176:179], v[136:139], v[120:123], v[176:179]
    v_mfma_f32_16x16x32_bf16 v[196:199], v[136:139], v[124:127], v[196:199]
    v_mfma_f32_16x16x32_bf16 v[216:219], v[136:139], v[128:131], v[216:219]
    v_mfma_f32_16x16x32_bf16 v[236:239], v[136:139], v[132:135], v[236:239]
    s_add_u32 s45, s37, 31744
    buffer_load_dwordx4 v[136:139], v2, s[12:15], s45 offen
    v_mfma_f32_16x16x32_bf16 v[180:183], v[140:143], v[120:123], v[180:183]
    v_mfma_f32_16x16x32_bf16 v[200:203], v[140:143], v[124:127], v[200:203]
    v_mfma_f32_16x16x32_bf16 v[220:223], v[140:143], v[128:131], v[220:223]
    v_mfma_f32_16x16x32_bf16 v[240:243], v[140:143], v[132:135], v[240:243]
    s_add_u32 s45, s37, 162816
    buffer_load_dwordx4 v[140:143], v2, s[12:15], s45 offen
    v_mfma_f32_16x16x32_bf16 v[184:187], v[144:147], v[120:123], v[184:187]
    v_mfma_f32_16x16x32_bf16 v[204:207], v[144:147], v[124:127], v[204:207]
    v_mfma_f32_16x16x32_bf16 v[224:227], v[144:147], v[128:131], v[224:227]
    v_mfma_f32_16x16x32_bf16 v[244:247], v[144:147], v[132:135], v[244:247]
    s_add_u32 s45, s37, 293888
    buffer_load_dwordx4 v[144:147], v2, s[12:15], s45 offen
    v_mfma_f32_16x16x32_bf16 v[188:191], v[148:151], v[120:123], v[188:191]
    v_mfma_f32_16x16x32_bf16 v[208:211], v[148:151], v[124:127], v[208:211]
    v_mfma_f32_16x16x32_bf16 v[228:231], v[148:151], v[128:131], v[228:231]
    v_mfma_f32_16x16x32_bf16 v[248:251], v[148:151], v[132:135], v[248:251]
    s_add_u32 s45, s37, 424960
    buffer_load_dwordx4 v[148:151], v2, s[12:15], s45 offen
    v_mfma_f32_16x16x32_bf16 v[192:195], v[152:155], v[120:123], v[192:195]
    v_mfma_f32_16x16x32_bf16 v[212:215], v[152:155], v[124:127], v[212:215]
    v_mfma_f32_16x16x32_bf16 v[232:235], v[152:155], v[128:131], v[232:235]
    v_mfma_f32_16x16x32_bf16 v[252:255], v[152:155], v[132:135], v[252:255]
    s_add_u32 s45, s37, 556032
    buffer_load_dwordx4 v[152:155], v2, s[12:15], s45 offen
    s_add_u32 s43, s36, 63488
    s_add_u32 s44, s35, 63488
    buffer_load_dwordx4 v[120:123], v1, s[8:11], s43 offen
    buffer_load_dwordx4 v[124:127], v1, s[8:11], s43 offen offset:256
    buffer_load_dwordx4 v[128:131], v1, s[8:11], s44 offen
    buffer_load_dwordx4 v[132:135], v1, s[8:11], s44 offen offset:256
    s_waitcnt vmcnt(27)
    v_mfma_f32_16x16x32_bf16 v[176:179], v[28:31], v[12:15], v[176:179]
    v_mfma_f32_16x16x32_bf16 v[196:199], v[28:31], v[16:19], v[196:199]
    v_mfma_f32_16x16x32_bf16 v[216:219], v[28:31], v[20:23], v[216:219]
    v_mfma_f32_16x16x32_bf16 v[236:239], v[28:31], v[24:27], v[236:239]
    v_mfma_f32_16x16x32_bf16 v[180:183], v[32:35], v[12:15], v[180:183]
    v_mfma_f32_16x16x32_bf16 v[200:203], v[32:35], v[16:19], v[200:203]
    v_mfma_f32_16x16x32_bf16 v[220:223], v[32:35], v[20:23], v[220:223]
    v_mfma_f32_16x16x32_bf16 v[240:243], v[32:35], v[24:27], v[240:243]
    v_mfma_f32_16x16x32_bf16 v[184:187], v[36:39], v[12:15], v[184:187]
    v_mfma_f32_16x16x32_bf16 v[204:207], v[36:39], v[16:19], v[204:207]
    v_mfma_f32_16x16x32_bf16 v[224:227], v[36:39], v[20:23], v[224:227]
    v_mfma_f32_16x16x32_bf16 v[244:247], v[36:39], v[24:27], v[244:247]
    v_mfma_f32_16x16x32_bf16 v[188:191], v[40:43], v[12:15], v[188:191]
    v_mfma_f32_16x16x32_bf16 v[208:211], v[40:43], v[16:19], v[208:211]
    v_mfma_f32_16x16x32_bf16 v[228:231], v[40:43], v[20:23], v[228:231]
    v_mfma_f32_16x16x32_bf16 v[248:251], v[40:43], v[24:27], v[248:251]
    v_mfma_f32_16x16x32_bf16 v[192:195], v[44:47], v[12:15], v[192:195]
    v_mfma_f32_16x16x32_bf16 v[212:215], v[44:47], v[16:19], v[212:215]
    v_mfma_f32_16x16x32_bf16 v[232:235], v[44:47], v[20:23], v[232:235]
    v_mfma_f32_16x16x32_bf16 v[252:255], v[44:47], v[24:27], v[252:255]
    s_waitcnt vmcnt(18)
    v_mfma_f32_16x16x32_bf16 v[176:179], v[64:67], v[48:51], v[176:179]
    v_mfma_f32_16x16x32_bf16 v[196:199], v[64:67], v[52:55], v[196:199]
    v_mfma_f32_16x16x32_bf16 v[216:219], v[64:67], v[56:59], v[216:219]
    v_mfma_f32_16x16x32_bf16 v[236:239], v[64:67], v[60:63], v[236:239]
    v_mfma_f32_16x16x32_bf16 v[180:183], v[68:71], v[48:51], v[180:183]
    v_mfma_f32_16x16x32_bf16 v[200:203], v[68:71], v[52:55], v[200:203]
    v_mfma_f32_16x16x32_bf16 v[220:223], v[68:71], v[56:59], v[220:223]
    v_mfma_f32_16x16x32_bf16 v[240:243], v[68:71], v[60:63], v[240:243]
    v_mfma_f32_16x16x32_bf16 v[184:187], v[72:75], v[48:51], v[184:187]
    v_mfma_f32_16x16x32_bf16 v[204:207], v[72:75], v[52:55], v[204:207]
    v_mfma_f32_16x16x32_bf16 v[224:227], v[72:75], v[56:59], v[224:227]
    v_mfma_f32_16x16x32_bf16 v[244:247], v[72:75], v[60:63], v[244:247]
    v_mfma_f32_16x16x32_bf16 v[188:191], v[76:79], v[48:51], v[188:191]
    v_mfma_f32_16x16x32_bf16 v[208:211], v[76:79], v[52:55], v[208:211]
    v_mfma_f32_16x16x32_bf16 v[228:231], v[76:79], v[56:59], v[228:231]
    v_mfma_f32_16x16x32_bf16 v[248:251], v[76:79], v[60:63], v[248:251]
    v_mfma_f32_16x16x32_bf16 v[192:195], v[80:83], v[48:51], v[192:195]
    v_mfma_f32_16x16x32_bf16 v[212:215], v[80:83], v[52:55], v[212:215]
    v_mfma_f32_16x16x32_bf16 v[232:235], v[80:83], v[56:59], v[232:235]
    v_mfma_f32_16x16x32_bf16 v[252:255], v[80:83], v[60:63], v[252:255]
    s_waitcnt vmcnt(9)
    v_mfma_f32_16x16x32_bf16 v[176:179], v[100:103], v[84:87], v[176:179]
    v_mfma_f32_16x16x32_bf16 v[196:199], v[100:103], v[88:91], v[196:199]
    v_mfma_f32_16x16x32_bf16 v[216:219], v[100:103], v[92:95], v[216:219]
    v_mfma_f32_16x16x32_bf16 v[236:239], v[100:103], v[96:99], v[236:239]
    v_mfma_f32_16x16x32_bf16 v[180:183], v[104:107], v[84:87], v[180:183]
    v_mfma_f32_16x16x32_bf16 v[200:203], v[104:107], v[88:91], v[200:203]
    v_mfma_f32_16x16x32_bf16 v[220:223], v[104:107], v[92:95], v[220:223]
    v_mfma_f32_16x16x32_bf16 v[240:243], v[104:107], v[96:99], v[240:243]
    v_mfma_f32_16x16x32_bf16 v[184:187], v[108:111], v[84:87], v[184:187]
    v_mfma_f32_16x16x32_bf16 v[204:207], v[108:111], v[88:91], v[204:207]
    v_mfma_f32_16x16x32_bf16 v[224:227], v[108:111], v[92:95], v[224:227]
    v_mfma_f32_16x16x32_bf16 v[244:247], v[108:111], v[96:99], v[244:247]
    v_mfma_f32_16x16x32_bf16 v[188:191], v[112:115], v[84:87], v[188:191]
    v_mfma_f32_16x16x32_bf16 v[208:211], v[112:115], v[88:91], v[208:211]
    v_mfma_f32_16x16x32_bf16 v[228:231], v[112:115], v[92:95], v[228:231]
    v_mfma_f32_16x16x32_bf16 v[248:251], v[112:115], v[96:99], v[248:251]
    v_mfma_f32_16x16x32_bf16 v[192:195], v[116:119], v[84:87], v[192:195]
    v_mfma_f32_16x16x32_bf16 v[212:215], v[116:119], v[88:91], v[212:215]
    v_mfma_f32_16x16x32_bf16 v[232:235], v[116:119], v[92:95], v[232:235]
    v_mfma_f32_16x16x32_bf16 v[252:255], v[116:119], v[96:99], v[252:255]
    s_waitcnt vmcnt(0)
    v_mfma_f32_16x16x32_bf16 v[176:179], v[136:139], v[120:123], v[176:179]
    v_mfma_f32_16x16x32_bf16 v[196:199], v[136:139], v[124:127], v[196:199]
    v_mfma_f32_16x16x32_bf16 v[216:219], v[136:139], v[128:131], v[216:219]
    v_mfma_f32_16x16x32_bf16 v[236:239], v[136:139], v[132:135], v[236:239]
    v_mfma_f32_16x16x32_bf16 v[180:183], v[140:143], v[120:123], v[180:183]
    v_mfma_f32_16x16x32_bf16 v[200:203], v[140:143], v[124:127], v[200:203]
    v_mfma_f32_16x16x32_bf16 v[220:223], v[140:143], v[128:131], v[220:223]
    v_mfma_f32_16x16x32_bf16 v[240:243], v[140:143], v[132:135], v[240:243]
    v_mfma_f32_16x16x32_bf16 v[184:187], v[144:147], v[120:123], v[184:187]
    v_mfma_f32_16x16x32_bf16 v[204:207], v[144:147], v[124:127], v[204:207]
    v_mfma_f32_16x16x32_bf16 v[224:227], v[144:147], v[128:131], v[224:227]
    v_mfma_f32_16x16x32_bf16 v[244:247], v[144:147], v[132:135], v[244:247]
    v_mfma_f32_16x16x32_bf16 v[188:191], v[148:151], v[120:123], v[188:191]
    v_mfma_f32_16x16x32_bf16 v[208:211], v[148:151], v[124:127], v[208:211]
    v_mfma_f32_16x16x32_bf16 v[228:231], v[148:151], v[128:131], v[228:231]
    v_mfma_f32_16x16x32_bf16 v[248:251], v[148:151], v[132:135], v[248:251]
    v_mfma_f32_16x16x32_bf16 v[192:195], v[152:155], v[120:123], v[192:195]
    v_mfma_f32_16x16x32_bf16 v[212:215], v[152:155], v[124:127], v[212:215]
    v_mfma_f32_16x16x32_bf16 v[232:235], v[152:155], v[128:131], v[232:235]
    v_mfma_f32_16x16x32_bf16 v[252:255], v[152:155], v[132:135], v[252:255]
    v_lshrrev_b32 v4, 2, v9
    v_and_b32 v5, 3, v9
    s_lshl_b32 s40, s30, 6
    v_add_u32 v10, s40, v4
    s_mul_i32 s41, s31, 80
    v_mul_u32_u24 v11, 20, v5
    v_add_u32 v11, s41, v11
    v_add_u32 v6, 0, v11
    v_lshrrev_b32 v52, 5, v10
    v_mul_u32_u24 v52, 40, v52
    v_lshrrev_b32 v7, 4, v6
    v_add_u32 v52, v52, v7
    v_lshlrev_b32 v52, 10, v52
    v_and_b32 v7, 31, v10
    v_lshl_add_u32 v52, v7, 4, v52
    v_lshrrev_b32 v7, 3, v6
    v_and_b32 v7, 1, v7
    v_lshl_add_u32 v52, v7, 9, v52
    v_and_b32 v7, 7, v6
    v_lshl_add_u32 v52, v7, 1, v52
    v_add_u32 v6, 4, v11
    v_lshrrev_b32 v53, 5, v10
    v_mul_u32_u24 v53, 40, v53
    v_lshrrev_b32 v7, 4, v6
    v_add_u32 v53, v53, v7
    v_lshlrev_b32 v53, 10, v53
    v_and_b32 v7, 31, v10
    v_lshl_add_u32 v53, v7, 4, v53
    v_lshrrev_b32 v7, 3, v6
    v_and_b32 v7, 1, v7
    v_lshl_add_u32 v53, v7, 9, v53
    v_and_b32 v7, 7, v6
    v_lshl_add_u32 v53, v7, 1, v53
    v_add_u32 v6, 8, v11
    v_lshrrev_b32 v54, 5, v10
    v_mul_u32_u24 v54, 40, v54
    v_lshrrev_b32 v7, 4, v6
    v_add_u32 v54, v54, v7
    v_lshlrev_b32 v54, 10, v54
    v_and_b32 v7, 31, v10
    v_lshl_add_u32 v54, v7, 4, v54
    v_lshrrev_b32 v7, 3, v6
    v_and_b32 v7, 1, v7
    v_lshl_add_u32 v54, v7, 9, v54
    v_and_b32 v7, 7, v6
    v_lshl_add_u32 v54, v7, 1, v54
    v_add_u32 v6, 12, v11
    v_lshrrev_b32 v55, 5, v10
    v_mul_u32_u24 v55, 40, v55
    v_lshrrev_b32 v7, 4, v6
    v_add_u32 v55, v55, v7
    v_lshlrev_b32 v55, 10, v55
    v_and_b32 v7, 31, v10
    v_lshl_add_u32 v55, v7, 4, v55
    v_lshrrev_b32 v7, 3, v6
    v_and_b32 v7, 1, v7
    v_lshl_add_u32 v55, v7, 9, v55
    v_and_b32 v7, 7, v6
    v_lshl_add_u32 v55, v7, 1, v55
    v_add_u32 v6, 16, v11
    v_lshrrev_b32 v56, 5, v10
    v_mul_u32_u24 v56, 40, v56
    v_lshrrev_b32 v7, 4, v6
    v_add_u32 v56, v56, v7
    v_lshlrev_b32 v56, 10, v56
    v_and_b32 v7, 31, v10
    v_lshl_add_u32 v56, v7, 4, v56
    v_lshrrev_b32 v7, 3, v6
    v_and_b32 v7, 1, v7
    v_lshl_add_u32 v56, v7, 9, v56
    v_and_b32 v7, 7, v6
    v_lshl_add_u32 v56, v7, 1, v56
    v_mul_u32_u24 v57, 1280, v10
    v_lshl_add_u32 v57, v11, 1, v57
    s_add_u32 s16, s6, 81788928
    s_addc_u32 s17, s7, 0
    s_mov_b32 s18, 2621440
    s_mov_b32 s19, 0x00020000
    s_mov_b32 s20, s24
    s_mov_b32 s21, s25
    s_mov_b32 s22, 2621440
    s_mov_b32 s23, 0x00020000
    s_add_u32 s44, s6, 75497472
    s_addc_u32 s45, s7, 0
    s_mov_b32 s46, 131072
    s_mov_b32 s47, 0x00020000
    buffer_load_dwordx2 v[58:59], v57, s[20:23], 0 offen offset:0
    buffer_load_dwordx2 v[60:61], v57, s[20:23], 0 offen offset:8
    buffer_load_dwordx2 v[62:63], v57, s[20:23], 0 offen offset:16
    buffer_load_dwordx2 v[64:65], v57, s[20:23], 0 offen offset:24
    buffer_load_dwordx2 v[66:67], v57, s[20:23], 0 offen offset:32
    v_and_b32 v6, 15, v0
    v_mul_u32_u24 v6, 336, v6
    v_lshrrev_b32 v7, 4, v0
    v_lshl_add_u32 v6, v7, 4, v6
    s_mul_i32 s40, s3, 22016
    v_add_u32 v6, s40, v6
    ds_write_b128 v6, v[176:179] offset:0
    ds_write_b128 v6, v[180:183] offset:64
    ds_write_b128 v6, v[184:187] offset:128
    ds_write_b128 v6, v[188:191] offset:192
    ds_write_b128 v6, v[192:195] offset:256
    ds_write_b128 v6, v[196:199] offset:5376
    ds_write_b128 v6, v[200:203] offset:5440
    ds_write_b128 v6, v[204:207] offset:5504
    ds_write_b128 v6, v[208:211] offset:5568
    ds_write_b128 v6, v[212:215] offset:5632
    ds_write_b128 v6, v[216:219] offset:10752
    ds_write_b128 v6, v[220:223] offset:10816
    ds_write_b128 v6, v[224:227] offset:10880
    ds_write_b128 v6, v[228:231] offset:10944
    ds_write_b128 v6, v[232:235] offset:11008
    ds_write_b128 v6, v[236:239] offset:16128
    ds_write_b128 v6, v[240:243] offset:16192
    ds_write_b128 v6, v[244:247] offset:16256
    ds_write_b128 v6, v[248:251] offset:16320
    ds_write_b128 v6, v[252:255] offset:16384
    s_waitcnt lgkmcnt(0)
    s_barrier
    v_mul_u32_u24 v6, 336, v4
    v_mul_u32_u24 v7, 80, v5
    v_add_u32 v6, v6, v7
    ds_read_b128 v[12:15], v6 offset:0
    ds_read_b128 v[16:19], v6 offset:16
    ds_read_b128 v[20:23], v6 offset:32
    ds_read_b128 v[24:27], v6 offset:48
    ds_read_b128 v[28:31], v6 offset:64
    ds_read_b128 v[32:35], v6 offset:22016
    ds_read_b128 v[36:39], v6 offset:22032
    ds_read_b128 v[40:43], v6 offset:22048
    ds_read_b128 v[44:47], v6 offset:22064
    ds_read_b128 v[48:51], v6 offset:22080
    s_waitcnt lgkmcnt(4)
    v_add_f32 v12, v12, v32
    v_add_f32 v13, v13, v33
    v_add_f32 v14, v14, v34
    v_add_f32 v15, v15, v35
    s_waitcnt lgkmcnt(3)
    v_add_f32 v16, v16, v36
    v_add_f32 v17, v17, v37
    v_add_f32 v18, v18, v38
    v_add_f32 v19, v19, v39
    s_waitcnt lgkmcnt(2)
    v_add_f32 v20, v20, v40
    v_add_f32 v21, v21, v41
    v_add_f32 v22, v22, v42
    v_add_f32 v23, v23, v43
    s_waitcnt lgkmcnt(1)
    v_add_f32 v24, v24, v44
    v_add_f32 v25, v25, v45
    v_add_f32 v26, v26, v46
    v_add_f32 v27, v27, v47
    s_waitcnt lgkmcnt(0)
    v_add_f32 v28, v28, v48
    v_add_f32 v29, v29, v49
    v_add_f32 v30, v30, v50
    v_add_f32 v31, v31, v51
    ds_read_b128 v[32:35], v6 offset:44032
    ds_read_b128 v[36:39], v6 offset:44048
    ds_read_b128 v[40:43], v6 offset:44064
    ds_read_b128 v[44:47], v6 offset:44080
    ds_read_b128 v[48:51], v6 offset:44096
    s_waitcnt lgkmcnt(4)
    v_add_f32 v12, v12, v32
    v_add_f32 v13, v13, v33
    v_add_f32 v14, v14, v34
    v_add_f32 v15, v15, v35
    s_waitcnt lgkmcnt(3)
    v_add_f32 v16, v16, v36
    v_add_f32 v17, v17, v37
    v_add_f32 v18, v18, v38
    v_add_f32 v19, v19, v39
    s_waitcnt lgkmcnt(2)
    v_add_f32 v20, v20, v40
    v_add_f32 v21, v21, v41
    v_add_f32 v22, v22, v42
    v_add_f32 v23, v23, v43
    s_waitcnt lgkmcnt(1)
    v_add_f32 v24, v24, v44
    v_add_f32 v25, v25, v45
    v_add_f32 v26, v26, v46
    v_add_f32 v27, v27, v47
    s_waitcnt lgkmcnt(0)
    v_add_f32 v28, v28, v48
    v_add_f32 v29, v29, v49
    v_add_f32 v30, v30, v50
    v_add_f32 v31, v31, v51
    v_add_u32 v7, 66048, v6
    ds_read_b128 v[32:35], v7 offset:0
    ds_read_b128 v[36:39], v7 offset:16
    ds_read_b128 v[40:43], v7 offset:32
    ds_read_b128 v[44:47], v7 offset:48
    ds_read_b128 v[48:51], v7 offset:64
    s_waitcnt lgkmcnt(4)
    v_add_f32 v12, v12, v32
    v_add_f32 v13, v13, v33
    v_add_f32 v14, v14, v34
    v_add_f32 v15, v15, v35
    s_waitcnt lgkmcnt(3)
    v_add_f32 v16, v16, v36
    v_add_f32 v17, v17, v37
    v_add_f32 v18, v18, v38
    v_add_f32 v19, v19, v39
    s_waitcnt lgkmcnt(2)
    v_add_f32 v20, v20, v40
    v_add_f32 v21, v21, v41
    v_add_f32 v22, v22, v42
    v_add_f32 v23, v23, v43
    s_waitcnt lgkmcnt(1)
    v_add_f32 v24, v24, v44
    v_add_f32 v25, v25, v45
    v_add_f32 v26, v26, v46
    v_add_f32 v27, v27, v47
    s_waitcnt lgkmcnt(0)
    v_add_f32 v28, v28, v48
    v_add_f32 v29, v29, v49
    v_add_f32 v30, v30, v50
    v_add_f32 v31, v31, v51
    s_waitcnt vmcnt(4)
    v_lshlrev_b32 v6, 16, v58
    v_add_f32 v12, v12, v6
    v_and_b32 v7, 0xffff0000, v58
    v_add_f32 v13, v13, v7
    v_lshlrev_b32 v6, 16, v59
    v_add_f32 v14, v14, v6
    v_and_b32 v7, 0xffff0000, v59
    v_add_f32 v15, v15, v7
    s_waitcnt vmcnt(3)
    v_lshlrev_b32 v6, 16, v60
    v_add_f32 v16, v16, v6
    v_and_b32 v7, 0xffff0000, v60
    v_add_f32 v17, v17, v7
    v_lshlrev_b32 v6, 16, v61
    v_add_f32 v18, v18, v6
    v_and_b32 v7, 0xffff0000, v61
    v_add_f32 v19, v19, v7
    s_waitcnt vmcnt(2)
    v_lshlrev_b32 v6, 16, v62
    v_add_f32 v20, v20, v6
    v_and_b32 v7, 0xffff0000, v62
    v_add_f32 v21, v21, v7
    v_lshlrev_b32 v6, 16, v63
    v_add_f32 v22, v22, v6
    v_and_b32 v7, 0xffff0000, v63
    v_add_f32 v23, v23, v7
    s_waitcnt vmcnt(1)
    v_lshlrev_b32 v6, 16, v64
    v_add_f32 v24, v24, v6
    v_and_b32 v7, 0xffff0000, v64
    v_add_f32 v25, v25, v7
    v_lshlrev_b32 v6, 16, v65
    v_add_f32 v26, v26, v6
    v_and_b32 v7, 0xffff0000, v65
    v_add_f32 v27, v27, v7
    s_waitcnt vmcnt(0)
    v_lshlrev_b32 v6, 16, v66
    v_add_f32 v28, v28, v6
    v_and_b32 v7, 0xffff0000, v66
    v_add_f32 v29, v29, v7
    v_lshlrev_b32 v6, 16, v67
    v_add_f32 v30, v30, v6
    v_and_b32 v7, 0xffff0000, v67
    v_add_f32 v31, v31, v7
    v_cvt_pk_bf16_f32 v32, v12, v13
    v_cvt_pk_bf16_f32 v33, v14, v15
    v_cvt_pk_bf16_f32 v34, v16, v17
    v_cvt_pk_bf16_f32 v35, v18, v19
    v_cvt_pk_bf16_f32 v36, v20, v21
    v_cvt_pk_bf16_f32 v37, v22, v23
    v_cvt_pk_bf16_f32 v38, v24, v25
    v_cvt_pk_bf16_f32 v39, v26, v27
    v_cvt_pk_bf16_f32 v40, v28, v29
    v_cvt_pk_bf16_f32 v41, v30, v31
    buffer_store_dwordx2 v[32:33], v52, s[16:19], 0 offen
    buffer_store_dwordx2 v[34:35], v53, s[16:19], 0 offen
    buffer_store_dwordx2 v[36:37], v54, s[16:19], 0 offen
    buffer_store_dwordx2 v[38:39], v55, s[16:19], 0 offen
    buffer_store_dwordx2 v[40:41], v56, s[16:19], 0 offen
    v_lshlrev_b32 v12, 16, v32
    v_and_b32 v13, 0xffff0000, v32
    v_lshlrev_b32 v14, 16, v33
    v_and_b32 v15, 0xffff0000, v33
    v_lshlrev_b32 v16, 16, v34
    v_and_b32 v17, 0xffff0000, v34
    v_lshlrev_b32 v18, 16, v35
    v_and_b32 v19, 0xffff0000, v35
    v_lshlrev_b32 v20, 16, v36
    v_and_b32 v21, 0xffff0000, v36
    v_lshlrev_b32 v22, 16, v37
    v_and_b32 v23, 0xffff0000, v37
    v_lshlrev_b32 v24, 16, v38
    v_and_b32 v25, 0xffff0000, v38
    v_lshlrev_b32 v26, 16, v39
    v_and_b32 v27, 0xffff0000, v39
    v_lshlrev_b32 v28, 16, v40
    v_and_b32 v29, 0xffff0000, v40
    v_lshlrev_b32 v30, 16, v41
    v_and_b32 v31, 0xffff0000, v41
    v_add_f32 v6, v12, v13
    v_mul_f32 v7, v12, v12
    v_add_f32 v6, v6, v14
    v_add_f32 v6, v6, v15
    v_add_f32 v6, v6, v16
    v_add_f32 v6, v6, v17
    v_add_f32 v6, v6, v18
    v_add_f32 v6, v6, v19
    v_add_f32 v6, v6, v20
    v_add_f32 v6, v6, v21
    v_add_f32 v6, v6, v22
    v_add_f32 v6, v6, v23
    v_add_f32 v6, v6, v24
    v_add_f32 v6, v6, v25
    v_add_f32 v6, v6, v26
    v_add_f32 v6, v6, v27
    v_add_f32 v6, v6, v28
    v_add_f32 v6, v6, v29
    v_add_f32 v6, v6, v30
    v_add_f32 v6, v6, v31
    v_fmac_f32 v7, v13, v13
    v_fmac_f32 v7, v14, v14
    v_fmac_f32 v7, v15, v15
    v_fmac_f32 v7, v16, v16
    v_fmac_f32 v7, v17, v17
    v_fmac_f32 v7, v18, v18
    v_fmac_f32 v7, v19, v19
    v_fmac_f32 v7, v20, v20
    v_fmac_f32 v7, v21, v21
    v_fmac_f32 v7, v22, v22
    v_fmac_f32 v7, v23, v23
    v_fmac_f32 v7, v24, v24
    v_fmac_f32 v7, v25, v25
    v_fmac_f32 v7, v26, v26
    v_fmac_f32 v7, v27, v27
    v_fmac_f32 v7, v28, v28
    v_fmac_f32 v7, v29, v29
    v_fmac_f32 v7, v30, v30
    v_fmac_f32 v7, v31, v31
    v_add_f32_dpp v4, v6, v6 quad_perm:[1,0,3,2] row_mask:0xf bank_mask:0xf
    s_nop 0
    v_add_f32_dpp v5, v7, v7 quad_perm:[1,0,3,2] row_mask:0xf bank_mask:0xf
    v_mov_b32 v6, v4
    v_mov_b32 v7, v5
    s_nop 0
    v_add_f32_dpp v4, v6, v6 quad_perm:[2,3,0,1] row_mask:0xf bank_mask:0xf
    v_add_f32_dpp v5, v7, v7 quad_perm:[2,3,0,1] row_mask:0xf bank_mask:0xf
    v_mov_b32 v6, v4
    v_mov_b32 v7, v5
    s_lshl_b32 s40, s31, 11
    v_add_u32 v4, s40, v10
    v_lshlrev_b32 v4, 3, v4
    buffer_store_dwordx2 v[6:7], v4, s[44:47], 0 offen
    s_waitcnt vmcnt(0)
K3_KERNEL_END:
    s_endpgm
.globl k5_kernel
.p2align 8
.type k5_kernel,@function
k5_kernel:
    s_cmp_ge_u32 s2, 224
    s_cbranch_scc1 K5_KERNEL_END
    s_load_dwordx2 s[6:7], s[0:1], 104
    s_load_dwordx2 s[24:25], s[0:1], 64
    v_lshrrev_b32 v1, 6, v0
    v_and_b32 v0, 63, v0
    v_readfirstlane_b32 s3, v1
    s_and_b32 s30, s2, 7
    s_lshl_b32 s30, s30, 2
    s_lshr_b32 s31, s2, 3
    s_and_b32 s33, s31, 3
    s_add_u32 s30, s30, s33
    s_lshr_b32 s31, s2, 5
    v_lshlrev_b32 v2, 4, v0
    v_lshrrev_b32 v3, 5, v0
    v_lshlrev_b32 v3, 11, v3
    v_lshrrev_b32 v4, 4, v0
    v_and_b32 v4, 1, v4
    v_lshl_add_u32 v3, v4, 9, v3
    v_and_b32 v4, 15, v0
    v_lshl_add_u32 v1, v4, 4, v3
    v_add_u32 v3, 40960, v1
    s_lshl_b32 s37, s31, 4
    s_lshl_b32 s38, s3, 2
    s_add_u32 s37, s37, s38
    s_lshl_b32 s39, s37, 4
    s_mul_i32 s37, s37, 20480
    s_mul_i32 s36, s30, 81920
    s_lshl_b32 s40, s3, 10
    s_waitcnt lgkmcnt(0)
    s_add_u32 s8, s6, 81788928
    s_addc_u32 s9, s7, 0
    s_mov_b32 s10, 2621440
    s_mov_b32 s11, 0x00020000
    s_add_u32 s12, s6, 65011712
    s_addc_u32 s13, s7, 0
    s_mov_b32 s14, 2293760
    s_mov_b32 s15, 0x00020000
    s_add_u32 s16, s6, 85983232
    s_addc_u32 s17, s7, 0
    s_mov_b32 s18, 7077888
    s_mov_b32 s19, 0x00020000
    s_mov_b32 s20, s24
    s_mov_b32 s21, s25
    s_mov_b32 s22, 3456
    s_mov_b32 s23, 0x00020000
    s_add_u32 s60, s6, 75497472
    s_addc_u32 s61, s7, 0
    s_mov_b32 s62, 131072
    s_mov_b32 s63, 0x00020000
    s_lshr_b32 s41, s3, 1
    s_and_b32 s42, s3, 1
    s_mul_i32 s42, s42, 40960
    s_lshl_b32 s41, s41, 10
    s_add_u32 s41, s41, s42
    s_add_u32 s41, s41, s36
    s_add_u32 m0, s40, 0
    s_add_u32 s42, s41, 0
    buffer_load_dwordx4 v2, s[8:11], s42 offen lds
    s_add_u32 m0, s40, 4096
    s_add_u32 s42, s41, 2048
    buffer_load_dwordx4 v2, s[8:11], s42 offen lds
    s_add_u32 m0, s40, 8192
    s_add_u32 s42, s41, 4096
    buffer_load_dwordx4 v2, s[8:11], s42 offen lds
    s_add_u32 m0, s40, 12288
    s_add_u32 s42, s41, 6144
    buffer_load_dwordx4 v2, s[8:11], s42 offen lds
    s_add_u32 m0, s40, 16384
    s_add_u32 s42, s41, 8192
    buffer_load_dwordx4 v2, s[8:11], s42 offen lds
    s_add_u32 s45, s37, 0
    buffer_load_dwordx4 v[64:67], v2, s[12:15], s45 offen
    s_add_u32 s45, s37, 20480
    buffer_load_dwordx4 v[68:71], v2, s[12:15], s45 offen
    s_add_u32 s45, s37, 40960
    buffer_load_dwordx4 v[72:75], v2, s[12:15], s45 offen
    s_add_u32 s45, s37, 61440
    buffer_load_dwordx4 v[76:79], v2, s[12:15], s45 offen
    s_add_u32 m0, s40, 20480
    s_add_u32 s42, s41, 10240
    buffer_load_dwordx4 v2, s[8:11], s42 offen lds
    s_add_u32 m0, s40, 24576
    s_add_u32 s42, s41, 12288
    buffer_load_dwordx4 v2, s[8:11], s42 offen lds
    s_add_u32 m0, s40, 28672
    s_add_u32 s42, s41, 14336
    buffer_load_dwordx4 v2, s[8:11], s42 offen lds
    s_add_u32 m0, s40, 32768
    s_add_u32 s42, s41, 16384
    buffer_load_dwordx4 v2, s[8:11], s42 offen lds
    s_add_u32 m0, s40, 36864
    s_add_u32 s42, s41, 18432
    buffer_load_dwordx4 v2, s[8:11], s42 offen lds
    s_add_u32 s45, s37, 1024
    buffer_load_dwordx4 v[80:83], v2, s[12:15], s45 offen
    s_add_u32 s45, s37, 21504
    buffer_load_dwordx4 v[84:87], v2, s[12:15], s45 offen
    s_add_u32 s45, s37, 41984
    buffer_load_dwordx4 v[88:91], v2, s[12:15], s45 offen
    s_add_u32 s45, s37, 62464
    buffer_load_dwordx4 v[92:95], v2, s[12:15], s45 offen
    s_add_u32 m0, s40, 40960
    s_add_u32 s42, s41, 20480
    buffer_load_dwordx4 v2, s[8:11], s42 offen lds
    s_add_u32 m0, s40, 45056
    s_add_u32 s42, s41, 22528
    buffer_load_dwordx4 v2, s[8:11], s42 offen lds
    s_add_u32 m0, s40, 49152
    s_add_u32 s42, s41, 24576
    buffer_load_dwordx4 v2, s[8:11], s42 offen lds
    s_add_u32 m0, s40, 53248
    s_add_u32 s42, s41, 26624
    buffer_load_dwordx4 v2, s[8:11], s42 offen lds
    s_add_u32 m0, s40, 57344
    s_add_u32 s42, s41, 28672
    buffer_load_dwordx4 v2, s[8:11], s42 offen lds
    s_add_u32 s45, s37, 2048
    buffer_load_dwordx4 v[96:99], v2, s[12:15], s45 offen
    s_add_u32 s45, s37, 22528
    buffer_load_dwordx4 v[100:103], v2, s[12:15], s45 offen
    s_add_u32 s45, s37, 43008
    buffer_load_dwordx4 v[104:107], v2, s[12:15], s45 offen
    s_add_u32 s45, s37, 63488
    buffer_load_dwordx4 v[108:111], v2, s[12:15], s45 offen
    s_add_u32 m0, s40, 61440
    s_add_u32 s42, s41, 30720
    buffer_load_dwordx4 v2, s[8:11], s42 offen lds
    s_add_u32 m0, s40, 65536
    s_add_u32 s42, s41, 32768
    buffer_load_dwordx4 v2, s[8:11], s42 offen lds
    s_add_u32 m0, s40, 69632
    s_add_u32 s42, s41, 34816
    buffer_load_dwordx4 v2, s[8:11], s42 offen lds
    s_add_u32 m0, s40, 73728
    s_add_u32 s42, s41, 36864
    buffer_load_dwordx4 v2, s[8:11], s42 offen lds
    s_add_u32 m0, s40, 77824
    s_add_u32 s42, s41, 38912
    buffer_load_dwordx4 v2, s[8:11], s42 offen lds
    s_add_u32 s45, s37, 3072
    buffer_load_dwordx4 v[112:115], v2, s[12:15], s45 offen
    s_add_u32 s45, s37, 23552
    buffer_load_dwordx4 v[116:119], v2, s[12:15], s45 offen
    s_add_u32 s45, s37, 44032
    buffer_load_dwordx4 v[120:123], v2, s[12:15], s45 offen
    s_add_u32 s45, s37, 64512
    buffer_load_dwordx4 v[124:127], v2, s[12:15], s45 offen
    s_add_u32 s45, s37, 4096
    buffer_load_dwordx4 v[128:131], v2, s[12:15], s45 offen
    s_add_u32 s45, s37, 24576
    buffer_load_dwordx4 v[132:135], v2, s[12:15], s45 offen
    s_add_u32 s45, s37, 45056
    buffer_load_dwordx4 v[136:139], v2, s[12:15], s45 offen
    s_add_u32 s45, s37, 65536
    buffer_load_dwordx4 v[140:143], v2, s[12:15], s45 offen
    s_lshl_b32 s41, s30, 6
    v_add_u32 v5, s41, v0
    v_lshlrev_b32 v5, 3, v5
    s_mov_b32 s42, 0
    buffer_load_dwordx2 v[12:13], v5, s[60:63], s42 offen
    s_mov_b32 s42, 16384
    buffer_load_dwordx2 v[14:15], v5, s[60:63], s42 offen
    s_mov_b32 s42, 32768
    buffer_load_dwordx2 v[16:17], v5, s[60:63], s42 offen
    s_mov_b32 s42, 49152
    buffer_load_dwordx2 v[18:19], v5, s[60:63], s42 offen
    s_mov_b32 s42, 65536
    buffer_load_dwordx2 v[20:21], v5, s[60:63], s42 offen
    s_mov_b32 s42, 81920
    buffer_load_dwordx2 v[22:23], v5, s[60:63], s42 offen
    s_mov_b32 s42, 98304
    buffer_load_dwordx2 v[24:25], v5, s[60:63], s42 offen
    s_mov_b32 s42, 114688
    buffer_load_dwordx2 v[26:27], v5, s[60:63], s42 offen
    v_lshrrev_b32 v6, 4, v0
    v_lshlrev_b32 v6, 3, v6
    s_lshl_b32 s42, s39, 1
    buffer_load_dwordx2 v[28:29], v6, s[20:23], s42 offen offset:0
    buffer_load_dwordx2 v[30:31], v6, s[20:23], s42 offen offset:32
    buffer_load_dwordx2 v[32:33], v6, s[20:23], s42 offen offset:64
    buffer_load_dwordx2 v[34:35], v6, s[20:23], s42 offen offset:96
    v_mov_b32 v176, 0
    v_mov_b32 v177, 0
    v_mov_b32 v178, 0
    v_mov_b32 v179, 0
    v_mov_b32 v180, 0
    v_mov_b32 v181, 0
    v_mov_b32 v182, 0
    v_mov_b32 v183, 0
    v_mov_b32 v184, 0
    v_mov_b32 v185, 0
    v_mov_b32 v186, 0
    v_mov_b32 v187, 0
    v_mov_b32 v188, 0
    v_mov_b32 v189, 0
    v_mov_b32 v190, 0
    v_mov_b32 v191, 0
    v_mov_b32 v192, 0
    v_mov_b32 v193, 0
    v_mov_b32 v194, 0
    v_mov_b32 v195, 0
    v_mov_b32 v196, 0
    v_mov_b32 v197, 0
    v_mov_b32 v198, 0
    v_mov_b32 v199, 0
    v_mov_b32 v200, 0
    v_mov_b32 v201, 0
    v_mov_b32 v202, 0
    v_mov_b32 v203, 0
    v_mov_b32 v204, 0
    v_mov_b32 v205, 0
    v_mov_b32 v206, 0
    v_mov_b32 v207, 0
    v_mov_b32 v208, 0
    v_mov_b32 v209, 0
    v_mov_b32 v210, 0
    v_mov_b32 v211, 0
    v_mov_b32 v212, 0
    v_mov_b32 v213, 0
    v_mov_b32 v214, 0
    v_mov_b32 v215, 0
    v_mov_b32 v216, 0
    v_mov_b32 v217, 0
    v_mov_b32 v218, 0
    v_mov_b32 v219, 0
    v_mov_b32 v220, 0
    v_mov_b32 v221, 0
    v_mov_b32 v222, 0
    v_mov_b32 v223, 0
    v_mov_b32 v224, 0
    v_mov_b32 v225, 0
    v_mov_b32 v226, 0
    v_mov_b32 v227, 0
    v_mov_b32 v228, 0
    v_mov_b32 v229, 0
    v_mov_b32 v230, 0
    v_mov_b32 v231, 0
    v_mov_b32 v232, 0
    v_mov_b32 v233, 0
    v_mov_b32 v234, 0
    v_mov_b32 v235, 0
    v_mov_b32 v236, 0
    v_mov_b32 v237, 0
    v_mov_b32 v238, 0
    v_mov_b32 v239, 0
    v_mov_b32 v240, 0
    v_mov_b32 v241, 0
    v_mov_b32 v242, 0
    v_mov_b32 v243, 0
    v_mov_b32 v244, 0
    v_mov_b32 v245, 0
    v_mov_b32 v246, 0
    v_mov_b32 v247, 0
    v_mov_b32 v248, 0
    v_mov_b32 v249, 0
    v_mov_b32 v250, 0
    v_mov_b32 v251, 0
    v_mov_b32 v252, 0
    v_mov_b32 v253, 0
    v_mov_b32 v254, 0
    v_mov_b32 v255, 0
    v_mov_b32 v60, 0x3f803f80
    v_mov_b32 v61, 0x3f803f80
    v_mov_b32 v62, 0x3f803f80
    v_mov_b32 v63, 0x3f803f80
    s_waitcnt vmcnt(47)
    s_barrier
    ds_read_b128 v[144:147], v1 offset:0
    ds_read_b128 v[148:151], v1 offset:256
    ds_read_b128 v[152:155], v1 offset:1024
    ds_read_b128 v[156:159], v1 offset:1280
    s_waitcnt vmcnt(43)
    s_waitcnt lgkmcnt(3)
    v_mfma_f32_16x16x32_bf16 v[176:179], v[64:67], v[144:147], v[176:179]
    s_waitcnt lgkmcnt(2)
    v_mfma_f32_16x16x32_bf16 v[192:195], v[64:67], v[148:151], v[192:195]
    s_waitcnt lgkmcnt(1)
    v_mfma_f32_16x16x32_bf16 v[208:211], v[64:67], v[152:155], v[208:211]
    s_waitcnt lgkmcnt(0)
    v_mfma_f32_16x16x32_bf16 v[224:227], v[64:67], v[156:159], v[224:227]
    v_mfma_f32_16x16x32_bf16 v[240:243], v[64:67], v[60:63], v[240:243]
    ds_read_b128 v[160:163], v1 offset:4096
    s_add_u32 s45, s37, 5120
    buffer_load_dwordx4 v[64:67], v2, s[12:15], s45 offen
    v_mfma_f32_16x16x32_bf16 v[180:183], v[68:71], v[144:147], v[180:183]
    v_mfma_f32_16x16x32_bf16 v[196:199], v[68:71], v[148:151], v[196:199]
    v_mfma_f32_16x16x32_bf16 v[212:215], v[68:71], v[152:155], v[212:215]
    v_mfma_f32_16x16x32_bf16 v[228:231], v[68:71], v[156:159], v[228:231]
    v_mfma_f32_16x16x32_bf16 v[244:247], v[68:71], v[60:63], v[244:247]
    ds_read_b128 v[164:167], v1 offset:4352
    s_add_u32 s45, s37, 25600
    buffer_load_dwordx4 v[68:71], v2, s[12:15], s45 offen
    v_mfma_f32_16x16x32_bf16 v[184:187], v[72:75], v[144:147], v[184:187]
    v_mfma_f32_16x16x32_bf16 v[200:203], v[72:75], v[148:151], v[200:203]
    v_mfma_f32_16x16x32_bf16 v[216:219], v[72:75], v[152:155], v[216:219]
    v_mfma_f32_16x16x32_bf16 v[232:235], v[72:75], v[156:159], v[232:235]
    v_mfma_f32_16x16x32_bf16 v[248:251], v[72:75], v[60:63], v[248:251]
    ds_read_b128 v[168:171], v1 offset:5120
    s_add_u32 s45, s37, 46080
    buffer_load_dwordx4 v[72:75], v2, s[12:15], s45 offen
    v_mfma_f32_16x16x32_bf16 v[188:191], v[76:79], v[144:147], v[188:191]
    v_mfma_f32_16x16x32_bf16 v[204:207], v[76:79], v[148:151], v[204:207]
    v_mfma_f32_16x16x32_bf16 v[220:223], v[76:79], v[152:155], v[220:223]
    v_mfma_f32_16x16x32_bf16 v[236:239], v[76:79], v[156:159], v[236:239]
    v_mfma_f32_16x16x32_bf16 v[252:255], v[76:79], v[60:63], v[252:255]
    ds_read_b128 v[172:175], v1 offset:5376
    s_add_u32 s45, s37, 66560
    buffer_load_dwordx4 v[76:79], v2, s[12:15], s45 offen
    s_waitcnt vmcnt(38)
    s_waitcnt lgkmcnt(3)
    v_mfma_f32_16x16x32_bf16 v[176:179], v[80:83], v[160:163], v[176:179]
    s_waitcnt lgkmcnt(2)
    v_mfma_f32_16x16x32_bf16 v[192:195], v[80:83], v[164:167], v[192:195]
    s_waitcnt lgkmcnt(1)
    v_mfma_f32_16x16x32_bf16 v[208:211], v[80:83], v[168:171], v[208:211]
    s_waitcnt lgkmcnt(0)
    v_mfma_f32_16x16x32_bf16 v[224:227], v[80:83], v[172:175], v[224:227]
    v_mfma_f32_16x16x32_bf16 v[240:243], v[80:83], v[60:63], v[240:243]
    ds_read_b128 v[144:147], v1 offset:8192
    s_add_u32 s45, s37, 6144
    buffer_load_dwordx4 v[80:83], v2, s[12:15], s45 offen
    v_mfma_f32_16x16x32_bf16 v[180:183], v[84:87], v[160:163], v[180:183]
    v_mfma_f32_16x16x32_bf16 v[196:199], v[84:87], v[164:167], v[196:199]
    v_mfma_f32_16x16x32_bf16 v[212:215], v[84:87], v[168:171], v[212:215]
    v_mfma_f32_16x16x32_bf16 v[228:231], v[84:87], v[172:175], v[228:231]
    v_mfma_f32_16x16x32_bf16 v[244:247], v[84:87], v[60:63], v[244:247]
    ds_read_b128 v[148:151], v1 offset:8448
    s_add_u32 s45, s37, 26624
    buffer_load_dwordx4 v[84:87], v2, s[12:15], s45 offen
    v_mfma_f32_16x16x32_bf16 v[184:187], v[88:91], v[160:163], v[184:187]
    v_mfma_f32_16x16x32_bf16 v[200:203], v[88:91], v[164:167], v[200:203]
    v_mfma_f32_16x16x32_bf16 v[216:219], v[88:91], v[168:171], v[216:219]
    v_mfma_f32_16x16x32_bf16 v[232:235], v[88:91], v[172:175], v[232:235]
    v_mfma_f32_16x16x32_bf16 v[248:251], v[88:91], v[60:63], v[248:251]
    ds_read_b128 v[152:155], v1 offset:9216
    s_add_u32 s45, s37, 47104
    buffer_load_dwordx4 v[88:91], v2, s[12:15], s45 offen
    v_mfma_f32_16x16x32_bf16 v[188:191], v[92:95], v[160:163], v[188:191]
    v_mfma_f32_16x16x32_bf16 v[204:207], v[92:95], v[164:167], v[204:207]
    v_mfma_f32_16x16x32_bf16 v[220:223], v[92:95], v[168:171], v[220:223]
    v_mfma_f32_16x16x32_bf16 v[236:239], v[92:95], v[172:175], v[236:239]
    v_mfma_f32_16x16x32_bf16 v[252:255], v[92:95], v[60:63], v[252:255]
    ds_read_b128 v[156:159], v1 offset:9472
    s_add_u32 s45, s37, 67584
    buffer_load_dwordx4 v[92:95], v2, s[12:15], s45 offen
    s_waitcnt vmcnt(33)
    s_waitcnt lgkmcnt(3)
    v_mfma_f32_16x16x32_bf16 v[176:179], v[96:99], v[144:147], v[176:179]
    s_waitcnt lgkmcnt(2)
    v_mfma_f32_16x16x32_bf16 v[192:195], v[96:99], v[148:151], v[192:195]
    s_waitcnt lgkmcnt(1)
    v_mfma_f32_16x16x32_bf16 v[208:211], v[96:99], v[152:155], v[208:211]
    s_waitcnt lgkmcnt(0)
    v_mfma_f32_16x16x32_bf16 v[224:227], v[96:99], v[156:159], v[224:227]
    v_mfma_f32_16x16x32_bf16 v[240:243], v[96:99], v[60:63], v[240:243]
    ds_read_b128 v[160:163], v1 offset:12288
    s_add_u32 s45, s37, 7168
    buffer_load_dwordx4 v[96:99], v2, s[12:15], s45 offen
    v_mfma_f32_16x16x32_bf16 v[180:183], v[100:103], v[144:147], v[180:183]
    v_mfma_f32_16x16x32_bf16 v[196:199], v[100:103], v[148:151], v[196:199]
    v_mfma_f32_16x16x32_bf16 v[212:215], v[100:103], v[152:155], v[212:215]
    v_mfma_f32_16x16x32_bf16 v[228:231], v[100:103], v[156:159], v[228:231]
    v_mfma_f32_16x16x32_bf16 v[244:247], v[100:103], v[60:63], v[244:247]
    ds_read_b128 v[164:167], v1 offset:12544
    s_add_u32 s45, s37, 27648
    buffer_load_dwordx4 v[100:103], v2, s[12:15], s45 offen
    v_mfma_f32_16x16x32_bf16 v[184:187], v[104:107], v[144:147], v[184:187]
    v_mfma_f32_16x16x32_bf16 v[200:203], v[104:107], v[148:151], v[200:203]
    v_mfma_f32_16x16x32_bf16 v[216:219], v[104:107], v[152:155], v[216:219]
    v_mfma_f32_16x16x32_bf16 v[232:235], v[104:107], v[156:159], v[232:235]
    v_mfma_f32_16x16x32_bf16 v[248:251], v[104:107], v[60:63], v[248:251]
    ds_read_b128 v[168:171], v1 offset:13312
    s_add_u32 s45, s37, 48128
    buffer_load_dwordx4 v[104:107], v2, s[12:15], s45 offen
    v_mfma_f32_16x16x32_bf16 v[188:191], v[108:111], v[144:147], v[188:191]
    v_mfma_f32_16x16x32_bf16 v[204:207], v[108:111], v[148:151], v[204:207]
    v_mfma_f32_16x16x32_bf16 v[220:223], v[108:111], v[152:155], v[220:223]
    v_mfma_f32_16x16x32_bf16 v[236:239], v[108:111], v[156:159], v[236:239]
    v_mfma_f32_16x16x32_bf16 v[252:255], v[108:111], v[60:63], v[252:255]
    ds_read_b128 v[172:175], v1 offset:13568
    s_add_u32 s45, s37, 68608
    buffer_load_dwordx4 v[108:111], v2, s[12:15], s45 offen
    s_waitcnt vmcnt(28)
    s_waitcnt lgkmcnt(3)
    v_mfma_f32_16x16x32_bf16 v[176:179], v[112:115], v[160:163], v[176:179]
    s_waitcnt lgkmcnt(2)
    v_mfma_f32_16x16x32_bf16 v[192:195], v[112:115], v[164:167], v[192:195]
    s_waitcnt lgkmcnt(1)
    v_mfma_f32_16x16x32_bf16 v[208:211], v[112:115], v[168:171], v[208:211]
    s_waitcnt lgkmcnt(0)
    v_mfma_f32_16x16x32_bf16 v[224:227], v[112:115], v[172:175], v[224:227]
    v_mfma_f32_16x16x32_bf16 v[240:243], v[112:115], v[60:63], v[240:243]
    ds_read_b128 v[144:147], v1 offset:16384
    s_add_u32 s45, s37, 8192
    buffer_load_dwordx4 v[112:115], v2, s[12:15], s45 offen
    v_mfma_f32_16x16x32_bf16 v[180:183], v[116:119], v[160:163], v[180:183]
    v_mfma_f32_16x16x32_bf16 v[196:199], v[116:119], v[164:167], v[196:199]
    v_mfma_f32_16x16x32_bf16 v[212:215], v[116:119], v[168:171], v[212:215]
    v_mfma_f32_16x16x32_bf16 v[228:231], v[116:119], v[172:175], v[228:231]
    v_mfma_f32_16x16x32_bf16 v[244:247], v[116:119], v[60:63], v[244:247]
    ds_read_b128 v[148:151], v1 offset:16640
    s_add_u32 s45, s37, 28672
    buffer_load_dwordx4 v[116:119], v2, s[12:15], s45 offen
    v_mfma_f32_16x16x32_bf16 v[184:187], v[120:123], v[160:163], v[184:187]
    v_mfma_f32_16x16x32_bf16 v[200:203], v[120:123], v[164:167], v[200:203]
    v_mfma_f32_16x16x32_bf16 v[216:219], v[120:123], v[168:171], v[216:219]
    v_mfma_f32_16x16x32_bf16 v[232:235], v[120:123], v[172:175], v[232:235]
    v_mfma_f32_16x16x32_bf16 v[248:251], v[120:123], v[60:63], v[248:251]
    ds_read_b128 v[152:155], v1 offset:17408
    s_add_u32 s45, s37, 49152
    buffer_load_dwordx4 v[120:123], v2, s[12:15], s45 offen
    v_mfma_f32_16x16x32_bf16 v[188:191], v[124:127], v[160:163], v[188:191]
    v_mfma_f32_16x16x32_bf16 v[204:207], v[124:127], v[164:167], v[204:207]
    v_mfma_f32_16x16x32_bf16 v[220:223], v[124:127], v[168:171], v[220:223]
    v_mfma_f32_16x16x32_bf16 v[236:239], v[124:127], v[172:175], v[236:239]
    v_mfma_f32_16x16x32_bf16 v[252:255], v[124:127], v[60:63], v[252:255]
    ds_read_b128 v[156:159], v1 offset:17664
    s_add_u32 s45, s37, 69632
    buffer_load_dwordx4 v[124:127], v2, s[12:15], s45 offen
    s_waitcnt vmcnt(28)
    s_barrier
    s_waitcnt lgkmcnt(3)
    v_mfma_f32_16x16x32_bf16 v[176:179], v[128:131], v[144:147], v[176:179]
    s_waitcnt lgkmcnt(2)
    v_mfma_f32_16x16x32_bf16 v[192:195], v[128:131], v[148:151], v[192:195]
    s_waitcnt lgkmcnt(1)
    v_mfma_f32_16x16x32_bf16 v[208:211], v[128:131], v[152:155], v[208:211]
    s_waitcnt lgkmcnt(0)
    v_mfma_f32_16x16x32_bf16 v[224:227], v[128:131], v[156:159], v[224:227]
    v_mfma_f32_16x16x32_bf16 v[240:243], v[128:131], v[60:63], v[240:243]
    ds_read_b128 v[160:163], v1 offset:20480
    s_add_u32 s45, s37, 9216
    buffer_load_dwordx4 v[128:131], v2, s[12:15], s45 offen
    v_mfma_f32_16x16x32_bf16 v[180:183], v[132:135], v[144:147], v[180:183]
    v_mfma_f32_16x16x32_bf16 v[196:199], v[132:135], v[148:151], v[196:199]
    v_mfma_f32_16x16x32_bf16 v[212:215], v[132:135], v[152:155], v[212:215]
    v_mfma_f32_16x16x32_bf16 v[228:231], v[132:135], v[156:159], v[228:231]
    v_mfma_f32_16x16x32_bf16 v[244:247], v[132:135], v[60:63], v[244:247]
    ds_read_b128 v[164:167], v1 offset:20736
    s_add_u32 s45, s37, 29696
    buffer_load_dwordx4 v[132:135], v2, s[12:15], s45 offen
    v_mfma_f32_16x16x32_bf16 v[184:187], v[136:139], v[144:147], v[184:187]
    v_mfma_f32_16x16x32_bf16 v[200:203], v[136:139], v[148:151], v[200:203]
    v_mfma_f32_16x16x32_bf16 v[216:219], v[136:139], v[152:155], v[216:219]
    v_mfma_f32_16x16x32_bf16 v[232:235], v[136:139], v[156:159], v[232:235]
    v_mfma_f32_16x16x32_bf16 v[248:251], v[136:139], v[60:63], v[248:251]
    ds_read_b128 v[168:171], v1 offset:21504
    s_add_u32 s45, s37, 50176
    buffer_load_dwordx4 v[136:139], v2, s[12:15], s45 offen
    v_mfma_f32_16x16x32_bf16 v[188:191], v[140:143], v[144:147], v[188:191]
    v_mfma_f32_16x16x32_bf16 v[204:207], v[140:143], v[148:151], v[204:207]
    v_mfma_f32_16x16x32_bf16 v[220:223], v[140:143], v[152:155], v[220:223]
    v_mfma_f32_16x16x32_bf16 v[236:239], v[140:143], v[156:159], v[236:239]
    v_mfma_f32_16x16x32_bf16 v[252:255], v[140:143], v[60:63], v[252:255]
    ds_read_b128 v[172:175], v1 offset:21760
    s_add_u32 s45, s37, 70656
    buffer_load_dwordx4 v[140:143], v2, s[12:15], s45 offen
    s_waitcnt vmcnt(16)
    s_waitcnt lgkmcnt(3)
    v_mfma_f32_16x16x32_bf16 v[176:179], v[64:67], v[160:163], v[176:179]
    s_waitcnt lgkmcnt(2)
    v_mfma_f32_16x16x32_bf16 v[192:195], v[64:67], v[164:167], v[192:195]
    s_waitcnt lgkmcnt(1)
    v_mfma_f32_16x16x32_bf16 v[208:211], v[64:67], v[168:171], v[208:211]
    s_waitcnt lgkmcnt(0)
    v_mfma_f32_16x16x32_bf16 v[224:227], v[64:67], v[172:175], v[224:227]
    v_mfma_f32_16x16x32_bf16 v[240:243], v[64:67], v[60:63], v[240:243]
    ds_read_b128 v[144:147], v1 offset:24576
    s_add_u32 s45, s37, 10240
    buffer_load_dwordx4 v[64:67], v2, s[12:15], s45 offen
    v_mfma_f32_16x16x32_bf16 v[180:183], v[68:71], v[160:163], v[180:183]
    v_mfma_f32_16x16x32_bf16 v[196:199], v[68:71], v[164:167], v[196:199]
    v_mfma_f32_16x16x32_bf16 v[212:215], v[68:71], v[168:171], v[212:215]
    v_mfma_f32_16x16x32_bf16 v[228:231], v[68:71], v[172:175], v[228:231]
    v_mfma_f32_16x16x32_bf16 v[244:247], v[68:71], v[60:63], v[244:247]
    ds_read_b128 v[148:151], v1 offset:24832
    s_add_u32 s45, s37, 30720
    buffer_load_dwordx4 v[68:71], v2, s[12:15], s45 offen
    v_mfma_f32_16x16x32_bf16 v[184:187], v[72:75], v[160:163], v[184:187]
    v_mfma_f32_16x16x32_bf16 v[200:203], v[72:75], v[164:167], v[200:203]
    v_mfma_f32_16x16x32_bf16 v[216:219], v[72:75], v[168:171], v[216:219]
    v_mfma_f32_16x16x32_bf16 v[232:235], v[72:75], v[172:175], v[232:235]
    v_mfma_f32_16x16x32_bf16 v[248:251], v[72:75], v[60:63], v[248:251]
    ds_read_b128 v[152:155], v1 offset:25600
    s_add_u32 s45, s37, 51200
    buffer_load_dwordx4 v[72:75], v2, s[12:15], s45 offen
    v_mfma_f32_16x16x32_bf16 v[188:191], v[76:79], v[160:163], v[188:191]
    v_mfma_f32_16x16x32_bf16 v[204:207], v[76:79], v[164:167], v[204:207]
    v_mfma_f32_16x16x32_bf16 v[220:223], v[76:79], v[168:171], v[220:223]
    v_mfma_f32_16x16x32_bf16 v[236:239], v[76:79], v[172:175], v[236:239]
    v_mfma_f32_16x16x32_bf16 v[252:255], v[76:79], v[60:63], v[252:255]
    ds_read_b128 v[156:159], v1 offset:25856
    s_add_u32 s45, s37, 71680
    buffer_load_dwordx4 v[76:79], v2, s[12:15], s45 offen
    s_waitcnt vmcnt(16)
    s_waitcnt lgkmcnt(3)
    v_mfma_f32_16x16x32_bf16 v[176:179], v[80:83], v[144:147], v[176:179]
    s_waitcnt lgkmcnt(2)
    v_mfma_f32_16x16x32_bf16 v[192:195], v[80:83], v[148:151], v[192:195]
    s_waitcnt lgkmcnt(1)
    v_mfma_f32_16x16x32_bf16 v[208:211], v[80:83], v[152:155], v[208:211]
    s_waitcnt lgkmcnt(0)
    v_mfma_f32_16x16x32_bf16 v[224:227], v[80:83], v[156:159], v[224:227]
    v_mfma_f32_16x16x32_bf16 v[240:243], v[80:83], v[60:63], v[240:243]
    ds_read_b128 v[160:163], v1 offset:28672
    s_add_u32 s45, s37, 11264
    buffer_load_dwordx4 v[80:83], v2, s[12:15], s45 offen
    v_mfma_f32_16x16x32_bf16 v[180:183], v[84:87], v[144:147], v[180:183]
    v_mfma_f32_16x16x32_bf16 v[196:199], v[84:87], v[148:151], v[196:199]
    v_mfma_f32_16x16x32_bf16 v[212:215], v[84:87], v[152:155], v[212:215]
    v_mfma_f32_16x16x32_bf16 v[228:231], v[84:87], v[156:159], v[228:231]
    v_mfma_f32_16x16x32_bf16 v[244:247], v[84:87], v[60:63], v[244:247]
    ds_read_b128 v[164:167], v1 offset:28928
    s_add_u32 s45, s37, 31744
    buffer_load_dwordx4 v[84:87], v2, s[12:15], s45 offen
    v_mfma_f32_16x16x32_bf16 v[184:187], v[88:91], v[144:147], v[184:187]
    v_mfma_f32_16x16x32_bf16 v[200:203], v[88:91], v[148:151], v[200:203]
    v_mfma_f32_16x16x32_bf16 v[216:219], v[88:91], v[152:155], v[216:219]
    v_mfma_f32_16x16x32_bf16 v[232:235], v[88:91], v[156:159], v[232:235]
    v_mfma_f32_16x16x32_bf16 v[248:251], v[88:91], v[60:63], v[248:251]
    ds_read_b128 v[168:171], v1 offset:29696
    s_add_u32 s45, s37, 52224
    buffer_load_dwordx4 v[88:91], v2, s[12:15], s45 offen
    v_mfma_f32_16x16x32_bf16 v[188:191], v[92:95], v[144:147], v[188:191]
    v_mfma_f32_16x16x32_bf16 v[204:207], v[92:95], v[148:151], v[204:207]
    v_mfma_f32_16x16x32_bf16 v[220:223], v[92:95], v[152:155], v[220:223]
    v_mfma_f32_16x16x32_bf16 v[236:239], v[92:95], v[156:159], v[236:239]
    v_mfma_f32_16x16x32_bf16 v[252:255], v[92:95], v[60:63], v[252:255]
    ds_read_b128 v[172:175], v1 offset:29952
    s_add_u32 s45, s37, 72704
    buffer_load_dwordx4 v[92:95], v2, s[12:15], s45 offen
    s_waitcnt vmcnt(16)
    s_waitcnt lgkmcnt(3)
    v_mfma_f32_16x16x32_bf16 v[176:179], v[96:99], v[160:163], v[176:179]
    s_waitcnt lgkmcnt(2)
    v_mfma_f32_16x16x32_bf16 v[192:195], v[96:99], v[164:167], v[192:195]
    s_waitcnt lgkmcnt(1)
    v_mfma_f32_16x16x32_bf16 v[208:211], v[96:99], v[168:171], v[208:211]
    s_waitcnt lgkmcnt(0)
    v_mfma_f32_16x16x32_bf16 v[224:227], v[96:99], v[172:175], v[224:227]
    v_mfma_f32_16x16x32_bf16 v[240:243], v[96:99], v[60:63], v[240:243]
    ds_read_b128 v[144:147], v1 offset:32768
    s_add_u32 s45, s37, 12288
    buffer_load_dwordx4 v[96:99], v2, s[12:15], s45 offen
    v_mfma_f32_16x16x32_bf16 v[180:183], v[100:103], v[160:163], v[180:183]
    v_mfma_f32_16x16x32_bf16 v[196:199], v[100:103], v[164:167], v[196:199]
    v_mfma_f32_16x16x32_bf16 v[212:215], v[100:103], v[168:171], v[212:215]
    v_mfma_f32_16x16x32_bf16 v[228:231], v[100:103], v[172:175], v[228:231]
    v_mfma_f32_16x16x32_bf16 v[244:247], v[100:103], v[60:63], v[244:247]
    ds_read_b128 v[148:151], v1 offset:33024
    s_add_u32 s45, s37, 32768
    buffer_load_dwordx4 v[100:103], v2, s[12:15], s45 offen
    v_mfma_f32_16x16x32_bf16 v[184:187], v[104:107], v[160:163], v[184:187]
    v_mfma_f32_16x16x32_bf16 v[200:203], v[104:107], v[164:167], v[200:203]
    v_mfma_f32_16x16x32_bf16 v[216:219], v[104:107], v[168:171], v[216:219]
    v_mfma_f32_16x16x32_bf16 v[232:235], v[104:107], v[172:175], v[232:235]
    v_mfma_f32_16x16x32_bf16 v[248:251], v[104:107], v[60:63], v[248:251]
    ds_read_b128 v[152:155], v1 offset:33792
    s_add_u32 s45, s37, 53248
    buffer_load_dwordx4 v[104:107], v2, s[12:15], s45 offen
    v_mfma_f32_16x16x32_bf16 v[188:191], v[108:111], v[160:163], v[188:191]
    v_mfma_f32_16x16x32_bf16 v[204:207], v[108:111], v[164:167], v[204:207]
    v_mfma_f32_16x16x32_bf16 v[220:223], v[108:111], v[168:171], v[220:223]
    v_mfma_f32_16x16x32_bf16 v[236:239], v[108:111], v[172:175], v[236:239]
    v_mfma_f32_16x16x32_bf16 v[252:255], v[108:111], v[60:63], v[252:255]
    ds_read_b128 v[156:159], v1 offset:34048
    s_add_u32 s45, s37, 73728
    buffer_load_dwordx4 v[108:111], v2, s[12:15], s45 offen
    s_waitcnt vmcnt(16)
    s_waitcnt lgkmcnt(3)
    v_mfma_f32_16x16x32_bf16 v[176:179], v[112:115], v[144:147], v[176:179]
    s_waitcnt lgkmcnt(2)
    v_mfma_f32_16x16x32_bf16 v[192:195], v[112:115], v[148:151], v[192:195]
    s_waitcnt lgkmcnt(1)
    v_mfma_f32_16x16x32_bf16 v[208:211], v[112:115], v[152:155], v[208:211]
    s_waitcnt lgkmcnt(0)
    v_mfma_f32_16x16x32_bf16 v[224:227], v[112:115], v[156:159], v[224:227]
    v_mfma_f32_16x16x32_bf16 v[240:243], v[112:115], v[60:63], v[240:243]
    ds_read_b128 v[160:163], v1 offset:36864
    s_add_u32 s45, s37, 13312
    buffer_load_dwordx4 v[112:115], v2, s[12:15], s45 offen
    v_mfma_f32_16x16x32_bf16 v[180:183], v[116:119], v[144:147], v[180:183]
    v_mfma_f32_16x16x32_bf16 v[196:199], v[116:119], v[148:151], v[196:199]
    v_mfma_f32_16x16x32_bf16 v[212:215], v[116:119], v[152:155], v[212:215]
    v_mfma_f32_16x16x32_bf16 v[228:231], v[116:119], v[156:159], v[228:231]
    v_mfma_f32_16x16x32_bf16 v[244:247], v[116:119], v[60:63], v[244:247]
    ds_read_b128 v[164:167], v1 offset:37120
    s_add_u32 s45, s37, 33792
    buffer_load_dwordx4 v[116:119], v2, s[12:15], s45 offen
    v_mfma_f32_16x16x32_bf16 v[184:187], v[120:123], v[144:147], v[184:187]
    v_mfma_f32_16x16x32_bf16 v[200:203], v[120:123], v[148:151], v[200:203]
    v_mfma_f32_16x16x32_bf16 v[216:219], v[120:123], v[152:155], v[216:219]
    v_mfma_f32_16x16x32_bf16 v[232:235], v[120:123], v[156:159], v[232:235]
    v_mfma_f32_16x16x32_bf16 v[248:251], v[120:123], v[60:63], v[248:251]
    ds_read_b128 v[168:171], v1 offset:37888
    s_add_u32 s45, s37, 54272
    buffer_load_dwordx4 v[120:123], v2, s[12:15], s45 offen
    v_mfma_f32_16x16x32_bf16 v[188:191], v[124:127], v[144:147], v[188:191]
    v_mfma_f32_16x16x32_bf16 v[204:207], v[124:127], v[148:151], v[204:207]
    v_mfma_f32_16x16x32_bf16 v[220:223], v[124:127], v[152:155], v[220:223]
    v_mfma_f32_16x16x32_bf16 v[236:239], v[124:127], v[156:159], v[236:239]
    v_mfma_f32_16x16x32_bf16 v[252:255], v[124:127], v[60:63], v[252:255]
    ds_read_b128 v[172:175], v1 offset:38144
    s_add_u32 s45, s37, 74752
    buffer_load_dwordx4 v[124:127], v2, s[12:15], s45 offen
    s_waitcnt vmcnt(16)
    s_barrier
    s_waitcnt lgkmcnt(3)
    v_mfma_f32_16x16x32_bf16 v[176:179], v[128:131], v[160:163], v[176:179]
    s_waitcnt lgkmcnt(2)
    v_mfma_f32_16x16x32_bf16 v[192:195], v[128:131], v[164:167], v[192:195]
    s_waitcnt lgkmcnt(1)
    v_mfma_f32_16x16x32_bf16 v[208:211], v[128:131], v[168:171], v[208:211]
    s_waitcnt lgkmcnt(0)
    v_mfma_f32_16x16x32_bf16 v[224:227], v[128:131], v[172:175], v[224:227]
    v_mfma_f32_16x16x32_bf16 v[240:243], v[128:131], v[60:63], v[240:243]
    ds_read_b128 v[144:147], v3 offset:0
    s_add_u32 s45, s37, 14336
    buffer_load_dwordx4 v[128:131], v2, s[12:15], s45 offen
    v_mfma_f32_16x16x32_bf16 v[180:183], v[132:135], v[160:163], v[180:183]
    v_mfma_f32_16x16x32_bf16 v[196:199], v[132:135], v[164:167], v[196:199]
    v_mfma_f32_16x16x32_bf16 v[212:215], v[132:135], v[168:171], v[212:215]
    v_mfma_f32_16x16x32_bf16 v[228:231], v[132:135], v[172:175], v[228:231]
    v_mfma_f32_16x16x32_bf16 v[244:247], v[132:135], v[60:63], v[244:247]
    ds_read_b128 v[148:151], v3 offset:256
    s_add_u32 s45, s37, 34816
    buffer_load_dwordx4 v[132:135], v2, s[12:15], s45 offen
    v_mfma_f32_16x16x32_bf16 v[184:187], v[136:139], v[160:163], v[184:187]
    v_mfma_f32_16x16x32_bf16 v[200:203], v[136:139], v[164:167], v[200:203]
    v_mfma_f32_16x16x32_bf16 v[216:219], v[136:139], v[168:171], v[216:219]
    v_mfma_f32_16x16x32_bf16 v[232:235], v[136:139], v[172:175], v[232:235]
    v_mfma_f32_16x16x32_bf16 v[248:251], v[136:139], v[60:63], v[248:251]
    ds_read_b128 v[152:155], v3 offset:1024
    s_add_u32 s45, s37, 55296
    buffer_load_dwordx4 v[136:139], v2, s[12:15], s45 offen
    v_mfma_f32_16x16x32_bf16 v[188:191], v[140:143], v[160:163], v[188:191]
    v_mfma_f32_16x16x32_bf16 v[204:207], v[140:143], v[164:167], v[204:207]
    v_mfma_f32_16x16x32_bf16 v[220:223], v[140:143], v[168:171], v[220:223]
    v_mfma_f32_16x16x32_bf16 v[236:239], v[140:143], v[172:175], v[236:239]
    v_mfma_f32_16x16x32_bf16 v[252:255], v[140:143], v[60:63], v[252:255]
    ds_read_b128 v[156:159], v3 offset:1280
    s_add_u32 s45, s37, 75776
    buffer_load_dwordx4 v[140:143], v2, s[12:15], s45 offen
    s_waitcnt vmcnt(16)
    s_waitcnt lgkmcnt(3)
    v_mfma_f32_16x16x32_bf16 v[176:179], v[64:67], v[144:147], v[176:179]
    s_waitcnt lgkmcnt(2)
    v_mfma_f32_16x16x32_bf16 v[192:195], v[64:67], v[148:151], v[192:195]
    s_waitcnt lgkmcnt(1)
    v_mfma_f32_16x16x32_bf16 v[208:211], v[64:67], v[152:155], v[208:211]
    s_waitcnt lgkmcnt(0)
    v_mfma_f32_16x16x32_bf16 v[224:227], v[64:67], v[156:159], v[224:227]
    v_mfma_f32_16x16x32_bf16 v[240:243], v[64:67], v[60:63], v[240:243]
    ds_read_b128 v[160:163], v3 offset:4096
    s_add_u32 s45, s37, 15360
    buffer_load_dwordx4 v[64:67], v2, s[12:15], s45 offen
    v_mfma_f32_16x16x32_bf16 v[180:183], v[68:71], v[144:147], v[180:183]
    v_mfma_f32_16x16x32_bf16 v[196:199], v[68:71], v[148:151], v[196:199]
    v_mfma_f32_16x16x32_bf16 v[212:215], v[68:71], v[152:155], v[212:215]
    v_mfma_f32_16x16x32_bf16 v[228:231], v[68:71], v[156:159], v[228:231]
    v_mfma_f32_16x16x32_bf16 v[244:247], v[68:71], v[60:63], v[244:247]
    ds_read_b128 v[164:167], v3 offset:4352
    s_add_u32 s45, s37, 35840
    buffer_load_dwordx4 v[68:71], v2, s[12:15], s45 offen
    v_mfma_f32_16x16x32_bf16 v[184:187], v[72:75], v[144:147], v[184:187]
    v_mfma_f32_16x16x32_bf16 v[200:203], v[72:75], v[148:151], v[200:203]
    v_mfma_f32_16x16x32_bf16 v[216:219], v[72:75], v[152:155], v[216:219]
    v_mfma_f32_16x16x32_bf16 v[232:235], v[72:75], v[156:159], v[232:235]
    v_mfma_f32_16x16x32_bf16 v[248:251], v[72:75], v[60:63], v[248:251]
    ds_read_b128 v[168:171], v3 offset:5120
    s_add_u32 s45, s37, 56320
    buffer_load_dwordx4 v[72:75], v2, s[12:15], s45 offen
    v_mfma_f32_16x16x32_bf16 v[188:191], v[76:79], v[144:147], v[188:191]
    v_mfma_f32_16x16x32_bf16 v[204:207], v[76:79], v[148:151], v[204:207]
    v_mfma_f32_16x16x32_bf16 v[220:223], v[76:79], v[152:155], v[220:223]
    v_mfma_f32_16x16x32_bf16 v[236:239], v[76:79], v[156:159], v[236:239]
    v_mfma_f32_16x16x32_bf16 v[252:255], v[76:79], v[60:63], v[252:255]
    ds_read_b128 v[172:175], v3 offset:5376
    s_add_u32 s45, s37, 76800
    buffer_load_dwordx4 v[76:79], v2, s[12:15], s45 offen
    s_waitcnt vmcnt(44)
    v_add_f32 v12, v12, v14
    v_add_f32 v13, v13, v15
    v_add_f32 v12, v12, v16
    v_add_f32 v13, v13, v17
    v_add_f32 v12, v12, v18
    v_add_f32 v13, v13, v19
    v_add_f32 v12, v12, v20
    v_add_f32 v13, v13, v21
    v_add_f32 v12, v12, v22
    v_add_f32 v13, v13, v23
    v_add_f32 v12, v12, v24
    v_add_f32 v13, v13, v25
    v_add_f32 v12, v12, v26
    v_add_f32 v13, v13, v27
    v_mul_f32 v4, 0x3acccccd, v12
    v_mul_f32 v5, 0x3acccccd, v13
    v_fma_f32 v5, -v4, v4, v5
    v_max_f32 v5, 0, v5
    v_add_f32 v5, 0x3727c5ac, v5
    v_rsq_f32 v5, v5
    s_nop 0
    v_mul_f32 v4, v4, v5
    v_sub_f32 v4, 0, v4
    v_and_b32 v6, 15, v0
    v_lshlrev_b32 v6, 2, v6
    v_add_u32 v7, 0, v6
    ds_bpermute_b32 v14, v7, v5
    ds_bpermute_b32 v15, v7, v4
    v_add_u32 v7, 64, v6
    ds_bpermute_b32 v16, v7, v5
    ds_bpermute_b32 v17, v7, v4
    v_add_u32 v7, 128, v6
    ds_bpermute_b32 v18, v7, v5
    ds_bpermute_b32 v19, v7, v4
    v_add_u32 v7, 192, v6
    ds_bpermute_b32 v20, v7, v5
    ds_bpermute_b32 v21, v7, v4
    s_waitcnt lgkmcnt(0)
    s_waitcnt vmcnt(16)
    v_mfma_f32_16x16x32_bf16 v[176:179], v[80:83], v[160:163], v[176:179]
    v_mfma_f32_16x16x32_bf16 v[192:195], v[80:83], v[164:167], v[192:195]
    v_mfma_f32_16x16x32_bf16 v[208:211], v[80:83], v[168:171], v[208:211]
    v_mfma_f32_16x16x32_bf16 v[224:227], v[80:83], v[172:175], v[224:227]
    v_mfma_f32_16x16x32_bf16 v[240:243], v[80:83], v[60:63], v[240:243]
    ds_read_b128 v[144:147], v3 offset:8192
    s_add_u32 s45, s37, 16384
    buffer_load_dwordx4 v[80:83], v2, s[12:15], s45 offen
    v_mfma_f32_16x16x32_bf16 v[180:183], v[84:87], v[160:163], v[180:183]
    v_mfma_f32_16x16x32_bf16 v[196:199], v[84:87], v[164:167], v[196:199]
    v_mfma_f32_16x16x32_bf16 v[212:215], v[84:87], v[168:171], v[212:215]
    v_mfma_f32_16x16x32_bf16 v[228:231], v[84:87], v[172:175], v[228:231]
    v_mfma_f32_16x16x32_bf16 v[244:247], v[84:87], v[60:63], v[244:247]
    ds_read_b128 v[148:151], v3 offset:8448
    s_add_u32 s45, s37, 36864
    buffer_load_dwordx4 v[84:87], v2, s[12:15], s45 offen
    v_mfma_f32_16x16x32_bf16 v[184:187], v[88:91], v[160:163], v[184:187]
    v_mfma_f32_16x16x32_bf16 v[200:203], v[88:91], v[164:167], v[200:203]
    v_mfma_f32_16x16x32_bf16 v[216:219], v[88:91], v[168:171], v[216:219]
    v_mfma_f32_16x16x32_bf16 v[232:235], v[88:91], v[172:175], v[232:235]
    v_mfma_f32_16x16x32_bf16 v[248:251], v[88:91], v[60:63], v[248:251]
    ds_read_b128 v[152:155], v3 offset:9216
    s_add_u32 s45, s37, 57344
    buffer_load_dwordx4 v[88:91], v2, s[12:15], s45 offen
    v_mfma_f32_16x16x32_bf16 v[188:191], v[92:95], v[160:163], v[188:191]
    v_mfma_f32_16x16x32_bf16 v[204:207], v[92:95], v[164:167], v[204:207]
    v_mfma_f32_16x16x32_bf16 v[220:223], v[92:95], v[168:171], v[220:223]
    v_mfma_f32_16x16x32_bf16 v[236:239], v[92:95], v[172:175], v[236:239]
    v_mfma_f32_16x16x32_bf16 v[252:255], v[92:95], v[60:63], v[252:255]
    ds_read_b128 v[156:159], v3 offset:9472
    s_add_u32 s45, s37, 77824
    buffer_load_dwordx4 v[92:95], v2, s[12:15], s45 offen
    s_waitcnt vmcnt(16)
    s_waitcnt lgkmcnt(3)
    v_mfma_f32_16x16x32_bf16 v[176:179], v[96:99], v[144:147], v[176:179]
    s_waitcnt lgkmcnt(2)
    v_mfma_f32_16x16x32_bf16 v[192:195], v[96:99], v[148:151], v[192:195]
    s_waitcnt lgkmcnt(1)
    v_mfma_f32_16x16x32_bf16 v[208:211], v[96:99], v[152:155], v[208:211]
    s_waitcnt lgkmcnt(0)
    v_mfma_f32_16x16x32_bf16 v[224:227], v[96:99], v[156:159], v[224:227]
    v_mfma_f32_16x16x32_bf16 v[240:243], v[96:99], v[60:63], v[240:243]
    ds_read_b128 v[160:163], v3 offset:12288
    s_add_u32 s45, s37, 17408
    buffer_load_dwordx4 v[96:99], v2, s[12:15], s45 offen
    v_mfma_f32_16x16x32_bf16 v[180:183], v[100:103], v[144:147], v[180:183]
    v_mfma_f32_16x16x32_bf16 v[196:199], v[100:103], v[148:151], v[196:199]
    v_mfma_f32_16x16x32_bf16 v[212:215], v[100:103], v[152:155], v[212:215]
    v_mfma_f32_16x16x32_bf16 v[228:231], v[100:103], v[156:159], v[228:231]
    v_mfma_f32_16x16x32_bf16 v[244:247], v[100:103], v[60:63], v[244:247]
    ds_read_b128 v[164:167], v3 offset:12544
    s_add_u32 s45, s37, 37888
    buffer_load_dwordx4 v[100:103], v2, s[12:15], s45 offen
    v_mfma_f32_16x16x32_bf16 v[184:187], v[104:107], v[144:147], v[184:187]
    v_mfma_f32_16x16x32_bf16 v[200:203], v[104:107], v[148:151], v[200:203]
    v_mfma_f32_16x16x32_bf16 v[216:219], v[104:107], v[152:155], v[216:219]
    v_mfma_f32_16x16x32_bf16 v[232:235], v[104:107], v[156:159], v[232:235]
    v_mfma_f32_16x16x32_bf16 v[248:251], v[104:107], v[60:63], v[248:251]
    ds_read_b128 v[168:171], v3 offset:13312
    s_add_u32 s45, s37, 58368
    buffer_load_dwordx4 v[104:107], v2, s[12:15], s45 offen
    v_mfma_f32_16x16x32_bf16 v[188:191], v[108:111], v[144:147], v[188:191]
    v_mfma_f32_16x16x32_bf16 v[204:207], v[108:111], v[148:151], v[204:207]
    v_mfma_f32_16x16x32_bf16 v[220:223], v[108:111], v[152:155], v[220:223]
    v_mfma_f32_16x16x32_bf16 v[236:239], v[108:111], v[156:159], v[236:239]
    v_mfma_f32_16x16x32_bf16 v[252:255], v[108:111], v[60:63], v[252:255]
    ds_read_b128 v[172:175], v3 offset:13568
    s_add_u32 s45, s37, 78848
    buffer_load_dwordx4 v[108:111], v2, s[12:15], s45 offen
    s_waitcnt vmcnt(16)
    s_waitcnt lgkmcnt(3)
    v_mfma_f32_16x16x32_bf16 v[176:179], v[112:115], v[160:163], v[176:179]
    s_waitcnt lgkmcnt(2)
    v_mfma_f32_16x16x32_bf16 v[192:195], v[112:115], v[164:167], v[192:195]
    s_waitcnt lgkmcnt(1)
    v_mfma_f32_16x16x32_bf16 v[208:211], v[112:115], v[168:171], v[208:211]
    s_waitcnt lgkmcnt(0)
    v_mfma_f32_16x16x32_bf16 v[224:227], v[112:115], v[172:175], v[224:227]
    v_mfma_f32_16x16x32_bf16 v[240:243], v[112:115], v[60:63], v[240:243]
    ds_read_b128 v[144:147], v3 offset:16384
    s_add_u32 s45, s37, 18432
    buffer_load_dwordx4 v[112:115], v2, s[12:15], s45 offen
    v_mfma_f32_16x16x32_bf16 v[180:183], v[116:119], v[160:163], v[180:183]
    v_mfma_f32_16x16x32_bf16 v[196:199], v[116:119], v[164:167], v[196:199]
    v_mfma_f32_16x16x32_bf16 v[212:215], v[116:119], v[168:171], v[212:215]
    v_mfma_f32_16x16x32_bf16 v[228:231], v[116:119], v[172:175], v[228:231]
    v_mfma_f32_16x16x32_bf16 v[244:247], v[116:119], v[60:63], v[244:247]
    ds_read_b128 v[148:151], v3 offset:16640
    s_add_u32 s45, s37, 38912
    buffer_load_dwordx4 v[116:119], v2, s[12:15], s45 offen
    v_mfma_f32_16x16x32_bf16 v[184:187], v[120:123], v[160:163], v[184:187]
    v_mfma_f32_16x16x32_bf16 v[200:203], v[120:123], v[164:167], v[200:203]
    v_mfma_f32_16x16x32_bf16 v[216:219], v[120:123], v[168:171], v[216:219]
    v_mfma_f32_16x16x32_bf16 v[232:235], v[120:123], v[172:175], v[232:235]
    v_mfma_f32_16x16x32_bf16 v[248:251], v[120:123], v[60:63], v[248:251]
    ds_read_b128 v[152:155], v3 offset:17408
    s_add_u32 s45, s37, 59392
    buffer_load_dwordx4 v[120:123], v2, s[12:15], s45 offen
    v_mfma_f32_16x16x32_bf16 v[188:191], v[124:127], v[160:163], v[188:191]
    v_mfma_f32_16x16x32_bf16 v[204:207], v[124:127], v[164:167], v[204:207]
    v_mfma_f32_16x16x32_bf16 v[220:223], v[124:127], v[168:171], v[220:223]
    v_mfma_f32_16x16x32_bf16 v[236:239], v[124:127], v[172:175], v[236:239]
    v_mfma_f32_16x16x32_bf16 v[252:255], v[124:127], v[60:63], v[252:255]
    ds_read_b128 v[156:159], v3 offset:17664
    s_add_u32 s45, s37, 79872
    buffer_load_dwordx4 v[124:127], v2, s[12:15], s45 offen
    s_waitcnt vmcnt(16)
    s_barrier
    s_waitcnt lgkmcnt(3)
    v_mfma_f32_16x16x32_bf16 v[176:179], v[128:131], v[144:147], v[176:179]
    s_waitcnt lgkmcnt(2)
    v_mfma_f32_16x16x32_bf16 v[192:195], v[128:131], v[148:151], v[192:195]
    s_waitcnt lgkmcnt(1)
    v_mfma_f32_16x16x32_bf16 v[208:211], v[128:131], v[152:155], v[208:211]
    s_waitcnt lgkmcnt(0)
    v_mfma_f32_16x16x32_bf16 v[224:227], v[128:131], v[156:159], v[224:227]
    v_mfma_f32_16x16x32_bf16 v[240:243], v[128:131], v[60:63], v[240:243]
    ds_read_b128 v[160:163], v3 offset:20480
    s_add_u32 s45, s37, 19456
    buffer_load_dwordx4 v[128:131], v2, s[12:15], s45 offen
    v_mfma_f32_16x16x32_bf16 v[180:183], v[132:135], v[144:147], v[180:183]
    v_mfma_f32_16x16x32_bf16 v[196:199], v[132:135], v[148:151], v[196:199]
    v_mfma_f32_16x16x32_bf16 v[212:215], v[132:135], v[152:155], v[212:215]
    v_mfma_f32_16x16x32_bf16 v[228:231], v[132:135], v[156:159], v[228:231]
    v_mfma_f32_16x16x32_bf16 v[244:247], v[132:135], v[60:63], v[244:247]
    ds_read_b128 v[164:167], v3 offset:20736
    s_add_u32 s45, s37, 39936
    buffer_load_dwordx4 v[132:135], v2, s[12:15], s45 offen
    v_mfma_f32_16x16x32_bf16 v[184:187], v[136:139], v[144:147], v[184:187]
    v_mfma_f32_16x16x32_bf16 v[200:203], v[136:139], v[148:151], v[200:203]
    v_mfma_f32_16x16x32_bf16 v[216:219], v[136:139], v[152:155], v[216:219]
    v_mfma_f32_16x16x32_bf16 v[232:235], v[136:139], v[156:159], v[232:235]
    v_mfma_f32_16x16x32_bf16 v[248:251], v[136:139], v[60:63], v[248:251]
    ds_read_b128 v[168:171], v3 offset:21504
    s_add_u32 s45, s37, 60416
    buffer_load_dwordx4 v[136:139], v2, s[12:15], s45 offen
    v_mfma_f32_16x16x32_bf16 v[188:191], v[140:143], v[144:147], v[188:191]
    v_mfma_f32_16x16x32_bf16 v[204:207], v[140:143], v[148:151], v[204:207]
    v_mfma_f32_16x16x32_bf16 v[220:223], v[140:143], v[152:155], v[220:223]
    v_mfma_f32_16x16x32_bf16 v[236:239], v[140:143], v[156:159], v[236:239]
    v_mfma_f32_16x16x32_bf16 v[252:255], v[140:143], v[60:63], v[252:255]
    ds_read_b128 v[172:175], v3 offset:21760
    s_add_u32 s45, s37, 80896
    buffer_load_dwordx4 v[140:143], v2, s[12:15], s45 offen
    s_waitcnt vmcnt(16)
    s_waitcnt lgkmcnt(3)
    v_mfma_f32_16x16x32_bf16 v[176:179], v[64:67], v[160:163], v[176:179]
    s_waitcnt lgkmcnt(2)
    v_mfma_f32_16x16x32_bf16 v[192:195], v[64:67], v[164:167], v[192:195]
    s_waitcnt lgkmcnt(1)
    v_mfma_f32_16x16x32_bf16 v[208:211], v[64:67], v[168:171], v[208:211]
    s_waitcnt lgkmcnt(0)
    v_mfma_f32_16x16x32_bf16 v[224:227], v[64:67], v[172:175], v[224:227]
    v_mfma_f32_16x16x32_bf16 v[240:243], v[64:67], v[60:63], v[240:243]
    ds_read_b128 v[144:147], v3 offset:24576
    v_mfma_f32_16x16x32_bf16 v[180:183], v[68:71], v[160:163], v[180:183]
    v_mfma_f32_16x16x32_bf16 v[196:199], v[68:71], v[164:167], v[196:199]
    v_mfma_f32_16x16x32_bf16 v[212:215], v[68:71], v[168:171], v[212:215]
    v_mfma_f32_16x16x32_bf16 v[228:231], v[68:71], v[172:175], v[228:231]
    v_mfma_f32_16x16x32_bf16 v[244:247], v[68:71], v[60:63], v[244:247]
    ds_read_b128 v[148:151], v3 offset:24832
    v_mfma_f32_16x16x32_bf16 v[184:187], v[72:75], v[160:163], v[184:187]
    v_mfma_f32_16x16x32_bf16 v[200:203], v[72:75], v[164:167], v[200:203]
    v_mfma_f32_16x16x32_bf16 v[216:219], v[72:75], v[168:171], v[216:219]
    v_mfma_f32_16x16x32_bf16 v[232:235], v[72:75], v[172:175], v[232:235]
    v_mfma_f32_16x16x32_bf16 v[248:251], v[72:75], v[60:63], v[248:251]
    ds_read_b128 v[152:155], v3 offset:25600
    v_mfma_f32_16x16x32_bf16 v[188:191], v[76:79], v[160:163], v[188:191]
    v_mfma_f32_16x16x32_bf16 v[204:207], v[76:79], v[164:167], v[204:207]
    v_mfma_f32_16x16x32_bf16 v[220:223], v[76:79], v[168:171], v[220:223]
    v_mfma_f32_16x16x32_bf16 v[236:239], v[76:79], v[172:175], v[236:239]
    v_mfma_f32_16x16x32_bf16 v[252:255], v[76:79], v[60:63], v[252:255]
    ds_read_b128 v[156:159], v3 offset:25856
    s_waitcnt vmcnt(12)
    s_waitcnt lgkmcnt(3)
    v_mfma_f32_16x16x32_bf16 v[176:179], v[80:83], v[144:147], v[176:179]
    s_waitcnt lgkmcnt(2)
    v_mfma_f32_16x16x32_bf16 v[192:195], v[80:83], v[148:151], v[192:195]
    s_waitcnt lgkmcnt(1)
    v_mfma_f32_16x16x32_bf16 v[208:211], v[80:83], v[152:155], v[208:211]
    s_waitcnt lgkmcnt(0)
    v_mfma_f32_16x16x32_bf16 v[224:227], v[80:83], v[156:159], v[224:227]
    v_mfma_f32_16x16x32_bf16 v[240:243], v[80:83], v[60:63], v[240:243]
    ds_read_b128 v[160:163], v3 offset:28672
    v_mfma_f32_16x16x32_bf16 v[180:183], v[84:87], v[144:147], v[180:183]
    v_mfma_f32_16x16x32_bf16 v[196:199], v[84:87], v[148:151], v[196:199]
    v_mfma_f32_16x16x32_bf16 v[212:215], v[84:87], v[152:155], v[212:215]
    v_mfma_f32_16x16x32_bf16 v[228:231], v[84:87], v[156:159], v[228:231]
    v_mfma_f32_16x16x32_bf16 v[244:247], v[84:87], v[60:63], v[244:247]
    ds_read_b128 v[164:167], v3 offset:28928
    v_mfma_f32_16x16x32_bf16 v[184:187], v[88:91], v[144:147], v[184:187]
    v_mfma_f32_16x16x32_bf16 v[200:203], v[88:91], v[148:151], v[200:203]
    v_mfma_f32_16x16x32_bf16 v[216:219], v[88:91], v[152:155], v[216:219]
    v_mfma_f32_16x16x32_bf16 v[232:235], v[88:91], v[156:159], v[232:235]
    v_mfma_f32_16x16x32_bf16 v[248:251], v[88:91], v[60:63], v[248:251]
    ds_read_b128 v[168:171], v3 offset:29696
    v_mfma_f32_16x16x32_bf16 v[188:191], v[92:95], v[144:147], v[188:191]
    v_mfma_f32_16x16x32_bf16 v[204:207], v[92:95], v[148:151], v[204:207]
    v_mfma_f32_16x16x32_bf16 v[220:223], v[92:95], v[152:155], v[220:223]
    v_mfma_f32_16x16x32_bf16 v[236:239], v[92:95], v[156:159], v[236:239]
    v_mfma_f32_16x16x32_bf16 v[252:255], v[92:95], v[60:63], v[252:255]
    ds_read_b128 v[172:175], v3 offset:29952
    s_waitcnt vmcnt(8)
    s_waitcnt lgkmcnt(3)
    v_mfma_f32_16x16x32_bf16 v[176:179], v[96:99], v[160:163], v[176:179]
    s_waitcnt lgkmcnt(2)
    v_mfma_f32_16x16x32_bf16 v[192:195], v[96:99], v[164:167], v[192:195]
    s_waitcnt lgkmcnt(1)
    v_mfma_f32_16x16x32_bf16 v[208:211], v[96:99], v[168:171], v[208:211]
    s_waitcnt lgkmcnt(0)
    v_mfma_f32_16x16x32_bf16 v[224:227], v[96:99], v[172:175], v[224:227]
    v_mfma_f32_16x16x32_bf16 v[240:243], v[96:99], v[60:63], v[240:243]
    ds_read_b128 v[144:147], v3 offset:32768
    v_mfma_f32_16x16x32_bf16 v[180:183], v[100:103], v[160:163], v[180:183]
    v_mfma_f32_16x16x32_bf16 v[196:199], v[100:103], v[164:167], v[196:199]
    v_mfma_f32_16x16x32_bf16 v[212:215], v[100:103], v[168:171], v[212:215]
    v_mfma_f32_16x16x32_bf16 v[228:231], v[100:103], v[172:175], v[228:231]
    v_mfma_f32_16x16x32_bf16 v[244:247], v[100:103], v[60:63], v[244:247]
    ds_read_b128 v[148:151], v3 offset:33024
    v_mfma_f32_16x16x32_bf16 v[184:187], v[104:107], v[160:163], v[184:187]
    v_mfma_f32_16x16x32_bf16 v[200:203], v[104:107], v[164:167], v[200:203]
    v_mfma_f32_16x16x32_bf16 v[216:219], v[104:107], v[168:171], v[216:219]
    v_mfma_f32_16x16x32_bf16 v[232:235], v[104:107], v[172:175], v[232:235]
    v_mfma_f32_16x16x32_bf16 v[248:251], v[104:107], v[60:63], v[248:251]
    ds_read_b128 v[152:155], v3 offset:33792
    v_mfma_f32_16x16x32_bf16 v[188:191], v[108:111], v[160:163], v[188:191]
    v_mfma_f32_16x16x32_bf16 v[204:207], v[108:111], v[164:167], v[204:207]
    v_mfma_f32_16x16x32_bf16 v[220:223], v[108:111], v[168:171], v[220:223]
    v_mfma_f32_16x16x32_bf16 v[236:239], v[108:111], v[172:175], v[236:239]
    v_mfma_f32_16x16x32_bf16 v[252:255], v[108:111], v[60:63], v[252:255]
    ds_read_b128 v[156:159], v3 offset:34048
    s_waitcnt vmcnt(4)
    s_waitcnt lgkmcnt(3)
    v_mfma_f32_16x16x32_bf16 v[176:179], v[112:115], v[144:147], v[176:179]
    s_waitcnt lgkmcnt(2)
    v_mfma_f32_16x16x32_bf16 v[192:195], v[112:115], v[148:151], v[192:195]
    s_waitcnt lgkmcnt(1)
    v_mfma_f32_16x16x32_bf16 v[208:211], v[112:115], v[152:155], v[208:211]
    s_waitcnt lgkmcnt(0)
    v_mfma_f32_16x16x32_bf16 v[224:227], v[112:115], v[156:159], v[224:227]
    v_mfma_f32_16x16x32_bf16 v[240:243], v[112:115], v[60:63], v[240:243]
    ds_read_b128 v[160:163], v3 offset:36864
    v_mfma_f32_16x16x32_bf16 v[180:183], v[116:119], v[144:147], v[180:183]
    v_mfma_f32_16x16x32_bf16 v[196:199], v[116:119], v[148:151], v[196:199]
    v_mfma_f32_16x16x32_bf16 v[212:215], v[116:119], v[152:155], v[212:215]
    v_mfma_f32_16x16x32_bf16 v[228:231], v[116:119], v[156:159], v[228:231]
    v_mfma_f32_16x16x32_bf16 v[244:247], v[116:119], v[60:63], v[244:247]
    ds_read_b128 v[164:167], v3 offset:37120
    v_mfma_f32_16x16x32_bf16 v[184:187], v[120:123], v[144:147], v[184:187]
    v_mfma_f32_16x16x32_bf16 v[200:203], v[120:123], v[148:151], v[200:203]
    v_mfma_f32_16x16x32_bf16 v[216:219], v[120:123], v[152:155], v[216:219]
    v_mfma_f32_16x16x32_bf16 v[232:235], v[120:123], v[156:159], v[232:235]
    v_mfma_f32_16x16x32_bf16 v[248:251], v[120:123], v[60:63], v[248:251]
    ds_read_b128 v[168:171], v3 offset:37888
    v_mfma_f32_16x16x32_bf16 v[188:191], v[124:127], v[144:147], v[188:191]
    v_mfma_f32_16x16x32_bf16 v[204:207], v[124:127], v[148:151], v[204:207]
    v_mfma_f32_16x16x32_bf16 v[220:223], v[124:127], v[152:155], v[220:223]
    v_mfma_f32_16x16x32_bf16 v[236:239], v[124:127], v[156:159], v[236:239]
    v_mfma_f32_16x16x32_bf16 v[252:255], v[124:127], v[60:63], v[252:255]
    ds_read_b128 v[172:175], v3 offset:38144
    s_waitcnt vmcnt(0)
    s_waitcnt lgkmcnt(3)
    v_mfma_f32_16x16x32_bf16 v[176:179], v[128:131], v[160:163], v[176:179]
    s_waitcnt lgkmcnt(2)
    v_mfma_f32_16x16x32_bf16 v[192:195], v[128:131], v[164:167], v[192:195]
    s_waitcnt lgkmcnt(1)
    v_mfma_f32_16x16x32_bf16 v[208:211], v[128:131], v[168:171], v[208:211]
    s_waitcnt lgkmcnt(0)
    v_mfma_f32_16x16x32_bf16 v[224:227], v[128:131], v[172:175], v[224:227]
    v_mfma_f32_16x16x32_bf16 v[240:243], v[128:131], v[60:63], v[240:243]
    v_mfma_f32_16x16x32_bf16 v[180:183], v[132:135], v[160:163], v[180:183]
    v_mfma_f32_16x16x32_bf16 v[196:199], v[132:135], v[164:167], v[196:199]
    v_mfma_f32_16x16x32_bf16 v[212:215], v[132:135], v[168:171], v[212:215]
    v_mfma_f32_16x16x32_bf16 v[228:231], v[132:135], v[172:175], v[228:231]
    v_mfma_f32_16x16x32_bf16 v[244:247], v[132:135], v[60:63], v[244:247]
    v_mfma_f32_16x16x32_bf16 v[184:187], v[136:139], v[160:163], v[184:187]
    v_mfma_f32_16x16x32_bf16 v[200:203], v[136:139], v[164:167], v[200:203]
    v_mfma_f32_16x16x32_bf16 v[216:219], v[136:139], v[168:171], v[216:219]
    v_mfma_f32_16x16x32_bf16 v[232:235], v[136:139], v[172:175], v[232:235]
    v_mfma_f32_16x16x32_bf16 v[248:251], v[136:139], v[60:63], v[248:251]
    v_mfma_f32_16x16x32_bf16 v[188:191], v[140:143], v[160:163], v[188:191]
    v_mfma_f32_16x16x32_bf16 v[204:207], v[140:143], v[164:167], v[204:207]
    v_mfma_f32_16x16x32_bf16 v[220:223], v[140:143], v[168:171], v[220:223]
    v_mfma_f32_16x16x32_bf16 v[236:239], v[140:143], v[172:175], v[236:239]
    v_mfma_f32_16x16x32_bf16 v[252:255], v[140:143], v[60:63], v[252:255]
    v_mov_b32 v4, 0xc0135761
    v_mov_b32 v5, 0xc0135761
    v_mov_b32 v6, 0xbdd2d3e8
    v_mov_b32 v7, 0xbdd2d3e8
    v_mov_b32 v8, 1.0
    v_mov_b32 v9, 1.0
    v_lshlrev_b32 v36, 16, v28
    v_and_b32 v37, 0xffff0000, v28
    v_lshlrev_b32 v38, 16, v29
    v_and_b32 v39, 0xffff0000, v29
    v_lshlrev_b32 v40, 16, v30
    v_and_b32 v41, 0xffff0000, v30
    v_lshlrev_b32 v42, 16, v31
    v_and_b32 v43, 0xffff0000, v31
    v_lshlrev_b32 v44, 16, v32
    v_and_b32 v45, 0xffff0000, v32
    v_lshlrev_b32 v46, 16, v33
    v_and_b32 v47, 0xffff0000, v33
    v_lshlrev_b32 v48, 16, v34
    v_and_b32 v49, 0xffff0000, v34
    v_lshlrev_b32 v50, 16, v35
    v_and_b32 v51, 0xffff0000, v35
    v_lshrrev_b32 v10, 4, v0
    v_lshrrev_b32 v11, 1, v10
    v_lshlrev_b32 v11, 9, v11
    v_and_b32 v10, 1, v10
    v_lshl_add_u32 v11, v10, 3, v11
    v_and_b32 v10, 15, v0
    v_lshl_add_u32 v11, v10, 4, v11
    s_mul_i32 s41, s30, 221184
    s_lshl_b32 s42, s39, 6
    s_add_u32 s41, s41, s42
    v_fma_f32 v64, v15, v240, v36
    v_fma_f32 v65, v15, v241, v37
    v_fma_f32 v66, v15, v242, v38
    v_fma_f32 v67, v15, v243, v39
    v_fma_f32 v176, v14, v176, v64
    v_fma_f32 v177, v14, v177, v65
    v_fma_f32 v178, v14, v178, v66
    v_fma_f32 v179, v14, v179, v67
    v_pk_mul_f32 v[64:65], v[176:177], v[176:177]
    v_pk_mul_f32 v[66:67], v[178:179], v[178:179]
    v_pk_fma_f32 v[64:65], v[64:65], v[6:7], v[4:5]
    v_pk_fma_f32 v[66:67], v[66:67], v[6:7], v[4:5]
    v_pk_mul_f32 v[64:65], v[64:65], v[176:177]
    v_pk_mul_f32 v[66:67], v[66:67], v[178:179]
    v_exp_f32 v64, v64
    v_exp_f32 v65, v65
    v_exp_f32 v66, v66
    v_exp_f32 v67, v67
    v_pk_add_f32 v[64:65], v[64:65], v[8:9]
    v_pk_add_f32 v[66:67], v[66:67], v[8:9]
    v_rcp_f32 v64, v64
    v_rcp_f32 v65, v65
    v_rcp_f32 v66, v66
    v_rcp_f32 v67, v67
    v_pk_mul_f32 v[64:65], v[64:65], v[176:177]
    v_pk_mul_f32 v[66:67], v[66:67], v[178:179]
    v_cvt_pk_bf16_f32 v68, v64, v65
    v_cvt_pk_bf16_f32 v69, v66, v67
    s_add_u32 s42, s39, 0
    s_cmp_ge_u32 s42, 1728
    s_cbranch_scc1 K5_KERNEL_SK_18
    s_add_u32 s42, s41, 0
    buffer_store_dwordx2 v[68:69], v11, s[16:19], s42 offen offset:0
K5_KERNEL_SK_18:
    v_fma_f32 v72, v15, v244, v40
    v_fma_f32 v73, v15, v245, v41
    v_fma_f32 v74, v15, v246, v42
    v_fma_f32 v75, v15, v247, v43
    v_fma_f32 v180, v14, v180, v72
    v_fma_f32 v181, v14, v181, v73
    v_fma_f32 v182, v14, v182, v74
    v_fma_f32 v183, v14, v183, v75
    v_pk_mul_f32 v[72:73], v[180:181], v[180:181]
    v_pk_mul_f32 v[74:75], v[182:183], v[182:183]
    v_pk_fma_f32 v[72:73], v[72:73], v[6:7], v[4:5]
    v_pk_fma_f32 v[74:75], v[74:75], v[6:7], v[4:5]
    v_pk_mul_f32 v[72:73], v[72:73], v[180:181]
    v_pk_mul_f32 v[74:75], v[74:75], v[182:183]
    v_exp_f32 v72, v72
    v_exp_f32 v73, v73
    v_exp_f32 v74, v74
    v_exp_f32 v75, v75
    v_pk_add_f32 v[72:73], v[72:73], v[8:9]
    v_pk_add_f32 v[74:75], v[74:75], v[8:9]
    v_rcp_f32 v72, v72
    v_rcp_f32 v73, v73
    v_rcp_f32 v74, v74
    v_rcp_f32 v75, v75
    v_pk_mul_f32 v[72:73], v[72:73], v[180:181]
    v_pk_mul_f32 v[74:75], v[74:75], v[182:183]
    v_cvt_pk_bf16_f32 v76, v72, v73
    v_cvt_pk_bf16_f32 v77, v74, v75
    s_add_u32 s42, s39, 16
    s_cmp_ge_u32 s42, 1728
    s_cbranch_scc1 K5_KERNEL_SK_19
    s_add_u32 s42, s41, 1024
    buffer_store_dwordx2 v[76:77], v11, s[16:19], s42 offen offset:0
K5_KERNEL_SK_19:
    v_fma_f32 v80, v15, v248, v44
    v_fma_f32 v81, v15, v249, v45
    v_fma_f32 v82, v15, v250, v46
    v_fma_f32 v83, v15, v251, v47
    v_fma_f32 v184, v14, v184, v80
    v_fma_f32 v185, v14, v185, v81
    v_fma_f32 v186, v14, v186, v82
    v_fma_f32 v187, v14, v187, v83
    v_pk_mul_f32 v[80:81], v[184:185], v[184:185]
    v_pk_mul_f32 v[82:83], v[186:187], v[186:187]
    v_pk_fma_f32 v[80:81], v[80:81], v[6:7], v[4:5]
    v_pk_fma_f32 v[82:83], v[82:83], v[6:7], v[4:5]
    v_pk_mul_f32 v[80:81], v[80:81], v[184:185]
    v_pk_mul_f32 v[82:83], v[82:83], v[186:187]
    v_exp_f32 v80, v80
    v_exp_f32 v81, v81
    v_exp_f32 v82, v82
    v_exp_f32 v83, v83
    v_pk_add_f32 v[80:81], v[80:81], v[8:9]
    v_pk_add_f32 v[82:83], v[82:83], v[8:9]
    v_rcp_f32 v80, v80
    v_rcp_f32 v81, v81
    v_rcp_f32 v82, v82
    v_rcp_f32 v83, v83
    v_pk_mul_f32 v[80:81], v[80:81], v[184:185]
    v_pk_mul_f32 v[82:83], v[82:83], v[186:187]
    v_cvt_pk_bf16_f32 v84, v80, v81
    v_cvt_pk_bf16_f32 v85, v82, v83
    s_add_u32 s42, s39, 32
    s_cmp_ge_u32 s42, 1728
    s_cbranch_scc1 K5_KERNEL_SK_20
    s_add_u32 s42, s41, 2048
    buffer_store_dwordx2 v[84:85], v11, s[16:19], s42 offen offset:0
K5_KERNEL_SK_20:
    v_fma_f32 v88, v15, v252, v48
    v_fma_f32 v89, v15, v253, v49
    v_fma_f32 v90, v15, v254, v50
    v_fma_f32 v91, v15, v255, v51
    v_fma_f32 v188, v14, v188, v88
    v_fma_f32 v189, v14, v189, v89
    v_fma_f32 v190, v14, v190, v90
    v_fma_f32 v191, v14, v191, v91
    v_pk_mul_f32 v[88:89], v[188:189], v[188:189]
    v_pk_mul_f32 v[90:91], v[190:191], v[190:191]
    v_pk_fma_f32 v[88:89], v[88:89], v[6:7], v[4:5]
    v_pk_fma_f32 v[90:91], v[90:91], v[6:7], v[4:5]
    v_pk_mul_f32 v[88:89], v[88:89], v[188:189]
    v_pk_mul_f32 v[90:91], v[90:91], v[190:191]
    v_exp_f32 v88, v88
    v_exp_f32 v89, v89
    v_exp_f32 v90, v90
    v_exp_f32 v91, v91
    v_pk_add_f32 v[88:89], v[88:89], v[8:9]
    v_pk_add_f32 v[90:91], v[90:91], v[8:9]
    v_rcp_f32 v88, v88
    v_rcp_f32 v89, v89
    v_rcp_f32 v90, v90
    v_rcp_f32 v91, v91
    v_pk_mul_f32 v[88:89], v[88:89], v[188:189]
    v_pk_mul_f32 v[90:91], v[90:91], v[190:191]
    v_cvt_pk_bf16_f32 v92, v88, v89
    v_cvt_pk_bf16_f32 v93, v90, v91
    s_add_u32 s42, s39, 48
    s_cmp_ge_u32 s42, 1728
    s_cbranch_scc1 K5_KERNEL_SK_21
    s_add_u32 s42, s41, 3072
    buffer_store_dwordx2 v[92:93], v11, s[16:19], s42 offen offset:0
K5_KERNEL_SK_21:
    v_fma_f32 v64, v17, v240, v36
    v_fma_f32 v65, v17, v241, v37
    v_fma_f32 v66, v17, v242, v38
    v_fma_f32 v67, v17, v243, v39
    v_fma_f32 v192, v16, v192, v64
    v_fma_f32 v193, v16, v193, v65
    v_fma_f32 v194, v16, v194, v66
    v_fma_f32 v195, v16, v195, v67
    v_pk_mul_f32 v[64:65], v[192:193], v[192:193]
    v_pk_mul_f32 v[66:67], v[194:195], v[194:195]
    v_pk_fma_f32 v[64:65], v[64:65], v[6:7], v[4:5]
    v_pk_fma_f32 v[66:67], v[66:67], v[6:7], v[4:5]
    v_pk_mul_f32 v[64:65], v[64:65], v[192:193]
    v_pk_mul_f32 v[66:67], v[66:67], v[194:195]
    v_exp_f32 v64, v64
    v_exp_f32 v65, v65
    v_exp_f32 v66, v66
    v_exp_f32 v67, v67
    v_pk_add_f32 v[64:65], v[64:65], v[8:9]
    v_pk_add_f32 v[66:67], v[66:67], v[8:9]
    v_rcp_f32 v64, v64
    v_rcp_f32 v65, v65
    v_rcp_f32 v66, v66
    v_rcp_f32 v67, v67
    v_pk_mul_f32 v[64:65], v[64:65], v[192:193]
    v_pk_mul_f32 v[66:67], v[66:67], v[194:195]
    v_cvt_pk_bf16_f32 v68, v64, v65
    v_cvt_pk_bf16_f32 v69, v66, v67
    s_add_u32 s42, s39, 0
    s_cmp_ge_u32 s42, 1728
    s_cbranch_scc1 K5_KERNEL_SK_22
    s_add_u32 s42, s41, 0
    buffer_store_dwordx2 v[68:69], v11, s[16:19], s42 offen offset:256
K5_KERNEL_SK_22:
    v_fma_f32 v72, v17, v244, v40
    v_fma_f32 v73, v17, v245, v41
    v_fma_f32 v74, v17, v246, v42
    v_fma_f32 v75, v17, v247, v43
    v_fma_f32 v196, v16, v196, v72
    v_fma_f32 v197, v16, v197, v73
    v_fma_f32 v198, v16, v198, v74
    v_fma_f32 v199, v16, v199, v75
    v_pk_mul_f32 v[72:73], v[196:197], v[196:197]
    v_pk_mul_f32 v[74:75], v[198:199], v[198:199]
    v_pk_fma_f32 v[72:73], v[72:73], v[6:7], v[4:5]
    v_pk_fma_f32 v[74:75], v[74:75], v[6:7], v[4:5]
    v_pk_mul_f32 v[72:73], v[72:73], v[196:197]
    v_pk_mul_f32 v[74:75], v[74:75], v[198:199]
    v_exp_f32 v72, v72
    v_exp_f32 v73, v73
    v_exp_f32 v74, v74
    v_exp_f32 v75, v75
    v_pk_add_f32 v[72:73], v[72:73], v[8:9]
    v_pk_add_f32 v[74:75], v[74:75], v[8:9]
    v_rcp_f32 v72, v72
    v_rcp_f32 v73, v73
    v_rcp_f32 v74, v74
    v_rcp_f32 v75, v75
    v_pk_mul_f32 v[72:73], v[72:73], v[196:197]
    v_pk_mul_f32 v[74:75], v[74:75], v[198:199]
    v_cvt_pk_bf16_f32 v76, v72, v73
    v_cvt_pk_bf16_f32 v77, v74, v75
    s_add_u32 s42, s39, 16
    s_cmp_ge_u32 s42, 1728
    s_cbranch_scc1 K5_KERNEL_SK_23
    s_add_u32 s42, s41, 1024
    buffer_store_dwordx2 v[76:77], v11, s[16:19], s42 offen offset:256
K5_KERNEL_SK_23:
    v_fma_f32 v80, v17, v248, v44
    v_fma_f32 v81, v17, v249, v45
    v_fma_f32 v82, v17, v250, v46
    v_fma_f32 v83, v17, v251, v47
    v_fma_f32 v200, v16, v200, v80
    v_fma_f32 v201, v16, v201, v81
    v_fma_f32 v202, v16, v202, v82
    v_fma_f32 v203, v16, v203, v83
    v_pk_mul_f32 v[80:81], v[200:201], v[200:201]
    v_pk_mul_f32 v[82:83], v[202:203], v[202:203]
    v_pk_fma_f32 v[80:81], v[80:81], v[6:7], v[4:5]
    v_pk_fma_f32 v[82:83], v[82:83], v[6:7], v[4:5]
    v_pk_mul_f32 v[80:81], v[80:81], v[200:201]
    v_pk_mul_f32 v[82:83], v[82:83], v[202:203]
    v_exp_f32 v80, v80
    v_exp_f32 v81, v81
    v_exp_f32 v82, v82
    v_exp_f32 v83, v83
    v_pk_add_f32 v[80:81], v[80:81], v[8:9]
    v_pk_add_f32 v[82:83], v[82:83], v[8:9]
    v_rcp_f32 v80, v80
    v_rcp_f32 v81, v81
    v_rcp_f32 v82, v82
    v_rcp_f32 v83, v83
    v_pk_mul_f32 v[80:81], v[80:81], v[200:201]
    v_pk_mul_f32 v[82:83], v[82:83], v[202:203]
    v_cvt_pk_bf16_f32 v84, v80, v81
    v_cvt_pk_bf16_f32 v85, v82, v83
    s_add_u32 s42, s39, 32
    s_cmp_ge_u32 s42, 1728
    s_cbranch_scc1 K5_KERNEL_SK_24
    s_add_u32 s42, s41, 2048
    buffer_store_dwordx2 v[84:85], v11, s[16:19], s42 offen offset:256
K5_KERNEL_SK_24:
    v_fma_f32 v88, v17, v252, v48
    v_fma_f32 v89, v17, v253, v49
    v_fma_f32 v90, v17, v254, v50
    v_fma_f32 v91, v17, v255, v51
    v_fma_f32 v204, v16, v204, v88
    v_fma_f32 v205, v16, v205, v89
    v_fma_f32 v206, v16, v206, v90
    v_fma_f32 v207, v16, v207, v91
    v_pk_mul_f32 v[88:89], v[204:205], v[204:205]
    v_pk_mul_f32 v[90:91], v[206:207], v[206:207]
    v_pk_fma_f32 v[88:89], v[88:89], v[6:7], v[4:5]
    v_pk_fma_f32 v[90:91], v[90:91], v[6:7], v[4:5]
    v_pk_mul_f32 v[88:89], v[88:89], v[204:205]
    v_pk_mul_f32 v[90:91], v[90:91], v[206:207]
    v_exp_f32 v88, v88
    v_exp_f32 v89, v89
    v_exp_f32 v90, v90
    v_exp_f32 v91, v91
    v_pk_add_f32 v[88:89], v[88:89], v[8:9]
    v_pk_add_f32 v[90:91], v[90:91], v[8:9]
    v_rcp_f32 v88, v88
    v_rcp_f32 v89, v89
    v_rcp_f32 v90, v90
    v_rcp_f32 v91, v91
    v_pk_mul_f32 v[88:89], v[88:89], v[204:205]
    v_pk_mul_f32 v[90:91], v[90:91], v[206:207]
    v_cvt_pk_bf16_f32 v92, v88, v89
    v_cvt_pk_bf16_f32 v93, v90, v91
    s_add_u32 s42, s39, 48
    s_cmp_ge_u32 s42, 1728
    s_cbranch_scc1 K5_KERNEL_SK_25
    s_add_u32 s42, s41, 3072
    buffer_store_dwordx2 v[92:93], v11, s[16:19], s42 offen offset:256
K5_KERNEL_SK_25:
    v_fma_f32 v64, v19, v240, v36
    v_fma_f32 v65, v19, v241, v37
    v_fma_f32 v66, v19, v242, v38
    v_fma_f32 v67, v19, v243, v39
    v_fma_f32 v208, v18, v208, v64
    v_fma_f32 v209, v18, v209, v65
    v_fma_f32 v210, v18, v210, v66
    v_fma_f32 v211, v18, v211, v67
    v_pk_mul_f32 v[64:65], v[208:209], v[208:209]
    v_pk_mul_f32 v[66:67], v[210:211], v[210:211]
    v_pk_fma_f32 v[64:65], v[64:65], v[6:7], v[4:5]
    v_pk_fma_f32 v[66:67], v[66:67], v[6:7], v[4:5]
    v_pk_mul_f32 v[64:65], v[64:65], v[208:209]
    v_pk_mul_f32 v[66:67], v[66:67], v[210:211]
    v_exp_f32 v64, v64
    v_exp_f32 v65, v65
    v_exp_f32 v66, v66
    v_exp_f32 v67, v67
    v_pk_add_f32 v[64:65], v[64:65], v[8:9]
    v_pk_add_f32 v[66:67], v[66:67], v[8:9]
    v_rcp_f32 v64, v64
    v_rcp_f32 v65, v65
    v_rcp_f32 v66, v66
    v_rcp_f32 v67, v67
    v_pk_mul_f32 v[64:65], v[64:65], v[208:209]
    v_pk_mul_f32 v[66:67], v[66:67], v[210:211]
    v_cvt_pk_bf16_f32 v68, v64, v65
    v_cvt_pk_bf16_f32 v69, v66, v67
    s_add_u32 s42, s39, 0
    s_cmp_ge_u32 s42, 1728
    s_cbranch_scc1 K5_KERNEL_SK_26
    s_add_u32 s42, s41, 110592
    buffer_store_dwordx2 v[68:69], v11, s[16:19], s42 offen offset:0
K5_KERNEL_SK_26:
    v_fma_f32 v72, v19, v244, v40
    v_fma_f32 v73, v19, v245, v41
    v_fma_f32 v74, v19, v246, v42
    v_fma_f32 v75, v19, v247, v43
    v_fma_f32 v212, v18, v212, v72
    v_fma_f32 v213, v18, v213, v73
    v_fma_f32 v214, v18, v214, v74
    v_fma_f32 v215, v18, v215, v75
    v_pk_mul_f32 v[72:73], v[212:213], v[212:213]
    v_pk_mul_f32 v[74:75], v[214:215], v[214:215]
    v_pk_fma_f32 v[72:73], v[72:73], v[6:7], v[4:5]
    v_pk_fma_f32 v[74:75], v[74:75], v[6:7], v[4:5]
    v_pk_mul_f32 v[72:73], v[72:73], v[212:213]
    v_pk_mul_f32 v[74:75], v[74:75], v[214:215]
    v_exp_f32 v72, v72
    v_exp_f32 v73, v73
    v_exp_f32 v74, v74
    v_exp_f32 v75, v75
    v_pk_add_f32 v[72:73], v[72:73], v[8:9]
    v_pk_add_f32 v[74:75], v[74:75], v[8:9]
    v_rcp_f32 v72, v72
    v_rcp_f32 v73, v73
    v_rcp_f32 v74, v74
    v_rcp_f32 v75, v75
    v_pk_mul_f32 v[72:73], v[72:73], v[212:213]
    v_pk_mul_f32 v[74:75], v[74:75], v[214:215]
    v_cvt_pk_bf16_f32 v76, v72, v73
    v_cvt_pk_bf16_f32 v77, v74, v75
    s_add_u32 s42, s39, 16
    s_cmp_ge_u32 s42, 1728
    s_cbranch_scc1 K5_KERNEL_SK_27
    s_add_u32 s42, s41, 111616
    buffer_store_dwordx2 v[76:77], v11, s[16:19], s42 offen offset:0
K5_KERNEL_SK_27:
    v_fma_f32 v80, v19, v248, v44
    v_fma_f32 v81, v19, v249, v45
    v_fma_f32 v82, v19, v250, v46
    v_fma_f32 v83, v19, v251, v47
    v_fma_f32 v216, v18, v216, v80
    v_fma_f32 v217, v18, v217, v81
    v_fma_f32 v218, v18, v218, v82
    v_fma_f32 v219, v18, v219, v83
    v_pk_mul_f32 v[80:81], v[216:217], v[216:217]
    v_pk_mul_f32 v[82:83], v[218:219], v[218:219]
    v_pk_fma_f32 v[80:81], v[80:81], v[6:7], v[4:5]
    v_pk_fma_f32 v[82:83], v[82:83], v[6:7], v[4:5]
    v_pk_mul_f32 v[80:81], v[80:81], v[216:217]
    v_pk_mul_f32 v[82:83], v[82:83], v[218:219]
    v_exp_f32 v80, v80
    v_exp_f32 v81, v81
    v_exp_f32 v82, v82
    v_exp_f32 v83, v83
    v_pk_add_f32 v[80:81], v[80:81], v[8:9]
    v_pk_add_f32 v[82:83], v[82:83], v[8:9]
    v_rcp_f32 v80, v80
    v_rcp_f32 v81, v81
    v_rcp_f32 v82, v82
    v_rcp_f32 v83, v83
    v_pk_mul_f32 v[80:81], v[80:81], v[216:217]
    v_pk_mul_f32 v[82:83], v[82:83], v[218:219]
    v_cvt_pk_bf16_f32 v84, v80, v81
    v_cvt_pk_bf16_f32 v85, v82, v83
    s_add_u32 s42, s39, 32
    s_cmp_ge_u32 s42, 1728
    s_cbranch_scc1 K5_KERNEL_SK_28
    s_add_u32 s42, s41, 112640
    buffer_store_dwordx2 v[84:85], v11, s[16:19], s42 offen offset:0
K5_KERNEL_SK_28:
    v_fma_f32 v88, v19, v252, v48
    v_fma_f32 v89, v19, v253, v49
    v_fma_f32 v90, v19, v254, v50
    v_fma_f32 v91, v19, v255, v51
    v_fma_f32 v220, v18, v220, v88
    v_fma_f32 v221, v18, v221, v89
    v_fma_f32 v222, v18, v222, v90
    v_fma_f32 v223, v18, v223, v91
    v_pk_mul_f32 v[88:89], v[220:221], v[220:221]
    v_pk_mul_f32 v[90:91], v[222:223], v[222:223]
    v_pk_fma_f32 v[88:89], v[88:89], v[6:7], v[4:5]
    v_pk_fma_f32 v[90:91], v[90:91], v[6:7], v[4:5]
    v_pk_mul_f32 v[88:89], v[88:89], v[220:221]
    v_pk_mul_f32 v[90:91], v[90:91], v[222:223]
    v_exp_f32 v88, v88
    v_exp_f32 v89, v89
    v_exp_f32 v90, v90
    v_exp_f32 v91, v91
    v_pk_add_f32 v[88:89], v[88:89], v[8:9]
    v_pk_add_f32 v[90:91], v[90:91], v[8:9]
    v_rcp_f32 v88, v88
    v_rcp_f32 v89, v89
    v_rcp_f32 v90, v90
    v_rcp_f32 v91, v91
    v_pk_mul_f32 v[88:89], v[88:89], v[220:221]
    v_pk_mul_f32 v[90:91], v[90:91], v[222:223]
    v_cvt_pk_bf16_f32 v92, v88, v89
    v_cvt_pk_bf16_f32 v93, v90, v91
    s_add_u32 s42, s39, 48
    s_cmp_ge_u32 s42, 1728
    s_cbranch_scc1 K5_KERNEL_SK_29
    s_add_u32 s42, s41, 113664
    buffer_store_dwordx2 v[92:93], v11, s[16:19], s42 offen offset:0
K5_KERNEL_SK_29:
    v_fma_f32 v64, v21, v240, v36
    v_fma_f32 v65, v21, v241, v37
    v_fma_f32 v66, v21, v242, v38
    v_fma_f32 v67, v21, v243, v39
    v_fma_f32 v224, v20, v224, v64
    v_fma_f32 v225, v20, v225, v65
    v_fma_f32 v226, v20, v226, v66
    v_fma_f32 v227, v20, v227, v67
    v_pk_mul_f32 v[64:65], v[224:225], v[224:225]
    v_pk_mul_f32 v[66:67], v[226:227], v[226:227]
    v_pk_fma_f32 v[64:65], v[64:65], v[6:7], v[4:5]
    v_pk_fma_f32 v[66:67], v[66:67], v[6:7], v[4:5]
    v_pk_mul_f32 v[64:65], v[64:65], v[224:225]
    v_pk_mul_f32 v[66:67], v[66:67], v[226:227]
    v_exp_f32 v64, v64
    v_exp_f32 v65, v65
    v_exp_f32 v66, v66
    v_exp_f32 v67, v67
    v_pk_add_f32 v[64:65], v[64:65], v[8:9]
    v_pk_add_f32 v[66:67], v[66:67], v[8:9]
    v_rcp_f32 v64, v64
    v_rcp_f32 v65, v65
    v_rcp_f32 v66, v66
    v_rcp_f32 v67, v67
    v_pk_mul_f32 v[64:65], v[64:65], v[224:225]
    v_pk_mul_f32 v[66:67], v[66:67], v[226:227]
    v_cvt_pk_bf16_f32 v68, v64, v65
    v_cvt_pk_bf16_f32 v69, v66, v67
    s_add_u32 s42, s39, 0
    s_cmp_ge_u32 s42, 1728
    s_cbranch_scc1 K5_KERNEL_SK_30
    s_add_u32 s42, s41, 110592
    buffer_store_dwordx2 v[68:69], v11, s[16:19], s42 offen offset:256
K5_KERNEL_SK_30:
    v_fma_f32 v72, v21, v244, v40
    v_fma_f32 v73, v21, v245, v41
    v_fma_f32 v74, v21, v246, v42
    v_fma_f32 v75, v21, v247, v43
    v_fma_f32 v228, v20, v228, v72
    v_fma_f32 v229, v20, v229, v73
    v_fma_f32 v230, v20, v230, v74
    v_fma_f32 v231, v20, v231, v75
    v_pk_mul_f32 v[72:73], v[228:229], v[228:229]
    v_pk_mul_f32 v[74:75], v[230:231], v[230:231]
    v_pk_fma_f32 v[72:73], v[72:73], v[6:7], v[4:5]
    v_pk_fma_f32 v[74:75], v[74:75], v[6:7], v[4:5]
    v_pk_mul_f32 v[72:73], v[72:73], v[228:229]
    v_pk_mul_f32 v[74:75], v[74:75], v[230:231]
    v_exp_f32 v72, v72
    v_exp_f32 v73, v73
    v_exp_f32 v74, v74
    v_exp_f32 v75, v75
    v_pk_add_f32 v[72:73], v[72:73], v[8:9]
    v_pk_add_f32 v[74:75], v[74:75], v[8:9]
    v_rcp_f32 v72, v72
    v_rcp_f32 v73, v73
    v_rcp_f32 v74, v74
    v_rcp_f32 v75, v75
    v_pk_mul_f32 v[72:73], v[72:73], v[228:229]
    v_pk_mul_f32 v[74:75], v[74:75], v[230:231]
    v_cvt_pk_bf16_f32 v76, v72, v73
    v_cvt_pk_bf16_f32 v77, v74, v75
    s_add_u32 s42, s39, 16
    s_cmp_ge_u32 s42, 1728
    s_cbranch_scc1 K5_KERNEL_SK_31
    s_add_u32 s42, s41, 111616
    buffer_store_dwordx2 v[76:77], v11, s[16:19], s42 offen offset:256
K5_KERNEL_SK_31:
    v_fma_f32 v80, v21, v248, v44
    v_fma_f32 v81, v21, v249, v45
    v_fma_f32 v82, v21, v250, v46
    v_fma_f32 v83, v21, v251, v47
    v_fma_f32 v232, v20, v232, v80
    v_fma_f32 v233, v20, v233, v81
    v_fma_f32 v234, v20, v234, v82
    v_fma_f32 v235, v20, v235, v83
    v_pk_mul_f32 v[80:81], v[232:233], v[232:233]
    v_pk_mul_f32 v[82:83], v[234:235], v[234:235]
    v_pk_fma_f32 v[80:81], v[80:81], v[6:7], v[4:5]
    v_pk_fma_f32 v[82:83], v[82:83], v[6:7], v[4:5]
    v_pk_mul_f32 v[80:81], v[80:81], v[232:233]
    v_pk_mul_f32 v[82:83], v[82:83], v[234:235]
    v_exp_f32 v80, v80
    v_exp_f32 v81, v81
    v_exp_f32 v82, v82
    v_exp_f32 v83, v83
    v_pk_add_f32 v[80:81], v[80:81], v[8:9]
    v_pk_add_f32 v[82:83], v[82:83], v[8:9]
    v_rcp_f32 v80, v80
    v_rcp_f32 v81, v81
    v_rcp_f32 v82, v82
    v_rcp_f32 v83, v83
    v_pk_mul_f32 v[80:81], v[80:81], v[232:233]
    v_pk_mul_f32 v[82:83], v[82:83], v[234:235]
    v_cvt_pk_bf16_f32 v84, v80, v81
    v_cvt_pk_bf16_f32 v85, v82, v83
    s_add_u32 s42, s39, 32
    s_cmp_ge_u32 s42, 1728
    s_cbranch_scc1 K5_KERNEL_SK_32
    s_add_u32 s42, s41, 112640
    buffer_store_dwordx2 v[84:85], v11, s[16:19], s42 offen offset:256
K5_KERNEL_SK_32:
    v_fma_f32 v88, v21, v252, v48
    v_fma_f32 v89, v21, v253, v49
    v_fma_f32 v90, v21, v254, v50
    v_fma_f32 v91, v21, v255, v51
    v_fma_f32 v236, v20, v236, v88
    v_fma_f32 v237, v20, v237, v89
    v_fma_f32 v238, v20, v238, v90
    v_fma_f32 v239, v20, v239, v91
    v_pk_mul_f32 v[88:89], v[236:237], v[236:237]
    v_pk_mul_f32 v[90:91], v[238:239], v[238:239]
    v_pk_fma_f32 v[88:89], v[88:89], v[6:7], v[4:5]
    v_pk_fma_f32 v[90:91], v[90:91], v[6:7], v[4:5]
    v_pk_mul_f32 v[88:89], v[88:89], v[236:237]
    v_pk_mul_f32 v[90:91], v[90:91], v[238:239]
    v_exp_f32 v88, v88
    v_exp_f32 v89, v89
    v_exp_f32 v90, v90
    v_exp_f32 v91, v91
    v_pk_add_f32 v[88:89], v[88:89], v[8:9]
    v_pk_add_f32 v[90:91], v[90:91], v[8:9]
    v_rcp_f32 v88, v88
    v_rcp_f32 v89, v89
    v_rcp_f32 v90, v90
    v_rcp_f32 v91, v91
    v_pk_mul_f32 v[88:89], v[88:89], v[236:237]
    v_pk_mul_f32 v[90:91], v[90:91], v[238:239]
    v_cvt_pk_bf16_f32 v92, v88, v89
    v_cvt_pk_bf16_f32 v93, v90, v91
    s_add_u32 s42, s39, 48
    s_cmp_ge_u32 s42, 1728
    s_cbranch_scc1 K5_KERNEL_SK_33
    s_add_u32 s42, s41, 113664
    buffer_store_dwordx2 v[92:93], v11, s[16:19], s42 offen offset:256
K5_KERNEL_SK_33:
    s_waitcnt vmcnt(0)
K5_KERNEL_END:
    s_endpgm
.globl k6_kernel
.p2align 8
.type k6_kernel,@function
k6_kernel:
    s_cmp_ge_u32 s2, 256
    s_cbranch_scc1 K6_KERNEL_END
    s_load_dwordx2 s[6:7], s[0:1], 104
    s_load_dwordx4 s[24:27], s[0:1], 80
    v_lshrrev_b32 v1, 6, v0
    v_mov_b32 v9, v0
    v_and_b32 v0, 63, v0
    v_readfirstlane_b32 s3, v1
    s_and_b32 s30, s2, 7
    s_lshl_b32 s30, s30, 2
    s_lshr_b32 s31, s2, 3
    s_and_b32 s33, s31, 3
    s_add_u32 s30, s30, s33
    s_lshr_b32 s31, s2, 5
    s_mov_b32 s32, s3
    s_mov_b32 s33, 0
    v_lshrrev_b32 v2, 5, v0
    v_lshlrev_b32 v2, 10, v2
    v_lshrrev_b32 v3, 4, v0
    v_and_b32 v3, 1, v3
    v_lshl_add_u32 v2, v3, 9, v2
    v_and_b32 v3, 15, v0
    v_lshl_add_u32 v1, v3, 4, v2
    v_lshlrev_b32 v2, 4, v0
    s_mul_i32 s36, s30, 221184
    s_mul_i32 s37, s32, 28672
    s_add_u32 s36, s36, s37
    s_add_u32 s35, s36, 110592
    s_mul_i32 s37, s31, 286720
    s_mul_i32 s38, s33, 286720
    s_add_u32 s37, s37, s38
    s_mul_i32 s38, s32, 14336
    s_add_u32 s37, s37, s38
    s_waitcnt lgkmcnt(0)
    s_add_u32 s8, s6, 85983232
    s_addc_u32 s9, s7, 0
    s_mov_b32 s10, 7077888
    s_mov_b32 s11, 0x00020000
    s_add_u32 s12, s6, 60817408
    s_addc_u32 s13, s7, 0
    s_mov_b32 s14, 2293760
    s_mov_b32 s15, 0x00020000
    s_add_u32 s45, s37, 0
    buffer_load_dwordx4 v[28:31], v2, s[12:15], s45 offen
    s_add_u32 s45, s37, 57344
    buffer_load_dwordx4 v[32:35], v2, s[12:15], s45 offen
    s_add_u32 s45, s37, 114688
    buffer_load_dwordx4 v[36:39], v2, s[12:15], s45 offen
    s_add_u32 s45, s37, 172032
    buffer_load_dwordx4 v[40:43], v2, s[12:15], s45 offen
    s_add_u32 s45, s37, 229376
    buffer_load_dwordx4 v[44:47], v2, s[12:15], s45 offen
    s_add_u32 s43, s36, 0
    s_add_u32 s44, s35, 0
    buffer_load_dwordx4 v[12:15], v1, s[8:11], s43 offen
    buffer_load_dwordx4 v[16:19], v1, s[8:11], s43 offen offset:256
    buffer_load_dwordx4 v[20:23], v1, s[8:11], s44 offen
    buffer_load_dwordx4 v[24:27], v1, s[8:11], s44 offen offset:256
    s_add_u32 s45, s37, 1024
    buffer_load_dwordx4 v[64:67], v2, s[12:15], s45 offen
    s_add_u32 s45, s37, 58368
    buffer_load_dwordx4 v[68:71], v2, s[12:15], s45 offen
    s_add_u32 s45, s37, 115712
    buffer_load_dwordx4 v[72:75], v2, s[12:15], s45 offen
    s_add_u32 s45, s37, 173056
    buffer_load_dwordx4 v[76:79], v2, s[12:15], s45 offen
    s_add_u32 s45, s37, 230400
    buffer_load_dwordx4 v[80:83], v2, s[12:15], s45 offen
    s_add_u32 s43, s36, 2048
    s_add_u32 s44, s35, 2048
    buffer_load_dwordx4 v[48:51], v1, s[8:11], s43 offen
    buffer_load_dwordx4 v[52:55], v1, s[8:11], s43 offen offset:256
    buffer_load_dwordx4 v[56:59], v1, s[8:11], s44 offen
    buffer_load_dwordx4 v[60:63], v1, s[8:11], s44 offen offset:256
    s_add_u32 s45, s37, 2048
    buffer_load_dwordx4 v[100:103], v2, s[12:15], s45 offen
    s_add_u32 s45, s37, 59392
    buffer_load_dwordx4 v[104:107], v2, s[12:15], s45 offen
    s_add_u32 s45, s37, 116736
    buffer_load_dwordx4 v[108:111], v2, s[12:15], s45 offen
    s_add_u32 s45, s37, 174080
    buffer_load_dwordx4 v[112:115], v2, s[12:15], s45 offen
    s_add_u32 s45, s37, 231424
    buffer_load_dwordx4 v[116:119], v2, s[12:15], s45 offen
    s_add_u32 s43, s36, 4096
    s_add_u32 s44, s35, 4096
    buffer_load_dwordx4 v[84:87], v1, s[8:11], s43 offen
    buffer_load_dwordx4 v[88:91], v1, s[8:11], s43 offen offset:256
    buffer_load_dwordx4 v[92:95], v1, s[8:11], s44 offen
    buffer_load_dwordx4 v[96:99], v1, s[8:11], s44 offen offset:256
    s_add_u32 s45, s37, 3072
    buffer_load_dwordx4 v[136:139], v2, s[12:15], s45 offen
    s_add_u32 s45, s37, 60416
    buffer_load_dwordx4 v[140:143], v2, s[12:15], s45 offen
    s_add_u32 s45, s37, 117760
    buffer_load_dwordx4 v[144:147], v2, s[12:15], s45 offen
    s_add_u32 s45, s37, 175104
    buffer_load_dwordx4 v[148:151], v2, s[12:15], s45 offen
    s_add_u32 s45, s37, 232448
    buffer_load_dwordx4 v[152:155], v2, s[12:15], s45 offen
    s_add_u32 s43, s36, 6144
    s_add_u32 s44, s35, 6144
    buffer_load_dwordx4 v[120:123], v1, s[8:11], s43 offen
    buffer_load_dwordx4 v[124:127], v1, s[8:11], s43 offen offset:256
    buffer_load_dwordx4 v[128:131], v1, s[8:11], s44 offen
    buffer_load_dwordx4 v[132:135], v1, s[8:11], s44 offen offset:256
    v_mov_b32 v176, 0
    v_mov_b32 v177, 0
    v_mov_b32 v178, 0
    v_mov_b32 v179, 0
    v_mov_b32 v180, 0
    v_mov_b32 v181, 0
    v_mov_b32 v182, 0
    v_mov_b32 v183, 0
    v_mov_b32 v184, 0
    v_mov_b32 v185, 0
    v_mov_b32 v186, 0
    v_mov_b32 v187, 0
    v_mov_b32 v188, 0
    v_mov_b32 v189, 0
    v_mov_b32 v190, 0
    v_mov_b32 v191, 0
    v_mov_b32 v192, 0
    v_mov_b32 v193, 0
    v_mov_b32 v194, 0
    v_mov_b32 v195, 0
    v_mov_b32 v196, 0
    v_mov_b32 v197, 0
    v_mov_b32 v198, 0
    v_mov_b32 v199, 0
    v_mov_b32 v200, 0
    v_mov_b32 v201, 0
    v_mov_b32 v202, 0
    v_mov_b32 v203, 0
    v_mov_b32 v204, 0
    v_mov_b32 v205, 0
    v_mov_b32 v206, 0
    v_mov_b32 v207, 0
    v_mov_b32 v208, 0
    v_mov_b32 v209, 0
    v_mov_b32 v210, 0
    v_mov_b32 v211, 0
    v_mov_b32 v212, 0
    v_mov_b32 v213, 0
    v_mov_b32 v214, 0
    v_mov_b32 v215, 0
    v_mov_b32 v216, 0
    v_mov_b32 v217, 0
    v_mov_b32 v218, 0
    v_mov_b32 v219, 0
    v_mov_b32 v220, 0
    v_mov_b32 v221, 0
    v_mov_b32 v222, 0
    v_mov_b32 v223, 0
    v_mov_b32 v224, 0
    v_mov_b32 v225, 0
    v_mov_b32 v226, 0
    v_mov_b32 v227, 0
    v_mov_b32 v228, 0
    v_mov_b32 v229, 0
    v_mov_b32 v230, 0
    v_mov_b32 v231, 0
    v_mov_b32 v232, 0
    v_mov_b32 v233, 0
    v_mov_b32 v234, 0
    v_mov_b32 v235, 0
    v_mov_b32 v236, 0
    v_mov_b32 v237, 0
    v_mov_b32 v238, 0
    v_mov_b32 v239, 0
    v_mov_b32 v240, 0
    v_mov_b32 v241, 0
    v_mov_b32 v242, 0
    v_mov_b32 v243, 0
    v_mov_b32 v244, 0
    v_mov_b32 v245, 0
    v_mov_b32 v246, 0
    v_mov_b32 v247, 0
    v_mov_b32 v248, 0
    v_mov_b32 v249, 0
    v_mov_b32 v250, 0
    v_mov_b32 v251, 0
    v_mov_b32 v252, 0
    v_mov_b32 v253, 0
    v_mov_b32 v254, 0
    v_mov_b32 v255, 0
    s_waitcnt vmcnt(27)
    v_mfma_f32_16x16x32_bf16 v[176:179], v[28:31], v[12:15], v[176:179]
    v_mfma_f32_16x16x32_bf16 v[196:199], v[28:31], v[16:19], v[196:199]
    v_mfma_f32_16x16x32_bf16 v[216:219], v[28:31], v[20:23], v[216:219]
    v_mfma_f32_16x16x32_bf16 v[236:239], v[28:31], v[24:27], v[236:239]
    s_add_u32 s45, s37, 4096
    buffer_load_dwordx4 v[28:31], v2, s[12:15], s45 offen
    v_mfma_f32_16x16x32_bf16 v[180:183], v[32:35], v[12:15], v[180:183]
    v_mfma_f32_16x16x32_bf16 v[200:203], v[32:35], v[16:19], v[200:203]
    v_mfma_f32_16x16x32_bf16 v[220:223], v[32:35], v[20:23], v[220:223]
    v_mfma_f32_16x16x32_bf16 v[240:243], v[32:35], v[24:27], v[240:243]
    s_add_u32 s45, s37, 61440
    buffer_load_dwordx4 v[32:35], v2, s[12:15], s45 offen
    v_mfma_f32_16x16x32_bf16 v[184:187], v[36:39], v[12:15], v[184:187]
    v_mfma_f32_16x16x32_bf16 v[204:207], v[36:39], v[16:19], v[204:207]
    v_mfma_f32_16x16x32_bf16 v[224:227], v[36:39], v[20:23], v[224:227]
    v_mfma_f32_16x16x32_bf16 v[244:247], v[36:39], v[24:27], v[244:247]
    s_add_u32 s45, s37, 118784
    buffer_load_dwordx4 v[36:39], v2, s[12:15], s45 offen
    v_mfma_f32_16x16x32_bf16 v[188:191], v[40:43], v[12:15], v[188:191]
    v_mfma_f32_16x16x32_bf16 v[208:211], v[40:43], v[16:19], v[208:211]
    v_mfma_f32_16x16x32_bf16 v[228:231], v[40:43], v[20:23], v[228:231]
    v_mfma_f32_16x16x32_bf16 v[248:251], v[40:43], v[24:27], v[248:251]
    s_add_u32 s45, s37, 176128
    buffer_load_dwordx4 v[40:43], v2, s[12:15], s45 offen
    v_mfma_f32_16x16x32_bf16 v[192:195], v[44:47], v[12:15], v[192:195]
    v_mfma_f32_16x16x32_bf16 v[212:215], v[44:47], v[16:19], v[212:215]
    v_mfma_f32_16x16x32_bf16 v[232:235], v[44:47], v[20:23], v[232:235]
    v_mfma_f32_16x16x32_bf16 v[252:255], v[44:47], v[24:27], v[252:255]
    s_add_u32 s45, s37, 233472
    buffer_load_dwordx4 v[44:47], v2, s[12:15], s45 offen
    s_add_u32 s43, s36, 8192
    s_add_u32 s44, s35, 8192
    buffer_load_dwordx4 v[12:15], v1, s[8:11], s43 offen
    buffer_load_dwordx4 v[16:19], v1, s[8:11], s43 offen offset:256
    buffer_load_dwordx4 v[20:23], v1, s[8:11], s44 offen
    buffer_load_dwordx4 v[24:27], v1, s[8:11], s44 offen offset:256
    s_waitcnt vmcnt(27)
    v_mfma_f32_16x16x32_bf16 v[176:179], v[64:67], v[48:51], v[176:179]
    v_mfma_f32_16x16x32_bf16 v[196:199], v[64:67], v[52:55], v[196:199]
    v_mfma_f32_16x16x32_bf16 v[216:219], v[64:67], v[56:59], v[216:219]
    v_mfma_f32_16x16x32_bf16 v[236:239], v[64:67], v[60:63], v[236:239]
    s_add_u32 s45, s37, 5120
    buffer_load_dwordx4 v[64:67], v2, s[12:15], s45 offen
    v_mfma_f32_16x16x32_bf16 v[180:183], v[68:71], v[48:51], v[180:183]
    v_mfma_f32_16x16x32_bf16 v[200:203], v[68:71], v[52:55], v[200:203]
    v_mfma_f32_16x16x32_bf16 v[220:223], v[68:71], v[56:59], v[220:223]
    v_mfma_f32_16x16x32_bf16 v[240:243], v[68:71], v[60:63], v[240:243]
    s_add_u32 s45, s37, 62464
    buffer_load_dwordx4 v[68:71], v2, s[12:15], s45 offen
    v_mfma_f32_16x16x32_bf16 v[184:187], v[72:75], v[48:51], v[184:187]
    v_mfma_f32_16x16x32_bf16 v[204:207], v[72:75], v[52:55], v[204:207]
    v_mfma_f32_16x16x32_bf16 v[224:227], v[72:75], v[56:59], v[224:227]
    v_mfma_f32_16x16x32_bf16 v[244:247], v[72:75], v[60:63], v[244:247]
    s_add_u32 s45, s37, 119808
    buffer_load_dwordx4 v[72:75], v2, s[12:15], s45 offen
    v_mfma_f32_16x16x32_bf16 v[188:191], v[76:79], v[48:51], v[188:191]
    v_mfma_f32_16x16x32_bf16 v[208:211], v[76:79], v[52:55], v[208:211]
    v_mfma_f32_16x16x32_bf16 v[228:231], v[76:79], v[56:59], v[228:231]
    v_mfma_f32_16x16x32_bf16 v[248:251], v[76:79], v[60:63], v[248:251]
    s_add_u32 s45, s37, 177152
    buffer_load_dwordx4 v[76:79], v2, s[12:15], s45 offen
    v_mfma_f32_16x16x32_bf16 v[192:195], v[80:83], v[48:51], v[192:195]
    v_mfma_f32_16x16x32_bf16 v[212:215], v[80:83], v[52:55], v[212:215]
    v_mfma_f32_16x16x32_bf16 v[232:235], v[80:83], v[56:59], v[232:235]
    v_mfma_f32_16x16x32_bf16 v[252:255], v[80:83], v[60:63], v[252:255]
    s_add_u32 s45, s37, 234496
    buffer_load_dwordx4 v[80:83], v2, s[12:15], s45 offen
    s_add_u32 s43, s36, 10240
    s_add_u32 s44, s35, 10240
    buffer_load_dwordx4 v[48:51], v1, s[8:11], s43 offen
    buffer_load_dwordx4 v[52:55], v1, s[8:11], s43 offen offset:256
    buffer_load_dwordx4 v[56:59], v1, s[8:11], s44 offen
    buffer_load_dwordx4 v[60:63], v1, s[8:11], s44 offen offset:256
    s_waitcnt vmcnt(27)
    v_mfma_f32_16x16x32_bf16 v[176:179], v[100:103], v[84:87], v[176:179]
    v_mfma_f32_16x16x32_bf16 v[196:199], v[100:103], v[88:91], v[196:199]
    v_mfma_f32_16x16x32_bf16 v[216:219], v[100:103], v[92:95], v[216:219]
    v_mfma_f32_16x16x32_bf16 v[236:239], v[100:103], v[96:99], v[236:239]
    s_add_u32 s45, s37, 6144
    buffer_load_dwordx4 v[100:103], v2, s[12:15], s45 offen
    v_mfma_f32_16x16x32_bf16 v[180:183], v[104:107], v[84:87], v[180:183]
    v_mfma_f32_16x16x32_bf16 v[200:203], v[104:107], v[88:91], v[200:203]
    v_mfma_f32_16x16x32_bf16 v[220:223], v[104:107], v[92:95], v[220:223]
    v_mfma_f32_16x16x32_bf16 v[240:243], v[104:107], v[96:99], v[240:243]
    s_add_u32 s45, s37, 63488
    buffer_load_dwordx4 v[104:107], v2, s[12:15], s45 offen
    v_mfma_f32_16x16x32_bf16 v[184:187], v[108:111], v[84:87], v[184:187]
    v_mfma_f32_16x16x32_bf16 v[204:207], v[108:111], v[88:91], v[204:207]
    v_mfma_f32_16x16x32_bf16 v[224:227], v[108:111], v[92:95], v[224:227]
    v_mfma_f32_16x16x32_bf16 v[244:247], v[108:111], v[96:99], v[244:247]
    s_add_u32 s45, s37, 120832
    buffer_load_dwordx4 v[108:111], v2, s[12:15], s45 offen
    v_mfma_f32_16x16x32_bf16 v[188:191], v[112:115], v[84:87], v[188:191]
    v_mfma_f32_16x16x32_bf16 v[208:211], v[112:115], v[88:91], v[208:211]
    v_mfma_f32_16x16x32_bf16 v[228:231], v[112:115], v[92:95], v[228:231]
    v_mfma_f32_16x16x32_bf16 v[248:251], v[112:115], v[96:99], v[248:251]
    s_add_u32 s45, s37, 178176
    buffer_load_dwordx4 v[112:115], v2, s[12:15], s45 offen
    v_mfma_f32_16x16x32_bf16 v[192:195], v[116:119], v[84:87], v[192:195]
    v_mfma_f32_16x16x32_bf16 v[212:215], v[116:119], v[88:91], v[212:215]
    v_mfma_f32_16x16x32_bf16 v[232:235], v[116:119], v[92:95], v[232:235]
    v_mfma_f32_16x16x32_bf16 v[252:255], v[116:119], v[96:99], v[252:255]
    s_add_u32 s45, s37, 235520
    buffer_load_dwordx4 v[116:119], v2, s[12:15], s45 offen
    s_add_u32 s43, s36, 12288
    s_add_u32 s44, s35, 12288
    buffer_load_dwordx4 v[84:87], v1, s[8:11], s43 offen
    buffer_load_dwordx4 v[88:91], v1, s[8:11], s43 offen offset:256
    buffer_load_dwordx4 v[92:95], v1, s[8:11], s44 offen
    buffer_load_dwordx4 v[96:99], v1, s[8:11], s44 offen offset:256
    s_waitcnt vmcnt(27)
    v_mfma_f32_16x16x32_bf16 v[176:179], v[136:139], v[120:123], v[176:179]
    v_mfma_f32_16x16x32_bf16 v[196:199], v[136:139], v[124:127], v[196:199]
    v_mfma_f32_16x16x32_bf16 v[216:219], v[136:139], v[128:131], v[216:219]
    v_mfma_f32_16x16x32_bf16 v[236:239], v[136:139], v[132:135], v[236:239]
    s_add_u32 s45, s37, 7168
    buffer_load_dwordx4 v[136:139], v2, s[12:15], s45 offen
    v_mfma_f32_16x16x32_bf16 v[180:183], v[140:143], v[120:123], v[180:183]
    v_mfma_f32_16x16x32_bf16 v[200:203], v[140:143], v[124:127], v[200:203]
    v_mfma_f32_16x16x32_bf16 v[220:223], v[140:143], v[128:131], v[220:223]
    v_mfma_f32_16x16x32_bf16 v[240:243], v[140:143], v[132:135], v[240:243]
    s_add_u32 s45, s37, 64512
    buffer_load_dwordx4 v[140:143], v2, s[12:15], s45 offen
    v_mfma_f32_16x16x32_bf16 v[184:187], v[144:147], v[120:123], v[184:187]
    v_mfma_f32_16x16x32_bf16 v[204:207], v[144:147], v[124:127], v[204:207]
    v_mfma_f32_16x16x32_bf16 v[224:227], v[144:147], v[128:131], v[224:227]
    v_mfma_f32_16x16x32_bf16 v[244:247], v[144:147], v[132:135], v[244:247]
    s_add_u32 s45, s37, 121856
    buffer_load_dwordx4 v[144:147], v2, s[12:15], s45 offen
    v_mfma_f32_16x16x32_bf16 v[188:191], v[148:151], v[120:123], v[188:191]
    v_mfma_f32_16x16x32_bf16 v[208:211], v[148:151], v[124:127], v[208:211]
    v_mfma_f32_16x16x32_bf16 v[228:231], v[148:151], v[128:131], v[228:231]
    v_mfma_f32_16x16x32_bf16 v[248:251], v[148:151], v[132:135], v[248:251]
    s_add_u32 s45, s37, 179200
    buffer_load_dwordx4 v[148:151], v2, s[12:15], s45 offen
    v_mfma_f32_16x16x32_bf16 v[192:195], v[152:155], v[120:123], v[192:195]
    v_mfma_f32_16x16x32_bf16 v[212:215], v[152:155], v[124:127], v[212:215]
    v_mfma_f32_16x16x32_bf16 v[232:235], v[152:155], v[128:131], v[232:235]
    v_mfma_f32_16x16x32_bf16 v[252:255], v[152:155], v[132:135], v[252:255]
    s_add_u32 s45, s37, 236544
    buffer_load_dwordx4 v[152:155], v2, s[12:15], s45 offen
    s_add_u32 s43, s36, 14336
    s_add_u32 s44, s35, 14336
    buffer_load_dwordx4 v[120:123], v1, s[8:11], s43 offen
    buffer_load_dwordx4 v[124:127], v1, s[8:11], s43 offen offset:256
    buffer_load_dwordx4 v[128:131], v1, s[8:11], s44 offen
    buffer_load_dwordx4 v[132:135], v1, s[8:11], s44 offen offset:256
    s_waitcnt vmcnt(27)
    v_mfma_f32_16x16x32_bf16 v[176:179], v[28:31], v[12:15], v[176:179]
    v_mfma_f32_16x16x32_bf16 v[196:199], v[28:31], v[16:19], v[196:199]
    v_mfma_f32_16x16x32_bf16 v[216:219], v[28:31], v[20:23], v[216:219]
    v_mfma_f32_16x16x32_bf16 v[236:239], v[28:31], v[24:27], v[236:239]
    s_add_u32 s45, s37, 8192
    buffer_load_dwordx4 v[28:31], v2, s[12:15], s45 offen
    v_mfma_f32_16x16x32_bf16 v[180:183], v[32:35], v[12:15], v[180:183]
    v_mfma_f32_16x16x32_bf16 v[200:203], v[32:35], v[16:19], v[200:203]
    v_mfma_f32_16x16x32_bf16 v[220:223], v[32:35], v[20:23], v[220:223]
    v_mfma_f32_16x16x32_bf16 v[240:243], v[32:35], v[24:27], v[240:243]
    s_add_u32 s45, s37, 65536
    buffer_load_dwordx4 v[32:35], v2, s[12:15], s45 offen
    v_mfma_f32_16x16x32_bf16 v[184:187], v[36:39], v[12:15], v[184:187]
    v_mfma_f32_16x16x32_bf16 v[204:207], v[36:39], v[16:19], v[204:207]
    v_mfma_f32_16x16x32_bf16 v[224:227], v[36:39], v[20:23], v[224:227]
    v_mfma_f32_16x16x32_bf16 v[244:247], v[36:39], v[24:27], v[244:247]
    s_add_u32 s45, s37, 122880
    buffer_load_dwordx4 v[36:39], v2, s[12:15], s45 offen
    v_mfma_f32_16x16x32_bf16 v[188:191], v[40:43], v[12:15], v[188:191]
    v_mfma_f32_16x16x32_bf16 v[208:211], v[40:43], v[16:19], v[208:211]
    v_mfma_f32_16x16x32_bf16 v[228:231], v[40:43], v[20:23], v[228:231]
    v_mfma_f32_16x16x32_bf16 v[248:251], v[40:43], v[24:27], v[248:251]
    s_add_u32 s45, s37, 180224
    buffer_load_dwordx4 v[40:43], v2, s[12:15], s45 offen
    v_mfma_f32_16x16x32_bf16 v[192:195], v[44:47], v[12:15], v[192:195]
    v_mfma_f32_16x16x32_bf16 v[212:215], v[44:47], v[16:19], v[212:215]
    v_mfma_f32_16x16x32_bf16 v[232:235], v[44:47], v[20:23], v[232:235]
    v_mfma_f32_16x16x32_bf16 v[252:255], v[44:47], v[24:27], v[252:255]
    s_add_u32 s45, s37, 237568
    buffer_load_dwordx4 v[44:47], v2, s[12:15], s45 offen
    s_add_u32 s43, s36, 16384
    s_add_u32 s44, s35, 16384
    buffer_load_dwordx4 v[12:15], v1, s[8:11], s43 offen
    buffer_load_dwordx4 v[16:19], v1, s[8:11], s43 offen offset:256
    buffer_load_dwordx4 v[20:23], v1, s[8:11], s44 offen
    buffer_load_dwordx4 v[24:27], v1, s[8:11], s44 offen offset:256
    s_waitcnt vmcnt(27)
    v_mfma_f32_16x16x32_bf16 v[176:179], v[64:67], v[48:51], v[176:179]
    v_mfma_f32_16x16x32_bf16 v[196:199], v[64:67], v[52:55], v[196:199]
    v_mfma_f32_16x16x32_bf16 v[216:219], v[64:67], v[56:59], v[216:219]
    v_mfma_f32_16x16x32_bf16 v[236:239], v[64:67], v[60:63], v[236:239]
    s_add_u32 s45, s37, 9216
    buffer_load_dwordx4 v[64:67], v2, s[12:15], s45 offen
    v_mfma_f32_16x16x32_bf16 v[180:183], v[68:71], v[48:51], v[180:183]
    v_mfma_f32_16x16x32_bf16 v[200:203], v[68:71], v[52:55], v[200:203]
    v_mfma_f32_16x16x32_bf16 v[220:223], v[68:71], v[56:59], v[220:223]
    v_mfma_f32_16x16x32_bf16 v[240:243], v[68:71], v[60:63], v[240:243]
    s_add_u32 s45, s37, 66560
    buffer_load_dwordx4 v[68:71], v2, s[12:15], s45 offen
    v_mfma_f32_16x16x32_bf16 v[184:187], v[72:75], v[48:51], v[184:187]
    v_mfma_f32_16x16x32_bf16 v[204:207], v[72:75], v[52:55], v[204:207]
    v_mfma_f32_16x16x32_bf16 v[224:227], v[72:75], v[56:59], v[224:227]
    v_mfma_f32_16x16x32_bf16 v[244:247], v[72:75], v[60:63], v[244:247]
    s_add_u32 s45, s37, 123904
    buffer_load_dwordx4 v[72:75], v2, s[12:15], s45 offen
    v_mfma_f32_16x16x32_bf16 v[188:191], v[76:79], v[48:51], v[188:191]
    v_mfma_f32_16x16x32_bf16 v[208:211], v[76:79], v[52:55], v[208:211]
    v_mfma_f32_16x16x32_bf16 v[228:231], v[76:79], v[56:59], v[228:231]
    v_mfma_f32_16x16x32_bf16 v[248:251], v[76:79], v[60:63], v[248:251]
    s_add_u32 s45, s37, 181248
    buffer_load_dwordx4 v[76:79], v2, s[12:15], s45 offen
    v_mfma_f32_16x16x32_bf16 v[192:195], v[80:83], v[48:51], v[192:195]
    v_mfma_f32_16x16x32_bf16 v[212:215], v[80:83], v[52:55], v[212:215]
    v_mfma_f32_16x16x32_bf16 v[232:235], v[80:83], v[56:59], v[232:235]
    v_mfma_f32_16x16x32_bf16 v[252:255], v[80:83], v[60:63], v[252:255]
    s_add_u32 s45, s37, 238592
    buffer_load_dwordx4 v[80:83], v2, s[12:15], s45 offen
    s_add_u32 s43, s36, 18432
    s_add_u32 s44, s35, 18432
    buffer_load_dwordx4 v[48:51], v1, s[8:11], s43 offen
    buffer_load_dwordx4 v[52:55], v1, s[8:11], s43 offen offset:256
    buffer_load_dwordx4 v[56:59], v1, s[8:11], s44 offen
    buffer_load_dwordx4 v[60:63], v1, s[8:11], s44 offen offset:256
    s_waitcnt vmcnt(27)
    v_mfma_f32_16x16x32_bf16 v[176:179], v[100:103], v[84:87], v[176:179]
    v_mfma_f32_16x16x32_bf16 v[196:199], v[100:103], v[88:91], v[196:199]
    v_mfma_f32_16x16x32_bf16 v[216:219], v[100:103], v[92:95], v[216:219]
    v_mfma_f32_16x16x32_bf16 v[236:239], v[100:103], v[96:99], v[236:239]
    s_add_u32 s45, s37, 10240
    buffer_load_dwordx4 v[100:103], v2, s[12:15], s45 offen
    v_mfma_f32_16x16x32_bf16 v[180:183], v[104:107], v[84:87], v[180:183]
    v_mfma_f32_16x16x32_bf16 v[200:203], v[104:107], v[88:91], v[200:203]
    v_mfma_f32_16x16x32_bf16 v[220:223], v[104:107], v[92:95], v[220:223]
    v_mfma_f32_16x16x32_bf16 v[240:243], v[104:107], v[96:99], v[240:243]
    s_add_u32 s45, s37, 67584
    buffer_load_dwordx4 v[104:107], v2, s[12:15], s45 offen
    v_mfma_f32_16x16x32_bf16 v[184:187], v[108:111], v[84:87], v[184:187]
    v_mfma_f32_16x16x32_bf16 v[204:207], v[108:111], v[88:91], v[204:207]
    v_mfma_f32_16x16x32_bf16 v[224:227], v[108:111], v[92:95], v[224:227]
    v_mfma_f32_16x16x32_bf16 v[244:247], v[108:111], v[96:99], v[244:247]
    s_add_u32 s45, s37, 124928
    buffer_load_dwordx4 v[108:111], v2, s[12:15], s45 offen
    v_mfma_f32_16x16x32_bf16 v[188:191], v[112:115], v[84:87], v[188:191]
    v_mfma_f32_16x16x32_bf16 v[208:211], v[112:115], v[88:91], v[208:211]
    v_mfma_f32_16x16x32_bf16 v[228:231], v[112:115], v[92:95], v[228:231]
    v_mfma_f32_16x16x32_bf16 v[248:251], v[112:115], v[96:99], v[248:251]
    s_add_u32 s45, s37, 182272
    buffer_load_dwordx4 v[112:115], v2, s[12:15], s45 offen
    v_mfma_f32_16x16x32_bf16 v[192:195], v[116:119], v[84:87], v[192:195]
    v_mfma_f32_16x16x32_bf16 v[212:215], v[116:119], v[88:91], v[212:215]
    v_mfma_f32_16x16x32_bf16 v[232:235], v[116:119], v[92:95], v[232:235]
    v_mfma_f32_16x16x32_bf16 v[252:255], v[116:119], v[96:99], v[252:255]
    s_add_u32 s45, s37, 239616
    buffer_load_dwordx4 v[116:119], v2, s[12:15], s45 offen
    s_add_u32 s43, s36, 20480
    s_add_u32 s44, s35, 20480
    buffer_load_dwordx4 v[84:87], v1, s[8:11], s43 offen
    buffer_load_dwordx4 v[88:91], v1, s[8:11], s43 offen offset:256
    buffer_load_dwordx4 v[92:95], v1, s[8:11], s44 offen
    buffer_load_dwordx4 v[96:99], v1, s[8:11], s44 offen offset:256
    s_waitcnt vmcnt(27)
    v_mfma_f32_16x16x32_bf16 v[176:179], v[136:139], v[120:123], v[176:179]
    v_mfma_f32_16x16x32_bf16 v[196:199], v[136:139], v[124:127], v[196:199]
    v_mfma_f32_16x16x32_bf16 v[216:219], v[136:139], v[128:131], v[216:219]
    v_mfma_f32_16x16x32_bf16 v[236:239], v[136:139], v[132:135], v[236:239]
    s_add_u32 s45, s37, 11264
    buffer_load_dwordx4 v[136:139], v2, s[12:15], s45 offen
    v_mfma_f32_16x16x32_bf16 v[180:183], v[140:143], v[120:123], v[180:183]
    v_mfma_f32_16x16x32_bf16 v[200:203], v[140:143], v[124:127], v[200:203]
    v_mfma_f32_16x16x32_bf16 v[220:223], v[140:143], v[128:131], v[220:223]
    v_mfma_f32_16x16x32_bf16 v[240:243], v[140:143], v[132:135], v[240:243]
    s_add_u32 s45, s37, 68608
    buffer_load_dwordx4 v[140:143], v2, s[12:15], s45 offen
    v_mfma_f32_16x16x32_bf16 v[184:187], v[144:147], v[120:123], v[184:187]
    v_mfma_f32_16x16x32_bf16 v[204:207], v[144:147], v[124:127], v[204:207]
    v_mfma_f32_16x16x32_bf16 v[224:227], v[144:147], v[128:131], v[224:227]
    v_mfma_f32_16x16x32_bf16 v[244:247], v[144:147], v[132:135], v[244:247]
    s_add_u32 s45, s37, 125952
    buffer_load_dwordx4 v[144:147], v2, s[12:15], s45 offen
    v_mfma_f32_16x16x32_bf16 v[188:191], v[148:151], v[120:123], v[188:191]
    v_mfma_f32_16x16x32_bf16 v[208:211], v[148:151], v[124:127], v[208:211]
    v_mfma_f32_16x16x32_bf16 v[228:231], v[148:151], v[128:131], v[228:231]
    v_mfma_f32_16x16x32_bf16 v[248:251], v[148:151], v[132:135], v[248:251]
    s_add_u32 s45, s37, 183296
    buffer_load_dwordx4 v[148:151], v2, s[12:15], s45 offen
    v_mfma_f32_16x16x32_bf16 v[192:195], v[152:155], v[120:123], v[192:195]
    v_mfma_f32_16x16x32_bf16 v[212:215], v[152:155], v[124:127], v[212:215]
    v_mfma_f32_16x16x32_bf16 v[232:235], v[152:155], v[128:131], v[232:235]
    v_mfma_f32_16x16x32_bf16 v[252:255], v[152:155], v[132:135], v[252:255]
    s_add_u32 s45, s37, 240640
    buffer_load_dwordx4 v[152:155], v2, s[12:15], s45 offen
    s_add_u32 s43, s36, 22528
    s_add_u32 s44, s35, 22528
    buffer_load_dwordx4 v[120:123], v1, s[8:11], s43 offen
    buffer_load_dwordx4 v[124:127], v1, s[8:11], s43 offen offset:256
    buffer_load_dwordx4 v[128:131], v1, s[8:11], s44 offen
    buffer_load_dwordx4 v[132:135], v1, s[8:11], s44 offen offset:256
    s_waitcnt vmcnt(27)
    v_mfma_f32_16x16x32_bf16 v[176:179], v[28:31], v[12:15], v[176:179]
    v_mfma_f32_16x16x32_bf16 v[196:199], v[28:31], v[16:19], v[196:199]
    v_mfma_f32_16x16x32_bf16 v[216:219], v[28:31], v[20:23], v[216:219]
    v_mfma_f32_16x16x32_bf16 v[236:239], v[28:31], v[24:27], v[236:239]
    s_add_u32 s45, s37, 12288
    buffer_load_dwordx4 v[28:31], v2, s[12:15], s45 offen
    v_mfma_f32_16x16x32_bf16 v[180:183], v[32:35], v[12:15], v[180:183]
    v_mfma_f32_16x16x32_bf16 v[200:203], v[32:35], v[16:19], v[200:203]
    v_mfma_f32_16x16x32_bf16 v[220:223], v[32:35], v[20:23], v[220:223]
    v_mfma_f32_16x16x32_bf16 v[240:243], v[32:35], v[24:27], v[240:243]
    s_add_u32 s45, s37, 69632
    buffer_load_dwordx4 v[32:35], v2, s[12:15], s45 offen
    v_mfma_f32_16x16x32_bf16 v[184:187], v[36:39], v[12:15], v[184:187]
    v_mfma_f32_16x16x32_bf16 v[204:207], v[36:39], v[16:19], v[204:207]
    v_mfma_f32_16x16x32_bf16 v[224:227], v[36:39], v[20:23], v[224:227]
    v_mfma_f32_16x16x32_bf16 v[244:247], v[36:39], v[24:27], v[244:247]
    s_add_u32 s45, s37, 126976
    buffer_load_dwordx4 v[36:39], v2, s[12:15], s45 offen
    v_mfma_f32_16x16x32_bf16 v[188:191], v[40:43], v[12:15], v[188:191]
    v_mfma_f32_16x16x32_bf16 v[208:211], v[40:43], v[16:19], v[208:211]
    v_mfma_f32_16x16x32_bf16 v[228:231], v[40:43], v[20:23], v[228:231]
    v_mfma_f32_16x16x32_bf16 v[248:251], v[40:43], v[24:27], v[248:251]
    s_add_u32 s45, s37, 184320
    buffer_load_dwordx4 v[40:43], v2, s[12:15], s45 offen
    v_mfma_f32_16x16x32_bf16 v[192:195], v[44:47], v[12:15], v[192:195]
    v_mfma_f32_16x16x32_bf16 v[212:215], v[44:47], v[16:19], v[212:215]
    v_mfma_f32_16x16x32_bf16 v[232:235], v[44:47], v[20:23], v[232:235]
    v_mfma_f32_16x16x32_bf16 v[252:255], v[44:47], v[24:27], v[252:255]
    s_add_u32 s45, s37, 241664
    buffer_load_dwordx4 v[44:47], v2, s[12:15], s45 offen
    s_add_u32 s43, s36, 24576
    s_add_u32 s44, s35, 24576
    buffer_load_dwordx4 v[12:15], v1, s[8:11], s43 offen
    buffer_load_dwordx4 v[16:19], v1, s[8:11], s43 offen offset:256
    buffer_load_dwordx4 v[20:23], v1, s[8:11], s44 offen
    buffer_load_dwordx4 v[24:27], v1, s[8:11], s44 offen offset:256
    s_waitcnt vmcnt(27)
    v_mfma_f32_16x16x32_bf16 v[176:179], v[64:67], v[48:51], v[176:179]
    v_mfma_f32_16x16x32_bf16 v[196:199], v[64:67], v[52:55], v[196:199]
    v_mfma_f32_16x16x32_bf16 v[216:219], v[64:67], v[56:59], v[216:219]
    v_mfma_f32_16x16x32_bf16 v[236:239], v[64:67], v[60:63], v[236:239]
    s_add_u32 s45, s37, 13312
    buffer_load_dwordx4 v[64:67], v2, s[12:15], s45 offen
    v_mfma_f32_16x16x32_bf16 v[180:183], v[68:71], v[48:51], v[180:183]
    v_mfma_f32_16x16x32_bf16 v[200:203], v[68:71], v[52:55], v[200:203]
    v_mfma_f32_16x16x32_bf16 v[220:223], v[68:71], v[56:59], v[220:223]
    v_mfma_f32_16x16x32_bf16 v[240:243], v[68:71], v[60:63], v[240:243]
    s_add_u32 s45, s37, 70656
    buffer_load_dwordx4 v[68:71], v2, s[12:15], s45 offen
    v_mfma_f32_16x16x32_bf16 v[184:187], v[72:75], v[48:51], v[184:187]
    v_mfma_f32_16x16x32_bf16 v[204:207], v[72:75], v[52:55], v[204:207]
    v_mfma_f32_16x16x32_bf16 v[224:227], v[72:75], v[56:59], v[224:227]
    v_mfma_f32_16x16x32_bf16 v[244:247], v[72:75], v[60:63], v[244:247]
    s_add_u32 s45, s37, 128000
    buffer_load_dwordx4 v[72:75], v2, s[12:15], s45 offen
    v_mfma_f32_16x16x32_bf16 v[188:191], v[76:79], v[48:51], v[188:191]
    v_mfma_f32_16x16x32_bf16 v[208:211], v[76:79], v[52:55], v[208:211]
    v_mfma_f32_16x16x32_bf16 v[228:231], v[76:79], v[56:59], v[228:231]
    v_mfma_f32_16x16x32_bf16 v[248:251], v[76:79], v[60:63], v[248:251]
    s_add_u32 s45, s37, 185344
    buffer_load_dwordx4 v[76:79], v2, s[12:15], s45 offen
    v_mfma_f32_16x16x32_bf16 v[192:195], v[80:83], v[48:51], v[192:195]
    v_mfma_f32_16x16x32_bf16 v[212:215], v[80:83], v[52:55], v[212:215]
    v_mfma_f32_16x16x32_bf16 v[232:235], v[80:83], v[56:59], v[232:235]
    v_mfma_f32_16x16x32_bf16 v[252:255], v[80:83], v[60:63], v[252:255]
    s_add_u32 s45, s37, 242688
    buffer_load_dwordx4 v[80:83], v2, s[12:15], s45 offen
    s_add_u32 s43, s36, 26624
    s_add_u32 s44, s35, 26624
    buffer_load_dwordx4 v[48:51], v1, s[8:11], s43 offen
    buffer_load_dwordx4 v[52:55], v1, s[8:11], s43 offen offset:256
    buffer_load_dwordx4 v[56:59], v1, s[8:11], s44 offen
    buffer_load_dwordx4 v[60:63], v1, s[8:11], s44 offen offset:256
    s_waitcnt vmcnt(27)
    v_mfma_f32_16x16x32_bf16 v[176:179], v[100:103], v[84:87], v[176:179]
    v_mfma_f32_16x16x32_bf16 v[196:199], v[100:103], v[88:91], v[196:199]
    v_mfma_f32_16x16x32_bf16 v[216:219], v[100:103], v[92:95], v[216:219]
    v_mfma_f32_16x16x32_bf16 v[236:239], v[100:103], v[96:99], v[236:239]
    v_mfma_f32_16x16x32_bf16 v[180:183], v[104:107], v[84:87], v[180:183]
    v_mfma_f32_16x16x32_bf16 v[200:203], v[104:107], v[88:91], v[200:203]
    v_mfma_f32_16x16x32_bf16 v[220:223], v[104:107], v[92:95], v[220:223]
    v_mfma_f32_16x16x32_bf16 v[240:243], v[104:107], v[96:99], v[240:243]
    v_mfma_f32_16x16x32_bf16 v[184:187], v[108:111], v[84:87], v[184:187]
    v_mfma_f32_16x16x32_bf16 v[204:207], v[108:111], v[88:91], v[204:207]
    v_mfma_f32_16x16x32_bf16 v[224:227], v[108:111], v[92:95], v[224:227]
    v_mfma_f32_16x16x32_bf16 v[244:247], v[108:111], v[96:99], v[244:247]
    v_mfma_f32_16x16x32_bf16 v[188:191], v[112:115], v[84:87], v[188:191]
    v_mfma_f32_16x16x32_bf16 v[208:211], v[112:115], v[88:91], v[208:211]
    v_mfma_f32_16x16x32_bf16 v[228:231], v[112:115], v[92:95], v[228:231]
    v_mfma_f32_16x16x32_bf16 v[248:251], v[112:115], v[96:99], v[248:251]
    v_mfma_f32_16x16x32_bf16 v[192:195], v[116:119], v[84:87], v[192:195]
    v_mfma_f32_16x16x32_bf16 v[212:215], v[116:119], v[88:91], v[212:215]
    v_mfma_f32_16x16x32_bf16 v[232:235], v[116:119], v[92:95], v[232:235]
    v_mfma_f32_16x16x32_bf16 v[252:255], v[116:119], v[96:99], v[252:255]
    s_waitcnt vmcnt(18)
    v_mfma_f32_16x16x32_bf16 v[176:179], v[136:139], v[120:123], v[176:179]
    v_mfma_f32_16x16x32_bf16 v[196:199], v[136:139], v[124:127], v[196:199]
    v_mfma_f32_16x16x32_bf16 v[216:219], v[136:139], v[128:131], v[216:219]
    v_mfma_f32_16x16x32_bf16 v[236:239], v[136:139], v[132:135], v[236:239]
    v_mfma_f32_16x16x32_bf16 v[180:183], v[140:143], v[120:123], v[180:183]
    v_mfma_f32_16x16x32_bf16 v[200:203], v[140:143], v[124:127], v[200:203]
    v_mfma_f32_16x16x32_bf16 v[220:223], v[140:143], v[128:131], v[220:223]
    v_mfma_f32_16x16x32_bf16 v[240:243], v[140:143], v[132:135], v[240:243]
    v_mfma_f32_16x16x32_bf16 v[184:187], v[144:147], v[120:123], v[184:187]
    v_mfma_f32_16x16x32_bf16 v[204:207], v[144:147], v[124:127], v[204:207]
    v_mfma_f32_16x16x32_bf16 v[224:227], v[144:147], v[128:131], v[224:227]
    v_mfma_f32_16x16x32_bf16 v[244:247], v[144:147], v[132:135], v[244:247]
    v_mfma_f32_16x16x32_bf16 v[188:191], v[148:151], v[120:123], v[188:191]
    v_mfma_f32_16x16x32_bf16 v[208:211], v[148:151], v[124:127], v[208:211]
    v_mfma_f32_16x16x32_bf16 v[228:231], v[148:151], v[128:131], v[228:231]
    v_mfma_f32_16x16x32_bf16 v[248:251], v[148:151], v[132:135], v[248:251]
    v_mfma_f32_16x16x32_bf16 v[192:195], v[152:155], v[120:123], v[192:195]
    v_mfma_f32_16x16x32_bf16 v[212:215], v[152:155], v[124:127], v[212:215]
    v_mfma_f32_16x16x32_bf16 v[232:235], v[152:155], v[128:131], v[232:235]
    v_mfma_f32_16x16x32_bf16 v[252:255], v[152:155], v[132:135], v[252:255]
    s_waitcnt vmcnt(9)
    v_mfma_f32_16x16x32_bf16 v[176:179], v[28:31], v[12:15], v[176:179]
    v_mfma_f32_16x16x32_bf16 v[196:199], v[28:31], v[16:19], v[196:199]
    v_mfma_f32_16x16x32_bf16 v[216:219], v[28:31], v[20:23], v[216:219]
    v_mfma_f32_16x16x32_bf16 v[236:239], v[28:31], v[24:27], v[236:239]
    v_mfma_f32_16x16x32_bf16 v[180:183], v[32:35], v[12:15], v[180:183]
    v_mfma_f32_16x16x32_bf16 v[200:203], v[32:35], v[16:19], v[200:203]
    v_mfma_f32_16x16x32_bf16 v[220:223], v[32:35], v[20:23], v[220:223]
    v_mfma_f32_16x16x32_bf16 v[240:243], v[32:35], v[24:27], v[240:243]
    v_mfma_f32_16x16x32_bf16 v[184:187], v[36:39], v[12:15], v[184:187]
    v_mfma_f32_16x16x32_bf16 v[204:207], v[36:39], v[16:19], v[204:207]
    v_mfma_f32_16x16x32_bf16 v[224:227], v[36:39], v[20:23], v[224:227]
    v_mfma_f32_16x16x32_bf16 v[244:247], v[36:39], v[24:27], v[244:247]
    v_mfma_f32_16x16x32_bf16 v[188:191], v[40:43], v[12:15], v[188:191]
    v_mfma_f32_16x16x32_bf16 v[208:211], v[40:43], v[16:19], v[208:211]
    v_mfma_f32_16x16x32_bf16 v[228:231], v[40:43], v[20:23], v[228:231]
    v_mfma_f32_16x16x32_bf16 v[248:251], v[40:43], v[24:27], v[248:251]
    v_mfma_f32_16x16x32_bf16 v[192:195], v[44:47], v[12:15], v[192:195]
    v_mfma_f32_16x16x32_bf16 v[212:215], v[44:47], v[16:19], v[212:215]
    v_mfma_f32_16x16x32_bf16 v[232:235], v[44:47], v[20:23], v[232:235]
    v_mfma_f32_16x16x32_bf16 v[252:255], v[44:47], v[24:27], v[252:255]
    s_waitcnt vmcnt(0)
    v_mfma_f32_16x16x32_bf16 v[176:179], v[64:67], v[48:51], v[176:179]
    v_mfma_f32_16x16x32_bf16 v[196:199], v[64:67], v[52:55], v[196:199]
    v_mfma_f32_16x16x32_bf16 v[216:219], v[64:67], v[56:59], v[216:219]
    v_mfma_f32_16x16x32_bf16 v[236:239], v[64:67], v[60:63], v[236:239]
    v_mfma_f32_16x16x32_bf16 v[180:183], v[68:71], v[48:51], v[180:183]
    v_mfma_f32_16x16x32_bf16 v[200:203], v[68:71], v[52:55], v[200:203]
    v_mfma_f32_16x16x32_bf16 v[220:223], v[68:71], v[56:59], v[220:223]
    v_mfma_f32_16x16x32_bf16 v[240:243], v[68:71], v[60:63], v[240:243]
    v_mfma_f32_16x16x32_bf16 v[184:187], v[72:75], v[48:51], v[184:187]
    v_mfma_f32_16x16x32_bf16 v[204:207], v[72:75], v[52:55], v[204:207]
    v_mfma_f32_16x16x32_bf16 v[224:227], v[72:75], v[56:59], v[224:227]
    v_mfma_f32_16x16x32_bf16 v[244:247], v[72:75], v[60:63], v[244:247]
    v_mfma_f32_16x16x32_bf16 v[188:191], v[76:79], v[48:51], v[188:191]
    v_mfma_f32_16x16x32_bf16 v[208:211], v[76:79], v[52:55], v[208:211]
    v_mfma_f32_16x16x32_bf16 v[228:231], v[76:79], v[56:59], v[228:231]
    v_mfma_f32_16x16x32_bf16 v[248:251], v[76:79], v[60:63], v[248:251]
    v_mfma_f32_16x16x32_bf16 v[192:195], v[80:83], v[48:51], v[192:195]
    v_mfma_f32_16x16x32_bf16 v[212:215], v[80:83], v[52:55], v[212:215]
    v_mfma_f32_16x16x32_bf16 v[232:235], v[80:83], v[56:59], v[232:235]
    v_mfma_f32_16x16x32_bf16 v[252:255], v[80:83], v[60:63], v[252:255]
    v_lshrrev_b32 v4, 2, v9
    v_and_b32 v5, 3, v9
    s_lshl_b32 s40, s30, 6
    v_add_u32 v10, s40, v4
    s_mul_i32 s41, s31, 80
    v_mul_u32_u24 v11, 20, v5
    v_add_u32 v11, s41, v11
    v_add_u32 v6, 0, v11
    v_lshrrev_b32 v52, 5, v10
    v_mul_u32_u24 v52, 40, v52
    v_lshrrev_b32 v7, 4, v6
    v_add_u32 v52, v52, v7
    v_lshlrev_b32 v52, 10, v52
    v_and_b32 v7, 31, v10
    v_lshl_add_u32 v52, v7, 4, v52
    v_lshrrev_b32 v7, 3, v6
    v_and_b32 v7, 1, v7
    v_lshl_add_u32 v52, v7, 9, v52
    v_and_b32 v7, 7, v6
    v_lshl_add_u32 v52, v7, 1, v52
    v_add_u32 v6, 4, v11
    v_lshrrev_b32 v53, 5, v10
    v_mul_u32_u24 v53, 40, v53
    v_lshrrev_b32 v7, 4, v6
    v_add_u32 v53, v53, v7
    v_lshlrev_b32 v53, 10, v53
    v_and_b32 v7, 31, v10
    v_lshl_add_u32 v53, v7, 4, v53
    v_lshrrev_b32 v7, 3, v6
    v_and_b32 v7, 1, v7
    v_lshl_add_u32 v53, v7, 9, v53
    v_and_b32 v7, 7, v6
    v_lshl_add_u32 v53, v7, 1, v53
    v_add_u32 v6, 8, v11
    v_lshrrev_b32 v54, 5, v10
    v_mul_u32_u24 v54, 40, v54
    v_lshrrev_b32 v7, 4, v6
    v_add_u32 v54, v54, v7
    v_lshlrev_b32 v54, 10, v54
    v_and_b32 v7, 31, v10
    v_lshl_add_u32 v54, v7, 4, v54
    v_lshrrev_b32 v7, 3, v6
    v_and_b32 v7, 1, v7
    v_lshl_add_u32 v54, v7, 9, v54
    v_and_b32 v7, 7, v6
    v_lshl_add_u32 v54, v7, 1, v54
    v_add_u32 v6, 12, v11
    v_lshrrev_b32 v55, 5, v10
    v_mul_u32_u24 v55, 40, v55
    v_lshrrev_b32 v7, 4, v6
    v_add_u32 v55, v55, v7
    v_lshlrev_b32 v55, 10, v55
    v_and_b32 v7, 31, v10
    v_lshl_add_u32 v55, v7, 4, v55
    v_lshrrev_b32 v7, 3, v6
    v_and_b32 v7, 1, v7
    v_lshl_add_u32 v55, v7, 9, v55
    v_and_b32 v7, 7, v6
    v_lshl_add_u32 v55, v7, 1, v55
    v_add_u32 v6, 16, v11
    v_lshrrev_b32 v56, 5, v10
    v_mul_u32_u24 v56, 40, v56
    v_lshrrev_b32 v7, 4, v6
    v_add_u32 v56, v56, v7
    v_lshlrev_b32 v56, 10, v56
    v_and_b32 v7, 31, v10
    v_lshl_add_u32 v56, v7, 4, v56
    v_lshrrev_b32 v7, 3, v6
    v_and_b32 v7, 1, v7
    v_lshl_add_u32 v56, v7, 9, v56
    v_and_b32 v7, 7, v6
    v_lshl_add_u32 v56, v7, 1, v56
    v_mul_u32_u24 v57, 1280, v10
    v_lshl_add_u32 v57, v11, 1, v57
    s_add_u32 s16, s6, 81788928
    s_addc_u32 s17, s7, 0
    s_mov_b32 s18, 2621440
    s_mov_b32 s19, 0x00020000
    s_mov_b32 s20, s24
    s_mov_b32 s21, s25
    s_mov_b32 s22, 1280
    s_mov_b32 s23, 0x00020000
    s_mov_b32 s44, s26
    s_mov_b32 s45, s27
    s_mov_b32 s46, 2621440
    s_mov_b32 s47, 0x00020000
    v_lshlrev_b32 v6, 1, v11
    buffer_load_dwordx2 v[58:59], v52, s[16:19], 0 offen
    buffer_load_dwordx2 v[60:61], v53, s[16:19], 0 offen
    buffer_load_dwordx2 v[62:63], v54, s[16:19], 0 offen
    buffer_load_dwordx2 v[64:65], v55, s[16:19], 0 offen
    buffer_load_dwordx2 v[66:67], v56, s[16:19], 0 offen
    buffer_load_dwordx2 v[68:69], v6, s[20:23], 0 offen offset:0
    buffer_load_dwordx2 v[70:71], v6, s[20:23], 0 offen offset:8
    buffer_load_dwordx2 v[72:73], v6, s[20:23], 0 offen offset:16
    buffer_load_dwordx2 v[74:75], v6, s[20:23], 0 offen offset:24
    buffer_load_dwordx2 v[76:77], v6, s[20:23], 0 offen offset:32
    v_and_b32 v6, 15, v0
    v_mul_u32_u24 v6, 336, v6
    v_lshrrev_b32 v7, 4, v0
    v_lshl_add_u32 v6, v7, 4, v6
    s_mul_i32 s40, s3, 22016
    v_add_u32 v6, s40, v6
    ds_write_b128 v6, v[176:179] offset:0
    ds_write_b128 v6, v[180:183] offset:64
    ds_write_b128 v6, v[184:187] offset:128
    ds_write_b128 v6, v[188:191] offset:192
    ds_write_b128 v6, v[192:195] offset:256
    ds_write_b128 v6, v[196:199] offset:5376
    ds_write_b128 v6, v[200:203] offset:5440
    ds_write_b128 v6, v[204:207] offset:5504
    ds_write_b128 v6, v[208:211] offset:5568
    ds_write_b128 v6, v[212:215] offset:5632
    ds_write_b128 v6, v[216:219] offset:10752
    ds_write_b128 v6, v[220:223] offset:10816
    ds_write_b128 v6, v[224:227] offset:10880
    ds_write_b128 v6, v[228:231] offset:10944
    ds_write_b128 v6, v[232:235] offset:11008
    ds_write_b128 v6, v[236:239] offset:16128
    ds_write_b128 v6, v[240:243] offset:16192
    ds_write_b128 v6, v[244:247] offset:16256
    ds_write_b128 v6, v[248:251] offset:16320
    ds_write_b128 v6, v[252:255] offset:16384
    s_waitcnt lgkmcnt(0)
    s_barrier
    v_mul_u32_u24 v6, 336, v4
    v_mul_u32_u24 v7, 80, v5
    v_add_u32 v6, v6, v7
    ds_read_b128 v[12:15], v6 offset:0
    ds_read_b128 v[16:19], v6 offset:16
    ds_read_b128 v[20:23], v6 offset:32
    ds_read_b128 v[24:27], v6 offset:48
    ds_read_b128 v[28:31], v6 offset:64
    ds_read_b128 v[32:35], v6 offset:22016
    ds_read_b128 v[36:39], v6 offset:22032
    ds_read_b128 v[40:43], v6 offset:22048
    ds_read_b128 v[44:47], v6 offset:22064
    ds_read_b128 v[48:51], v6 offset:22080
    s_waitcnt lgkmcnt(4)
    v_add_f32 v12, v12, v32
    v_add_f32 v13, v13, v33
    v_add_f32 v14, v14, v34
    v_add_f32 v15, v15, v35
    s_waitcnt lgkmcnt(3)
    v_add_f32 v16, v16, v36
    v_add_f32 v17, v17, v37
    v_add_f32 v18, v18, v38
    v_add_f32 v19, v19, v39
    s_waitcnt lgkmcnt(2)
    v_add_f32 v20, v20, v40
    v_add_f32 v21, v21, v41
    v_add_f32 v22, v22, v42
    v_add_f32 v23, v23, v43
    s_waitcnt lgkmcnt(1)
    v_add_f32 v24, v24, v44
    v_add_f32 v25, v25, v45
    v_add_f32 v26, v26, v46
    v_add_f32 v27, v27, v47
    s_waitcnt lgkmcnt(0)
    v_add_f32 v28, v28, v48
    v_add_f32 v29, v29, v49
    v_add_f32 v30, v30, v50
    v_add_f32 v31, v31, v51
    ds_read_b128 v[32:35], v6 offset:44032
    ds_read_b128 v[36:39], v6 offset:44048
    ds_read_b128 v[40:43], v6 offset:44064
    ds_read_b128 v[44:47], v6 offset:44080
    ds_read_b128 v[48:51], v6 offset:44096
    s_waitcnt lgkmcnt(4)
    v_add_f32 v12, v12, v32
    v_add_f32 v13, v13, v33
    v_add_f32 v14, v14, v34
    v_add_f32 v15, v15, v35
    s_waitcnt lgkmcnt(3)
    v_add_f32 v16, v16, v36
    v_add_f32 v17, v17, v37
    v_add_f32 v18, v18, v38
    v_add_f32 v19, v19, v39
    s_waitcnt lgkmcnt(2)
    v_add_f32 v20, v20, v40
    v_add_f32 v21, v21, v41
    v_add_f32 v22, v22, v42
    v_add_f32 v23, v23, v43
    s_waitcnt lgkmcnt(1)
    v_add_f32 v24, v24, v44
    v_add_f32 v25, v25, v45
    v_add_f32 v26, v26, v46
    v_add_f32 v27, v27, v47
    s_waitcnt lgkmcnt(0)
    v_add_f32 v28, v28, v48
    v_add_f32 v29, v29, v49
    v_add_f32 v30, v30, v50
    v_add_f32 v31, v31, v51
    v_add_u32 v7, 66048, v6
    ds_read_b128 v[32:35], v7 offset:0
    ds_read_b128 v[36:39], v7 offset:16
    ds_read_b128 v[40:43], v7 offset:32
    ds_read_b128 v[44:47], v7 offset:48
    ds_read_b128 v[48:51], v7 offset:64
    s_waitcnt lgkmcnt(4)
    v_add_f32 v12, v12, v32
    v_add_f32 v13, v13, v33
    v_add_f32 v14, v14, v34
    v_add_f32 v15, v15, v35
    s_waitcnt lgkmcnt(3)
    v_add_f32 v16, v16, v36
    v_add_f32 v17, v17, v37
    v_add_f32 v18, v18, v38
    v_add_f32 v19, v19, v39
    s_waitcnt lgkmcnt(2)
    v_add_f32 v20, v20, v40
    v_add_f32 v21, v21, v41
    v_add_f32 v22, v22, v42
    v_add_f32 v23, v23, v43
    s_waitcnt lgkmcnt(1)
    v_add_f32 v24, v24, v44
    v_add_f32 v25, v25, v45
    v_add_f32 v26, v26, v46
    v_add_f32 v27, v27, v47
    s_waitcnt lgkmcnt(0)
    v_add_f32 v28, v28, v48
    v_add_f32 v29, v29, v49
    v_add_f32 v30, v30, v50
    v_add_f32 v31, v31, v51
    s_waitcnt vmcnt(9)
    v_lshlrev_b32 v6, 16, v58
    v_add_f32 v12, v12, v6
    v_and_b32 v7, 0xffff0000, v58
    v_add_f32 v13, v13, v7
    v_lshlrev_b32 v6, 16, v59
    v_add_f32 v14, v14, v6
    v_and_b32 v7, 0xffff0000, v59
    v_add_f32 v15, v15, v7
    s_waitcnt vmcnt(8)
    v_lshlrev_b32 v6, 16, v60
    v_add_f32 v16, v16, v6
    v_and_b32 v7, 0xffff0000, v60
    v_add_f32 v17, v17, v7
    v_lshlrev_b32 v6, 16, v61
    v_add_f32 v18, v18, v6
    v_and_b32 v7, 0xffff0000, v61
    v_add_f32 v19, v19, v7
    s_waitcnt vmcnt(7)
    v_lshlrev_b32 v6, 16, v62
    v_add_f32 v20, v20, v6
    v_and_b32 v7, 0xffff0000, v62
    v_add_f32 v21, v21, v7
    v_lshlrev_b32 v6, 16, v63
    v_add_f32 v22, v22, v6
    v_and_b32 v7, 0xffff0000, v63
    v_add_f32 v23, v23, v7
    s_waitcnt vmcnt(6)
    v_lshlrev_b32 v6, 16, v64
    v_add_f32 v24, v24, v6
    v_and_b32 v7, 0xffff0000, v64
    v_add_f32 v25, v25, v7
    v_lshlrev_b32 v6, 16, v65
    v_add_f32 v26, v26, v6
    v_and_b32 v7, 0xffff0000, v65
    v_add_f32 v27, v27, v7
    s_waitcnt vmcnt(5)
    v_lshlrev_b32 v6, 16, v66
    v_add_f32 v28, v28, v6
    v_and_b32 v7, 0xffff0000, v66
    v_add_f32 v29, v29, v7
    v_lshlrev_b32 v6, 16, v67
    v_add_f32 v30, v30, v6
    v_and_b32 v7, 0xffff0000, v67
    v_add_f32 v31, v31, v7
    s_waitcnt vmcnt(4)
    v_lshlrev_b32 v6, 16, v68
    v_add_f32 v12, v12, v6
    v_and_b32 v7, 0xffff0000, v68
    v_add_f32 v13, v13, v7
    v_lshlrev_b32 v6, 16, v69
    v_add_f32 v14, v14, v6
    v_and_b32 v7, 0xffff0000, v69
    v_add_f32 v15, v15, v7
    s_waitcnt vmcnt(3)
    v_lshlrev_b32 v6, 16, v70
    v_add_f32 v16, v16, v6
    v_and_b32 v7, 0xffff0000, v70
    v_add_f32 v17, v17, v7
    v_lshlrev_b32 v6, 16, v71
    v_add_f32 v18, v18, v6
    v_and_b32 v7, 0xffff0000, v71
    v_add_f32 v19, v19, v7
    s_waitcnt vmcnt(2)
    v_lshlrev_b32 v6, 16, v72
    v_add_f32 v20, v20, v6
    v_and_b32 v7, 0xffff0000, v72
    v_add_f32 v21, v21, v7
    v_lshlrev_b32 v6, 16, v73
    v_add_f32 v22, v22, v6
    v_and_b32 v7, 0xffff0000, v73
    v_add_f32 v23, v23, v7
    s_waitcnt vmcnt(1)
    v_lshlrev_b32 v6, 16, v74
    v_add_f32 v24, v24, v6
    v_and_b32 v7, 0xffff0000, v74
    v_add_f32 v25, v25, v7
    v_lshlrev_b32 v6, 16, v75
    v_add_f32 v26, v26, v6
    v_and_b32 v7, 0xffff0000, v75
    v_add_f32 v27, v27, v7
    s_waitcnt vmcnt(0)
    v_lshlrev_b32 v6, 16, v76
    v_add_f32 v28, v28, v6
    v_and_b32 v7, 0xffff0000, v76
    v_add_f32 v29, v29, v7
    v_lshlrev_b32 v6, 16, v77
    v_add_f32 v30, v30, v6
    v_and_b32 v7, 0xffff0000, v77
    v_add_f32 v31, v31, v7
    v_cvt_pk_bf16_f32 v32, v12, v13
    v_cvt_pk_bf16_f32 v33, v14, v15
    v_cvt_pk_bf16_f32 v34, v16, v17
    v_cvt_pk_bf16_f32 v35, v18, v19
    v_cvt_pk_bf16_f32 v36, v20, v21
    v_cvt_pk_bf16_f32 v37, v22, v23
    v_cvt_pk_bf16_f32 v38, v24, v25
    v_cvt_pk_bf16_f32 v39, v26, v27
    v_cvt_pk_bf16_f32 v40, v28, v29
    v_cvt_pk_bf16_f32 v41, v30, v31
    buffer_store_dwordx2 v[32:33], v57, s[44:47], 0 offen offset:0
    buffer_store_dwordx2 v[34:35], v57, s[44:47], 0 offen offset:8
    buffer_store_dwordx2 v[36:37], v57, s[44:47], 0 offen offset:16
    buffer_store_dwordx2 v[38:39], v57, s[44:47], 0 offen offset:24
    buffer_store_dwordx2 v[40:41], v57, s[44:47], 0 offen offset:32
    s_waitcnt vmcnt(0)
K6_KERNEL_END:
    s_endpgm
.section .rodata,"a"
.p2align 6
.amdhsa_kernel k1_kernel
  .amdhsa_next_free_vgpr 256
  .amdhsa_next_free_sgpr 102
  .amdhsa_accum_offset 256
  .amdhsa_group_segment_fixed_size 0
  .amdhsa_kernarg_size 112
  .amdhsa_user_sgpr_count 2
  .amdhsa_user_sgpr_kernarg_segment_ptr 1
  .amdhsa_system_sgpr_workgroup_id_x 1
.end_amdhsa_kernel
.p2align 6
.amdhsa_kernel k2_kernel
  .amdhsa_next_free_vgpr 256
  .amdhsa_next_free_sgpr 102
  .amdhsa_accum_offset 256
  .amdhsa_group_segment_fixed_size 0
  .amdhsa_kernarg_size 112
  .amdhsa_user_sgpr_count 2
  .amdhsa_user_sgpr_kernarg_segment_ptr 1
  .amdhsa_system_sgpr_workgroup_id_x 1
.end_amdhsa_kernel
.p2align 6
.amdhsa_kernel k3_kernel
  .amdhsa_next_free_vgpr 256
  .amdhsa_next_free_sgpr 102
  .amdhsa_accum_offset 256
  .amdhsa_group_segment_fixed_size 0
  .amdhsa_kernarg_size 112
  .amdhsa_user_sgpr_count 2
  .amdhsa_user_sgpr_kernarg_segment_ptr 1
  .amdhsa_system_sgpr_workgroup_id_x 1
.end_amdhsa_kernel
.p2align 6
.amdhsa_kernel k5_kernel
  .amdhsa_next_free_vgpr 256
  .amdhsa_next_free_sgpr 102
  .amdhsa_accum_offset 256
  .amdhsa_group_segment_fixed_size 0
  .amdhsa_kernarg_size 112
  .amdhsa_user_sgpr_count 2
  .amdhsa_user_sgpr_kernarg_segment_ptr 1
  .amdhsa_system_sgpr_workgroup_id_x 1
.end_amdhsa_kernel
.p2align 6
.amdhsa_kernel k6_kernel
  .amdhsa_next_free_vgpr 256
  .amdhsa_next_free_sgpr 102
  .amdhsa_accum_offset 256
  .amdhsa_group_segment_fixed_size 0
  .amdhsa_kernarg_size 112
  .amdhsa_user_sgpr_count 2
  .amdhsa_user_sgpr_kernarg_segment_ptr 1
  .amdhsa_system_sgpr_workgroup_id_x 1
.end_amdhsa_kernel
```
